```python
import torch

def _softmax(x, axis=-1):
    return torch.softmax(x, dim=axis)

def _gelu(x):
    return torch.nn.functional.gelu(x, approximate='tanh')

def _silu(x):
    return torch.nn.functional.silu(x)

def _sigmoid(x):
    return torch.sigmoid(x)

def _layernorm(x, axis=-1, eps=1e-05):
    m = x.mean(dim=axis, keepdim=True)
    v = x.var(dim=axis, keepdim=True, unbiased=False)
    return (x - m) / torch.sqrt(v + eps)

def _scatter_add(tgt, idx, src, axis=0):
    return tgt.clone().index_add_(axis, idx, src)

def _segment_sum(src, seg, n):
    out = torch.zeros((n,) + src.shape[1:], dtype=src.dtype)
    return out.index_add_(0, seg, src)

def _pad(x, pw):
    flat = tuple((v for pair in reversed(pw) for v in pair))
    return torch.nn.functional.pad(x, flat)
kernel_name = 'gated_mix__memory_aug_recurrent_mem_tr__ssm_conv_s4d__prompt'

def setup_inputs():

    _w = lambda a: (lambda t: t.to(torch.bfloat16) if t.is_floating_point() else t)(torch.as_tensor(a))

    def _A_setup():
        B, S, Dm = (1, 2048, 576)
        H, Dh = (32, 128)
        M, seg = (8, 32)
        seg = min(seg, S)
        S = S // seg * seg
        return {'x': _w((lambda *s: torch.randn(*s, dtype=torch.bfloat16) * 0.05)(B, S, Dm)), 'mem0': _w((lambda *s: torch.randn(*s, dtype=torch.bfloat16) * 0.4)(B, M, Dm)), 'Wq': _w((lambda *s: torch.randn(*s, dtype=torch.bfloat16) * 6.4)(Dm, H, Dh) * Dm ** (-0.5)), 'Wk': _w((lambda *s: torch.randn(*s, dtype=torch.bfloat16) * 6.4)(Dm, H, Dh) * Dm ** (-0.5)), 'Wv': _w((lambda *s: torch.randn(*s, dtype=torch.bfloat16) * 0.4)(Dm, H, Dh) * Dm ** (-0.5)), 'Wo': _w((lambda *s: torch.randn(*s, dtype=torch.bfloat16) * 0.4)(H, Dh, Dm) * (H * Dh) ** (-0.5)), 'seg_len': seg}
    _A_in = _A_setup()

    def _B_setup():
        Bsz, L, D, N = (1, 2048, 576, 128)
        return {'u': _w((lambda *s: torch.randn(*s, dtype=torch.bfloat16) * 0.05)(Bsz, L, D)), 'log_A_real': _w((lambda *s: torch.randn(*s, dtype=torch.bfloat16) * 6.4)(D, N) * 0.5), 'A_imag': _w((lambda *s: torch.randn(*s, dtype=torch.bfloat16) * 0.05)(D, N) * 3.14), 'C_real': _w((lambda *s: torch.randn(*s, dtype=torch.bfloat16) * 0.2)(D, N) / N ** 0.5), 'C_imag': _w((lambda *s: torch.randn(*s, dtype=torch.bfloat16) * 0.2)(D, N) / N ** 0.5), 'log_dt': _w((lambda *s: torch.randn(*s, dtype=torch.bfloat16) * 0.05)(D) * 0.5 - 4.0), 'D_skip': _w((lambda *s: torch.randn(*s, dtype=torch.bfloat16) * 0.05)(D))}
    _B_in = _B_setup()
    return {'A_x': _A_in['x'], 'A_mem0': _A_in['mem0'], 'A_Wq': _A_in['Wq'], 'A_Wk': _A_in['Wk'], 'A_Wv': _A_in['Wv'], 'A_Wo': _A_in['Wo'], 'A_seg_len': _A_in['seg_len'], 'B_u': _B_in['u'], 'B_log_A_real': _B_in['log_A_real'], 'B_A_imag': _B_in['A_imag'], 'B_C_real': _B_in['C_real'], 'B_C_imag': _B_in['C_imag'], 'B_log_dt': _B_in['log_dt'], 'B_D_skip': _B_in['D_skip'], 'gate_w': _w((lambda *s: torch.randn(*s, dtype=torch.bfloat16) * 0.05)(576) * 16.0)}

def reference(A_x, A_mem0, A_Wq, A_Wk, A_Wv, A_Wo, A_seg_len, B_u, B_log_A_real, B_A_imag, B_C_real, B_C_imag, B_log_dt, B_D_skip, gate_w):

    def _A_ref(x, mem0, Wq, Wk, Wv, Wo, seg_len):
        B, S, Dm = x.shape
        H, Dh = (Wq.shape[1], Wq.shape[2])
        M = mem0.shape[1]
        scale = Dh ** (-0.5)
        n_seg = S // seg_len
        L = M + seg_len
        idx = torch.arange(L)
        mask = (idx[:, None] < M) | (idx[:, None] >= idx[None, :])
        mem = mem0
        outs = []
        for s in range(n_seg):
            xs = x[:, s * seg_len:(s + 1) * seg_len, :].clone()
            h = torch.concatenate([mem, xs], axis=1)
            q = torch.einsum('btd,dhe->bhte', h, Wq)
            k = torch.einsum('btd,dhe->bhte', h, Wk)
            v = torch.einsum('btd,dhe->bhte', h, Wv)
            scores = torch.einsum('bhqe,bhke->bhqk', q, k) * scale
            scores = torch.where(mask[None, None], scores, -1000000000.0)
            p = _softmax(scores, axis=-1)
            o = torch.einsum('bhqk,bhke->bhqe', p, v)
            o = torch.einsum('bhte,hed->btd', o, Wo)
            mem = o[:, :M, :].clone()
            outs.append(o[:, M:, :])
        return torch.concatenate(outs, axis=1)

    def _B_ref(u, log_A_real, A_imag, C_real, C_imag, log_dt, D_skip):
        L = u.shape[1]
        dt = torch.exp(log_dt)
        A = -torch.exp(log_A_real) + 1j * A_imag
        C = (C_real + 1j * C_imag) * dt[:, None]
        pos = (lambda x, dt: x.to(dt))(torch.arange(L), log_dt.dtype)
        P = torch.exp((A * dt[:, None])[:, :, None] * pos[None, None, :])
        K = 2.0 * torch.einsum('dn,dnl->dl', C, P).real
        L2 = 2 * L
        u_t = (lambda x, *d: x.permute(*d))(u, 0, 2, 1)
        Kf = (lambda x, *a, **k: torch.fft.rfft(x.float(), *a, **k))(K, L2)
        Uf = (lambda x, *a, **k: torch.fft.rfft(x.float(), *a, **k))(u_t, L2)
        y = (lambda x, *a, **k: torch.fft.irfft(x, *a, **k).to(torch.bfloat16))(Uf * Kf[None, :, :], L2)[:, :, :L]
        y = (lambda x, *d: x.permute(*d))(y, 0, 2, 1)
        return y + u * D_skip[None, None, :]
    x = A_x
    g = _sigmoid((x * gate_w).sum(-1, keepdims=True))
    a = _A_ref(x, A_mem0, A_Wq, A_Wk, A_Wv, A_Wo, A_seg_len)
    b = _B_ref(x, B_log_A_real, B_A_imag, B_C_real, B_C_imag, B_log_dt, B_D_skip)
    return g * a + (1 - g) * b
```

```asm
; @launch grid=(256,1,1) block=(256,1,1) lds=163840
.amdgcn_target "amdgcn-amd-amdhsa--gfx950"
.text
.globl gated_mix__memory_aug_recurrent_mem_tr__ssm_conv_s4d__prompt_kernel
.p2align 8
.type gated_mix__memory_aug_recurrent_mem_tr__ssm_conv_s4d__prompt_kernel,@function
gated_mix__memory_aug_recurrent_mem_tr__ssm_conv_s4d__prompt_kernel:
 s_cmp_ge_u32 s2, 256
 s_cbranch_scc1 KEND
 v_lshrrev_b32 v1, 6, v0
 s_and_b32 s5, s2, 7
 v_readfirstlane_b32 s4, v1
 s_lshr_b32 s3, s2, 3
 s_cmp_eq_u32 s5, 0
 s_cbranch_scc1 REC
 s_cmp_le_u32 s5, 4
 s_cbranch_scc1 ATT
 s_branch CONV
KEND:
 s_endpgm
ATT:
 s_load_dwordx2 s[8:9], s[0:1], 136
 s_load_dwordx2 s[12:13], s[0:1], 128
 s_load_dwordx2 s[16:17], s[0:1], 16
 s_load_dwordx2 s[20:21], s[0:1], 24
 s_load_dwordx2 s[24:25], s[0:1], 32
 s_load_dwordx2 s[28:29], s[0:1], 0
 s_mov_b32 s10, 100663296
 s_mov_b32 s11, 0x20000
 s_mov_b32 s14, 256
 s_mov_b32 s15, 0x20000
 s_mov_b32 s18, 4718592
 s_mov_b32 s19, 0x20000
 s_mov_b32 s22, 4718592
 s_mov_b32 s23, 0x20000
 s_mov_b32 s26, 4718592
 s_mov_b32 s27, 0x20000
 s_mov_b32 s30, 2359296
 s_mov_b32 s31, 0x20000
 s_waitcnt lgkmcnt(0)
 s_sub_u32 s54, s5, 1
 s_lshl_b32 s54, s54, 5
 s_add_u32 s57, s54, s3
 s_lshr_b32 s6, s57, 2
 s_and_b32 s7, s57, 3
 s_lshl_b32 s59, s6, 7
 s_add_u32 s59, s59, s7
 s_add_u32 s59, s59, 1179648
 v_mbcnt_lo_u32_b32 v8, -1, 0
 v_mbcnt_hi_u32_b32 v8, -1, v8
 v_mov_b32 v2, 0
 v_bfe_u32 v9, v8, 0, 2
 v_lshl_add_u32 v2, v9, 4, v2
 v_mov_b32 v3, 0
 v_bfe_u32 v9, v8, 4, 2
 v_lshl_add_u32 v3, v9, 4, v3
 v_xor_b32 v2, v2, v3
 v_mov_b32 v2, v2
 v_bfe_u32 v9, v8, 2, 4
 s_mov_b32 s101, 1152
 v_mad_u32_u24 v2, v9, s101, v2
 s_and_b32 s54, s4, 1
 s_lshr_b32 s55, s4, 1
 s_mul_i32 s41, s54, 18432
 s_mul_i32 s56, s55, 576
 s_add_u32 s41, s41, s56
 s_mul_i32 s56, s7, 36864
 s_add_u32 s41, s41, s56
 s_lshl_b32 s42, s54, 10
 s_mul_i32 s56, s55, 18432
 s_add_u32 s42, s42, s56
 s_add_u32 m0, s42, 0
 s_add_u32 s54, s41, 0
 buffer_load_dwordx4 v2, s[28:31], s54 offen lds
 s_add_u32 m0, s42, 2048
 s_add_u32 s54, s41, 64
 buffer_load_dwordx4 v2, s[28:31], s54 offen lds
 s_add_u32 m0, s42, 4096
 s_add_u32 s54, s41, 128
 buffer_load_dwordx4 v2, s[28:31], s54 offen lds
 s_add_u32 m0, s42, 6144
 s_add_u32 s54, s41, 192
 buffer_load_dwordx4 v2, s[28:31], s54 offen lds
 s_add_u32 m0, s42, 8192
 s_add_u32 s54, s41, 256
 buffer_load_dwordx4 v2, s[28:31], s54 offen lds
 s_add_u32 m0, s42, 10240
 s_add_u32 s54, s41, 320
 buffer_load_dwordx4 v2, s[28:31], s54 offen lds
 s_add_u32 m0, s42, 12288
 s_add_u32 s54, s41, 384
 buffer_load_dwordx4 v2, s[28:31], s54 offen lds
 s_add_u32 m0, s42, 14336
 s_add_u32 s54, s41, 448
 buffer_load_dwordx4 v2, s[28:31], s54 offen lds
 s_add_u32 m0, s42, 16384
 s_add_u32 s54, s41, 512
 buffer_load_dwordx4 v2, s[28:31], s54 offen lds
 s_add_u32 s41, s41, 147456
 s_xor_b32 s42, s42, 0x10000
 s_lshl_b32 s54, s6, 8
 s_lshl_b32 s55, s4, 6
 s_add_u32 s54, s54, s55
 s_mul_i32 s43, s4, 30720
 s_add_u32 s43, s43, 36864
 v_mov_b32 v0, s54
 v_bfe_u32 v9, v8, 2, 4
 v_lshl_add_u32 v0, v9, 13, v0
 v_bfe_u32 v9, v8, 0, 2
 v_lshl_add_u32 v0, v9, 4, v0
 v_mov_b32 v1, s43
 v_bfe_u32 v9, v8, 5, 1
 v_lshl_add_u32 v1, v9, 9, v1
 v_bfe_u32 v9, v8, 2, 2
 v_lshl_add_u32 v1, v9, 6, v1
 v_bfe_u32 v9, v8, 4, 1
 v_lshl_add_u32 v1, v9, 5, v1
 v_bfe_u32 v9, v8, 0, 2
 v_lshl_add_u32 v1, v9, 3, v1
 s_add_u32 m0, s43, 0
 s_mov_b32 s54, 0
 buffer_load_dwordx4 v0, s[20:23], s54 offen lds
 s_add_u32 m0, s43, 1024
 s_mov_b32 s54, 131072
 buffer_load_dwordx4 v0, s[20:23], s54 offen lds
 s_add_u32 m0, s43, 2048
 s_mov_b32 s54, 262144
 buffer_load_dwordx4 v0, s[20:23], s54 offen lds
 s_add_u32 m0, s43, 3072
 s_mov_b32 s54, 393216
 buffer_load_dwordx4 v0, s[20:23], s54 offen lds
 s_add_u32 m0, s43, 4096
 s_mov_b32 s54, 524288
 buffer_load_dwordx4 v0, s[20:23], s54 offen lds
 s_add_u32 m0, s43, 5120
 s_mov_b32 s54, 655360
 buffer_load_dwordx4 v0, s[20:23], s54 offen lds
 s_add_u32 m0, s43, 6144
 s_mov_b32 s54, 786432
 buffer_load_dwordx4 v0, s[20:23], s54 offen lds
 s_add_u32 m0, s43, 7168
 s_mov_b32 s54, 917504
 buffer_load_dwordx4 v0, s[20:23], s54 offen lds
 s_add_u32 m0, s43, 8192
 s_mov_b32 s54, 1048576
 buffer_load_dwordx4 v0, s[20:23], s54 offen lds
 s_add_u32 m0, s43, 9216
 s_mov_b32 s54, 1179648
 buffer_load_dwordx4 v0, s[20:23], s54 offen lds
 s_add_u32 m0, s43, 10240
 s_mov_b32 s54, 1310720
 buffer_load_dwordx4 v0, s[20:23], s54 offen lds
 s_add_u32 m0, s43, 11264
 s_mov_b32 s54, 1441792
 buffer_load_dwordx4 v0, s[20:23], s54 offen lds
 s_add_u32 m0, s43, 12288
 s_mov_b32 s54, 1572864
 buffer_load_dwordx4 v0, s[20:23], s54 offen lds
 s_add_u32 m0, s43, 13312
 s_mov_b32 s54, 1703936
 buffer_load_dwordx4 v0, s[20:23], s54 offen lds
 s_add_u32 m0, s43, 14336
 s_mov_b32 s54, 1835008
 buffer_load_dwordx4 v0, s[20:23], s54 offen lds
 s_add_u32 m0, s43, 15360
 s_mov_b32 s54, 1966080
 buffer_load_dwordx4 v0, s[20:23], s54 offen lds
 s_add_u32 m0, s43, 16384
 s_mov_b32 s54, 2097152
 buffer_load_dwordx4 v0, s[20:23], s54 offen lds
 s_add_u32 m0, s43, 17408
 s_mov_b32 s54, 2228224
 buffer_load_dwordx4 v0, s[20:23], s54 offen lds
 s_add_u32 m0, s43, 18432
 s_mov_b32 s54, 2359296
 buffer_load_dwordx4 v0, s[20:23], s54 offen lds
 s_add_u32 m0, s43, 19456
 s_mov_b32 s54, 2490368
 buffer_load_dwordx4 v0, s[20:23], s54 offen lds
 s_add_u32 m0, s43, 20480
 s_mov_b32 s54, 2621440
 buffer_load_dwordx4 v0, s[20:23], s54 offen lds
 s_add_u32 m0, s43, 21504
 s_mov_b32 s54, 2752512
 buffer_load_dwordx4 v0, s[20:23], s54 offen lds
 s_add_u32 m0, s43, 22528
 s_mov_b32 s54, 2883584
 buffer_load_dwordx4 v0, s[20:23], s54 offen lds
 s_add_u32 m0, s43, 23552
 s_mov_b32 s54, 3014656
 buffer_load_dwordx4 v0, s[20:23], s54 offen lds
 s_add_u32 m0, s43, 24576
 s_mov_b32 s54, 3145728
 buffer_load_dwordx4 v0, s[20:23], s54 offen lds
 s_add_u32 m0, s43, 25600
 s_mov_b32 s54, 3276800
 buffer_load_dwordx4 v0, s[20:23], s54 offen lds
 s_add_u32 m0, s43, 26624
 s_mov_b32 s54, 3407872
 buffer_load_dwordx4 v0, s[20:23], s54 offen lds
 s_add_u32 m0, s43, 27648
 s_mov_b32 s54, 3538944
 buffer_load_dwordx4 v0, s[20:23], s54 offen lds
 s_add_u32 m0, s43, 28672
 s_mov_b32 s54, 3670016
 buffer_load_dwordx4 v0, s[20:23], s54 offen lds
 s_add_u32 m0, s43, 29696
 s_mov_b32 s54, 3801088
 buffer_load_dwordx4 v0, s[20:23], s54 offen lds
 s_lshl_b32 s54, s7, 2
 s_add_u32 s54, s54, s4
 s_add_u32 s54, s54, 2
 s_lshl_b32 s54, s54, 18
 s_lshl_b32 s55, s6, 8
 s_add_u32 s54, s54, s55
 v_mov_b32 v3, 0
 v_bfe_u32 v9, v8, 0, 1
 v_lshl_add_u32 v3, v9, 7, v3
 v_bfe_u32 v9, v8, 1, 5
 v_lshl_add_u32 v3, v9, 13, v3
 buffer_load_dword v16, v3, s[24:27], s54 offen
 buffer_load_dword v16, v3, s[16:19], s54 offen
 s_lshl_b32 s54, s7, 5
 s_add_u32 s54, s54, s6
 s_lshl_b32 s37, s54, 14
 s_add_u32 s37, s37, 16777216
 s_lshl_b32 s38, s54, 13
 s_add_u32 s38, s38, 50331648
 s_lshl_b32 s39, s54, 12
 s_add_u32 s39, s39, 84017152
 s_lshl_b32 s40, s7, 1
 s_and_b32 s55, s4, 1
 s_add_u32 s40, s40, s55
 s_lshl_b32 s40, s40, 5
 s_add_u32 s40, s40, s6
 s_lshl_b32 s40, s40, 12
 s_lshr_b32 s55, s4, 1
 s_lshl_b32 s55, s55, 11
 s_add_u32 s40, s40, s55
 s_add_u32 s40, s40, 67108864
 s_mov_b32 s36, 0
 v_mov_b32 v3, 0
 v_bfe_u32 v9, v8, 5, 1
 v_lshl_add_u32 v3, v9, 4, v3
 v_mov_b32 v4, 0
 v_bfe_u32 v9, v8, 2, 2
 v_lshl_add_u32 v4, v9, 4, v4
 v_xor_b32 v3, v3, v4
 v_mov_b32 v3, v3
 v_bfe_u32 v9, v8, 0, 5
 v_lshl_add_u32 v3, v9, 6, v3
 v_xor_b32 v4, 32, v3
 s_lshr_b32 s54, s4, 1
 s_and_b32 s55, s4, 1
 s_lshl_b32 s56, s54, 10
 s_lshl_b32 s58, s55, 7
 s_add_u32 s56, s56, s58
 v_mov_b32 v5, s56
 v_bfe_u32 v9, v8, 0, 1
 v_lshl_add_u32 v5, v9, 4, v5
 v_bfe_u32 v9, v8, 1, 1
 v_lshl_add_u32 v5, v9, 12, v5
 v_bfe_u32 v9, v8, 2, 1
 v_lshl_add_u32 v5, v9, 5, v5
 v_bfe_u32 v9, v8, 3, 1
 v_lshl_add_u32 v5, v9, 13, v5
 v_bfe_u32 v9, v8, 4, 1
 v_lshl_add_u32 v5, v9, 6, v5
 v_bfe_u32 v9, v8, 5, 1
 v_lshl_add_u32 v5, v9, 8, v5
 s_lshl_b32 s56, s54, 13
 s_lshl_b32 s58, s55, 10
 s_add_u32 s56, s56, s58
 s_add_u32 s56, s56, 2048
 v_mov_b32 v6, s56
 v_bfe_u32 v9, v8, 0, 3
 v_lshl_add_u32 v6, v9, 4, v6
 v_bfe_u32 v9, v8, 3, 1
 v_lshl_add_u32 v6, v9, 12, v6
 v_bfe_u32 v9, v8, 4, 1
 v_lshl_add_u32 v6, v9, 7, v6
 v_bfe_u32 v9, v8, 5, 1
 v_lshl_add_u32 v6, v9, 8, v6
 v_lshlrev_b32 v7, 4, v8
 s_lshl_b32 s54, s4, 11
 v_add_u32 v10, s54, v7
 s_lshl_b32 s54, s4, 10
 v_add_u32 v11, s54, v7
 v_mov_b64 v[12:13], -1
 v_mov_b64 v[14:15], -1
 s_waitcnt vmcnt(24)
 ds_read_b64_tr_b16 v[224:225], v1 offset:0
 ds_read_b64_tr_b16 v[226:227], v1 offset:256
 ds_read_b64_tr_b16 v[228:229], v1 offset:1024
 ds_read_b64_tr_b16 v[230:231], v1 offset:1280
 ds_read_b64_tr_b16 v[232:233], v1 offset:2048
 ds_read_b64_tr_b16 v[234:235], v1 offset:2304
 ds_read_b64_tr_b16 v[236:237], v1 offset:3072
 ds_read_b64_tr_b16 v[238:239], v1 offset:3328
 ds_read_b64_tr_b16 v[240:241], v1 offset:4096
 ds_read_b64_tr_b16 v[242:243], v1 offset:4352
 ds_read_b64_tr_b16 v[244:245], v1 offset:5120
 ds_read_b64_tr_b16 v[246:247], v1 offset:5376
 s_waitcnt lgkmcnt(0)
 s_add_u32 m0, s43, 0
 s_mov_b32 s54, 3932160
 buffer_load_dwordx4 v0, s[20:23], s54 offen lds
 s_add_u32 m0, s43, 1024
 s_mov_b32 s54, 4063232
 buffer_load_dwordx4 v0, s[20:23], s54 offen lds
 s_add_u32 m0, s43, 2048
 s_mov_b32 s54, 4194304
 buffer_load_dwordx4 v0, s[20:23], s54 offen lds
 s_add_u32 m0, s43, 3072
 s_mov_b32 s54, 4325376
 buffer_load_dwordx4 v0, s[20:23], s54 offen lds
 s_add_u32 m0, s43, 4096
 s_mov_b32 s54, 4456448
 buffer_load_dwordx4 v0, s[20:23], s54 offen lds
 s_add_u32 m0, s43, 5120
 s_mov_b32 s54, 4587520
 buffer_load_dwordx4 v0, s[20:23], s54 offen lds
 s_waitcnt vmcnt(24)
 ds_read_b64_tr_b16 v[248:249], v1 offset:6144
 ds_read_b64_tr_b16 v[250:251], v1 offset:6400
 ds_read_b64_tr_b16 v[252:253], v1 offset:7168
 ds_read_b64_tr_b16 v[254:255], v1 offset:7424
 ds_read_b64_tr_b16 a[0:1], v1 offset:8192
 ds_read_b64_tr_b16 a[2:3], v1 offset:8448
 ds_read_b64_tr_b16 a[4:5], v1 offset:9216
 ds_read_b64_tr_b16 a[6:7], v1 offset:9472
 ds_read_b64_tr_b16 a[8:9], v1 offset:10240
 ds_read_b64_tr_b16 a[10:11], v1 offset:10496
 ds_read_b64_tr_b16 a[12:13], v1 offset:11264
 ds_read_b64_tr_b16 a[14:15], v1 offset:11520
 s_waitcnt lgkmcnt(0)
 s_add_u32 m0, s43, 6144
 s_mov_b32 s54, 0
 buffer_load_dwordx4 v0, s[24:27], s54 offen lds
 s_add_u32 m0, s43, 7168
 s_mov_b32 s54, 131072
 buffer_load_dwordx4 v0, s[24:27], s54 offen lds
 s_add_u32 m0, s43, 8192
 s_mov_b32 s54, 262144
 buffer_load_dwordx4 v0, s[24:27], s54 offen lds
 s_add_u32 m0, s43, 9216
 s_mov_b32 s54, 393216
 buffer_load_dwordx4 v0, s[24:27], s54 offen lds
 s_add_u32 m0, s43, 10240
 s_mov_b32 s54, 524288
 buffer_load_dwordx4 v0, s[24:27], s54 offen lds
 s_add_u32 m0, s43, 11264
 s_mov_b32 s54, 655360
 buffer_load_dwordx4 v0, s[24:27], s54 offen lds
 s_waitcnt vmcnt(24)
 ds_read_b64_tr_b16 a[16:17], v1 offset:12288
 ds_read_b64_tr_b16 a[18:19], v1 offset:12544
 ds_read_b64_tr_b16 a[20:21], v1 offset:13312
 ds_read_b64_tr_b16 a[22:23], v1 offset:13568
 ds_read_b64_tr_b16 a[24:25], v1 offset:14336
 ds_read_b64_tr_b16 a[26:27], v1 offset:14592
 ds_read_b64_tr_b16 a[28:29], v1 offset:15360
 ds_read_b64_tr_b16 a[30:31], v1 offset:15616
 ds_read_b64_tr_b16 a[32:33], v1 offset:16384
 ds_read_b64_tr_b16 a[34:35], v1 offset:16640
 ds_read_b64_tr_b16 a[36:37], v1 offset:17408
 ds_read_b64_tr_b16 a[38:39], v1 offset:17664
 s_waitcnt lgkmcnt(0)
 s_add_u32 m0, s43, 12288
 s_mov_b32 s54, 786432
 buffer_load_dwordx4 v0, s[24:27], s54 offen lds
 s_add_u32 m0, s43, 13312
 s_mov_b32 s54, 917504
 buffer_load_dwordx4 v0, s[24:27], s54 offen lds
 s_add_u32 m0, s43, 14336
 s_mov_b32 s54, 1048576
 buffer_load_dwordx4 v0, s[24:27], s54 offen lds
 s_add_u32 m0, s43, 15360
 s_mov_b32 s54, 1179648
 buffer_load_dwordx4 v0, s[24:27], s54 offen lds
 s_add_u32 m0, s43, 16384
 s_mov_b32 s54, 1310720
 buffer_load_dwordx4 v0, s[24:27], s54 offen lds
 s_add_u32 m0, s43, 17408
 s_mov_b32 s54, 1441792
 buffer_load_dwordx4 v0, s[24:27], s54 offen lds
 s_waitcnt vmcnt(24)
 ds_read_b64_tr_b16 a[40:41], v1 offset:18432
 ds_read_b64_tr_b16 a[42:43], v1 offset:18688
 ds_read_b64_tr_b16 a[44:45], v1 offset:19456
 ds_read_b64_tr_b16 a[46:47], v1 offset:19712
 ds_read_b64_tr_b16 a[48:49], v1 offset:20480
 ds_read_b64_tr_b16 a[50:51], v1 offset:20736
 ds_read_b64_tr_b16 a[52:53], v1 offset:21504
 ds_read_b64_tr_b16 a[54:55], v1 offset:21760
 ds_read_b64_tr_b16 a[56:57], v1 offset:22528
 ds_read_b64_tr_b16 a[58:59], v1 offset:22784
 ds_read_b64_tr_b16 a[60:61], v1 offset:23552
 ds_read_b64_tr_b16 a[62:63], v1 offset:23808
 s_waitcnt lgkmcnt(0)
 s_add_u32 m0, s43, 18432
 s_mov_b32 s54, 1572864
 buffer_load_dwordx4 v0, s[24:27], s54 offen lds
 s_add_u32 m0, s43, 19456
 s_mov_b32 s54, 1703936
 buffer_load_dwordx4 v0, s[24:27], s54 offen lds
 s_add_u32 m0, s43, 20480
 s_mov_b32 s54, 1835008
 buffer_load_dwordx4 v0, s[24:27], s54 offen lds
 s_add_u32 m0, s43, 21504
 s_mov_b32 s54, 1966080
 buffer_load_dwordx4 v0, s[24:27], s54 offen lds
 s_add_u32 m0, s43, 22528
 s_mov_b32 s54, 2097152
 buffer_load_dwordx4 v0, s[24:27], s54 offen lds
 s_add_u32 m0, s43, 23552
 s_mov_b32 s54, 2228224
 buffer_load_dwordx4 v0, s[24:27], s54 offen lds
 s_waitcnt vmcnt(24)
 ds_read_b64_tr_b16 a[64:65], v1 offset:24576
 ds_read_b64_tr_b16 a[66:67], v1 offset:24832
 ds_read_b64_tr_b16 a[68:69], v1 offset:25600
 ds_read_b64_tr_b16 a[70:71], v1 offset:25856
 ds_read_b64_tr_b16 a[72:73], v1 offset:26624
 ds_read_b64_tr_b16 a[74:75], v1 offset:26880
 ds_read_b64_tr_b16 a[76:77], v1 offset:27648
 ds_read_b64_tr_b16 a[78:79], v1 offset:27904
 ds_read_b64_tr_b16 a[80:81], v1 offset:28672
 ds_read_b64_tr_b16 a[82:83], v1 offset:28928
 ds_read_b64_tr_b16 a[84:85], v1 offset:29696
 ds_read_b64_tr_b16 a[86:87], v1 offset:29952
 s_waitcnt lgkmcnt(0)
 s_add_u32 m0, s43, 24576
 s_mov_b32 s54, 2359296
 buffer_load_dwordx4 v0, s[24:27], s54 offen lds
 s_add_u32 m0, s43, 25600
 s_mov_b32 s54, 2490368
 buffer_load_dwordx4 v0, s[24:27], s54 offen lds
 s_add_u32 m0, s43, 26624
 s_mov_b32 s54, 2621440
 buffer_load_dwordx4 v0, s[24:27], s54 offen lds
 s_add_u32 m0, s43, 27648
 s_mov_b32 s54, 2752512
 buffer_load_dwordx4 v0, s[24:27], s54 offen lds
 s_add_u32 m0, s43, 28672
 s_mov_b32 s54, 2883584
 buffer_load_dwordx4 v0, s[24:27], s54 offen lds
 s_add_u32 m0, s43, 29696
 s_mov_b32 s54, 3014656
 buffer_load_dwordx4 v0, s[24:27], s54 offen lds
 s_waitcnt vmcnt(24)
 ds_read_b64_tr_b16 a[88:89], v1 offset:0
 ds_read_b64_tr_b16 a[90:91], v1 offset:256
 ds_read_b64_tr_b16 a[92:93], v1 offset:1024
 ds_read_b64_tr_b16 a[94:95], v1 offset:1280
 ds_read_b64_tr_b16 a[96:97], v1 offset:2048
 ds_read_b64_tr_b16 a[98:99], v1 offset:2304
 ds_read_b64_tr_b16 a[100:101], v1 offset:3072
 ds_read_b64_tr_b16 a[102:103], v1 offset:3328
 ds_read_b64_tr_b16 a[104:105], v1 offset:4096
 ds_read_b64_tr_b16 a[106:107], v1 offset:4352
 ds_read_b64_tr_b16 a[108:109], v1 offset:5120
 ds_read_b64_tr_b16 a[110:111], v1 offset:5376
 s_waitcnt lgkmcnt(0)
 s_add_u32 m0, s43, 0
 s_mov_b32 s54, 3145728
 buffer_load_dwordx4 v0, s[24:27], s54 offen lds
 s_add_u32 m0, s43, 1024
 s_mov_b32 s54, 3276800
 buffer_load_dwordx4 v0, s[24:27], s54 offen lds
 s_add_u32 m0, s43, 2048
 s_mov_b32 s54, 3407872
 buffer_load_dwordx4 v0, s[24:27], s54 offen lds
 s_add_u32 m0, s43, 3072
 s_mov_b32 s54, 3538944
 buffer_load_dwordx4 v0, s[24:27], s54 offen lds
 s_add_u32 m0, s43, 4096
 s_mov_b32 s54, 3670016
 buffer_load_dwordx4 v0, s[24:27], s54 offen lds
 s_add_u32 m0, s43, 5120
 s_mov_b32 s54, 3801088
 buffer_load_dwordx4 v0, s[24:27], s54 offen lds
 s_waitcnt vmcnt(24)
 ds_read_b64_tr_b16 a[112:113], v1 offset:6144
 ds_read_b64_tr_b16 a[114:115], v1 offset:6400
 ds_read_b64_tr_b16 a[116:117], v1 offset:7168
 ds_read_b64_tr_b16 a[118:119], v1 offset:7424
 ds_read_b64_tr_b16 a[120:121], v1 offset:8192
 ds_read_b64_tr_b16 a[122:123], v1 offset:8448
 ds_read_b64_tr_b16 a[124:125], v1 offset:9216
 ds_read_b64_tr_b16 a[126:127], v1 offset:9472
 ds_read_b64_tr_b16 a[128:129], v1 offset:10240
 ds_read_b64_tr_b16 a[130:131], v1 offset:10496
 ds_read_b64_tr_b16 a[132:133], v1 offset:11264
 ds_read_b64_tr_b16 a[134:135], v1 offset:11520
 s_waitcnt lgkmcnt(0)
 s_add_u32 m0, s43, 6144
 s_mov_b32 s54, 3932160
 buffer_load_dwordx4 v0, s[24:27], s54 offen lds
 s_add_u32 m0, s43, 7168
 s_mov_b32 s54, 4063232
 buffer_load_dwordx4 v0, s[24:27], s54 offen lds
 s_add_u32 m0, s43, 8192
 s_mov_b32 s54, 4194304
 buffer_load_dwordx4 v0, s[24:27], s54 offen lds
 s_add_u32 m0, s43, 9216
 s_mov_b32 s54, 4325376
 buffer_load_dwordx4 v0, s[24:27], s54 offen lds
 s_add_u32 m0, s43, 10240
 s_mov_b32 s54, 4456448
 buffer_load_dwordx4 v0, s[24:27], s54 offen lds
 s_add_u32 m0, s43, 11264
 s_mov_b32 s54, 4587520
 buffer_load_dwordx4 v0, s[24:27], s54 offen lds
 s_waitcnt vmcnt(24)
 ds_read_b64_tr_b16 a[136:137], v1 offset:12288
 ds_read_b64_tr_b16 a[138:139], v1 offset:12544
 ds_read_b64_tr_b16 a[140:141], v1 offset:13312
 ds_read_b64_tr_b16 a[142:143], v1 offset:13568
 ds_read_b64_tr_b16 a[144:145], v1 offset:14336
 ds_read_b64_tr_b16 a[146:147], v1 offset:14592
 ds_read_b64_tr_b16 a[148:149], v1 offset:15360
 ds_read_b64_tr_b16 a[150:151], v1 offset:15616
 ds_read_b64_tr_b16 a[152:153], v1 offset:16384
 ds_read_b64_tr_b16 a[154:155], v1 offset:16640
 ds_read_b64_tr_b16 a[156:157], v1 offset:17408
 ds_read_b64_tr_b16 a[158:159], v1 offset:17664
 s_waitcnt lgkmcnt(0)
 s_add_u32 m0, s43, 12288
 s_mov_b32 s54, 0
 buffer_load_dwordx4 v0, s[16:19], s54 offen lds
 s_add_u32 m0, s43, 13312
 s_mov_b32 s54, 131072
 buffer_load_dwordx4 v0, s[16:19], s54 offen lds
 s_add_u32 m0, s43, 14336
 s_mov_b32 s54, 262144
 buffer_load_dwordx4 v0, s[16:19], s54 offen lds
 s_add_u32 m0, s43, 15360
 s_mov_b32 s54, 393216
 buffer_load_dwordx4 v0, s[16:19], s54 offen lds
 s_add_u32 m0, s43, 16384
 s_mov_b32 s54, 524288
 buffer_load_dwordx4 v0, s[16:19], s54 offen lds
 s_add_u32 m0, s43, 17408
 s_mov_b32 s54, 655360
 buffer_load_dwordx4 v0, s[16:19], s54 offen lds
 s_waitcnt vmcnt(24)
 ds_read_b64_tr_b16 a[160:161], v1 offset:18432
 ds_read_b64_tr_b16 a[162:163], v1 offset:18688
 ds_read_b64_tr_b16 a[164:165], v1 offset:19456
 ds_read_b64_tr_b16 a[166:167], v1 offset:19712
 ds_read_b64_tr_b16 a[168:169], v1 offset:20480
 ds_read_b64_tr_b16 a[170:171], v1 offset:20736
 ds_read_b64_tr_b16 a[172:173], v1 offset:21504
 ds_read_b64_tr_b16 a[174:175], v1 offset:21760
 ds_read_b64_tr_b16 a[176:177], v1 offset:22528
 ds_read_b64_tr_b16 a[178:179], v1 offset:22784
 ds_read_b64_tr_b16 a[180:181], v1 offset:23552
 ds_read_b64_tr_b16 a[182:183], v1 offset:23808
 s_waitcnt lgkmcnt(0)
 s_add_u32 m0, s43, 18432
 s_mov_b32 s54, 786432
 buffer_load_dwordx4 v0, s[16:19], s54 offen lds
 s_add_u32 m0, s43, 19456
 s_mov_b32 s54, 917504
 buffer_load_dwordx4 v0, s[16:19], s54 offen lds
 s_add_u32 m0, s43, 20480
 s_mov_b32 s54, 1048576
 buffer_load_dwordx4 v0, s[16:19], s54 offen lds
 s_add_u32 m0, s43, 21504
 s_mov_b32 s54, 1179648
 buffer_load_dwordx4 v0, s[16:19], s54 offen lds
 s_add_u32 m0, s43, 22528
 s_mov_b32 s54, 1310720
 buffer_load_dwordx4 v0, s[16:19], s54 offen lds
 s_add_u32 m0, s43, 23552
 s_mov_b32 s54, 1441792
 buffer_load_dwordx4 v0, s[16:19], s54 offen lds
 s_waitcnt vmcnt(24)
 ds_read_b64_tr_b16 a[184:185], v1 offset:24576
 ds_read_b64_tr_b16 a[186:187], v1 offset:24832
 ds_read_b64_tr_b16 a[188:189], v1 offset:25600
 ds_read_b64_tr_b16 a[190:191], v1 offset:25856
 ds_read_b64_tr_b16 a[192:193], v1 offset:26624
 ds_read_b64_tr_b16 a[194:195], v1 offset:26880
 ds_read_b64_tr_b16 a[196:197], v1 offset:27648
 ds_read_b64_tr_b16 a[198:199], v1 offset:27904
 ds_read_b64_tr_b16 a[200:201], v1 offset:28672
 ds_read_b64_tr_b16 a[202:203], v1 offset:28928
 ds_read_b64_tr_b16 a[204:205], v1 offset:29696
 ds_read_b64_tr_b16 a[206:207], v1 offset:29952
 s_waitcnt lgkmcnt(0)
 s_add_u32 m0, s43, 24576
 s_mov_b32 s54, 1572864
 buffer_load_dwordx4 v0, s[16:19], s54 offen lds
 s_add_u32 m0, s43, 25600
 s_mov_b32 s54, 1703936
 buffer_load_dwordx4 v0, s[16:19], s54 offen lds
 s_add_u32 m0, s43, 26624
 s_mov_b32 s54, 1835008
 buffer_load_dwordx4 v0, s[16:19], s54 offen lds
 s_add_u32 m0, s43, 27648
 s_mov_b32 s54, 1966080
 buffer_load_dwordx4 v0, s[16:19], s54 offen lds
 s_add_u32 m0, s43, 28672
 s_mov_b32 s54, 2097152
 buffer_load_dwordx4 v0, s[16:19], s54 offen lds
 s_add_u32 m0, s43, 29696
 s_mov_b32 s54, 2228224
 buffer_load_dwordx4 v0, s[16:19], s54 offen lds
 s_waitcnt vmcnt(24)
 ds_read_b64_tr_b16 a[208:209], v1 offset:0
 ds_read_b64_tr_b16 a[210:211], v1 offset:256
 ds_read_b64_tr_b16 a[212:213], v1 offset:1024
 ds_read_b64_tr_b16 a[214:215], v1 offset:1280
 ds_read_b64_tr_b16 a[216:217], v1 offset:2048
 ds_read_b64_tr_b16 a[218:219], v1 offset:2304
 ds_read_b64_tr_b16 a[220:221], v1 offset:3072
 ds_read_b64_tr_b16 a[222:223], v1 offset:3328
 ds_read_b64_tr_b16 a[224:225], v1 offset:4096
 ds_read_b64_tr_b16 a[226:227], v1 offset:4352
 ds_read_b64_tr_b16 a[228:229], v1 offset:5120
 ds_read_b64_tr_b16 a[230:231], v1 offset:5376
 s_waitcnt lgkmcnt(0)
 s_add_u32 m0, s43, 0
 s_mov_b32 s54, 2359296
 buffer_load_dwordx4 v0, s[16:19], s54 offen lds
 s_add_u32 m0, s43, 1024
 s_mov_b32 s54, 2490368
 buffer_load_dwordx4 v0, s[16:19], s54 offen lds
 s_add_u32 m0, s43, 2048
 s_mov_b32 s54, 2621440
 buffer_load_dwordx4 v0, s[16:19], s54 offen lds
 s_add_u32 m0, s43, 3072
 s_mov_b32 s54, 2752512
 buffer_load_dwordx4 v0, s[16:19], s54 offen lds
 s_add_u32 m0, s43, 4096
 s_mov_b32 s54, 2883584
 buffer_load_dwordx4 v0, s[16:19], s54 offen lds
 s_add_u32 m0, s43, 5120
 s_mov_b32 s54, 3014656
 buffer_load_dwordx4 v0, s[16:19], s54 offen lds
 s_waitcnt vmcnt(24)
 ds_read_b64_tr_b16 a[232:233], v1 offset:6144
 ds_read_b64_tr_b16 a[234:235], v1 offset:6400
 ds_read_b64_tr_b16 a[236:237], v1 offset:7168
 ds_read_b64_tr_b16 a[238:239], v1 offset:7424
 ds_read_b64_tr_b16 a[240:241], v1 offset:8192
 ds_read_b64_tr_b16 a[242:243], v1 offset:8448
 ds_read_b64_tr_b16 a[244:245], v1 offset:9216
 ds_read_b64_tr_b16 a[246:247], v1 offset:9472
 ds_read_b64_tr_b16 a[248:249], v1 offset:10240
 ds_read_b64_tr_b16 a[250:251], v1 offset:10496
 ds_read_b64_tr_b16 a[252:253], v1 offset:11264
 ds_read_b64_tr_b16 a[254:255], v1 offset:11520
 s_waitcnt lgkmcnt(0)
 s_add_u32 m0, s43, 6144
 s_mov_b32 s54, 3145728
 buffer_load_dwordx4 v0, s[16:19], s54 offen lds
 s_add_u32 m0, s43, 7168
 s_mov_b32 s54, 3276800
 buffer_load_dwordx4 v0, s[16:19], s54 offen lds
 s_add_u32 m0, s43, 8192
 s_mov_b32 s54, 3407872
 buffer_load_dwordx4 v0, s[16:19], s54 offen lds
 s_add_u32 m0, s43, 9216
 s_mov_b32 s54, 3538944
 buffer_load_dwordx4 v0, s[16:19], s54 offen lds
 s_add_u32 m0, s43, 10240
 s_mov_b32 s54, 3670016
 buffer_load_dwordx4 v0, s[16:19], s54 offen lds
 s_add_u32 m0, s43, 11264
 s_mov_b32 s54, 3801088
 buffer_load_dwordx4 v0, s[16:19], s54 offen lds
 s_waitcnt vmcnt(24)
 ds_read_b64_tr_b16 v[80:81], v1 offset:12288
 ds_read_b64_tr_b16 v[82:83], v1 offset:12544
 ds_read_b64_tr_b16 v[84:85], v1 offset:13312
 ds_read_b64_tr_b16 v[86:87], v1 offset:13568
 ds_read_b64_tr_b16 v[88:89], v1 offset:14336
 ds_read_b64_tr_b16 v[90:91], v1 offset:14592
 ds_read_b64_tr_b16 v[92:93], v1 offset:15360
 ds_read_b64_tr_b16 v[94:95], v1 offset:15616
 ds_read_b64_tr_b16 v[96:97], v1 offset:16384
 ds_read_b64_tr_b16 v[98:99], v1 offset:16640
 ds_read_b64_tr_b16 v[100:101], v1 offset:17408
 ds_read_b64_tr_b16 v[102:103], v1 offset:17664
 s_waitcnt lgkmcnt(0)
 s_add_u32 m0, s43, 12288
 s_mov_b32 s54, 3932160
 buffer_load_dwordx4 v0, s[16:19], s54 offen lds
 s_add_u32 m0, s43, 13312
 s_mov_b32 s54, 4063232
 buffer_load_dwordx4 v0, s[16:19], s54 offen lds
 s_add_u32 m0, s43, 14336
 s_mov_b32 s54, 4194304
 buffer_load_dwordx4 v0, s[16:19], s54 offen lds
 s_add_u32 m0, s43, 15360
 s_mov_b32 s54, 4325376
 buffer_load_dwordx4 v0, s[16:19], s54 offen lds
 s_add_u32 m0, s43, 16384
 s_mov_b32 s54, 4456448
 buffer_load_dwordx4 v0, s[16:19], s54 offen lds
 s_add_u32 m0, s43, 17408
 s_mov_b32 s54, 4587520
 buffer_load_dwordx4 v0, s[16:19], s54 offen lds
 s_waitcnt vmcnt(24)
 ds_read_b64_tr_b16 v[104:105], v1 offset:18432
 ds_read_b64_tr_b16 v[106:107], v1 offset:18688
 ds_read_b64_tr_b16 v[108:109], v1 offset:19456
 ds_read_b64_tr_b16 v[110:111], v1 offset:19712
 ds_read_b64_tr_b16 v[112:113], v1 offset:20480
 ds_read_b64_tr_b16 v[114:115], v1 offset:20736
 ds_read_b64_tr_b16 v[116:117], v1 offset:21504
 ds_read_b64_tr_b16 v[118:119], v1 offset:21760
 ds_read_b64_tr_b16 v[120:121], v1 offset:22528
 ds_read_b64_tr_b16 v[122:123], v1 offset:22784
 ds_read_b64_tr_b16 v[124:125], v1 offset:23552
 ds_read_b64_tr_b16 v[126:127], v1 offset:23808
 s_waitcnt lgkmcnt(0)
 s_waitcnt vmcnt(18)
 ds_read_b64_tr_b16 v[128:129], v1 offset:24576
 ds_read_b64_tr_b16 v[130:131], v1 offset:24832
 ds_read_b64_tr_b16 v[132:133], v1 offset:25600
 ds_read_b64_tr_b16 v[134:135], v1 offset:25856
 ds_read_b64_tr_b16 v[136:137], v1 offset:26624
 ds_read_b64_tr_b16 v[138:139], v1 offset:26880
 ds_read_b64_tr_b16 v[140:141], v1 offset:27648
 ds_read_b64_tr_b16 v[142:143], v1 offset:27904
 ds_read_b64_tr_b16 v[144:145], v1 offset:28672
 ds_read_b64_tr_b16 v[146:147], v1 offset:28928
 ds_read_b64_tr_b16 v[148:149], v1 offset:29696
 ds_read_b64_tr_b16 v[150:151], v1 offset:29952
 s_waitcnt lgkmcnt(0)
 s_waitcnt vmcnt(12)
 ds_read_b64_tr_b16 v[152:153], v1 offset:0
 ds_read_b64_tr_b16 v[154:155], v1 offset:256
 ds_read_b64_tr_b16 v[156:157], v1 offset:1024
 ds_read_b64_tr_b16 v[158:159], v1 offset:1280
 ds_read_b64_tr_b16 v[160:161], v1 offset:2048
 ds_read_b64_tr_b16 v[162:163], v1 offset:2304
 ds_read_b64_tr_b16 v[164:165], v1 offset:3072
 ds_read_b64_tr_b16 v[166:167], v1 offset:3328
 ds_read_b64_tr_b16 v[168:169], v1 offset:4096
 ds_read_b64_tr_b16 v[170:171], v1 offset:4352
 ds_read_b64_tr_b16 v[172:173], v1 offset:5120
 ds_read_b64_tr_b16 v[174:175], v1 offset:5376
 s_waitcnt lgkmcnt(0)
 s_waitcnt vmcnt(6)
 ds_read_b64_tr_b16 v[176:177], v1 offset:6144
 ds_read_b64_tr_b16 v[178:179], v1 offset:6400
 ds_read_b64_tr_b16 v[180:181], v1 offset:7168
 ds_read_b64_tr_b16 v[182:183], v1 offset:7424
 ds_read_b64_tr_b16 v[184:185], v1 offset:8192
 ds_read_b64_tr_b16 v[186:187], v1 offset:8448
 ds_read_b64_tr_b16 v[188:189], v1 offset:9216
 ds_read_b64_tr_b16 v[190:191], v1 offset:9472
 ds_read_b64_tr_b16 v[192:193], v1 offset:10240
 ds_read_b64_tr_b16 v[194:195], v1 offset:10496
 ds_read_b64_tr_b16 v[196:197], v1 offset:11264
 ds_read_b64_tr_b16 v[198:199], v1 offset:11520
 s_waitcnt lgkmcnt(0)
 s_waitcnt vmcnt(0)
 ds_read_b64_tr_b16 v[200:201], v1 offset:12288
 ds_read_b64_tr_b16 v[202:203], v1 offset:12544
 ds_read_b64_tr_b16 v[204:205], v1 offset:13312
 ds_read_b64_tr_b16 v[206:207], v1 offset:13568
 ds_read_b64_tr_b16 v[208:209], v1 offset:14336
 ds_read_b64_tr_b16 v[210:211], v1 offset:14592
 ds_read_b64_tr_b16 v[212:213], v1 offset:15360
 ds_read_b64_tr_b16 v[214:215], v1 offset:15616
 ds_read_b64_tr_b16 v[216:217], v1 offset:16384
 ds_read_b64_tr_b16 v[218:219], v1 offset:16640
 ds_read_b64_tr_b16 v[220:221], v1 offset:17408
 ds_read_b64_tr_b16 v[222:223], v1 offset:17664
 s_waitcnt lgkmcnt(0)
 s_barrier
ATT1:
 ds_read_b128 v[64:67], v3 offset:0
 ds_read_b128 v[68:71], v4 offset:0
 ds_read_b128 v[72:75], v3 offset:2048
 s_waitcnt lgkmcnt(2)
 v_mfma_f32_32x32x16_bf16 v[32:47], v[224:227], v[64:67], 0
 ds_read_b128 v[76:79], v4 offset:2048
 v_mfma_f32_32x32x16_bf16 v[48:63], v[64:67], a[112:115], 0
 v_mfma_f32_32x32x16_bf16 v[16:31], v[80:83], v[64:67], 0
 s_waitcnt lgkmcnt(2)
 v_mfma_f32_32x32x16_bf16 v[32:47], v[228:231], v[68:71], v[32:47]
 ds_read_b128 v[64:67], v3 offset:4096
 v_mfma_f32_32x32x16_bf16 v[48:63], v[68:71], a[116:119], v[48:63]
 v_mfma_f32_32x32x16_bf16 v[16:31], v[84:87], v[68:71], v[16:31]
 s_waitcnt lgkmcnt(2)
 v_mfma_f32_32x32x16_bf16 v[32:47], v[232:235], v[72:75], v[32:47]
 ds_read_b128 v[68:71], v4 offset:4096
 v_mfma_f32_32x32x16_bf16 v[48:63], v[72:75], a[120:123], v[48:63]
 v_mfma_f32_32x32x16_bf16 v[16:31], v[88:91], v[72:75], v[16:31]
 s_waitcnt lgkmcnt(2)
 v_mfma_f32_32x32x16_bf16 v[32:47], v[236:239], v[76:79], v[32:47]
 ds_read_b128 v[72:75], v3 offset:6144
 v_mfma_f32_32x32x16_bf16 v[48:63], v[76:79], a[124:127], v[48:63]
 v_mfma_f32_32x32x16_bf16 v[16:31], v[92:95], v[76:79], v[16:31]
 s_waitcnt lgkmcnt(2)
 v_mfma_f32_32x32x16_bf16 v[32:47], v[240:243], v[64:67], v[32:47]
 ds_read_b128 v[76:79], v4 offset:6144
 v_mfma_f32_32x32x16_bf16 v[48:63], v[64:67], a[128:131], v[48:63]
 v_mfma_f32_32x32x16_bf16 v[16:31], v[96:99], v[64:67], v[16:31]
 s_waitcnt lgkmcnt(2)
 v_mfma_f32_32x32x16_bf16 v[32:47], v[244:247], v[68:71], v[32:47]
 ds_read_b128 v[64:67], v3 offset:8192
 v_mfma_f32_32x32x16_bf16 v[48:63], v[68:71], a[132:135], v[48:63]
 v_mfma_f32_32x32x16_bf16 v[16:31], v[100:103], v[68:71], v[16:31]
 s_waitcnt lgkmcnt(2)
 v_mfma_f32_32x32x16_bf16 v[32:47], v[248:251], v[72:75], v[32:47]
 ds_read_b128 v[68:71], v4 offset:8192
 v_mfma_f32_32x32x16_bf16 v[48:63], v[72:75], a[136:139], v[48:63]
 v_mfma_f32_32x32x16_bf16 v[16:31], v[104:107], v[72:75], v[16:31]
 s_waitcnt lgkmcnt(2)
 v_mfma_f32_32x32x16_bf16 v[32:47], v[252:255], v[76:79], v[32:47]
 ds_read_b128 v[72:75], v3 offset:10240
 v_mfma_f32_32x32x16_bf16 v[48:63], v[76:79], a[140:143], v[48:63]
 v_mfma_f32_32x32x16_bf16 v[16:31], v[108:111], v[76:79], v[16:31]
 s_waitcnt lgkmcnt(2)
 v_mfma_f32_32x32x16_bf16 v[32:47], a[0:3], v[64:67], v[32:47]
 ds_read_b128 v[76:79], v4 offset:10240
 v_mfma_f32_32x32x16_bf16 v[48:63], v[64:67], a[144:147], v[48:63]
 v_mfma_f32_32x32x16_bf16 v[16:31], v[112:115], v[64:67], v[16:31]
 s_waitcnt lgkmcnt(2)
 v_mfma_f32_32x32x16_bf16 v[32:47], a[4:7], v[68:71], v[32:47]
 ds_read_b128 v[64:67], v3 offset:12288
 v_mfma_f32_32x32x16_bf16 v[48:63], v[68:71], a[148:151], v[48:63]
 v_mfma_f32_32x32x16_bf16 v[16:31], v[116:119], v[68:71], v[16:31]
 s_waitcnt lgkmcnt(2)
 v_mfma_f32_32x32x16_bf16 v[32:47], a[8:11], v[72:75], v[32:47]
 ds_read_b128 v[68:71], v4 offset:12288
 v_mfma_f32_32x32x16_bf16 v[48:63], v[72:75], a[152:155], v[48:63]
 v_mfma_f32_32x32x16_bf16 v[16:31], v[120:123], v[72:75], v[16:31]
 s_waitcnt lgkmcnt(2)
 v_mfma_f32_32x32x16_bf16 v[32:47], a[12:15], v[76:79], v[32:47]
 ds_read_b128 v[72:75], v3 offset:14336
 v_mfma_f32_32x32x16_bf16 v[48:63], v[76:79], a[156:159], v[48:63]
 v_mfma_f32_32x32x16_bf16 v[16:31], v[124:127], v[76:79], v[16:31]
 s_waitcnt lgkmcnt(2)
 v_mfma_f32_32x32x16_bf16 v[32:47], a[16:19], v[64:67], v[32:47]
 ds_read_b128 v[76:79], v4 offset:14336
 s_waitcnt vmcnt(0)
 s_barrier
 v_mov_b32 v9, s36
 s_cmp_eq_u32 s4, 0
 s_cbranch_scc0 ATTNF
 buffer_store_byte v9, off, s[8:11], s59 sc1
 s_cmp_eq_u32 s36, 1
 s_cbranch_scc0 ATTNF
 buffer_store_byte v9, off, s[12:15], s57 sc1
ATTNF:
 v_mfma_f32_32x32x16_bf16 v[48:63], v[64:67], a[160:163], v[48:63]
 v_mfma_f32_32x32x16_bf16 v[16:31], v[128:131], v[64:67], v[16:31]
 s_waitcnt lgkmcnt(2)
 v_mfma_f32_32x32x16_bf16 v[32:47], a[20:23], v[68:71], v[32:47]
 ds_read_b128 v[64:67], v3 offset:16384
 v_mfma_f32_32x32x16_bf16 v[48:63], v[68:71], a[164:167], v[48:63]
 s_add_u32 m0, s42, 0
 s_add_u32 s54, s41, 0
 buffer_load_dwordx4 v2, s[28:31], s54 offen lds
 v_mfma_f32_32x32x16_bf16 v[16:31], v[132:135], v[68:71], v[16:31]
 s_waitcnt lgkmcnt(2)
 v_mfma_f32_32x32x16_bf16 v[32:47], a[24:27], v[72:75], v[32:47]
 ds_read_b128 v[68:71], v4 offset:16384
 v_mfma_f32_32x32x16_bf16 v[48:63], v[72:75], a[168:171], v[48:63]
 s_add_u32 m0, s42, 2048
 s_add_u32 s54, s41, 64
 buffer_load_dwordx4 v2, s[28:31], s54 offen lds
 v_mfma_f32_32x32x16_bf16 v[16:31], v[136:139], v[72:75], v[16:31]
 s_waitcnt lgkmcnt(2)
 v_mfma_f32_32x32x16_bf16 v[32:47], a[28:31], v[76:79], v[32:47]
 ds_read_b128 v[72:75], v3 offset:18432
 v_mfma_f32_32x32x16_bf16 v[48:63], v[76:79], a[172:175], v[48:63]
 s_add_u32 m0, s42, 4096
 s_add_u32 s54, s41, 128
 buffer_load_dwordx4 v2, s[28:31], s54 offen lds
 v_mfma_f32_32x32x16_bf16 v[16:31], v[140:143], v[76:79], v[16:31]
 s_waitcnt lgkmcnt(2)
 v_mfma_f32_32x32x16_bf16 v[32:47], a[32:35], v[64:67], v[32:47]
 ds_read_b128 v[76:79], v4 offset:18432
 v_mfma_f32_32x32x16_bf16 v[48:63], v[64:67], a[176:179], v[48:63]
 s_add_u32 m0, s42, 6144
 s_add_u32 s54, s41, 192
 buffer_load_dwordx4 v2, s[28:31], s54 offen lds
 v_mfma_f32_32x32x16_bf16 v[16:31], v[144:147], v[64:67], v[16:31]
 s_waitcnt lgkmcnt(2)
 v_mfma_f32_32x32x16_bf16 v[32:47], a[36:39], v[68:71], v[32:47]
 ds_read_b128 v[64:67], v3 offset:20480
 v_mfma_f32_32x32x16_bf16 v[48:63], v[68:71], a[180:183], v[48:63]
 s_add_u32 m0, s42, 8192
 s_add_u32 s54, s41, 256
 buffer_load_dwordx4 v2, s[28:31], s54 offen lds
 v_mfma_f32_32x32x16_bf16 v[16:31], v[148:151], v[68:71], v[16:31]
 s_waitcnt lgkmcnt(2)
 v_mfma_f32_32x32x16_bf16 v[32:47], a[40:43], v[72:75], v[32:47]
 ds_read_b128 v[68:71], v4 offset:20480
 v_mfma_f32_32x32x16_bf16 v[48:63], v[72:75], a[184:187], v[48:63]
 s_add_u32 m0, s42, 10240
 s_add_u32 s54, s41, 320
 buffer_load_dwordx4 v2, s[28:31], s54 offen lds
 v_mfma_f32_32x32x16_bf16 v[16:31], v[152:155], v[72:75], v[16:31]
 s_waitcnt lgkmcnt(2)
 v_mfma_f32_32x32x16_bf16 v[32:47], a[44:47], v[76:79], v[32:47]
 ds_read_b128 v[72:75], v3 offset:22528
 v_mfma_f32_32x32x16_bf16 v[48:63], v[76:79], a[188:191], v[48:63]
 s_add_u32 m0, s42, 12288
 s_add_u32 s54, s41, 384
 buffer_load_dwordx4 v2, s[28:31], s54 offen lds
 v_mfma_f32_32x32x16_bf16 v[16:31], v[156:159], v[76:79], v[16:31]
 s_waitcnt lgkmcnt(2)
 v_mfma_f32_32x32x16_bf16 v[32:47], a[48:51], v[64:67], v[32:47]
 ds_read_b128 v[76:79], v4 offset:22528
 v_mfma_f32_32x32x16_bf16 v[48:63], v[64:67], a[192:195], v[48:63]
 s_add_u32 m0, s42, 14336
 s_add_u32 s54, s41, 448
 buffer_load_dwordx4 v2, s[28:31], s54 offen lds
 v_mfma_f32_32x32x16_bf16 v[16:31], v[160:163], v[64:67], v[16:31]
 s_waitcnt lgkmcnt(2)
 v_mfma_f32_32x32x16_bf16 v[32:47], a[52:55], v[68:71], v[32:47]
 ds_read_b128 v[64:67], v3 offset:24576
 v_mfma_f32_32x32x16_bf16 v[48:63], v[68:71], a[196:199], v[48:63]
 s_add_u32 m0, s42, 16384
 s_add_u32 s54, s41, 512
 buffer_load_dwordx4 v2, s[28:31], s54 offen lds
 v_mfma_f32_32x32x16_bf16 v[16:31], v[164:167], v[68:71], v[16:31]
 s_waitcnt lgkmcnt(2)
 v_mfma_f32_32x32x16_bf16 v[32:47], a[56:59], v[72:75], v[32:47]
 ds_read_b128 v[68:71], v4 offset:24576
 v_mfma_f32_32x32x16_bf16 v[48:63], v[72:75], a[200:203], v[48:63]
 v_mfma_f32_32x32x16_bf16 v[16:31], v[168:171], v[72:75], v[16:31]
 s_waitcnt lgkmcnt(2)
 v_mfma_f32_32x32x16_bf16 v[32:47], a[60:63], v[76:79], v[32:47]
 ds_read_b128 v[72:75], v3 offset:26624
 v_mfma_f32_32x32x16_bf16 v[48:63], v[76:79], a[204:207], v[48:63]
 v_mfma_f32_32x32x16_bf16 v[16:31], v[172:175], v[76:79], v[16:31]
 s_waitcnt lgkmcnt(2)
 v_mfma_f32_32x32x16_bf16 v[32:47], a[64:67], v[64:67], v[32:47]
 ds_read_b128 v[76:79], v4 offset:26624
 v_mfma_f32_32x32x16_bf16 v[48:63], v[64:67], a[208:211], v[48:63]
 v_mfma_f32_32x32x16_bf16 v[16:31], v[176:179], v[64:67], v[16:31]
 s_waitcnt lgkmcnt(2)
 v_mfma_f32_32x32x16_bf16 v[32:47], a[68:71], v[68:71], v[32:47]
 ds_read_b128 v[64:67], v3 offset:28672
 v_mfma_f32_32x32x16_bf16 v[48:63], v[68:71], a[212:215], v[48:63]
 v_mfma_f32_32x32x16_bf16 v[16:31], v[180:183], v[68:71], v[16:31]
 s_waitcnt lgkmcnt(2)
 v_mfma_f32_32x32x16_bf16 v[32:47], a[72:75], v[72:75], v[32:47]
 ds_read_b128 v[68:71], v4 offset:28672
 v_mfma_f32_32x32x16_bf16 v[48:63], v[72:75], a[216:219], v[48:63]
 v_mfma_f32_32x32x16_bf16 v[16:31], v[184:187], v[72:75], v[16:31]
 s_waitcnt lgkmcnt(2)
 v_mfma_f32_32x32x16_bf16 v[32:47], a[76:79], v[76:79], v[32:47]
 ds_read_b128 v[72:75], v3 offset:30720
 v_mfma_f32_32x32x16_bf16 v[48:63], v[76:79], a[220:223], v[48:63]
 v_mfma_f32_32x32x16_bf16 v[16:31], v[188:191], v[76:79], v[16:31]
 s_waitcnt lgkmcnt(2)
 v_mfma_f32_32x32x16_bf16 v[32:47], a[80:83], v[64:67], v[32:47]
 ds_read_b128 v[76:79], v4 offset:30720
 v_mfma_f32_32x32x16_bf16 v[48:63], v[64:67], a[224:227], v[48:63]
 v_mfma_f32_32x32x16_bf16 v[16:31], v[192:195], v[64:67], v[16:31]
 s_waitcnt lgkmcnt(2)
 v_mfma_f32_32x32x16_bf16 v[32:47], a[84:87], v[68:71], v[32:47]
 ds_read_b128 v[64:67], v3 offset:32768
 v_mfma_f32_32x32x16_bf16 v[48:63], v[68:71], a[228:231], v[48:63]
 v_mfma_f32_32x32x16_bf16 v[16:31], v[196:199], v[68:71], v[16:31]
 s_waitcnt lgkmcnt(2)
 v_mfma_f32_32x32x16_bf16 v[32:47], a[88:91], v[72:75], v[32:47]
 ds_read_b128 v[68:71], v4 offset:32768
 v_mfma_f32_32x32x16_bf16 v[48:63], v[72:75], a[232:235], v[48:63]
 v_mfma_f32_32x32x16_bf16 v[16:31], v[200:203], v[72:75], v[16:31]
 s_waitcnt lgkmcnt(2)
 v_mfma_f32_32x32x16_bf16 v[32:47], a[92:95], v[76:79], v[32:47]
 ds_read_b128 v[72:75], v3 offset:34816
 v_mfma_f32_32x32x16_bf16 v[48:63], v[76:79], a[236:239], v[48:63]
 v_mfma_f32_32x32x16_bf16 v[16:31], v[204:207], v[76:79], v[16:31]
 s_waitcnt lgkmcnt(2)
 v_mfma_f32_32x32x16_bf16 v[32:47], a[96:99], v[64:67], v[32:47]
 ds_read_b128 v[76:79], v4 offset:34816
 v_mfma_f32_32x32x16_bf16 v[48:63], v[64:67], a[240:243], v[48:63]
 v_mfma_f32_32x32x16_bf16 v[16:31], v[208:211], v[64:67], v[16:31]
 s_waitcnt lgkmcnt(2)
 v_mfma_f32_32x32x16_bf16 v[32:47], a[100:103], v[68:71], v[32:47]
 v_mfma_f32_32x32x16_bf16 v[48:63], v[68:71], a[244:247], v[48:63]
 v_mfma_f32_32x32x16_bf16 v[16:31], v[212:215], v[68:71], v[16:31]
 s_waitcnt lgkmcnt(1)
 v_mfma_f32_32x32x16_bf16 v[32:47], a[104:107], v[72:75], v[32:47]
 v_mfma_f32_32x32x16_bf16 v[48:63], v[72:75], a[248:251], v[48:63]
 v_mfma_f32_32x32x16_bf16 v[16:31], v[216:219], v[72:75], v[16:31]
 s_waitcnt lgkmcnt(0)
 v_mfma_f32_32x32x16_bf16 v[32:47], a[108:111], v[76:79], v[32:47]
 v_mfma_f32_32x32x16_bf16 v[48:63], v[76:79], a[252:255], v[48:63]
 v_mfma_f32_32x32x16_bf16 v[16:31], v[220:223], v[76:79], v[16:31]
 v_xor_b32 v3, 0x10000, v3
 v_xor_b32 v4, 0x10000, v4
 s_add_u32 s41, s41, 147456
 s_min_u32 s41, s41, 2341440
 s_xor_b32 s42, s42, 0x10000
 s_waitcnt vmcnt(0)
 s_barrier
 buffer_store_dwordx4 v[12:15], v11, s[8:11], s39 offen sc1
 buffer_store_dwordx4 v[12:15], v7, s[8:11], s40 offen sc1
 buffer_store_dwordx4 v[12:15], v7, s[8:11], s40 offen offset:1024 sc1
 v_cvt_pk_bf16_f32 v32, v32, v33
 v_cvt_pk_bf16_f32 v33, v34, v35
 v_cvt_pk_bf16_f32 v34, v36, v37
 v_cvt_pk_bf16_f32 v35, v38, v39
 buffer_store_dwordx4 v[32:35], v5, s[8:11], s37 offen offset:0 sc1
 v_cvt_pk_bf16_f32 v40, v40, v41
 v_cvt_pk_bf16_f32 v41, v42, v43
 v_cvt_pk_bf16_f32 v42, v44, v45
 v_cvt_pk_bf16_f32 v43, v46, v47
 buffer_store_dwordx4 v[40:43], v5, s[8:11], s37 offen offset:512 sc1
 v_cvt_pk_bf16_f32 v48, v48, v49
 v_cvt_pk_bf16_f32 v49, v50, v51
 v_cvt_pk_bf16_f32 v50, v52, v53
 v_cvt_pk_bf16_f32 v51, v54, v55
 buffer_store_dwordx4 v[48:51], v6, s[8:11], s37 offen offset:0 sc1
 v_cvt_pk_bf16_f32 v56, v56, v57
 v_cvt_pk_bf16_f32 v57, v58, v59
 v_cvt_pk_bf16_f32 v58, v60, v61
 v_cvt_pk_bf16_f32 v59, v62, v63
 buffer_store_dwordx4 v[56:59], v6, s[8:11], s37 offen offset:512 sc1
 v_cvt_pk_bf16_f32 v16, v16, v17
 v_cvt_pk_bf16_f32 v17, v18, v19
 v_cvt_pk_bf16_f32 v18, v20, v21
 v_cvt_pk_bf16_f32 v19, v22, v23
 buffer_store_dwordx4 v[16:19], v10, s[8:11], s38 offen offset:0 sc1
 v_cvt_pk_bf16_f32 v24, v24, v25
 v_cvt_pk_bf16_f32 v25, v26, v27
 v_cvt_pk_bf16_f32 v26, v28, v29
 v_cvt_pk_bf16_f32 v27, v30, v31
 buffer_store_dwordx4 v[24:27], v10, s[8:11], s38 offen offset:1024 sc1
 s_add_u32 s37, s37, 0x200000
 s_add_u32 s38, s38, 0x100000
 s_add_u32 s39, s39, 0x80000
 s_add_u32 s40, s40, 0x100000
 s_add_u32 s36, s36, 1
 s_cmp_lt_u32 s36, 16
 s_cbranch_scc1 ATT1
 s_waitcnt vmcnt(0)
 s_barrier
 v_mov_b32 v9, s36
 s_cmp_eq_u32 s4, 0
 s_cbranch_scc0 ATTNG
 buffer_store_byte v9, off, s[8:11], s59 sc1
 buffer_store_byte v9, off, s[12:15], s57 sc1
ATTNG:
 s_lshl_b32 s54, s7, 5
 s_add_u32 s54, s54, s6
 s_lshl_b32 s37, s54, 14
 s_add_u32 s37, s37, 16777216
 s_lshl_b32 s38, s54, 13
 s_add_u32 s38, s38, 50331648
 s_lshl_b32 s39, s54, 12
 s_add_u32 s39, s39, 84017152
 s_lshl_b32 s40, s7, 1
 s_and_b32 s55, s4, 1
 s_add_u32 s40, s40, s55
 s_lshl_b32 s40, s40, 5
 s_add_u32 s40, s40, s6
 s_lshl_b32 s40, s40, 12
 s_lshr_b32 s55, s4, 1
 s_lshl_b32 s55, s55, 11
 s_add_u32 s40, s40, s55
 s_add_u32 s40, s40, 67108864
 s_mov_b32 s36, 0
 s_and_b32 s54, s4, 1
 s_lshl_b32 s55, s54, 8
 s_lshl_b32 s54, s54, 4
 s_lshr_b32 s56, s4, 1
 s_lshl_b32 s56, s56, 13
 s_add_u32 s56, s56, 2048
 v_mov_b32 v0, s55
 v_bfe_u32 v9, v8, 0, 4
 v_lshl_add_u32 v0, v9, 4, v0
 v_bfe_u32 v9, v8, 4, 2
 v_lshl_add_u32 v0, v9, 9, v0
 v_mov_b32 v1, 0
 v_bfe_u32 v9, v8, 0, 1
 v_lshl_add_u32 v1, v9, 4, v1
 v_bfe_u32 v9, v8, 1, 1
 v_lshl_add_u32 v1, v9, 12, v1
 v_bfe_u32 v9, v8, 2, 1
 v_lshl_add_u32 v1, v9, 5, v1
 v_bfe_u32 v9, v8, 3, 1
 v_lshl_add_u32 v1, v9, 6, v1
 v_bfe_u32 v9, v8, 4, 2
 v_lshl_add_u32 v1, v9, 8, v1
 v_add_u32 v2, 0x2000, v1
 v_add_u32 v3, s56, v7
 v_add_u32 v4, 0x1000, v3
 v_add_u32 v5, 0x1000, v0
 v_mov_b32 v10, s54
 v_bfe_u32 v9, v8, 0, 4
 v_lshl_add_u32 v10, v9, 0, v10
 v_mov_b32 v11, 0
 v_bfe_u32 v9, v8, 4, 1
 v_lshl_add_u32 v11, v9, 2, v11
 v_bfe_u32 v9, v8, 5, 1
 v_lshl_add_u32 v11, v9, 4, v11
 v_sub_u32 v10, v10, v11
 v_mov_b32 v11, 4048155338
 v_cmp_gt_i32 vcc, 0, v10
 s_nop 1
 v_cndmask_b32 v96, 0, v11, vcc
 v_cmp_gt_i32 vcc, 1, v10
 s_nop 1
 v_cndmask_b32 v97, 0, v11, vcc
 v_cmp_gt_i32 vcc, 2, v10
 s_nop 1
 v_cndmask_b32 v98, 0, v11, vcc
 v_cmp_gt_i32 vcc, 3, v10
 s_nop 1
 v_cndmask_b32 v99, 0, v11, vcc
 v_cmp_gt_i32 vcc, 8, v10
 s_nop 1
 v_cndmask_b32 v100, 0, v11, vcc
 v_cmp_gt_i32 vcc, 9, v10
 s_nop 1
 v_cndmask_b32 v101, 0, v11, vcc
 v_cmp_gt_i32 vcc, 10, v10
 s_nop 1
 v_cndmask_b32 v102, 0, v11, vcc
 v_cmp_gt_i32 vcc, 11, v10
 s_nop 1
 v_cndmask_b32 v103, 0, v11, vcc
 v_mov_b32 v148, 0x3f803f80
 v_mov_b32 v149, 0x3f803f80
 v_mov_b32 v150, 0x3f803f80
 v_mov_b32 v151, 0x3f803f80
 v_mov_b32 v125, 0
 v_mov_b32 v126, 0
 s_mov_b32 s50, 1040356334
 s_mov_b32 s49, 400000
ATT2:
 buffer_load_dwordx4 v[16:19], v0, s[8:11], s38 offen offset:0 sc1
 buffer_load_dwordx4 v[20:23], v0, s[8:11], s38 offen offset:2048 sc1
 buffer_load_dwordx4 v[24:27], v5, s[8:11], s38 offen offset:0 sc1
 buffer_load_dwordx4 v[28:31], v5, s[8:11], s38 offen offset:2048 sc1
 buffer_load_dwordx4 v[32:35], v1, s[8:11], s37 offen offset:0 sc1
 buffer_load_dwordx4 v[36:39], v1, s[8:11], s37 offen offset:128 sc1
 buffer_load_dwordx4 v[40:43], v1, s[8:11], s37 offen offset:1024 sc1
 buffer_load_dwordx4 v[44:47], v1, s[8:11], s37 offen offset:1152 sc1
 buffer_load_dwordx4 v[48:51], v2, s[8:11], s37 offen offset:0 sc1
 buffer_load_dwordx4 v[52:55], v2, s[8:11], s37 offen offset:128 sc1
 buffer_load_dwordx4 v[56:59], v2, s[8:11], s37 offen offset:1024 sc1
 buffer_load_dwordx4 v[60:63], v2, s[8:11], s37 offen offset:1152 sc1
 buffer_load_dwordx4 v[64:67], v3, s[8:11], s37 offen offset:0 sc1
 buffer_load_dwordx4 v[68:71], v3, s[8:11], s37 offen offset:1024 sc1
 buffer_load_dwordx4 v[72:75], v4, s[8:11], s37 offen offset:0 sc1
 buffer_load_dwordx4 v[76:79], v4, s[8:11], s37 offen offset:1024 sc1
 s_waitcnt vmcnt(11)
 v_mfma_f32_16x16x32_bf16 v[104:107], v[32:35], v[16:19], v[96:99]
 s_waitcnt vmcnt(7)
 v_mfma_f32_16x16x32_bf16 v[108:111], v[48:51], v[16:19], v[100:103]
 v_mfma_f32_16x16x32_bf16 v[104:107], v[36:39], v[20:23], v[104:107]
 s_waitcnt vmcnt(6)
 v_mfma_f32_16x16x32_bf16 v[108:111], v[52:55], v[20:23], v[108:111]
 v_mfma_f32_16x16x32_bf16 v[104:107], v[40:43], v[24:27], v[104:107]
 s_waitcnt vmcnt(5)
 v_mfma_f32_16x16x32_bf16 v[108:111], v[56:59], v[24:27], v[108:111]
 v_mfma_f32_16x16x32_bf16 v[104:107], v[44:47], v[28:31], v[104:107]
 s_waitcnt vmcnt(4)
 v_mfma_f32_16x16x32_bf16 v[108:111], v[60:63], v[28:31], v[108:111]
 s_nop 3
 v_max3_f32 v10, v104, v105, v106
 s_nop 2
 v_max3_f32 v10, v10, v107, v108
 v_max3_f32 v10, v10, v109, v110
 v_max_f32 v10, v10, v111
 s_waitcnt vmcnt(0)
 s_cmp_eq_u32 s4, 0
 s_cbranch_scc0 ATT2B
 s_cmp_ge_u32 s39, 92274688
 s_cselect_b32 s54, 0x20000, 0
 s_sub_u32 s54, s39, s54
ATT2L:
 buffer_load_dword v9, off, s[8:11], s54 offset:3072 sc1
 s_sub_u32 s49, s49, 1
 s_cselect_b32 s49, 0, s49
 s_cselect_b32 s66, -1, -2
 s_waitcnt vmcnt(0)
 v_cmp_lt_u32 vcc, s66, v9
 s_cbranch_vccnz ATT2L
ATT2B:
 s_barrier
ATT2P:
 buffer_load_dwordx4 v[80:83], v7, s[8:11], s39 offen offset:0 sc1
 buffer_load_dwordx4 v[84:87], v7, s[8:11], s39 offen offset:1024 sc1
 buffer_load_dwordx4 v[88:91], v7, s[8:11], s39 offen offset:2048 sc1
 buffer_load_dwordx4 v[92:95], v7, s[8:11], s39 offen offset:3072 sc1
 s_sub_u32 s49, s49, 1
 s_cselect_b32 s49, 0, s49
 s_cselect_b32 s66, -1, -2
 s_waitcnt vmcnt(1)
 v_max3_u32 v9, v80, v84, v88
 s_waitcnt vmcnt(0)
 v_max_u32 v9, v9, v92
 v_cmp_lt_u32 vcc, s66, v9
 v_swap_b32 v82, v84
 v_swap_b32 v83, v85
 v_swap_b32 v90, v92
 v_swap_b32 v91, v93
 s_cbranch_vccnz ATT2P
 v_mfma_f32_16x16x32_bf16 v[112:115], v[80:83], v[16:19], 0
 v_mfma_f32_16x16x32_bf16 v[116:119], v[80:83], v[20:23], 0
 v_mfma_f32_16x16x32_bf16 v[112:115], v[88:91], v[24:27], v[112:115]
 v_mfma_f32_16x16x32_bf16 v[116:119], v[88:91], v[28:31], v[116:119]
 s_cmp_lt_u32 s4, 2
 s_cbranch_scc1 ATT2E
 v_mov_b64 v[84:85], v[92:93]
 v_mov_b64 v[86:87], v[94:95]
ATT2E:
 s_nop 5
 v_add_f32 v112, v112, v118
 v_add_f32 v113, v113, v119
 v_max3_f32 v10, v10, v112, v113
 v_mov_b32 v11, v10
 s_nop 1
 v_permlane16_swap_b32 v10, v11
 v_max_f32 v10, v10, v11
 v_mov_b32 v11, v10
 s_nop 1
 v_permlane32_swap_b32 v10, v11
 v_max_f32 v10, v10, v11
 v_mul_f32 v10, s50, v10
 v_fma_f32 v104, v104, s50, -v10
 v_fma_f32 v105, v105, s50, -v10
 v_fma_f32 v106, v106, s50, -v10
 v_fma_f32 v107, v107, s50, -v10
 v_fma_f32 v108, v108, s50, -v10
 v_fma_f32 v109, v109, s50, -v10
 v_fma_f32 v110, v110, s50, -v10
 v_fma_f32 v111, v111, s50, -v10
 v_fma_f32 v112, v112, s50, -v10
 v_fma_f32 v113, v113, s50, -v10
 v_exp_f32 v104, v104
 v_exp_f32 v105, v105
 v_exp_f32 v106, v106
 v_exp_f32 v107, v107
 v_exp_f32 v108, v108
 v_exp_f32 v109, v109
 v_exp_f32 v110, v110
 v_exp_f32 v111, v111
 v_exp_f32 v112, v112
 v_exp_f32 v113, v113
 v_cvt_pk_bf16_f32 v120, v104, v105
 v_cvt_pk_bf16_f32 v121, v106, v107
 v_cvt_pk_bf16_f32 v122, v108, v109
 v_cvt_pk_bf16_f32 v123, v110, v111
 v_cvt_pk_bf16_f32 v124, v112, v113
 v_cvt_pk_bf16_f32 v127, v112, v113
 v_mfma_f32_16x16x32_bf16 v[128:131], v[148:151], v[120:123], 0
 v_mfma_f32_16x16x32_bf16 v[132:135], v[64:67], v[120:123], 0
 v_mfma_f32_16x16x32_bf16 v[136:139], v[72:75], v[120:123], 0
 v_mfma_f32_16x16x16_bf16 v[128:131], v[148:149], v[124:125], v[128:131]
 v_mfma_f32_16x16x32_bf16 v[140:143], v[68:71], v[120:123], 0
 v_mfma_f32_16x16x32_bf16 v[144:147], v[76:79], v[120:123], 0
 v_mfma_f32_16x16x16_bf16 v[132:135], v[84:85], v[124:125], v[132:135]
 v_mfma_f32_16x16x16_bf16 v[136:139], v[86:87], v[124:125], v[136:139]
 v_rcp_f32 v128, v128
 v_mfma_f32_16x16x16_bf16 v[140:143], v[84:85], v[126:127], v[140:143]
 v_mfma_f32_16x16x16_bf16 v[144:147], v[86:87], v[126:127], v[144:147]
 v_mul_f32 v132, v132, v128
 v_mul_f32 v133, v133, v128
 v_mul_f32 v134, v134, v128
 v_mul_f32 v135, v135, v128
 v_mul_f32 v136, v136, v128
 v_mul_f32 v137, v137, v128
 v_mul_f32 v138, v138, v128
 v_mul_f32 v139, v139, v128
 v_cvt_pk_bf16_f32 v132, v132, v133
 v_cvt_pk_bf16_f32 v133, v134, v135
 v_cvt_pk_bf16_f32 v134, v136, v137
 v_cvt_pk_bf16_f32 v135, v138, v139
 buffer_store_dwordx4 v[132:135], v7, s[8:11], s40 offen offset:0 sc1
 v_mul_f32 v140, v140, v128
 v_mul_f32 v141, v141, v128
 v_mul_f32 v142, v142, v128
 v_mul_f32 v143, v143, v128
 v_mul_f32 v144, v144, v128
 v_mul_f32 v145, v145, v128
 v_mul_f32 v146, v146, v128
 v_mul_f32 v147, v147, v128
 v_cvt_pk_bf16_f32 v140, v140, v141
 v_cvt_pk_bf16_f32 v141, v142, v143
 v_cvt_pk_bf16_f32 v142, v144, v145
 v_cvt_pk_bf16_f32 v143, v146, v147
 buffer_store_dwordx4 v[140:143], v7, s[8:11], s40 offen offset:1024 sc1
 s_add_u32 s37, s37, 0x200000
 s_add_u32 s38, s38, 0x100000
 s_add_u32 s39, s39, 0x80000
 s_add_u32 s40, s40, 0x100000
 s_add_u32 s36, s36, 1
 s_cmp_lt_u32 s36, 16
 s_cbranch_scc1 ATT2
 s_waitcnt vmcnt(0)
 s_endpgm
CONV:
 s_load_dwordx2 s[8:9], s[0:1], 136
 s_load_dwordx2 s[12:13], s[0:1], 128
 s_load_dwordx2 s[16:17], s[0:1], 0
 s_load_dwordx2 s[20:21], s[0:1], 40
 s_load_dwordx2 s[24:25], s[0:1], 120
 s_load_dwordx2 s[28:29], s[0:1], 112
 s_load_dwordx2 s[32:33], s[0:1], 64
 s_load_dwordx2 s[36:37], s[0:1], 72
 s_load_dwordx2 s[40:41], s[0:1], 80
 s_load_dwordx2 s[44:45], s[0:1], 88
 s_load_dwordx2 s[76:77], s[0:1], 96
 s_load_dwordx2 s[80:81], s[0:1], 104
 s_mov_b32 s10, 100663296
 s_mov_b32 s11, 0x20000
 s_mov_b32 s14, 256
 s_mov_b32 s15, 0x20000
 s_mov_b32 s18, 2359296
 s_mov_b32 s19, 0x20000
 s_mov_b32 s22, 4718592
 s_mov_b32 s23, 0x20000
 s_mov_b32 s26, 2359296
 s_mov_b32 s27, 0x20000
 s_mov_b32 s30, 1152
 s_mov_b32 s31, 0x20000
 s_mov_b32 s34, 147456
 s_mov_b32 s35, 0x20000
 s_mov_b32 s38, 147456
 s_mov_b32 s39, 0x20000
 s_mov_b32 s42, 147456
 s_mov_b32 s43, 0x20000
 s_mov_b32 s46, 147456
 s_mov_b32 s47, 0x20000
 s_mov_b32 s78, 1152
 s_mov_b32 s79, 0x20000
 s_mov_b32 s82, 1152
 s_mov_b32 s83, 0x20000
 s_waitcnt lgkmcnt(0)
 v_mbcnt_lo_u32_b32 v8, -1, 0
 v_mbcnt_hi_u32_b32 v8, -1, v8
 s_cmp_ge_u32 s3, 24
 s_cbranch_scc1 OUT
 s_sub_u32 s54, s5, 5
 s_mul_i32 s54, s54, 24
 s_add_u32 s54, s54, s3
 s_lshl_b32 s55, s54, 4
 s_lshl_b32 s6, s54, 3
 s_add_u32 s6, s6, s4
 v_mul_u32_u24 v1, 9216, v0
 s_add_u32 s54, s55, 0
 buffer_load_dwordx4 v[16:19], v1, s[16:19], s54 offen
 s_add_u32 s54, s55, 1152
 buffer_load_dwordx4 v[20:23], v1, s[16:19], s54 offen
 s_add_u32 s54, s55, 2304
 buffer_load_dwordx4 v[24:27], v1, s[16:19], s54 offen
 s_add_u32 s54, s55, 3456
 buffer_load_dwordx4 v[28:31], v1, s[16:19], s54 offen
 s_add_u32 s54, s55, 4608
 buffer_load_dwordx4 v[32:35], v1, s[16:19], s54 offen
 s_add_u32 s54, s55, 5760
 buffer_load_dwordx4 v[36:39], v1, s[16:19], s54 offen
 s_add_u32 s54, s55, 6912
 buffer_load_dwordx4 v[40:43], v1, s[16:19], s54 offen
 s_add_u32 s54, s55, 8064
 buffer_load_dwordx4 v[44:47], v1, s[16:19], s54 offen
 s_mul_i32 s7, s4, 33280
 s_add_u32 s56, s7, 4224
 v_lshlrev_b32 v2, 3, v8
 v_add_u32 v64, -7, v2
 v_cvt_f32_i32 v64, v64
 v_cvt_pk_bf16_f32 v64, v64, v64
 v_lshlrev_b32 v64, 16, v64
 v_cvt_i32_f32 v64, v64
 v_ashrrev_i32 v3, 2, v64
 v_add_u32 v3, 0x180, v3
 v_min_i32 v64, v64, v3
 v_lshl_add_u32 v64, v64, 2, s56
 v_add_u32 v65, -6, v2
 v_cvt_f32_i32 v65, v65
 v_cvt_pk_bf16_f32 v65, v65, v65
 v_lshlrev_b32 v65, 16, v65
 v_cvt_i32_f32 v65, v65
 v_ashrrev_i32 v3, 2, v65
 v_add_u32 v3, 0x180, v3
 v_min_i32 v65, v65, v3
 v_lshl_add_u32 v65, v65, 2, s56
 v_add_u32 v66, -5, v2
 v_cvt_f32_i32 v66, v66
 v_cvt_pk_bf16_f32 v66, v66, v66
 v_lshlrev_b32 v66, 16, v66
 v_cvt_i32_f32 v66, v66
 v_ashrrev_i32 v3, 2, v66
 v_add_u32 v3, 0x180, v3
 v_min_i32 v66, v66, v3
 v_lshl_add_u32 v66, v66, 2, s56
 v_add_u32 v67, -4, v2
 v_cvt_f32_i32 v67, v67
 v_cvt_pk_bf16_f32 v67, v67, v67
 v_lshlrev_b32 v67, 16, v67
 v_cvt_i32_f32 v67, v67
 v_ashrrev_i32 v3, 2, v67
 v_add_u32 v3, 0x180, v3
 v_min_i32 v67, v67, v3
 v_lshl_add_u32 v67, v67, 2, s56
 v_add_u32 v68, -3, v2
 v_cvt_f32_i32 v68, v68
 v_cvt_pk_bf16_f32 v68, v68, v68
 v_lshlrev_b32 v68, 16, v68
 v_cvt_i32_f32 v68, v68
 v_ashrrev_i32 v3, 2, v68
 v_add_u32 v3, 0x180, v3
 v_min_i32 v68, v68, v3
 v_lshl_add_u32 v68, v68, 2, s56
 v_add_u32 v69, -2, v2
 v_cvt_f32_i32 v69, v69
 v_cvt_pk_bf16_f32 v69, v69, v69
 v_lshlrev_b32 v69, 16, v69
 v_cvt_i32_f32 v69, v69
 v_ashrrev_i32 v3, 2, v69
 v_add_u32 v3, 0x180, v3
 v_min_i32 v69, v69, v3
 v_lshl_add_u32 v69, v69, 2, s56
 v_add_u32 v70, -1, v2
 v_cvt_f32_i32 v70, v70
 v_cvt_pk_bf16_f32 v70, v70, v70
 v_lshlrev_b32 v70, 16, v70
 v_cvt_i32_f32 v70, v70
 v_ashrrev_i32 v3, 2, v70
 v_add_u32 v3, 0x180, v3
 v_min_i32 v70, v70, v3
 v_lshl_add_u32 v70, v70, 2, s56
 v_add_u32 v71, 0, v2
 v_cvt_f32_i32 v71, v71
 v_cvt_pk_bf16_f32 v71, v71, v71
 v_lshlrev_b32 v71, 16, v71
 v_cvt_i32_f32 v71, v71
 v_ashrrev_i32 v3, 2, v71
 v_add_u32 v3, 0x180, v3
 v_min_i32 v71, v71, v3
 v_lshl_add_u32 v71, v71, 2, s56
 v_add_u32 v72, 1, v2
 v_cvt_f32_i32 v72, v72
 v_cvt_pk_bf16_f32 v72, v72, v72
 v_lshlrev_b32 v72, 16, v72
 v_cvt_i32_f32 v72, v72
 v_ashrrev_i32 v3, 2, v72
 v_add_u32 v3, 0x180, v3
 v_min_i32 v72, v72, v3
 v_lshl_add_u32 v72, v72, 2, s56
 v_add_u32 v73, 2, v2
 v_cvt_f32_i32 v73, v73
 v_cvt_pk_bf16_f32 v73, v73, v73
 v_lshlrev_b32 v73, 16, v73
 v_cvt_i32_f32 v73, v73
 v_ashrrev_i32 v3, 2, v73
 v_add_u32 v3, 0x180, v3
 v_min_i32 v73, v73, v3
 v_lshl_add_u32 v73, v73, 2, s56
 v_add_u32 v74, 3, v2
 v_cvt_f32_i32 v74, v74
 v_cvt_pk_bf16_f32 v74, v74, v74
 v_lshlrev_b32 v74, 16, v74
 v_cvt_i32_f32 v74, v74
 v_ashrrev_i32 v3, 2, v74
 v_add_u32 v3, 0x180, v3
 v_min_i32 v74, v74, v3
 v_lshl_add_u32 v74, v74, 2, s56
 v_add_u32 v75, 4, v2
 v_cvt_f32_i32 v75, v75
 v_cvt_pk_bf16_f32 v75, v75, v75
 v_lshlrev_b32 v75, 16, v75
 v_cvt_i32_f32 v75, v75
 v_ashrrev_i32 v3, 2, v75
 v_add_u32 v3, 0x180, v3
 v_min_i32 v75, v75, v3
 v_lshl_add_u32 v75, v75, 2, s56
 v_add_u32 v76, 5, v2
 v_cvt_f32_i32 v76, v76
 v_cvt_pk_bf16_f32 v76, v76, v76
 v_lshlrev_b32 v76, 16, v76
 v_cvt_i32_f32 v76, v76
 v_ashrrev_i32 v3, 2, v76
 v_add_u32 v3, 0x180, v3
 v_min_i32 v76, v76, v3
 v_lshl_add_u32 v76, v76, 2, s56
 v_add_u32 v77, 6, v2
 v_cvt_f32_i32 v77, v77
 v_cvt_pk_bf16_f32 v77, v77, v77
 v_lshlrev_b32 v77, 16, v77
 v_cvt_i32_f32 v77, v77
 v_ashrrev_i32 v3, 2, v77
 v_add_u32 v3, 0x180, v3
 v_min_i32 v77, v77, v3
 v_lshl_add_u32 v77, v77, 2, s56
 v_add_u32 v78, 7, v2
 v_cvt_f32_i32 v78, v78
 v_cvt_pk_bf16_f32 v78, v78, v78
 v_lshlrev_b32 v78, 16, v78
 v_cvt_i32_f32 v78, v78
 v_ashrrev_i32 v3, 2, v78
 v_add_u32 v3, 0x180, v3
 v_min_i32 v78, v78, v3
 v_lshl_add_u32 v78, v78, 2, s56
 v_add_u32 v79, 505, v2
 v_cvt_f32_i32 v79, v79
 v_cvt_pk_bf16_f32 v79, v79, v79
 v_lshlrev_b32 v79, 16, v79
 v_cvt_i32_f32 v79, v79
 v_ashrrev_i32 v3, 2, v79
 v_add_u32 v3, 0x180, v3
 v_min_i32 v79, v79, v3
 v_lshl_add_u32 v79, v79, 2, s56
 v_add_u32 v80, 506, v2
 v_cvt_f32_i32 v80, v80
 v_cvt_pk_bf16_f32 v80, v80, v80
 v_lshlrev_b32 v80, 16, v80
 v_cvt_i32_f32 v80, v80
 v_ashrrev_i32 v3, 2, v80
 v_add_u32 v3, 0x180, v3
 v_min_i32 v80, v80, v3
 v_lshl_add_u32 v80, v80, 2, s56
 v_add_u32 v81, 507, v2
 v_cvt_f32_i32 v81, v81
 v_cvt_pk_bf16_f32 v81, v81, v81
 v_lshlrev_b32 v81, 16, v81
 v_cvt_i32_f32 v81, v81
 v_ashrrev_i32 v3, 2, v81
 v_add_u32 v3, 0x180, v3
 v_min_i32 v81, v81, v3
 v_lshl_add_u32 v81, v81, 2, s56
 v_add_u32 v82, 508, v2
 v_cvt_f32_i32 v82, v82
 v_cvt_pk_bf16_f32 v82, v82, v82
 v_lshlrev_b32 v82, 16, v82
 v_cvt_i32_f32 v82, v82
 v_ashrrev_i32 v3, 2, v82
 v_add_u32 v3, 0x180, v3
 v_min_i32 v82, v82, v3
 v_lshl_add_u32 v82, v82, 2, s56
 v_add_u32 v83, 509, v2
 v_cvt_f32_i32 v83, v83
 v_cvt_pk_bf16_f32 v83, v83, v83
 v_lshlrev_b32 v83, 16, v83
 v_cvt_i32_f32 v83, v83
 v_ashrrev_i32 v3, 2, v83
 v_add_u32 v3, 0x180, v3
 v_min_i32 v83, v83, v3
 v_lshl_add_u32 v83, v83, 2, s56
 v_add_u32 v84, 510, v2
 v_cvt_f32_i32 v84, v84
 v_cvt_pk_bf16_f32 v84, v84, v84
 v_lshlrev_b32 v84, 16, v84
 v_cvt_i32_f32 v84, v84
 v_ashrrev_i32 v3, 2, v84
 v_add_u32 v3, 0x180, v3
 v_min_i32 v84, v84, v3
 v_lshl_add_u32 v84, v84, 2, s56
 v_add_u32 v85, 511, v2
 v_cvt_f32_i32 v85, v85
 v_cvt_pk_bf16_f32 v85, v85, v85
 v_lshlrev_b32 v85, 16, v85
 v_cvt_i32_f32 v85, v85
 v_ashrrev_i32 v3, 2, v85
 v_add_u32 v3, 0x180, v3
 v_min_i32 v85, v85, v3
 v_lshl_add_u32 v85, v85, 2, s56
 v_add_u32 v86, 512, v2
 v_cvt_f32_i32 v86, v86
 v_cvt_pk_bf16_f32 v86, v86, v86
 v_lshlrev_b32 v86, 16, v86
 v_cvt_i32_f32 v86, v86
 v_ashrrev_i32 v3, 2, v86
 v_add_u32 v3, 0x180, v3
 v_min_i32 v86, v86, v3
 v_lshl_add_u32 v86, v86, 2, s56
 v_add_u32 v87, 513, v2
 v_cvt_f32_i32 v87, v87
 v_cvt_pk_bf16_f32 v87, v87, v87
 v_lshlrev_b32 v87, 16, v87
 v_cvt_i32_f32 v87, v87
 v_ashrrev_i32 v3, 2, v87
 v_add_u32 v3, 0x180, v3
 v_min_i32 v87, v87, v3
 v_lshl_add_u32 v87, v87, 2, s56
 v_add_u32 v88, 514, v2
 v_cvt_f32_i32 v88, v88
 v_cvt_pk_bf16_f32 v88, v88, v88
 v_lshlrev_b32 v88, 16, v88
 v_cvt_i32_f32 v88, v88
 v_ashrrev_i32 v3, 2, v88
 v_add_u32 v3, 0x180, v3
 v_min_i32 v88, v88, v3
 v_lshl_add_u32 v88, v88, 2, s56
 v_add_u32 v89, 515, v2
 v_cvt_f32_i32 v89, v89
 v_cvt_pk_bf16_f32 v89, v89, v89
 v_lshlrev_b32 v89, 16, v89
 v_cvt_i32_f32 v89, v89
 v_ashrrev_i32 v3, 2, v89
 v_add_u32 v3, 0x180, v3
 v_min_i32 v89, v89, v3
 v_lshl_add_u32 v89, v89, 2, s56
 v_add_u32 v90, 516, v2
 v_cvt_f32_i32 v90, v90
 v_cvt_pk_bf16_f32 v90, v90, v90
 v_lshlrev_b32 v90, 16, v90
 v_cvt_i32_f32 v90, v90
 v_ashrrev_i32 v3, 2, v90
 v_add_u32 v3, 0x180, v3
 v_min_i32 v90, v90, v3
 v_lshl_add_u32 v90, v90, 2, s56
 v_add_u32 v91, 517, v2
 v_cvt_f32_i32 v91, v91
 v_cvt_pk_bf16_f32 v91, v91, v91
 v_lshlrev_b32 v91, 16, v91
 v_cvt_i32_f32 v91, v91
 v_ashrrev_i32 v3, 2, v91
 v_add_u32 v3, 0x180, v3
 v_min_i32 v91, v91, v3
 v_lshl_add_u32 v91, v91, 2, s56
 v_add_u32 v92, 518, v2
 v_cvt_f32_i32 v92, v92
 v_cvt_pk_bf16_f32 v92, v92, v92
 v_lshlrev_b32 v92, 16, v92
 v_cvt_i32_f32 v92, v92
 v_ashrrev_i32 v3, 2, v92
 v_add_u32 v3, 0x180, v3
 v_min_i32 v92, v92, v3
 v_lshl_add_u32 v92, v92, 2, s56
 v_add_u32 v93, 519, v2
 v_cvt_f32_i32 v93, v93
 v_cvt_pk_bf16_f32 v93, v93, v93
 v_lshlrev_b32 v93, 16, v93
 v_cvt_i32_f32 v93, v93
 v_ashrrev_i32 v3, 2, v93
 v_add_u32 v3, 0x180, v3
 v_min_i32 v93, v93, v3
 v_lshl_add_u32 v93, v93, 2, s56
 v_add_u32 v94, 1017, v2
 v_cvt_f32_i32 v94, v94
 v_cvt_pk_bf16_f32 v94, v94, v94
 v_lshlrev_b32 v94, 16, v94
 v_cvt_i32_f32 v94, v94
 v_ashrrev_i32 v3, 2, v94
 v_add_u32 v3, 0x180, v3
 v_min_i32 v94, v94, v3
 v_lshl_add_u32 v94, v94, 2, s56
 v_add_u32 v95, 1018, v2
 v_cvt_f32_i32 v95, v95
 v_cvt_pk_bf16_f32 v95, v95, v95
 v_lshlrev_b32 v95, 16, v95
 v_cvt_i32_f32 v95, v95
 v_ashrrev_i32 v3, 2, v95
 v_add_u32 v3, 0x180, v3
 v_min_i32 v95, v95, v3
 v_lshl_add_u32 v95, v95, 2, s56
 v_add_u32 v96, 1019, v2
 v_cvt_f32_i32 v96, v96
 v_cvt_pk_bf16_f32 v96, v96, v96
 v_lshlrev_b32 v96, 16, v96
 v_cvt_i32_f32 v96, v96
 v_ashrrev_i32 v3, 2, v96
 v_add_u32 v3, 0x180, v3
 v_min_i32 v96, v96, v3
 v_lshl_add_u32 v96, v96, 2, s56
 v_add_u32 v97, 1020, v2
 v_cvt_f32_i32 v97, v97
 v_cvt_pk_bf16_f32 v97, v97, v97
 v_lshlrev_b32 v97, 16, v97
 v_cvt_i32_f32 v97, v97
 v_ashrrev_i32 v3, 2, v97
 v_add_u32 v3, 0x180, v3
 v_min_i32 v97, v97, v3
 v_lshl_add_u32 v97, v97, 2, s56
 v_add_u32 v98, 1021, v2
 v_cvt_f32_i32 v98, v98
 v_cvt_pk_bf16_f32 v98, v98, v98
 v_lshlrev_b32 v98, 16, v98
 v_cvt_i32_f32 v98, v98
 v_ashrrev_i32 v3, 2, v98
 v_add_u32 v3, 0x180, v3
 v_min_i32 v98, v98, v3
 v_lshl_add_u32 v98, v98, 2, s56
 v_add_u32 v99, 1022, v2
 v_cvt_f32_i32 v99, v99
 v_cvt_pk_bf16_f32 v99, v99, v99
 v_lshlrev_b32 v99, 16, v99
 v_cvt_i32_f32 v99, v99
 v_ashrrev_i32 v3, 2, v99
 v_add_u32 v3, 0x180, v3
 v_min_i32 v99, v99, v3
 v_lshl_add_u32 v99, v99, 2, s56
 v_add_u32 v100, 1023, v2
 v_cvt_f32_i32 v100, v100
 v_cvt_pk_bf16_f32 v100, v100, v100
 v_lshlrev_b32 v100, 16, v100
 v_cvt_i32_f32 v100, v100
 v_ashrrev_i32 v3, 2, v100
 v_add_u32 v3, 0x180, v3
 v_min_i32 v100, v100, v3
 v_lshl_add_u32 v100, v100, 2, s56
 v_add_u32 v101, 1024, v2
 v_cvt_f32_i32 v101, v101
 v_cvt_pk_bf16_f32 v101, v101, v101
 v_lshlrev_b32 v101, 16, v101
 v_cvt_i32_f32 v101, v101
 v_ashrrev_i32 v3, 2, v101
 v_add_u32 v3, 0x180, v3
 v_min_i32 v101, v101, v3
 v_lshl_add_u32 v101, v101, 2, s56
 v_add_u32 v102, 1025, v2
 v_cvt_f32_i32 v102, v102
 v_cvt_pk_bf16_f32 v102, v102, v102
 v_lshlrev_b32 v102, 16, v102
 v_cvt_i32_f32 v102, v102
 v_ashrrev_i32 v3, 2, v102
 v_add_u32 v3, 0x180, v3
 v_min_i32 v102, v102, v3
 v_lshl_add_u32 v102, v102, 2, s56
 v_add_u32 v103, 1026, v2
 v_cvt_f32_i32 v103, v103
 v_cvt_pk_bf16_f32 v103, v103, v103
 v_lshlrev_b32 v103, 16, v103
 v_cvt_i32_f32 v103, v103
 v_ashrrev_i32 v3, 2, v103
 v_add_u32 v3, 0x180, v3
 v_min_i32 v103, v103, v3
 v_lshl_add_u32 v103, v103, 2, s56
 v_add_u32 v104, 1027, v2
 v_cvt_f32_i32 v104, v104
 v_cvt_pk_bf16_f32 v104, v104, v104
 v_lshlrev_b32 v104, 16, v104
 v_cvt_i32_f32 v104, v104
 v_ashrrev_i32 v3, 2, v104
 v_add_u32 v3, 0x180, v3
 v_min_i32 v104, v104, v3
 v_lshl_add_u32 v104, v104, 2, s56
 v_add_u32 v105, 1028, v2
 v_cvt_f32_i32 v105, v105
 v_cvt_pk_bf16_f32 v105, v105, v105
 v_lshlrev_b32 v105, 16, v105
 v_cvt_i32_f32 v105, v105
 v_ashrrev_i32 v3, 2, v105
 v_add_u32 v3, 0x180, v3
 v_min_i32 v105, v105, v3
 v_lshl_add_u32 v105, v105, 2, s56
 v_add_u32 v106, 1029, v2
 v_cvt_f32_i32 v106, v106
 v_cvt_pk_bf16_f32 v106, v106, v106
 v_lshlrev_b32 v106, 16, v106
 v_cvt_i32_f32 v106, v106
 v_ashrrev_i32 v3, 2, v106
 v_add_u32 v3, 0x180, v3
 v_min_i32 v106, v106, v3
 v_lshl_add_u32 v106, v106, 2, s56
 v_add_u32 v107, 1030, v2
 v_cvt_f32_i32 v107, v107
 v_cvt_pk_bf16_f32 v107, v107, v107
 v_lshlrev_b32 v107, 16, v107
 v_cvt_i32_f32 v107, v107
 v_ashrrev_i32 v3, 2, v107
 v_add_u32 v3, 0x180, v3
 v_min_i32 v107, v107, v3
 v_lshl_add_u32 v107, v107, 2, s56
 v_add_u32 v108, 1031, v2
 v_cvt_f32_i32 v108, v108
 v_cvt_pk_bf16_f32 v108, v108, v108
 v_lshlrev_b32 v108, 16, v108
 v_cvt_i32_f32 v108, v108
 v_ashrrev_i32 v3, 2, v108
 v_add_u32 v3, 0x180, v3
 v_min_i32 v108, v108, v3
 v_lshl_add_u32 v108, v108, 2, s56
 v_add_u32 v109, 1529, v2
 v_cvt_f32_i32 v109, v109
 v_cvt_pk_bf16_f32 v109, v109, v109
 v_lshlrev_b32 v109, 16, v109
 v_cvt_i32_f32 v109, v109
 v_ashrrev_i32 v3, 2, v109
 v_add_u32 v3, 0x180, v3
 v_min_i32 v109, v109, v3
 v_lshl_add_u32 v109, v109, 2, s56
 v_add_u32 v110, 1530, v2
 v_cvt_f32_i32 v110, v110
 v_cvt_pk_bf16_f32 v110, v110, v110
 v_lshlrev_b32 v110, 16, v110
 v_cvt_i32_f32 v110, v110
 v_ashrrev_i32 v3, 2, v110
 v_add_u32 v3, 0x180, v3
 v_min_i32 v110, v110, v3
 v_lshl_add_u32 v110, v110, 2, s56
 v_add_u32 v111, 1531, v2
 v_cvt_f32_i32 v111, v111
 v_cvt_pk_bf16_f32 v111, v111, v111
 v_lshlrev_b32 v111, 16, v111
 v_cvt_i32_f32 v111, v111
 v_ashrrev_i32 v3, 2, v111
 v_add_u32 v3, 0x180, v3
 v_min_i32 v111, v111, v3
 v_lshl_add_u32 v111, v111, 2, s56
 v_add_u32 v112, 1532, v2
 v_cvt_f32_i32 v112, v112
 v_cvt_pk_bf16_f32 v112, v112, v112
 v_lshlrev_b32 v112, 16, v112
 v_cvt_i32_f32 v112, v112
 v_ashrrev_i32 v3, 2, v112
 v_add_u32 v3, 0x180, v3
 v_min_i32 v112, v112, v3
 v_lshl_add_u32 v112, v112, 2, s56
 v_add_u32 v113, 1533, v2
 v_cvt_f32_i32 v113, v113
 v_cvt_pk_bf16_f32 v113, v113, v113
 v_lshlrev_b32 v113, 16, v113
 v_cvt_i32_f32 v113, v113
 v_ashrrev_i32 v3, 2, v113
 v_add_u32 v3, 0x180, v3
 v_min_i32 v113, v113, v3
 v_lshl_add_u32 v113, v113, 2, s56
 v_add_u32 v114, 1534, v2
 v_cvt_f32_i32 v114, v114
 v_cvt_pk_bf16_f32 v114, v114, v114
 v_lshlrev_b32 v114, 16, v114
 v_cvt_i32_f32 v114, v114
 v_ashrrev_i32 v3, 2, v114
 v_add_u32 v3, 0x180, v3
 v_min_i32 v114, v114, v3
 v_lshl_add_u32 v114, v114, 2, s56
 v_add_u32 v115, 1535, v2
 v_cvt_f32_i32 v115, v115
 v_cvt_pk_bf16_f32 v115, v115, v115
 v_lshlrev_b32 v115, 16, v115
 v_cvt_i32_f32 v115, v115
 v_ashrrev_i32 v3, 2, v115
 v_add_u32 v3, 0x180, v3
 v_min_i32 v115, v115, v3
 v_lshl_add_u32 v115, v115, 2, s56
 v_add_u32 v116, 1536, v2
 v_cvt_f32_i32 v116, v116
 v_cvt_pk_bf16_f32 v116, v116, v116
 v_lshlrev_b32 v116, 16, v116
 v_cvt_i32_f32 v116, v116
 v_ashrrev_i32 v3, 2, v116
 v_add_u32 v3, 0x180, v3
 v_min_i32 v116, v116, v3
 v_lshl_add_u32 v116, v116, 2, s56
 v_add_u32 v117, 1537, v2
 v_cvt_f32_i32 v117, v117
 v_cvt_pk_bf16_f32 v117, v117, v117
 v_lshlrev_b32 v117, 16, v117
 v_cvt_i32_f32 v117, v117
 v_ashrrev_i32 v3, 2, v117
 v_add_u32 v3, 0x180, v3
 v_min_i32 v117, v117, v3
 v_lshl_add_u32 v117, v117, 2, s56
 v_add_u32 v118, 1538, v2
 v_cvt_f32_i32 v118, v118
 v_cvt_pk_bf16_f32 v118, v118, v118
 v_lshlrev_b32 v118, 16, v118
 v_cvt_i32_f32 v118, v118
 v_ashrrev_i32 v3, 2, v118
 v_add_u32 v3, 0x180, v3
 v_min_i32 v118, v118, v3
 v_lshl_add_u32 v118, v118, 2, s56
 v_add_u32 v119, 1539, v2
 v_cvt_f32_i32 v119, v119
 v_cvt_pk_bf16_f32 v119, v119, v119
 v_lshlrev_b32 v119, 16, v119
 v_cvt_i32_f32 v119, v119
 v_ashrrev_i32 v3, 2, v119
 v_add_u32 v3, 0x180, v3
 v_min_i32 v119, v119, v3
 v_lshl_add_u32 v119, v119, 2, s56
 v_add_u32 v120, 1540, v2
 v_cvt_f32_i32 v120, v120
 v_cvt_pk_bf16_f32 v120, v120, v120
 v_lshlrev_b32 v120, 16, v120
 v_cvt_i32_f32 v120, v120
 v_ashrrev_i32 v3, 2, v120
 v_add_u32 v3, 0x180, v3
 v_min_i32 v120, v120, v3
 v_lshl_add_u32 v120, v120, 2, s56
 v_add_u32 v121, 1541, v2
 v_cvt_f32_i32 v121, v121
 v_cvt_pk_bf16_f32 v121, v121, v121
 v_lshlrev_b32 v121, 16, v121
 v_cvt_i32_f32 v121, v121
 v_ashrrev_i32 v3, 2, v121
 v_add_u32 v3, 0x180, v3
 v_min_i32 v121, v121, v3
 v_lshl_add_u32 v121, v121, 2, s56
 v_add_u32 v122, 1542, v2
 v_cvt_f32_i32 v122, v122
 v_cvt_pk_bf16_f32 v122, v122, v122
 v_lshlrev_b32 v122, 16, v122
 v_cvt_i32_f32 v122, v122
 v_ashrrev_i32 v3, 2, v122
 v_add_u32 v3, 0x180, v3
 v_min_i32 v122, v122, v3
 v_lshl_add_u32 v122, v122, 2, s56
 v_add_u32 v123, 1543, v2
 v_cvt_f32_i32 v123, v123
 v_cvt_pk_bf16_f32 v123, v123, v123
 v_lshlrev_b32 v123, 16, v123
 v_cvt_i32_f32 v123, v123
 v_ashrrev_i32 v3, 2, v123
 v_add_u32 v3, 0x180, v3
 v_min_i32 v123, v123, v3
 v_lshl_add_u32 v123, v123, 2, s56
 v_and_b32 v2, 15, v8
 v_cvt_f32_u32 v124, v2
 v_mul_f32 v125, 4.0, v124
 v_mul_f32 v126, 4.0, v125
 v_add_f32 v127, 1132462080, v126
 v_mul_f32 v128, 4.0, v126
 v_add_f32 v129, 1153433600, v128
 v_add_f32 v128, 1140850688, v128
 v_mov_b32 v2, 133120
 v_bfe_u32 v9, v0, 0, 5
 v_lshl_add_u32 v2, v9, 4, v2
 v_bfe_u32 v9, v0, 5, 2
 s_mov_b32 s101, 1552
 v_mad_u32_u24 v2, v9, s101, v2
 v_bfe_u32 v9, v0, 7, 1
 s_mov_b32 s101, 12416
 v_mad_u32_u24 v2, v9, s101, v2
 v_mov_b64 v[12:13], 0
 v_mov_b64 v[14:15], 0
 ds_write_b128 v2, v[12:15]
 ds_write_b128 v2, v[12:15] offset:6208
 v_mov_b32 v1, 133632
 v_bfe_u32 v9, v0, 0, 2
 s_mov_b32 s101, 1552
 v_mad_u32_u24 v1, v9, s101, v1
 v_bfe_u32 v9, v0, 2, 6
 v_lshl_add_u32 v1, v9, 4, v1
 s_mov_b32 s58, 0x05040100
 s_mov_b32 s59, 0x07060302
 s_waitcnt vmcnt(0)
 v_perm_b32 v48, v40, v44, s58
 v_perm_b32 v49, v32, v36, s58
 v_perm_b32 v50, v24, v28, s58
 v_perm_b32 v51, v16, v20, s58
 ds_write_b128 v1, v[48:51] offset:0
 v_perm_b32 v52, v40, v44, s59
 v_perm_b32 v53, v32, v36, s59
 v_perm_b32 v54, v24, v28, s59
 v_perm_b32 v55, v16, v20, s59
 ds_write_b128 v1, v[52:55] offset:6208
 v_perm_b32 v56, v41, v45, s58
 v_perm_b32 v57, v33, v37, s58
 v_perm_b32 v58, v25, v29, s58
 v_perm_b32 v59, v17, v21, s58
 ds_write_b128 v1, v[56:59] offset:12416
 v_perm_b32 v60, v41, v45, s59
 v_perm_b32 v61, v33, v37, s59
 v_perm_b32 v62, v25, v29, s59
 v_perm_b32 v63, v17, v21, s59
 ds_write_b128 v1, v[60:63] offset:18624
 s_waitcnt lgkmcnt(0)
 v_perm_b32 v48, v42, v46, s58
 v_perm_b32 v49, v34, v38, s58
 v_perm_b32 v50, v26, v30, s58
 v_perm_b32 v51, v18, v22, s58
 v_perm_b32 v52, v42, v46, s59
 v_perm_b32 v53, v34, v38, s59
 v_perm_b32 v54, v26, v30, s59
 v_perm_b32 v55, v18, v22, s59
 v_perm_b32 v56, v43, v47, s58
 v_perm_b32 v57, v35, v39, s58
 v_perm_b32 v58, v27, v31, s58
 v_perm_b32 v59, v19, v23, s58
 v_perm_b32 v60, v43, v47, s59
 v_perm_b32 v61, v35, v39, s59
 v_perm_b32 v62, v27, v31, s59
 v_perm_b32 v63, v19, v23, s59
 v_mov_b32 v2, s7
 v_bfe_u32 v9, v8, 0, 6
 v_lshl_add_u32 v2, v9, 5, v2
 v_mov_b32 v4, s56
 v_bfe_u32 v9, v8, 0, 4
 v_lshl_add_u32 v4, v9, 6, v4
 v_bfe_u32 v9, v8, 4, 2
 v_lshl_add_u32 v4, v9, 4, v4
 v_mov_b32 v5, s7
 v_bfe_u32 v9, v8, 0, 6
 v_lshl_add_u32 v5, v9, 4, v5
 v_mov_b32 v6, s7
 v_bfe_u32 v9, v8, 0, 3
 s_mov_b32 s101, 4160
 v_mad_u32_u24 v6, v9, s101, v6
 v_bfe_u32 v9, v8, 3, 2
 v_lshl_add_u32 v6, v9, 4, v6
 v_lshrrev_b32 v9, 5, v8
 v_xor_b32 v9, 1, v9
 v_lshl_add_u32 v6, v9, 4, v6
 s_mul_i32 s54, s4, 6208
 s_add_u32 s54, s54, 133120
 v_mov_b32 v7, s54
 v_bfe_u32 v9, v8, 0, 5
 v_lshl_add_u32 v7, v9, 4, v7
 v_bfe_u32 v9, v8, 5, 1
 s_mov_b32 s101, 1552
 v_mad_u32_u24 v7, v9, s101, v7
 v_mov_b32 v10, 0
 v_bfe_u32 v9, v8, 0, 5
 v_lshl_add_u32 v10, v9, 6, v10
 v_bfe_u32 v9, v8, 5, 1
 v_lshl_add_u32 v10, v9, 4, v10
 v_mov_b32 v11, s7
 v_bfe_u32 v9, v8, 0, 3
 s_mov_b32 s101, 4160
 v_mad_u32_u24 v11, v9, s101, v11
 v_bfe_u32 v9, v8, 3, 2
 v_lshl_add_u32 v11, v9, 4, v11
 s_mov_b32 s60, 0
 s_barrier
CONVR:
 s_lshl_b32 s54, s6, 8
 s_lshl_b32 s55, s6, 1
 v_lshlrev_b32 v9, 2, v8
 buffer_load_dword v148, v9, s[32:35], s54 offen
 buffer_load_dword v149, v9, s[36:39], s54 offen
 buffer_load_dword v150, v9, s[40:43], s54 offen
 buffer_load_dword v151, v9, s[44:47], s54 offen
 buffer_load_ushort v152, off, s[76:79], s55
 buffer_load_ushort v153, off, s[80:83], s55
 v_mov_b32 v3, s7
 v_bfe_u32 v9, v8, 4, 2
 v_lshl_add_u32 v3, v9, 4, v3
 v_mov_b32 v132, 0
 v_mov_b32 v133, 0
 v_mov_b32 v134, 0
 v_mov_b32 v135, 0
 v_mov_b32 v136, 0
 v_mov_b32 v137, 0
 v_mov_b32 v138, 0
 v_mov_b32 v139, 0
 v_mov_b32 v140, 0
 v_mov_b32 v141, 0
 v_mov_b32 v142, 0
 v_mov_b32 v143, 0
 v_mov_b32 v144, 0
 v_mov_b32 v145, 0
 v_mov_b32 v146, 0
 v_mov_b32 v147, 0
 s_waitcnt vmcnt(1)
 v_lshlrev_b32 v152, 16, v152
 v_mul_f32 v9, 916719579, v152
 v_mul_f32 v152, 1069066752, v152
 v_exp_f32 v152, v152
 s_nop 0
 v_fmac_f32 v152, v9, v152
 v_cvt_pk_bf16_f32 v152, v152, v152
 v_lshlrev_b32 v152, 16, v152
 s_waitcnt vmcnt(0)
 v_lshlrev_b32 v153, 16, v153
 v_cmp_eq_u32 vcc, 0, v8
 s_nop 1
 v_cndmask_b32 v132, 0, v153, vcc
 v_lshlrev_b32 v156, 16, v148
 v_lshlrev_b32 v157, 16, v149
 v_lshlrev_b32 v158, 16, v150
 v_lshlrev_b32 v159, 16, v151
 v_mul_f32 v9, 916719579, v156
 v_mul_f32 v156, 1069066752, v156
 v_exp_f32 v156, v156
 s_nop 0
 v_fmac_f32 v156, v9, v156
 v_cvt_pk_bf16_f32 v156, v156, v156
 v_lshlrev_b32 v156, 16, v156
 v_mul_f32 v156, v156, v152
 v_mul_f32 v157, v157, v152
 v_mul_f32 v158, v158, v152
 v_mul_f32 v159, v159, v152
 v_mul_f32 v156, 3216550459, v156
 v_mul_f32 v157, 0.15915494, v157
 v_add_f32 v158, v158, v158
 v_add_f32 v159, v159, v159
 ds_write_b128 v2, v[156:159] offset:12544
 v_and_b32 v160, 0xffff0000, v148
 v_and_b32 v161, 0xffff0000, v149
 v_and_b32 v162, 0xffff0000, v150
 v_and_b32 v163, 0xffff0000, v151
 v_mul_f32 v9, 916719579, v160
 v_mul_f32 v160, 1069066752, v160
 v_exp_f32 v160, v160
 s_nop 0
 v_fmac_f32 v160, v9, v160
 v_cvt_pk_bf16_f32 v160, v160, v160
 v_lshlrev_b32 v160, 16, v160
 v_mul_f32 v160, v160, v152
 v_mul_f32 v161, v161, v152
 v_mul_f32 v162, v162, v152
 v_mul_f32 v163, v163, v152
 v_mul_f32 v160, 3216550459, v160
 v_mul_f32 v161, 0.15915494, v161
 v_add_f32 v162, v162, v162
 v_add_f32 v163, v163, v163
 ds_write_b128 v2, v[160:163] offset:12560
 s_waitcnt lgkmcnt(0)
 ds_read_b128 v[148:151], v3 offset:12544
 s_mov_b32 s61, 0
CONVK:
 s_waitcnt lgkmcnt(0)
 v_mul_f32 v152, v148, v124
 v_mul_f32 v153, v149, v124
 v_mul_f32 v154, v148, v125
 v_mul_f32 v155, v149, v125
 v_mul_f32 v156, v148, v126
 v_mul_f32 v157, v149, v126
 v_mul_f32 v158, v148, v127
 v_mul_f32 v159, v149, v127
 v_mul_f32 v160, v148, v128
 v_mul_f32 v161, v149, v128
 v_mul_f32 v162, v148, v129
 v_mul_f32 v163, v149, v129
 v_mov_b64 v[164:165], v[150:151]
 v_add_u32 v3, 64, v3
 ds_read_b128 v[148:151], v3 offset:12544
 v_fract_f32 v153, v153
 v_exp_f32 v152, v152
 v_sin_f32 v166, v153
 v_cos_f32 v153, v153
 v_mul_f32 v166, v166, v152
 v_mul_f32 v152, v153, v152
 v_mul_f32 v172, v152, v164
 v_mul_f32 v173, v152, v165
 v_fma_f32 v172, -v166, v165, v172
 v_fma_f32 v173, -v166, v164, -v173
 v_fract_f32 v157, v157
 v_exp_f32 v156, v156
 v_sin_f32 v168, v157
 v_cos_f32 v157, v157
 v_mul_f32 v168, v168, v156
 v_mul_f32 v156, v157, v156
 s_nop 1
 v_mfma_f32_16x16x4_f32 v[132:135], v172, v156, v[132:135]
 v_fract_f32 v159, v159
 v_exp_f32 v158, v158
 v_sin_f32 v169, v159
 v_cos_f32 v159, v159
 v_mfma_f32_16x16x4_f32 v[132:135], v173, v168, v[132:135]
 v_mul_f32 v169, v169, v158
 v_mul_f32 v158, v159, v158
 s_nop 1
 v_mfma_f32_16x16x4_f32 v[136:139], v172, v158, v[136:139]
 v_fract_f32 v155, v155
 v_exp_f32 v154, v154
 v_sin_f32 v167, v155
 v_cos_f32 v155, v155
 v_mfma_f32_16x16x4_f32 v[136:139], v173, v169, v[136:139]
 v_mul_f32 v167, v167, v154
 v_mul_f32 v154, v155, v154
 v_mul_f32 v174, v154, v164
 v_mul_f32 v175, v154, v165
 v_fma_f32 v174, -v167, v165, v174
 v_fma_f32 v175, -v167, v164, -v175
 v_fract_f32 v161, v161
 v_exp_f32 v160, v160
 v_sin_f32 v170, v161
 v_cos_f32 v161, v161
 v_mul_f32 v170, v170, v160
 v_mul_f32 v160, v161, v160
 s_nop 1
 v_mfma_f32_16x16x4_f32 v[140:143], v174, v160, v[140:143]
 v_fract_f32 v163, v163
 v_exp_f32 v162, v162
 v_sin_f32 v171, v163
 v_cos_f32 v163, v163
 v_mfma_f32_16x16x4_f32 v[140:143], v175, v170, v[140:143]
 v_mul_f32 v171, v171, v162
 v_mul_f32 v162, v163, v162
 s_add_u32 s61, s61, 1
 s_cmp_lt_u32 s61, 32
 v_mfma_f32_16x16x4_f32 v[144:147], v174, v162, v[144:147]
 v_mfma_f32_16x16x4_f32 v[144:147], v175, v171, v[144:147]
 s_cbranch_scc1 CONVK
 ds_write_b128 v4, v[132:135] offset:0
 ds_write_b128 v4, v[136:139] offset:1024
 ds_write_b128 v4, v[140:143] offset:2048
 s_nop 7
 ds_write_b128 v4, v[144:147] offset:3072
 s_mov_b64 exec, 3
 ds_write_b128 v5, v[12:15] offset:4192
 s_mov_b64 exec, -1
 s_waitcnt lgkmcnt(0)
 ds_read_b32 v180, v64
 ds_read_b32 v181, v65
 ds_read_b32 v182, v66
 ds_read_b32 v183, v67
 ds_read_b32 v184, v68
 ds_read_b32 v185, v69
 ds_read_b32 v186, v70
 ds_read_b32 v187, v71
 ds_read_b32 v188, v72
 ds_read_b32 v189, v73
 ds_read_b32 v190, v74
 ds_read_b32 v191, v75
 ds_read_b32 v192, v76
 ds_read_b32 v193, v77
 ds_read_b32 v194, v78
 ds_read_b32 v195, v79
 ds_read_b32 v196, v80
 ds_read_b32 v197, v81
 ds_read_b32 v198, v82
 ds_read_b32 v199, v83
 ds_read_b32 v200, v84
 ds_read_b32 v201, v85
 ds_read_b32 v202, v86
 ds_read_b32 v203, v87
 ds_read_b32 v204, v88
 ds_read_b32 v205, v89
 ds_read_b32 v206, v90
 ds_read_b32 v207, v91
 ds_read_b32 v208, v92
 ds_read_b32 v209, v93
 ds_read_b32 v210, v94
 ds_read_b32 v211, v95
 ds_read_b32 v212, v96
 ds_read_b32 v213, v97
 ds_read_b32 v214, v98
 ds_read_b32 v215, v99
 ds_read_b32 v216, v100
 ds_read_b32 v217, v101
 ds_read_b32 v218, v102
 ds_read_b32 v219, v103
 ds_read_b32 v220, v104
 ds_read_b32 v221, v105
 ds_read_b32 v222, v106
 ds_read_b32 v223, v107
 ds_read_b32 v224, v108
 ds_read_b32 v225, v109
 ds_read_b32 v226, v110
 ds_read_b32 v227, v111
 ds_read_b32 v228, v112
 ds_read_b32 v229, v113
 ds_read_b32 v230, v114
 ds_read_b32 v231, v115
 ds_read_b32 v232, v116
 ds_read_b32 v233, v117
 ds_read_b32 v234, v118
 ds_read_b32 v235, v119
 ds_read_b32 v236, v120
 ds_read_b32 v237, v121
 ds_read_b32 v238, v122
 ds_read_b32 v239, v123
 s_waitcnt lgkmcnt(0)
 ds_write_b128 v11, v[12:15]
 v_cvt_pk_bf16_f32 v132, v180, v181
 v_cvt_pk_bf16_f32 v133, v182, v183
 v_cvt_pk_bf16_f32 v134, v184, v185
 v_cvt_pk_bf16_f32 v135, v186, v187
 ds_write_b128 v5, v[132:135] offset:48
 v_cvt_pk_bf16_f32 v136, v181, v182
 v_cvt_pk_bf16_f32 v137, v183, v184
 v_cvt_pk_bf16_f32 v138, v185, v186
 v_cvt_pk_bf16_f32 v139, v187, v188
 ds_write_b128 v5, v[136:139] offset:4208
 v_cvt_pk_bf16_f32 v140, v182, v183
 v_cvt_pk_bf16_f32 v141, v184, v185
 v_cvt_pk_bf16_f32 v142, v186, v187
 v_cvt_pk_bf16_f32 v143, v188, v189
 ds_write_b128 v5, v[140:143] offset:8368
 v_cvt_pk_bf16_f32 v144, v183, v184
 v_cvt_pk_bf16_f32 v145, v185, v186
 v_cvt_pk_bf16_f32 v146, v187, v188
 v_cvt_pk_bf16_f32 v147, v189, v190
 ds_write_b128 v5, v[144:147] offset:12528
 v_cvt_pk_bf16_f32 v148, v184, v185
 v_cvt_pk_bf16_f32 v149, v186, v187
 v_cvt_pk_bf16_f32 v150, v188, v189
 v_cvt_pk_bf16_f32 v151, v190, v191
 ds_write_b128 v5, v[148:151] offset:16688
 v_cvt_pk_bf16_f32 v152, v185, v186
 v_cvt_pk_bf16_f32 v153, v187, v188
 v_cvt_pk_bf16_f32 v154, v189, v190
 v_cvt_pk_bf16_f32 v155, v191, v192
 ds_write_b128 v5, v[152:155] offset:20848
 v_cvt_pk_bf16_f32 v156, v186, v187
 v_cvt_pk_bf16_f32 v157, v188, v189
 v_cvt_pk_bf16_f32 v158, v190, v191
 v_cvt_pk_bf16_f32 v159, v192, v193
 ds_write_b128 v5, v[156:159] offset:25008
 v_cvt_pk_bf16_f32 v160, v187, v188
 v_cvt_pk_bf16_f32 v161, v189, v190
 v_cvt_pk_bf16_f32 v162, v191, v192
 v_cvt_pk_bf16_f32 v163, v193, v194
 ds_write_b128 v5, v[160:163] offset:29168
 s_waitcnt lgkmcnt(0)
 v_cvt_pk_bf16_f32 v132, v195, v196
 v_cvt_pk_bf16_f32 v133, v197, v198
 v_cvt_pk_bf16_f32 v134, v199, v200
 v_cvt_pk_bf16_f32 v135, v201, v202
 ds_write_b128 v5, v[132:135] offset:1072
 v_cvt_pk_bf16_f32 v136, v196, v197
 v_cvt_pk_bf16_f32 v137, v198, v199
 v_cvt_pk_bf16_f32 v138, v200, v201
 v_cvt_pk_bf16_f32 v139, v202, v203
 ds_write_b128 v5, v[136:139] offset:5232
 v_cvt_pk_bf16_f32 v140, v197, v198
 v_cvt_pk_bf16_f32 v141, v199, v200
 v_cvt_pk_bf16_f32 v142, v201, v202
 v_cvt_pk_bf16_f32 v143, v203, v204
 ds_write_b128 v5, v[140:143] offset:9392
 v_cvt_pk_bf16_f32 v144, v198, v199
 v_cvt_pk_bf16_f32 v145, v200, v201
 v_cvt_pk_bf16_f32 v146, v202, v203
 v_cvt_pk_bf16_f32 v147, v204, v205
 ds_write_b128 v5, v[144:147] offset:13552
 v_cvt_pk_bf16_f32 v148, v199, v200
 v_cvt_pk_bf16_f32 v149, v201, v202
 v_cvt_pk_bf16_f32 v150, v203, v204
 v_cvt_pk_bf16_f32 v151, v205, v206
 ds_write_b128 v5, v[148:151] offset:17712
 v_cvt_pk_bf16_f32 v152, v200, v201
 v_cvt_pk_bf16_f32 v153, v202, v203
 v_cvt_pk_bf16_f32 v154, v204, v205
 v_cvt_pk_bf16_f32 v155, v206, v207
 ds_write_b128 v5, v[152:155] offset:21872
 v_cvt_pk_bf16_f32 v156, v201, v202
 v_cvt_pk_bf16_f32 v157, v203, v204
 v_cvt_pk_bf16_f32 v158, v205, v206
 v_cvt_pk_bf16_f32 v159, v207, v208
 ds_write_b128 v5, v[156:159] offset:26032
 v_cvt_pk_bf16_f32 v160, v202, v203
 v_cvt_pk_bf16_f32 v161, v204, v205
 v_cvt_pk_bf16_f32 v162, v206, v207
 v_cvt_pk_bf16_f32 v163, v208, v209
 ds_write_b128 v5, v[160:163] offset:30192
 s_waitcnt lgkmcnt(0)
 v_cvt_pk_bf16_f32 v132, v210, v211
 v_cvt_pk_bf16_f32 v133, v212, v213
 v_cvt_pk_bf16_f32 v134, v214, v215
 v_cvt_pk_bf16_f32 v135, v216, v217
 ds_write_b128 v5, v[132:135] offset:2096
 v_cvt_pk_bf16_f32 v136, v211, v212
 v_cvt_pk_bf16_f32 v137, v213, v214
 v_cvt_pk_bf16_f32 v138, v215, v216
 v_cvt_pk_bf16_f32 v139, v217, v218
 ds_write_b128 v5, v[136:139] offset:6256
 v_cvt_pk_bf16_f32 v140, v212, v213
 v_cvt_pk_bf16_f32 v141, v214, v215
 v_cvt_pk_bf16_f32 v142, v216, v217
 v_cvt_pk_bf16_f32 v143, v218, v219
 ds_write_b128 v5, v[140:143] offset:10416
 v_cvt_pk_bf16_f32 v144, v213, v214
 v_cvt_pk_bf16_f32 v145, v215, v216
 v_cvt_pk_bf16_f32 v146, v217, v218
 v_cvt_pk_bf16_f32 v147, v219, v220
 ds_write_b128 v5, v[144:147] offset:14576
 v_cvt_pk_bf16_f32 v148, v214, v215
 v_cvt_pk_bf16_f32 v149, v216, v217
 v_cvt_pk_bf16_f32 v150, v218, v219
 v_cvt_pk_bf16_f32 v151, v220, v221
 ds_write_b128 v5, v[148:151] offset:18736
 v_cvt_pk_bf16_f32 v152, v215, v216
 v_cvt_pk_bf16_f32 v153, v217, v218
 v_cvt_pk_bf16_f32 v154, v219, v220
 v_cvt_pk_bf16_f32 v155, v221, v222
 ds_write_b128 v5, v[152:155] offset:22896
 v_cvt_pk_bf16_f32 v156, v216, v217
 v_cvt_pk_bf16_f32 v157, v218, v219
 v_cvt_pk_bf16_f32 v158, v220, v221
 v_cvt_pk_bf16_f32 v159, v222, v223
 ds_write_b128 v5, v[156:159] offset:27056
 v_cvt_pk_bf16_f32 v160, v217, v218
 v_cvt_pk_bf16_f32 v161, v219, v220
 v_cvt_pk_bf16_f32 v162, v221, v222
 v_cvt_pk_bf16_f32 v163, v223, v224
 ds_write_b128 v5, v[160:163] offset:31216
 s_waitcnt lgkmcnt(0)
 v_cvt_pk_bf16_f32 v132, v225, v226
 v_cvt_pk_bf16_f32 v133, v227, v228
 v_cvt_pk_bf16_f32 v134, v229, v230
 v_cvt_pk_bf16_f32 v135, v231, v232
 ds_write_b128 v5, v[132:135] offset:3120
 v_cvt_pk_bf16_f32 v136, v226, v227
 v_cvt_pk_bf16_f32 v137, v228, v229
 v_cvt_pk_bf16_f32 v138, v230, v231
 v_cvt_pk_bf16_f32 v139, v232, v233
 ds_write_b128 v5, v[136:139] offset:7280
 v_cvt_pk_bf16_f32 v140, v227, v228
 v_cvt_pk_bf16_f32 v141, v229, v230
 v_cvt_pk_bf16_f32 v142, v231, v232
 v_cvt_pk_bf16_f32 v143, v233, v234
 ds_write_b128 v5, v[140:143] offset:11440
 v_cvt_pk_bf16_f32 v144, v228, v229
 v_cvt_pk_bf16_f32 v145, v230, v231
 v_cvt_pk_bf16_f32 v146, v232, v233
 v_cvt_pk_bf16_f32 v147, v234, v235
 ds_write_b128 v5, v[144:147] offset:15600
 v_cvt_pk_bf16_f32 v148, v229, v230
 v_cvt_pk_bf16_f32 v149, v231, v232
 v_cvt_pk_bf16_f32 v150, v233, v234
 v_cvt_pk_bf16_f32 v151, v235, v236
 ds_write_b128 v5, v[148:151] offset:19760
 v_cvt_pk_bf16_f32 v152, v230, v231
 v_cvt_pk_bf16_f32 v153, v232, v233
 v_cvt_pk_bf16_f32 v154, v234, v235
 v_cvt_pk_bf16_f32 v155, v236, v237
 ds_write_b128 v5, v[152:155] offset:23920
 v_cvt_pk_bf16_f32 v156, v231, v232
 v_cvt_pk_bf16_f32 v157, v233, v234
 v_cvt_pk_bf16_f32 v158, v235, v236
 v_cvt_pk_bf16_f32 v159, v237, v238
 ds_write_b128 v5, v[156:159] offset:28080
 v_cvt_pk_bf16_f32 v160, v232, v233
 v_cvt_pk_bf16_f32 v161, v234, v235
 v_cvt_pk_bf16_f32 v162, v236, v237
 v_cvt_pk_bf16_f32 v163, v238, v239
 ds_write_b128 v5, v[160:163] offset:32240
 s_waitcnt lgkmcnt(0)
 ds_read_b128 v[180:183], v6 offset:32
 ds_read_b128 v[184:187], v7 offset:512
 ds_read_b128 v[188:191], v7 offset:1024
 ds_read_b128 v[192:195], v6 offset:2080
 ds_read_b128 v[196:199], v6 offset:0
 ds_read_b128 v[200:203], v7 offset:3616
 ds_read_b128 v[204:207], v7 offset:4128
 ds_read_b128 v[208:211], v6 offset:2048
 s_waitcnt lgkmcnt(6)
 v_mfma_f32_32x32x16_bf16 v[132:147], v[180:183], v[184:187], 0
 ds_read_b128 v[212:215], v6 offset:96
 ds_read_b128 v[216:219], v7 offset:496
 s_waitcnt lgkmcnt(7)
 v_mfma_f32_32x32x16_bf16 v[148:163], v[180:183], v[188:191], 0
 ds_read_b128 v[220:223], v7 offset:1008
 s_waitcnt lgkmcnt(7)
 v_mfma_f32_32x32x16_bf16 v[164:179], v[192:195], v[184:187], 0
 ds_read_b128 v[224:227], v6 offset:2144
 s_waitcnt lgkmcnt(6)
 v_mfma_f32_32x32x16_bf16 v[132:147], v[196:199], v[200:203], v[132:147]
 ds_read_b128 v[180:183], v6 offset:64
 ds_read_b128 v[184:187], v7 offset:3600
 s_waitcnt lgkmcnt(7)
 v_mfma_f32_32x32x16_bf16 v[148:163], v[196:199], v[204:207], v[148:163]
 ds_read_b128 v[188:191], v7 offset:4112
 s_waitcnt lgkmcnt(7)
 v_mfma_f32_32x32x16_bf16 v[164:179], v[208:211], v[200:203], v[164:179]
 ds_read_b128 v[192:195], v6 offset:2112
 s_waitcnt lgkmcnt(6)
 v_mfma_f32_32x32x16_bf16 v[132:147], v[212:215], v[216:219], v[132:147]
 ds_read_b128 v[196:199], v6 offset:160
 ds_read_b128 v[200:203], v7 offset:480
 s_waitcnt lgkmcnt(7)
 v_mfma_f32_32x32x16_bf16 v[148:163], v[212:215], v[220:223], v[148:163]
 ds_read_b128 v[204:207], v7 offset:992
 s_waitcnt lgkmcnt(7)
 v_mfma_f32_32x32x16_bf16 v[164:179], v[224:227], v[216:219], v[164:179]
 ds_read_b128 v[208:211], v6 offset:2208
 s_waitcnt lgkmcnt(6)
 v_mfma_f32_32x32x16_bf16 v[132:147], v[180:183], v[184:187], v[132:147]
 ds_read_b128 v[212:215], v6 offset:128
 ds_read_b128 v[216:219], v7 offset:3584
 s_waitcnt lgkmcnt(7)
 v_mfma_f32_32x32x16_bf16 v[148:163], v[180:183], v[188:191], v[148:163]
 ds_read_b128 v[220:223], v7 offset:4096
 s_waitcnt lgkmcnt(7)
 v_mfma_f32_32x32x16_bf16 v[164:179], v[192:195], v[184:187], v[164:179]
 ds_read_b128 v[224:227], v6 offset:2176
 s_waitcnt lgkmcnt(6)
 v_mfma_f32_32x32x16_bf16 v[132:147], v[196:199], v[200:203], v[132:147]
 ds_read_b128 v[180:183], v6 offset:224
 ds_read_b128 v[184:187], v7 offset:464
 s_waitcnt lgkmcnt(7)
 v_mfma_f32_32x32x16_bf16 v[148:163], v[196:199], v[204:207], v[148:163]
 ds_read_b128 v[188:191], v7 offset:976
 s_waitcnt lgkmcnt(7)
 v_mfma_f32_32x32x16_bf16 v[164:179], v[208:211], v[200:203], v[164:179]
 ds_read_b128 v[192:195], v6 offset:2272
 s_waitcnt lgkmcnt(6)
 v_mfma_f32_32x32x16_bf16 v[132:147], v[212:215], v[216:219], v[132:147]
 ds_read_b128 v[196:199], v6 offset:192
 ds_read_b128 v[200:203], v7 offset:3568
 s_waitcnt lgkmcnt(7)
 v_mfma_f32_32x32x16_bf16 v[148:163], v[212:215], v[220:223], v[148:163]
 ds_read_b128 v[204:207], v7 offset:4080
 s_waitcnt lgkmcnt(7)
 v_mfma_f32_32x32x16_bf16 v[164:179], v[224:227], v[216:219], v[164:179]
 ds_read_b128 v[208:211], v6 offset:2240
 s_waitcnt lgkmcnt(6)
 v_mfma_f32_32x32x16_bf16 v[132:147], v[180:183], v[184:187], v[132:147]
 ds_read_b128 v[212:215], v6 offset:288
 ds_read_b128 v[216:219], v7 offset:448
 s_waitcnt lgkmcnt(7)
 v_mfma_f32_32x32x16_bf16 v[148:163], v[180:183], v[188:191], v[148:163]
 ds_read_b128 v[220:223], v7 offset:960
 s_waitcnt lgkmcnt(7)
 v_mfma_f32_32x32x16_bf16 v[164:179], v[192:195], v[184:187], v[164:179]
 ds_read_b128 v[224:227], v6 offset:2336
 s_waitcnt lgkmcnt(6)
 v_mfma_f32_32x32x16_bf16 v[132:147], v[196:199], v[200:203], v[132:147]
 ds_read_b128 v[180:183], v6 offset:256
 ds_read_b128 v[184:187], v7 offset:3552
 s_waitcnt lgkmcnt(7)
 v_mfma_f32_32x32x16_bf16 v[148:163], v[196:199], v[204:207], v[148:163]
 ds_read_b128 v[188:191], v7 offset:4064
 s_waitcnt lgkmcnt(7)
 v_mfma_f32_32x32x16_bf16 v[164:179], v[208:211], v[200:203], v[164:179]
 ds_read_b128 v[192:195], v6 offset:2304
 s_waitcnt lgkmcnt(6)
 v_mfma_f32_32x32x16_bf16 v[132:147], v[212:215], v[216:219], v[132:147]
 ds_read_b128 v[196:199], v6 offset:352
 ds_read_b128 v[200:203], v7 offset:432
 s_waitcnt lgkmcnt(7)
 v_mfma_f32_32x32x16_bf16 v[148:163], v[212:215], v[220:223], v[148:163]
 ds_read_b128 v[204:207], v7 offset:944
 s_waitcnt lgkmcnt(7)
 v_mfma_f32_32x32x16_bf16 v[164:179], v[224:227], v[216:219], v[164:179]
 ds_read_b128 v[208:211], v6 offset:2400
 s_waitcnt lgkmcnt(6)
 v_mfma_f32_32x32x16_bf16 v[132:147], v[180:183], v[184:187], v[132:147]
 ds_read_b128 v[212:215], v6 offset:320
 ds_read_b128 v[216:219], v7 offset:3536
 s_waitcnt lgkmcnt(7)
 v_mfma_f32_32x32x16_bf16 v[148:163], v[180:183], v[188:191], v[148:163]
 ds_read_b128 v[220:223], v7 offset:4048
 s_waitcnt lgkmcnt(7)
 v_mfma_f32_32x32x16_bf16 v[164:179], v[192:195], v[184:187], v[164:179]
 ds_read_b128 v[224:227], v6 offset:2368
 s_waitcnt lgkmcnt(6)
 v_mfma_f32_32x32x16_bf16 v[132:147], v[196:199], v[200:203], v[132:147]
 ds_read_b128 v[180:183], v6 offset:416
 ds_read_b128 v[184:187], v7 offset:416
 s_waitcnt lgkmcnt(7)
 v_mfma_f32_32x32x16_bf16 v[148:163], v[196:199], v[204:207], v[148:163]
 ds_read_b128 v[188:191], v7 offset:928
 s_waitcnt lgkmcnt(7)
 v_mfma_f32_32x32x16_bf16 v[164:179], v[208:211], v[200:203], v[164:179]
 ds_read_b128 v[192:195], v6 offset:2464
 s_waitcnt lgkmcnt(6)
 v_mfma_f32_32x32x16_bf16 v[132:147], v[212:215], v[216:219], v[132:147]
 ds_read_b128 v[196:199], v6 offset:384
 ds_read_b128 v[200:203], v7 offset:3520
 s_waitcnt lgkmcnt(7)
 v_mfma_f32_32x32x16_bf16 v[148:163], v[212:215], v[220:223], v[148:163]
 ds_read_b128 v[204:207], v7 offset:4032
 s_waitcnt lgkmcnt(7)
 v_mfma_f32_32x32x16_bf16 v[164:179], v[224:227], v[216:219], v[164:179]
 ds_read_b128 v[208:211], v6 offset:2432
 s_waitcnt lgkmcnt(6)
 v_mfma_f32_32x32x16_bf16 v[132:147], v[180:183], v[184:187], v[132:147]
 ds_read_b128 v[212:215], v6 offset:480
 ds_read_b128 v[216:219], v7 offset:400
 s_waitcnt lgkmcnt(7)
 v_mfma_f32_32x32x16_bf16 v[148:163], v[180:183], v[188:191], v[148:163]
 ds_read_b128 v[220:223], v7 offset:912
 s_waitcnt lgkmcnt(7)
 v_mfma_f32_32x32x16_bf16 v[164:179], v[192:195], v[184:187], v[164:179]
 ds_read_b128 v[224:227], v6 offset:2528
 s_waitcnt lgkmcnt(6)
 v_mfma_f32_32x32x16_bf16 v[132:147], v[196:199], v[200:203], v[132:147]
 ds_read_b128 v[180:183], v6 offset:448
 ds_read_b128 v[184:187], v7 offset:3504
 s_waitcnt lgkmcnt(7)
 v_mfma_f32_32x32x16_bf16 v[148:163], v[196:199], v[204:207], v[148:163]
 ds_read_b128 v[188:191], v7 offset:4016
 s_waitcnt lgkmcnt(7)
 v_mfma_f32_32x32x16_bf16 v[164:179], v[208:211], v[200:203], v[164:179]
 ds_read_b128 v[192:195], v6 offset:2496
 s_waitcnt lgkmcnt(6)
 v_mfma_f32_32x32x16_bf16 v[132:147], v[212:215], v[216:219], v[132:147]
 ds_read_b128 v[196:199], v6 offset:544
 ds_read_b128 v[200:203], v7 offset:384
 s_waitcnt lgkmcnt(7)
 v_mfma_f32_32x32x16_bf16 v[148:163], v[212:215], v[220:223], v[148:163]
 ds_read_b128 v[204:207], v7 offset:896
 s_waitcnt lgkmcnt(7)
 v_mfma_f32_32x32x16_bf16 v[164:179], v[224:227], v[216:219], v[164:179]
 ds_read_b128 v[208:211], v6 offset:2592
 s_waitcnt lgkmcnt(6)
 v_mfma_f32_32x32x16_bf16 v[132:147], v[180:183], v[184:187], v[132:147]
 ds_read_b128 v[212:215], v6 offset:512
 ds_read_b128 v[216:219], v7 offset:3488
 s_waitcnt lgkmcnt(7)
 v_mfma_f32_32x32x16_bf16 v[148:163], v[180:183], v[188:191], v[148:163]
 ds_read_b128 v[220:223], v7 offset:4000
 s_waitcnt lgkmcnt(7)
 v_mfma_f32_32x32x16_bf16 v[164:179], v[192:195], v[184:187], v[164:179]
 ds_read_b128 v[224:227], v6 offset:2560
 s_waitcnt lgkmcnt(6)
 v_mfma_f32_32x32x16_bf16 v[132:147], v[196:199], v[200:203], v[132:147]
 ds_read_b128 v[180:183], v6 offset:608
 ds_read_b128 v[184:187], v7 offset:368
 s_waitcnt lgkmcnt(7)
 v_mfma_f32_32x32x16_bf16 v[148:163], v[196:199], v[204:207], v[148:163]
 ds_read_b128 v[188:191], v7 offset:880
 s_waitcnt lgkmcnt(7)
 v_mfma_f32_32x32x16_bf16 v[164:179], v[208:211], v[200:203], v[164:179]
 ds_read_b128 v[192:195], v6 offset:2656
 s_waitcnt lgkmcnt(6)
 v_mfma_f32_32x32x16_bf16 v[132:147], v[212:215], v[216:219], v[132:147]
 ds_read_b128 v[196:199], v6 offset:576
 ds_read_b128 v[200:203], v7 offset:3472
 s_waitcnt lgkmcnt(7)
 v_mfma_f32_32x32x16_bf16 v[148:163], v[212:215], v[220:223], v[148:163]
 ds_read_b128 v[204:207], v7 offset:3984
 s_waitcnt lgkmcnt(7)
 v_mfma_f32_32x32x16_bf16 v[164:179], v[224:227], v[216:219], v[164:179]
 ds_read_b128 v[208:211], v6 offset:2624
 s_waitcnt lgkmcnt(6)
 v_mfma_f32_32x32x16_bf16 v[132:147], v[180:183], v[184:187], v[132:147]
 ds_read_b128 v[212:215], v6 offset:672
 ds_read_b128 v[216:219], v7 offset:352
 s_waitcnt lgkmcnt(7)
 v_mfma_f32_32x32x16_bf16 v[148:163], v[180:183], v[188:191], v[148:163]
 ds_read_b128 v[220:223], v7 offset:864
 s_waitcnt lgkmcnt(7)
 v_mfma_f32_32x32x16_bf16 v[164:179], v[192:195], v[184:187], v[164:179]
 ds_read_b128 v[224:227], v6 offset:2720
 s_waitcnt lgkmcnt(6)
 v_mfma_f32_32x32x16_bf16 v[132:147], v[196:199], v[200:203], v[132:147]
 ds_read_b128 v[180:183], v6 offset:640
 ds_read_b128 v[184:187], v7 offset:3456
 s_waitcnt lgkmcnt(7)
 v_mfma_f32_32x32x16_bf16 v[148:163], v[196:199], v[204:207], v[148:163]
 ds_read_b128 v[188:191], v7 offset:3968
 s_waitcnt lgkmcnt(7)
 v_mfma_f32_32x32x16_bf16 v[164:179], v[208:211], v[200:203], v[164:179]
 ds_read_b128 v[192:195], v6 offset:2688
 s_waitcnt lgkmcnt(6)
 v_mfma_f32_32x32x16_bf16 v[132:147], v[212:215], v[216:219], v[132:147]
 ds_read_b128 v[196:199], v6 offset:736
 ds_read_b128 v[200:203], v7 offset:336
 s_waitcnt lgkmcnt(7)
 v_mfma_f32_32x32x16_bf16 v[148:163], v[212:215], v[220:223], v[148:163]
 ds_read_b128 v[204:207], v7 offset:848
 s_waitcnt lgkmcnt(7)
 v_mfma_f32_32x32x16_bf16 v[164:179], v[224:227], v[216:219], v[164:179]
 ds_read_b128 v[208:211], v6 offset:2784
 s_waitcnt lgkmcnt(6)
 v_mfma_f32_32x32x16_bf16 v[132:147], v[180:183], v[184:187], v[132:147]
 ds_read_b128 v[212:215], v6 offset:704
 ds_read_b128 v[216:219], v7 offset:3440
 s_waitcnt lgkmcnt(7)
 v_mfma_f32_32x32x16_bf16 v[148:163], v[180:183], v[188:191], v[148:163]
 ds_read_b128 v[220:223], v7 offset:3952
 s_waitcnt lgkmcnt(7)
 v_mfma_f32_32x32x16_bf16 v[164:179], v[192:195], v[184:187], v[164:179]
 ds_read_b128 v[224:227], v6 offset:2752
 s_waitcnt lgkmcnt(6)
 v_mfma_f32_32x32x16_bf16 v[132:147], v[196:199], v[200:203], v[132:147]
 ds_read_b128 v[180:183], v6 offset:800
 ds_read_b128 v[184:187], v7 offset:320
 s_waitcnt lgkmcnt(7)
 v_mfma_f32_32x32x16_bf16 v[148:163], v[196:199], v[204:207], v[148:163]
 ds_read_b128 v[188:191], v7 offset:832
 s_waitcnt lgkmcnt(7)
 v_mfma_f32_32x32x16_bf16 v[164:179], v[208:211], v[200:203], v[164:179]
 ds_read_b128 v[192:195], v6 offset:2848
 s_waitcnt lgkmcnt(6)
 v_mfma_f32_32x32x16_bf16 v[132:147], v[212:215], v[216:219], v[132:147]
 ds_read_b128 v[196:199], v6 offset:768
 ds_read_b128 v[200:203], v7 offset:3424
 s_waitcnt lgkmcnt(7)
 v_mfma_f32_32x32x16_bf16 v[148:163], v[212:215], v[220:223], v[148:163]
 ds_read_b128 v[204:207], v7 offset:3936
 s_waitcnt lgkmcnt(7)
 v_mfma_f32_32x32x16_bf16 v[164:179], v[224:227], v[216:219], v[164:179]
 ds_read_b128 v[208:211], v6 offset:2816
 s_waitcnt lgkmcnt(6)
 v_mfma_f32_32x32x16_bf16 v[132:147], v[180:183], v[184:187], v[132:147]
 ds_read_b128 v[212:215], v6 offset:864
 ds_read_b128 v[216:219], v7 offset:304
 s_waitcnt lgkmcnt(7)
 v_mfma_f32_32x32x16_bf16 v[148:163], v[180:183], v[188:191], v[148:163]
 ds_read_b128 v[220:223], v7 offset:816
 s_waitcnt lgkmcnt(7)
 v_mfma_f32_32x32x16_bf16 v[164:179], v[192:195], v[184:187], v[164:179]
 ds_read_b128 v[224:227], v6 offset:2912
 s_waitcnt lgkmcnt(6)
 v_mfma_f32_32x32x16_bf16 v[132:147], v[196:199], v[200:203], v[132:147]
 ds_read_b128 v[180:183], v6 offset:832
 ds_read_b128 v[184:187], v7 offset:3408
 s_waitcnt lgkmcnt(7)
 v_mfma_f32_32x32x16_bf16 v[148:163], v[196:199], v[204:207], v[148:163]
 ds_read_b128 v[188:191], v7 offset:3920
 s_waitcnt lgkmcnt(7)
 v_mfma_f32_32x32x16_bf16 v[164:179], v[208:211], v[200:203], v[164:179]
 ds_read_b128 v[192:195], v6 offset:2880
 s_waitcnt lgkmcnt(6)
 v_mfma_f32_32x32x16_bf16 v[132:147], v[212:215], v[216:219], v[132:147]
 ds_read_b128 v[196:199], v6 offset:928
 ds_read_b128 v[200:203], v7 offset:288
 s_waitcnt lgkmcnt(7)
 v_mfma_f32_32x32x16_bf16 v[148:163], v[212:215], v[220:223], v[148:163]
 ds_read_b128 v[204:207], v7 offset:800
 s_waitcnt lgkmcnt(7)
 v_mfma_f32_32x32x16_bf16 v[164:179], v[224:227], v[216:219], v[164:179]
 ds_read_b128 v[208:211], v6 offset:2976
 s_waitcnt lgkmcnt(6)
 v_mfma_f32_32x32x16_bf16 v[132:147], v[180:183], v[184:187], v[132:147]
 ds_read_b128 v[212:215], v6 offset:896
 ds_read_b128 v[216:219], v7 offset:3392
 s_waitcnt lgkmcnt(7)
 v_mfma_f32_32x32x16_bf16 v[148:163], v[180:183], v[188:191], v[148:163]
 ds_read_b128 v[220:223], v7 offset:3904
 s_waitcnt lgkmcnt(7)
 v_mfma_f32_32x32x16_bf16 v[164:179], v[192:195], v[184:187], v[164:179]
 ds_read_b128 v[224:227], v6 offset:2944
 s_waitcnt lgkmcnt(6)
 v_mfma_f32_32x32x16_bf16 v[132:147], v[196:199], v[200:203], v[132:147]
 ds_read_b128 v[180:183], v6 offset:992
 ds_read_b128 v[184:187], v7 offset:272
 s_waitcnt lgkmcnt(7)
 v_mfma_f32_32x32x16_bf16 v[148:163], v[196:199], v[204:207], v[148:163]
 ds_read_b128 v[188:191], v7 offset:784
 s_waitcnt lgkmcnt(7)
 v_mfma_f32_32x32x16_bf16 v[164:179], v[208:211], v[200:203], v[164:179]
 ds_read_b128 v[192:195], v6 offset:3040
 s_waitcnt lgkmcnt(6)
 v_mfma_f32_32x32x16_bf16 v[132:147], v[212:215], v[216:219], v[132:147]
 ds_read_b128 v[196:199], v6 offset:960
 ds_read_b128 v[200:203], v7 offset:3376
 s_waitcnt lgkmcnt(7)
 v_mfma_f32_32x32x16_bf16 v[148:163], v[212:215], v[220:223], v[148:163]
 ds_read_b128 v[204:207], v7 offset:3888
 s_waitcnt lgkmcnt(7)
 v_mfma_f32_32x32x16_bf16 v[164:179], v[224:227], v[216:219], v[164:179]
 ds_read_b128 v[208:211], v6 offset:3008
 s_waitcnt lgkmcnt(6)
 v_mfma_f32_32x32x16_bf16 v[132:147], v[180:183], v[184:187], v[132:147]
 ds_read_b128 v[212:215], v6 offset:1056
 ds_read_b128 v[216:219], v7 offset:256
 s_waitcnt lgkmcnt(7)
 v_mfma_f32_32x32x16_bf16 v[148:163], v[180:183], v[188:191], v[148:163]
 ds_read_b128 v[220:223], v7 offset:768
 s_waitcnt lgkmcnt(7)
 v_mfma_f32_32x32x16_bf16 v[164:179], v[192:195], v[184:187], v[164:179]
 ds_read_b128 v[224:227], v6 offset:3104
 s_waitcnt lgkmcnt(6)
 v_mfma_f32_32x32x16_bf16 v[132:147], v[196:199], v[200:203], v[132:147]
 ds_read_b128 v[180:183], v6 offset:1024
 ds_read_b128 v[184:187], v7 offset:3360
 s_waitcnt lgkmcnt(7)
 v_mfma_f32_32x32x16_bf16 v[148:163], v[196:199], v[204:207], v[148:163]
 ds_read_b128 v[188:191], v7 offset:3872
 s_waitcnt lgkmcnt(7)
 v_mfma_f32_32x32x16_bf16 v[164:179], v[208:211], v[200:203], v[164:179]
 ds_read_b128 v[192:195], v6 offset:3072
 s_waitcnt lgkmcnt(6)
 v_mfma_f32_32x32x16_bf16 v[132:147], v[212:215], v[216:219], v[132:147]
 ds_read_b128 v[196:199], v6 offset:1120
 ds_read_b128 v[200:203], v7 offset:240
 s_waitcnt lgkmcnt(7)
 v_mfma_f32_32x32x16_bf16 v[148:163], v[212:215], v[220:223], v[148:163]
 ds_read_b128 v[204:207], v7 offset:752
 s_waitcnt lgkmcnt(7)
 v_mfma_f32_32x32x16_bf16 v[164:179], v[224:227], v[216:219], v[164:179]
 ds_read_b128 v[208:211], v6 offset:3168
 s_waitcnt lgkmcnt(6)
 v_mfma_f32_32x32x16_bf16 v[132:147], v[180:183], v[184:187], v[132:147]
 ds_read_b128 v[212:215], v6 offset:1088
 ds_read_b128 v[216:219], v7 offset:3344
 s_waitcnt lgkmcnt(7)
 v_mfma_f32_32x32x16_bf16 v[148:163], v[180:183], v[188:191], v[148:163]
 ds_read_b128 v[220:223], v7 offset:3856
 s_waitcnt lgkmcnt(7)
 v_mfma_f32_32x32x16_bf16 v[164:179], v[192:195], v[184:187], v[164:179]
 ds_read_b128 v[224:227], v6 offset:3136
 s_waitcnt lgkmcnt(6)
 v_mfma_f32_32x32x16_bf16 v[132:147], v[196:199], v[200:203], v[132:147]
 ds_read_b128 v[180:183], v6 offset:1184
 ds_read_b128 v[184:187], v7 offset:224
 s_waitcnt lgkmcnt(7)
 v_mfma_f32_32x32x16_bf16 v[148:163], v[196:199], v[204:207], v[148:163]
 ds_read_b128 v[188:191], v7 offset:736
 s_waitcnt lgkmcnt(7)
 v_mfma_f32_32x32x16_bf16 v[164:179], v[208:211], v[200:203], v[164:179]
 ds_read_b128 v[192:195], v6 offset:3232
 s_waitcnt lgkmcnt(6)
 v_mfma_f32_32x32x16_bf16 v[132:147], v[212:215], v[216:219], v[132:147]
 ds_read_b128 v[196:199], v6 offset:1152
 ds_read_b128 v[200:203], v7 offset:3328
 s_waitcnt lgkmcnt(7)
 v_mfma_f32_32x32x16_bf16 v[148:163], v[212:215], v[220:223], v[148:163]
 ds_read_b128 v[204:207], v7 offset:3840
 s_waitcnt lgkmcnt(7)
 v_mfma_f32_32x32x16_bf16 v[164:179], v[224:227], v[216:219], v[164:179]
 ds_read_b128 v[208:211], v6 offset:3200
 s_waitcnt lgkmcnt(6)
 v_mfma_f32_32x32x16_bf16 v[132:147], v[180:183], v[184:187], v[132:147]
 ds_read_b128 v[212:215], v6 offset:1248
 ds_read_b128 v[216:219], v7 offset:208
 s_waitcnt lgkmcnt(7)
 v_mfma_f32_32x32x16_bf16 v[148:163], v[180:183], v[188:191], v[148:163]
 ds_read_b128 v[220:223], v7 offset:720
 s_waitcnt lgkmcnt(7)
 v_mfma_f32_32x32x16_bf16 v[164:179], v[192:195], v[184:187], v[164:179]
 ds_read_b128 v[224:227], v6 offset:3296
 s_waitcnt lgkmcnt(6)
 v_mfma_f32_32x32x16_bf16 v[132:147], v[196:199], v[200:203], v[132:147]
 ds_read_b128 v[180:183], v6 offset:1216
 ds_read_b128 v[184:187], v7 offset:3312
 s_waitcnt lgkmcnt(7)
 v_mfma_f32_32x32x16_bf16 v[148:163], v[196:199], v[204:207], v[148:163]
 ds_read_b128 v[188:191], v7 offset:3824
 s_waitcnt lgkmcnt(7)
 v_mfma_f32_32x32x16_bf16 v[164:179], v[208:211], v[200:203], v[164:179]
 ds_read_b128 v[192:195], v6 offset:3264
 s_waitcnt lgkmcnt(6)
 v_mfma_f32_32x32x16_bf16 v[132:147], v[212:215], v[216:219], v[132:147]
 ds_read_b128 v[196:199], v6 offset:1312
 ds_read_b128 v[200:203], v7 offset:192
 s_waitcnt lgkmcnt(7)
 v_mfma_f32_32x32x16_bf16 v[148:163], v[212:215], v[220:223], v[148:163]
 ds_read_b128 v[204:207], v7 offset:704
 s_waitcnt lgkmcnt(7)
 v_mfma_f32_32x32x16_bf16 v[164:179], v[224:227], v[216:219], v[164:179]
 ds_read_b128 v[208:211], v6 offset:3360
 s_waitcnt lgkmcnt(6)
 v_mfma_f32_32x32x16_bf16 v[132:147], v[180:183], v[184:187], v[132:147]
 ds_read_b128 v[212:215], v6 offset:1280
 ds_read_b128 v[216:219], v7 offset:3296
 s_waitcnt lgkmcnt(7)
 v_mfma_f32_32x32x16_bf16 v[148:163], v[180:183], v[188:191], v[148:163]
 ds_read_b128 v[220:223], v7 offset:3808
 s_waitcnt lgkmcnt(7)
 v_mfma_f32_32x32x16_bf16 v[164:179], v[192:195], v[184:187], v[164:179]
 ds_read_b128 v[224:227], v6 offset:3328
 s_waitcnt lgkmcnt(6)
 v_mfma_f32_32x32x16_bf16 v[132:147], v[196:199], v[200:203], v[132:147]
 ds_read_b128 v[180:183], v6 offset:1376
 ds_read_b128 v[184:187], v7 offset:176
 s_waitcnt lgkmcnt(7)
 v_mfma_f32_32x32x16_bf16 v[148:163], v[196:199], v[204:207], v[148:163]
 ds_read_b128 v[188:191], v7 offset:688
 s_waitcnt lgkmcnt(7)
 v_mfma_f32_32x32x16_bf16 v[164:179], v[208:211], v[200:203], v[164:179]
 ds_read_b128 v[192:195], v6 offset:3424
 s_waitcnt lgkmcnt(6)
 v_mfma_f32_32x32x16_bf16 v[132:147], v[212:215], v[216:219], v[132:147]
 ds_read_b128 v[196:199], v6 offset:1344
 ds_read_b128 v[200:203], v7 offset:3280
 s_waitcnt lgkmcnt(7)
 v_mfma_f32_32x32x16_bf16 v[148:163], v[212:215], v[220:223], v[148:163]
 ds_read_b128 v[204:207], v7 offset:3792
 s_waitcnt lgkmcnt(7)
 v_mfma_f32_32x32x16_bf16 v[164:179], v[224:227], v[216:219], v[164:179]
 ds_read_b128 v[208:211], v6 offset:3392
 s_waitcnt lgkmcnt(6)
 v_mfma_f32_32x32x16_bf16 v[132:147], v[180:183], v[184:187], v[132:147]
 ds_read_b128 v[212:215], v6 offset:1440
 ds_read_b128 v[216:219], v7 offset:160
 s_waitcnt lgkmcnt(7)
 v_mfma_f32_32x32x16_bf16 v[148:163], v[180:183], v[188:191], v[148:163]
 ds_read_b128 v[220:223], v7 offset:672
 s_waitcnt lgkmcnt(7)
 v_mfma_f32_32x32x16_bf16 v[164:179], v[192:195], v[184:187], v[164:179]
 ds_read_b128 v[224:227], v6 offset:3488
 s_waitcnt lgkmcnt(6)
 v_mfma_f32_32x32x16_bf16 v[132:147], v[196:199], v[200:203], v[132:147]
 ds_read_b128 v[180:183], v6 offset:1408
 ds_read_b128 v[184:187], v7 offset:3264
 s_waitcnt lgkmcnt(7)
 v_mfma_f32_32x32x16_bf16 v[148:163], v[196:199], v[204:207], v[148:163]
 ds_read_b128 v[188:191], v7 offset:3776
 s_waitcnt lgkmcnt(7)
 v_mfma_f32_32x32x16_bf16 v[164:179], v[208:211], v[200:203], v[164:179]
 ds_read_b128 v[192:195], v6 offset:3456
 s_waitcnt lgkmcnt(6)
 v_mfma_f32_32x32x16_bf16 v[132:147], v[212:215], v[216:219], v[132:147]
 ds_read_b128 v[196:199], v6 offset:1504
 ds_read_b128 v[200:203], v7 offset:144
 s_waitcnt lgkmcnt(7)
 v_mfma_f32_32x32x16_bf16 v[148:163], v[212:215], v[220:223], v[148:163]
 ds_read_b128 v[204:207], v7 offset:656
 s_waitcnt lgkmcnt(7)
 v_mfma_f32_32x32x16_bf16 v[164:179], v[224:227], v[216:219], v[164:179]
 ds_read_b128 v[208:211], v6 offset:3552
 s_waitcnt lgkmcnt(6)
 v_mfma_f32_32x32x16_bf16 v[132:147], v[180:183], v[184:187], v[132:147]
 ds_read_b128 v[212:215], v6 offset:1472
 ds_read_b128 v[216:219], v7 offset:3248
 s_waitcnt lgkmcnt(7)
 v_mfma_f32_32x32x16_bf16 v[148:163], v[180:183], v[188:191], v[148:163]
 ds_read_b128 v[220:223], v7 offset:3760
 s_waitcnt lgkmcnt(7)
 v_mfma_f32_32x32x16_bf16 v[164:179], v[192:195], v[184:187], v[164:179]
 ds_read_b128 v[224:227], v6 offset:3520
 s_waitcnt lgkmcnt(6)
 v_mfma_f32_32x32x16_bf16 v[132:147], v[196:199], v[200:203], v[132:147]
 ds_read_b128 v[180:183], v6 offset:1568
 ds_read_b128 v[184:187], v7 offset:128
 s_waitcnt lgkmcnt(7)
 v_mfma_f32_32x32x16_bf16 v[148:163], v[196:199], v[204:207], v[148:163]
 ds_read_b128 v[188:191], v7 offset:640
 s_waitcnt lgkmcnt(7)
 v_mfma_f32_32x32x16_bf16 v[164:179], v[208:211], v[200:203], v[164:179]
 ds_read_b128 v[192:195], v6 offset:3616
 s_waitcnt lgkmcnt(6)
 v_mfma_f32_32x32x16_bf16 v[132:147], v[212:215], v[216:219], v[132:147]
 ds_read_b128 v[196:199], v6 offset:1536
 ds_read_b128 v[200:203], v7 offset:3232
 s_waitcnt lgkmcnt(7)
 v_mfma_f32_32x32x16_bf16 v[148:163], v[212:215], v[220:223], v[148:163]
 ds_read_b128 v[204:207], v7 offset:3744
 s_waitcnt lgkmcnt(7)
 v_mfma_f32_32x32x16_bf16 v[164:179], v[224:227], v[216:219], v[164:179]
 ds_read_b128 v[208:211], v6 offset:3584
 s_waitcnt lgkmcnt(6)
 v_mfma_f32_32x32x16_bf16 v[132:147], v[180:183], v[184:187], v[132:147]
 ds_read_b128 v[212:215], v6 offset:1632
 ds_read_b128 v[216:219], v7 offset:112
 s_waitcnt lgkmcnt(7)
 v_mfma_f32_32x32x16_bf16 v[148:163], v[180:183], v[188:191], v[148:163]
 ds_read_b128 v[220:223], v7 offset:624
 s_waitcnt lgkmcnt(7)
 v_mfma_f32_32x32x16_bf16 v[164:179], v[192:195], v[184:187], v[164:179]
 ds_read_b128 v[224:227], v6 offset:3680
 s_waitcnt lgkmcnt(6)
 v_mfma_f32_32x32x16_bf16 v[132:147], v[196:199], v[200:203], v[132:147]
 ds_read_b128 v[180:183], v6 offset:1600
 ds_read_b128 v[184:187], v7 offset:3216
 s_waitcnt lgkmcnt(7)
 v_mfma_f32_32x32x16_bf16 v[148:163], v[196:199], v[204:207], v[148:163]
 ds_read_b128 v[188:191], v7 offset:3728
 s_waitcnt lgkmcnt(7)
 v_mfma_f32_32x32x16_bf16 v[164:179], v[208:211], v[200:203], v[164:179]
 ds_read_b128 v[192:195], v6 offset:3648
 s_waitcnt lgkmcnt(6)
 v_mfma_f32_32x32x16_bf16 v[132:147], v[212:215], v[216:219], v[132:147]
 ds_read_b128 v[196:199], v6 offset:1696
 ds_read_b128 v[200:203], v7 offset:96
 s_waitcnt lgkmcnt(7)
 v_mfma_f32_32x32x16_bf16 v[148:163], v[212:215], v[220:223], v[148:163]
 ds_read_b128 v[204:207], v7 offset:608
 s_waitcnt lgkmcnt(7)
 v_mfma_f32_32x32x16_bf16 v[164:179], v[224:227], v[216:219], v[164:179]
 ds_read_b128 v[208:211], v6 offset:3744
 s_waitcnt lgkmcnt(6)
 v_mfma_f32_32x32x16_bf16 v[132:147], v[180:183], v[184:187], v[132:147]
 ds_read_b128 v[212:215], v6 offset:1664
 ds_read_b128 v[216:219], v7 offset:3200
 s_waitcnt lgkmcnt(7)
 v_mfma_f32_32x32x16_bf16 v[148:163], v[180:183], v[188:191], v[148:163]
 ds_read_b128 v[220:223], v7 offset:3712
 s_waitcnt lgkmcnt(7)
 v_mfma_f32_32x32x16_bf16 v[164:179], v[192:195], v[184:187], v[164:179]
 ds_read_b128 v[224:227], v6 offset:3712
 s_waitcnt lgkmcnt(6)
 v_mfma_f32_32x32x16_bf16 v[132:147], v[196:199], v[200:203], v[132:147]
 ds_read_b128 v[180:183], v6 offset:1760
 ds_read_b128 v[184:187], v7 offset:80
 s_waitcnt lgkmcnt(7)
 v_mfma_f32_32x32x16_bf16 v[148:163], v[196:199], v[204:207], v[148:163]
 ds_read_b128 v[188:191], v7 offset:592
 s_waitcnt lgkmcnt(7)
 v_mfma_f32_32x32x16_bf16 v[164:179], v[208:211], v[200:203], v[164:179]
 ds_read_b128 v[192:195], v6 offset:3808
 s_waitcnt lgkmcnt(6)
 v_mfma_f32_32x32x16_bf16 v[132:147], v[212:215], v[216:219], v[132:147]
 ds_read_b128 v[196:199], v6 offset:1728
 ds_read_b128 v[200:203], v7 offset:3184
 s_waitcnt lgkmcnt(7)
 v_mfma_f32_32x32x16_bf16 v[148:163], v[212:215], v[220:223], v[148:163]
 ds_read_b128 v[204:207], v7 offset:3696
 s_waitcnt lgkmcnt(7)
 v_mfma_f32_32x32x16_bf16 v[164:179], v[224:227], v[216:219], v[164:179]
 ds_read_b128 v[208:211], v6 offset:3776
 s_waitcnt lgkmcnt(6)
 v_mfma_f32_32x32x16_bf16 v[132:147], v[180:183], v[184:187], v[132:147]
 ds_read_b128 v[212:215], v6 offset:1824
 ds_read_b128 v[216:219], v7 offset:64
 s_waitcnt lgkmcnt(7)
 v_mfma_f32_32x32x16_bf16 v[148:163], v[180:183], v[188:191], v[148:163]
 ds_read_b128 v[220:223], v7 offset:576
 s_waitcnt lgkmcnt(7)
 v_mfma_f32_32x32x16_bf16 v[164:179], v[192:195], v[184:187], v[164:179]
 ds_read_b128 v[224:227], v6 offset:3872
 s_waitcnt lgkmcnt(6)
 v_mfma_f32_32x32x16_bf16 v[132:147], v[196:199], v[200:203], v[132:147]
 ds_read_b128 v[180:183], v6 offset:1792
 ds_read_b128 v[184:187], v7 offset:3168
 s_waitcnt lgkmcnt(7)
 v_mfma_f32_32x32x16_bf16 v[148:163], v[196:199], v[204:207], v[148:163]
 ds_read_b128 v[188:191], v7 offset:3680
 s_waitcnt lgkmcnt(7)
 v_mfma_f32_32x32x16_bf16 v[164:179], v[208:211], v[200:203], v[164:179]
 ds_read_b128 v[192:195], v6 offset:3840
 s_waitcnt lgkmcnt(6)
 v_mfma_f32_32x32x16_bf16 v[132:147], v[212:215], v[216:219], v[132:147]
 ds_read_b128 v[196:199], v6 offset:1888
 ds_read_b128 v[200:203], v7 offset:48
 s_waitcnt lgkmcnt(7)
 v_mfma_f32_32x32x16_bf16 v[148:163], v[212:215], v[220:223], v[148:163]
 ds_read_b128 v[204:207], v7 offset:560
 s_waitcnt lgkmcnt(7)
 v_mfma_f32_32x32x16_bf16 v[164:179], v[224:227], v[216:219], v[164:179]
 ds_read_b128 v[208:211], v6 offset:3936
 s_waitcnt lgkmcnt(6)
 v_mfma_f32_32x32x16_bf16 v[132:147], v[180:183], v[184:187], v[132:147]
 ds_read_b128 v[212:215], v6 offset:1856
 ds_read_b128 v[216:219], v7 offset:3152
 s_waitcnt lgkmcnt(7)
 v_mfma_f32_32x32x16_bf16 v[148:163], v[180:183], v[188:191], v[148:163]
 ds_read_b128 v[220:223], v7 offset:3664
 s_waitcnt lgkmcnt(7)
 v_mfma_f32_32x32x16_bf16 v[164:179], v[192:195], v[184:187], v[164:179]
 ds_read_b128 v[224:227], v6 offset:3904
 s_waitcnt lgkmcnt(6)
 v_mfma_f32_32x32x16_bf16 v[132:147], v[196:199], v[200:203], v[132:147]
 ds_read_b128 v[180:183], v6 offset:1952
 ds_read_b128 v[184:187], v7 offset:32
 s_waitcnt lgkmcnt(7)
 v_mfma_f32_32x32x16_bf16 v[148:163], v[196:199], v[204:207], v[148:163]
 ds_read_b128 v[188:191], v7 offset:544
 s_waitcnt lgkmcnt(7)
 v_mfma_f32_32x32x16_bf16 v[164:179], v[208:211], v[200:203], v[164:179]
 ds_read_b128 v[192:195], v6 offset:4000
 s_waitcnt lgkmcnt(6)
 v_mfma_f32_32x32x16_bf16 v[132:147], v[212:215], v[216:219], v[132:147]
 ds_read_b128 v[196:199], v6 offset:1920
 ds_read_b128 v[200:203], v7 offset:3136
 s_waitcnt lgkmcnt(7)
 v_mfma_f32_32x32x16_bf16 v[148:163], v[212:215], v[220:223], v[148:163]
 ds_read_b128 v[204:207], v7 offset:3648
 s_waitcnt lgkmcnt(7)
 v_mfma_f32_32x32x16_bf16 v[164:179], v[224:227], v[216:219], v[164:179]
 ds_read_b128 v[208:211], v6 offset:3968
 s_waitcnt lgkmcnt(6)
 v_mfma_f32_32x32x16_bf16 v[132:147], v[180:183], v[184:187], v[132:147]
 ds_read_b128 v[212:215], v6 offset:2016
 ds_read_b128 v[216:219], v7 offset:16
 s_waitcnt lgkmcnt(7)
 v_mfma_f32_32x32x16_bf16 v[148:163], v[180:183], v[188:191], v[148:163]
 ds_read_b128 v[220:223], v7 offset:528
 s_waitcnt lgkmcnt(7)
 v_mfma_f32_32x32x16_bf16 v[164:179], v[192:195], v[184:187], v[164:179]
 ds_read_b128 v[224:227], v6 offset:4064
 s_waitcnt lgkmcnt(6)
 v_mfma_f32_32x32x16_bf16 v[132:147], v[196:199], v[200:203], v[132:147]
 ds_read_b128 v[180:183], v6 offset:1984
 ds_read_b128 v[184:187], v7 offset:3120
 s_waitcnt lgkmcnt(7)
 v_mfma_f32_32x32x16_bf16 v[148:163], v[196:199], v[204:207], v[148:163]
 ds_read_b128 v[188:191], v7 offset:3632
 s_waitcnt lgkmcnt(7)
 v_mfma_f32_32x32x16_bf16 v[164:179], v[208:211], v[200:203], v[164:179]
 ds_read_b128 v[192:195], v6 offset:4032
 s_waitcnt lgkmcnt(6)
 v_mfma_f32_32x32x16_bf16 v[132:147], v[212:215], v[216:219], v[132:147]
 s_waitcnt lgkmcnt(5)
 v_mfma_f32_32x32x16_bf16 v[148:163], v[212:215], v[220:223], v[148:163]
 s_waitcnt lgkmcnt(4)
 v_mfma_f32_32x32x16_bf16 v[164:179], v[224:227], v[216:219], v[164:179]
 s_waitcnt lgkmcnt(2)
 v_mfma_f32_32x32x16_bf16 v[132:147], v[180:183], v[184:187], v[132:147]
 s_waitcnt lgkmcnt(1)
 v_mfma_f32_32x32x16_bf16 v[148:163], v[180:183], v[188:191], v[148:163]
 s_waitcnt lgkmcnt(0)
 v_mfma_f32_32x32x16_bf16 v[164:179], v[192:195], v[184:187], v[164:179]
 s_lshl_b32 s54, s6, 12
 s_add_u32 s54, s54, 93323264
 s_barrier
 ds_write_b128 v1, v[48:51] offset:0
 ds_write_b128 v1, v[52:55] offset:6208
 ds_write_b128 v1, v[56:59] offset:12416
 ds_write_b128 v1, v[60:63] offset:18624
 s_nop 4
 v_add_f32 v148, v148, v164
 v_add_f32 v149, v149, v165
 v_add_f32 v150, v150, v166
 v_add_f32 v151, v151, v167
 v_add_f32 v152, v152, v168
 v_add_f32 v153, v153, v169
 v_add_f32 v154, v154, v170
 v_add_f32 v155, v155, v171
 v_add_f32 v156, v156, v172
 v_add_f32 v157, v157, v173
 v_add_f32 v158, v158, v174
 v_add_f32 v159, v159, v175
 v_add_f32 v160, v160, v176
 v_add_f32 v161, v161, v177
 v_add_f32 v162, v162, v178
 v_add_f32 v163, v163, v179
 v_cvt_pk_bf16_f32 v132, v132, v133
 v_cvt_pk_bf16_f32 v133, v134, v135
 v_cvt_pk_bf16_f32 v134, v136, v137
 v_cvt_pk_bf16_f32 v135, v138, v139
 s_nop 0
 v_permlane32_swap_b32 v132, v134
 v_permlane32_swap_b32 v133, v135
 buffer_store_dwordx4 v[132:135], v10, s[8:11], s54 offen offset:0 sc1
 v_cvt_pk_bf16_f32 v140, v140, v141
 v_cvt_pk_bf16_f32 v141, v142, v143
 v_cvt_pk_bf16_f32 v142, v144, v145
 v_cvt_pk_bf16_f32 v143, v146, v147
 s_nop 0
 v_permlane32_swap_b32 v140, v142
 v_permlane32_swap_b32 v141, v143
 buffer_store_dwordx4 v[140:143], v10, s[8:11], s54 offen offset:32 sc1
 v_cvt_pk_bf16_f32 v148, v148, v149
 v_cvt_pk_bf16_f32 v149, v150, v151
 v_cvt_pk_bf16_f32 v150, v152, v153
 v_cvt_pk_bf16_f32 v151, v154, v155
 s_nop 0
 v_permlane32_swap_b32 v148, v150
 v_permlane32_swap_b32 v149, v151
 buffer_store_dwordx4 v[148:151], v10, s[8:11], s54 offen offset:2048 sc1
 v_cvt_pk_bf16_f32 v156, v156, v157
 v_cvt_pk_bf16_f32 v157, v158, v159
 v_cvt_pk_bf16_f32 v158, v160, v161
 v_cvt_pk_bf16_f32 v159, v162, v163
 s_nop 0
 v_permlane32_swap_b32 v156, v158
 v_permlane32_swap_b32 v157, v159
 buffer_store_dwordx4 v[156:159], v10, s[8:11], s54 offen offset:2080 sc1
 s_add_u32 s6, s6, 4
 s_add_u32 s60, s60, 1
 s_cmp_lt_u32 s60, 2
 s_waitcnt vmcnt(0)
 s_waitcnt lgkmcnt(0)
 s_barrier
 s_cbranch_scc1 CONVR
 s_cmp_eq_u32 s4, 0
 s_cbranch_scc0 OUT
 v_mov_b32 v9, 1
 s_mov_b64 exec, 1
 buffer_atomic_add v9, off, s[12:15], 0 offset:160 sc1
 s_mov_b64 exec, -1
OUT:
 s_sub_u32 s54, s5, 5
 s_lshl_b32 s54, s54, 5
 s_add_u32 s57, s54, s3
 s_mul_i32 s6, s57, 43
 s_lshr_b32 s6, s6, 9
 s_mul_i32 s54, s6, 12
 s_sub_u32 s7, s57, s54
 s_mul_i32 s54, s7, 96
 s_mul_i32 s55, s4, 1179648
 s_add_u32 s54, s54, s55
 s_mul_i32 s43, s4, 36864
 v_add_u32 v9, 0, v8
 v_mul_u32_u24 v10, 171, v9
 v_lshrrev_b32 v10, 10, v10
 v_mul_u32_u24 v11, 1056, v10
 v_lshl_add_u32 v11, v9, 4, v11
 v_add_u32 v0, s54, v11
 v_add_u32 v9, 64, v8
 v_mul_u32_u24 v10, 171, v9
 v_lshrrev_b32 v10, 10, v10
 v_mul_u32_u24 v11, 1056, v10
 v_lshl_add_u32 v11, v9, 4, v11
 v_add_u32 v1, s54, v11
 v_add_u32 v9, 128, v8
 v_mul_u32_u24 v10, 171, v9
 v_lshrrev_b32 v10, 10, v10
 v_mul_u32_u24 v11, 1056, v10
 v_lshl_add_u32 v11, v9, 4, v11
 v_add_u32 v2, s54, v11
 v_mov_b32 v3, s43
 v_bfe_u32 v9, v8, 5, 1
 s_mov_b32 s101, 1536
 v_mad_u32_u24 v3, v9, s101, v3
 v_bfe_u32 v9, v8, 4, 1
 s_mov_b32 s101, 384
 v_mad_u32_u24 v3, v9, s101, v3
 v_bfe_u32 v9, v8, 2, 2
 s_mov_b32 s101, 96
 v_mad_u32_u24 v3, v9, s101, v3
 v_bfe_u32 v9, v8, 0, 2
 v_lshl_add_u32 v3, v9, 3, v3
 s_add_u32 m0, s43, 0
 s_mov_b32 s54, 0
 buffer_load_dwordx4 v0, s[20:23], s54 offen lds
 s_add_u32 m0, s43, 1024
 s_mov_b32 s54, 0
 buffer_load_dwordx4 v1, s[20:23], s54 offen lds
 s_add_u32 m0, s43, 2048
 s_mov_b32 s54, 0
 buffer_load_dwordx4 v2, s[20:23], s54 offen lds
 s_add_u32 m0, s43, 3072
 s_mov_b32 s54, 36864
 buffer_load_dwordx4 v0, s[20:23], s54 offen lds
 s_add_u32 m0, s43, 4096
 s_mov_b32 s54, 36864
 buffer_load_dwordx4 v1, s[20:23], s54 offen lds
 s_add_u32 m0, s43, 5120
 s_mov_b32 s54, 36864
 buffer_load_dwordx4 v2, s[20:23], s54 offen lds
 s_add_u32 m0, s43, 6144
 s_mov_b32 s54, 73728
 buffer_load_dwordx4 v0, s[20:23], s54 offen lds
 s_add_u32 m0, s43, 7168
 s_mov_b32 s54, 73728
 buffer_load_dwordx4 v1, s[20:23], s54 offen lds
 s_add_u32 m0, s43, 8192
 s_mov_b32 s54, 73728
 buffer_load_dwordx4 v2, s[20:23], s54 offen lds
 s_add_u32 m0, s43, 9216
 s_mov_b32 s54, 110592
 buffer_load_dwordx4 v0, s[20:23], s54 offen lds
 s_add_u32 m0, s43, 10240
 s_mov_b32 s54, 110592
 buffer_load_dwordx4 v1, s[20:23], s54 offen lds
 s_add_u32 m0, s43, 11264
 s_mov_b32 s54, 110592
 buffer_load_dwordx4 v2, s[20:23], s54 offen lds
 s_add_u32 m0, s43, 12288
 s_mov_b32 s54, 147456
 buffer_load_dwordx4 v0, s[20:23], s54 offen lds
 s_add_u32 m0, s43, 13312
 s_mov_b32 s54, 147456
 buffer_load_dwordx4 v1, s[20:23], s54 offen lds
 s_add_u32 m0, s43, 14336
 s_mov_b32 s54, 147456
 buffer_load_dwordx4 v2, s[20:23], s54 offen lds
 s_add_u32 m0, s43, 15360
 s_mov_b32 s54, 184320
 buffer_load_dwordx4 v0, s[20:23], s54 offen lds
 s_add_u32 m0, s43, 16384
 s_mov_b32 s54, 184320
 buffer_load_dwordx4 v1, s[20:23], s54 offen lds
 s_add_u32 m0, s43, 17408
 s_mov_b32 s54, 184320
 buffer_load_dwordx4 v2, s[20:23], s54 offen lds
 s_add_u32 m0, s43, 18432
 s_mov_b32 s54, 221184
 buffer_load_dwordx4 v0, s[20:23], s54 offen lds
 s_add_u32 m0, s43, 19456
 s_mov_b32 s54, 221184
 buffer_load_dwordx4 v1, s[20:23], s54 offen lds
 s_add_u32 m0, s43, 20480
 s_mov_b32 s54, 221184
 buffer_load_dwordx4 v2, s[20:23], s54 offen lds
 s_add_u32 m0, s43, 21504
 s_mov_b32 s54, 258048
 buffer_load_dwordx4 v0, s[20:23], s54 offen lds
 s_add_u32 m0, s43, 22528
 s_mov_b32 s54, 258048
 buffer_load_dwordx4 v1, s[20:23], s54 offen lds
 s_add_u32 m0, s43, 23552
 s_mov_b32 s54, 258048
 buffer_load_dwordx4 v2, s[20:23], s54 offen lds
 s_add_u32 m0, s43, 24576
 s_mov_b32 s54, 294912
 buffer_load_dwordx4 v0, s[20:23], s54 offen lds
 s_add_u32 m0, s43, 25600
 s_mov_b32 s54, 294912
 buffer_load_dwordx4 v1, s[20:23], s54 offen lds
 s_add_u32 m0, s43, 26624
 s_mov_b32 s54, 294912
 buffer_load_dwordx4 v2, s[20:23], s54 offen lds
 s_add_u32 m0, s43, 27648
 s_mov_b32 s54, 331776
 buffer_load_dwordx4 v0, s[20:23], s54 offen lds
 s_add_u32 m0, s43, 28672
 s_mov_b32 s54, 331776
 buffer_load_dwordx4 v1, s[20:23], s54 offen lds
 s_add_u32 m0, s43, 29696
 s_mov_b32 s54, 331776
 buffer_load_dwordx4 v2, s[20:23], s54 offen lds
 s_add_u32 m0, s43, 30720
 s_mov_b32 s54, 368640
 buffer_load_dwordx4 v0, s[20:23], s54 offen lds
 s_add_u32 m0, s43, 31744
 s_mov_b32 s54, 368640
 buffer_load_dwordx4 v1, s[20:23], s54 offen lds
 s_add_u32 m0, s43, 32768
 s_mov_b32 s54, 368640
 buffer_load_dwordx4 v2, s[20:23], s54 offen lds
 s_add_u32 m0, s43, 33792
 s_mov_b32 s54, 405504
 buffer_load_dwordx4 v0, s[20:23], s54 offen lds
 s_add_u32 m0, s43, 34816
 s_mov_b32 s54, 405504
 buffer_load_dwordx4 v1, s[20:23], s54 offen lds
 s_add_u32 m0, s43, 35840
 s_mov_b32 s54, 405504
 buffer_load_dwordx4 v2, s[20:23], s54 offen lds
 s_waitcnt vmcnt(30)
 ds_read_b64_tr_b16 v[128:129], v3 offset:0
 ds_read_b64_tr_b16 v[130:131], v3 offset:768
 ds_read_b64_tr_b16 v[132:133], v3 offset:32
 ds_read_b64_tr_b16 v[134:135], v3 offset:800
 ds_read_b64_tr_b16 v[136:137], v3 offset:64
 ds_read_b64_tr_b16 v[138:139], v3 offset:832
 ds_read_b64_tr_b16 v[140:141], v3 offset:3072
 ds_read_b64_tr_b16 v[142:143], v3 offset:3840
 ds_read_b64_tr_b16 v[144:145], v3 offset:3104
 ds_read_b64_tr_b16 v[146:147], v3 offset:3872
 ds_read_b64_tr_b16 v[148:149], v3 offset:3136
 ds_read_b64_tr_b16 v[150:151], v3 offset:3904
 s_waitcnt lgkmcnt(0)
 s_add_u32 m0, s43, 0
 s_mov_b32 s54, 442368
 buffer_load_dwordx4 v0, s[20:23], s54 offen lds
 s_add_u32 m0, s43, 1024
 s_mov_b32 s54, 442368
 buffer_load_dwordx4 v1, s[20:23], s54 offen lds
 s_add_u32 m0, s43, 2048
 s_mov_b32 s54, 442368
 buffer_load_dwordx4 v2, s[20:23], s54 offen lds
 s_add_u32 m0, s43, 3072
 s_mov_b32 s54, 479232
 buffer_load_dwordx4 v0, s[20:23], s54 offen lds
 s_add_u32 m0, s43, 4096
 s_mov_b32 s54, 479232
 buffer_load_dwordx4 v1, s[20:23], s54 offen lds
 s_add_u32 m0, s43, 5120
 s_mov_b32 s54, 479232
 buffer_load_dwordx4 v2, s[20:23], s54 offen lds
 s_waitcnt vmcnt(30)
 ds_read_b64_tr_b16 v[152:153], v3 offset:6144
 ds_read_b64_tr_b16 v[154:155], v3 offset:6912
 ds_read_b64_tr_b16 v[156:157], v3 offset:6176
 ds_read_b64_tr_b16 v[158:159], v3 offset:6944
 ds_read_b64_tr_b16 v[160:161], v3 offset:6208
 ds_read_b64_tr_b16 v[162:163], v3 offset:6976
 ds_read_b64_tr_b16 v[164:165], v3 offset:9216
 ds_read_b64_tr_b16 v[166:167], v3 offset:9984
 ds_read_b64_tr_b16 v[168:169], v3 offset:9248
 ds_read_b64_tr_b16 v[170:171], v3 offset:10016
 ds_read_b64_tr_b16 v[172:173], v3 offset:9280
 ds_read_b64_tr_b16 v[174:175], v3 offset:10048
 s_waitcnt lgkmcnt(0)
 s_add_u32 m0, s43, 6144
 s_mov_b32 s54, 516096
 buffer_load_dwordx4 v0, s[20:23], s54 offen lds
 s_add_u32 m0, s43, 7168
 s_mov_b32 s54, 516096
 buffer_load_dwordx4 v1, s[20:23], s54 offen lds
 s_add_u32 m0, s43, 8192
 s_mov_b32 s54, 516096
 buffer_load_dwordx4 v2, s[20:23], s54 offen lds
 s_add_u32 m0, s43, 9216
 s_mov_b32 s54, 552960
 buffer_load_dwordx4 v0, s[20:23], s54 offen lds
 s_add_u32 m0, s43, 10240
 s_mov_b32 s54, 552960
 buffer_load_dwordx4 v1, s[20:23], s54 offen lds
 s_add_u32 m0, s43, 11264
 s_mov_b32 s54, 552960
 buffer_load_dwordx4 v2, s[20:23], s54 offen lds
 s_waitcnt vmcnt(30)
 ds_read_b64_tr_b16 v[176:177], v3 offset:12288
 ds_read_b64_tr_b16 v[178:179], v3 offset:13056
 ds_read_b64_tr_b16 v[180:181], v3 offset:12320
 ds_read_b64_tr_b16 v[182:183], v3 offset:13088
 ds_read_b64_tr_b16 v[184:185], v3 offset:12352
 ds_read_b64_tr_b16 v[186:187], v3 offset:13120
 ds_read_b64_tr_b16 v[188:189], v3 offset:15360
 ds_read_b64_tr_b16 v[190:191], v3 offset:16128
 ds_read_b64_tr_b16 v[192:193], v3 offset:15392
 ds_read_b64_tr_b16 v[194:195], v3 offset:16160
 ds_read_b64_tr_b16 v[196:197], v3 offset:15424
 ds_read_b64_tr_b16 v[198:199], v3 offset:16192
 s_waitcnt lgkmcnt(0)
 s_add_u32 m0, s43, 12288
 s_mov_b32 s54, 589824
 buffer_load_dwordx4 v0, s[20:23], s54 offen lds
 s_add_u32 m0, s43, 13312
 s_mov_b32 s54, 589824
 buffer_load_dwordx4 v1, s[20:23], s54 offen lds
 s_add_u32 m0, s43, 14336
 s_mov_b32 s54, 589824
 buffer_load_dwordx4 v2, s[20:23], s54 offen lds
 s_add_u32 m0, s43, 15360
 s_mov_b32 s54, 626688
 buffer_load_dwordx4 v0, s[20:23], s54 offen lds
 s_add_u32 m0, s43, 16384
 s_mov_b32 s54, 626688
 buffer_load_dwordx4 v1, s[20:23], s54 offen lds
 s_add_u32 m0, s43, 17408
 s_mov_b32 s54, 626688
 buffer_load_dwordx4 v2, s[20:23], s54 offen lds
 s_waitcnt vmcnt(30)
 ds_read_b64_tr_b16 v[200:201], v3 offset:18432
 ds_read_b64_tr_b16 v[202:203], v3 offset:19200
 ds_read_b64_tr_b16 v[204:205], v3 offset:18464
 ds_read_b64_tr_b16 v[206:207], v3 offset:19232
 ds_read_b64_tr_b16 v[208:209], v3 offset:18496
 ds_read_b64_tr_b16 v[210:211], v3 offset:19264
 ds_read_b64_tr_b16 v[212:213], v3 offset:21504
 ds_read_b64_tr_b16 v[214:215], v3 offset:22272
 ds_read_b64_tr_b16 v[216:217], v3 offset:21536
 ds_read_b64_tr_b16 v[218:219], v3 offset:22304
 ds_read_b64_tr_b16 v[220:221], v3 offset:21568
 ds_read_b64_tr_b16 v[222:223], v3 offset:22336
 s_waitcnt lgkmcnt(0)
 s_add_u32 m0, s43, 18432
 s_mov_b32 s54, 663552
 buffer_load_dwordx4 v0, s[20:23], s54 offen lds
 s_add_u32 m0, s43, 19456
 s_mov_b32 s54, 663552
 buffer_load_dwordx4 v1, s[20:23], s54 offen lds
 s_add_u32 m0, s43, 20480
 s_mov_b32 s54, 663552
 buffer_load_dwordx4 v2, s[20:23], s54 offen lds
 s_add_u32 m0, s43, 21504
 s_mov_b32 s54, 700416
 buffer_load_dwordx4 v0, s[20:23], s54 offen lds
 s_add_u32 m0, s43, 22528
 s_mov_b32 s54, 700416
 buffer_load_dwordx4 v1, s[20:23], s54 offen lds
 s_add_u32 m0, s43, 23552
 s_mov_b32 s54, 700416
 buffer_load_dwordx4 v2, s[20:23], s54 offen lds
 s_waitcnt vmcnt(30)
 ds_read_b64_tr_b16 v[224:225], v3 offset:24576
 ds_read_b64_tr_b16 v[226:227], v3 offset:25344
 ds_read_b64_tr_b16 v[228:229], v3 offset:24608
 ds_read_b64_tr_b16 v[230:231], v3 offset:25376
 ds_read_b64_tr_b16 v[232:233], v3 offset:24640
 ds_read_b64_tr_b16 v[234:235], v3 offset:25408
 ds_read_b64_tr_b16 v[236:237], v3 offset:27648
 ds_read_b64_tr_b16 v[238:239], v3 offset:28416
 ds_read_b64_tr_b16 v[240:241], v3 offset:27680
 ds_read_b64_tr_b16 v[242:243], v3 offset:28448
 ds_read_b64_tr_b16 v[244:245], v3 offset:27712
 ds_read_b64_tr_b16 v[246:247], v3 offset:28480
 s_waitcnt lgkmcnt(0)
 s_add_u32 m0, s43, 24576
 s_mov_b32 s54, 737280
 buffer_load_dwordx4 v0, s[20:23], s54 offen lds
 s_add_u32 m0, s43, 25600
 s_mov_b32 s54, 737280
 buffer_load_dwordx4 v1, s[20:23], s54 offen lds
 s_add_u32 m0, s43, 26624
 s_mov_b32 s54, 737280
 buffer_load_dwordx4 v2, s[20:23], s54 offen lds
 s_add_u32 m0, s43, 27648
 s_mov_b32 s54, 774144
 buffer_load_dwordx4 v0, s[20:23], s54 offen lds
 s_add_u32 m0, s43, 28672
 s_mov_b32 s54, 774144
 buffer_load_dwordx4 v1, s[20:23], s54 offen lds
 s_add_u32 m0, s43, 29696
 s_mov_b32 s54, 774144
 buffer_load_dwordx4 v2, s[20:23], s54 offen lds
 s_waitcnt vmcnt(30)
 ds_read_b64_tr_b16 v[248:249], v3 offset:30720
 ds_read_b64_tr_b16 v[250:251], v3 offset:31488
 ds_read_b64_tr_b16 v[252:253], v3 offset:30752
 ds_read_b64_tr_b16 v[254:255], v3 offset:31520
 ds_read_b64_tr_b16 a[0:1], v3 offset:30784
 ds_read_b64_tr_b16 a[2:3], v3 offset:31552
 ds_read_b64_tr_b16 a[4:5], v3 offset:33792
 ds_read_b64_tr_b16 a[6:7], v3 offset:34560
 ds_read_b64_tr_b16 a[8:9], v3 offset:33824
 ds_read_b64_tr_b16 a[10:11], v3 offset:34592
 ds_read_b64_tr_b16 a[12:13], v3 offset:33856
 ds_read_b64_tr_b16 a[14:15], v3 offset:34624
 s_waitcnt lgkmcnt(0)
 s_add_u32 m0, s43, 30720
 s_mov_b32 s54, 811008
 buffer_load_dwordx4 v0, s[20:23], s54 offen lds
 s_add_u32 m0, s43, 31744
 s_mov_b32 s54, 811008
 buffer_load_dwordx4 v1, s[20:23], s54 offen lds
 s_add_u32 m0, s43, 32768
 s_mov_b32 s54, 811008
 buffer_load_dwordx4 v2, s[20:23], s54 offen lds
 s_add_u32 m0, s43, 33792
 s_mov_b32 s54, 847872
 buffer_load_dwordx4 v0, s[20:23], s54 offen lds
 s_add_u32 m0, s43, 34816
 s_mov_b32 s54, 847872
 buffer_load_dwordx4 v1, s[20:23], s54 offen lds
 s_add_u32 m0, s43, 35840
 s_mov_b32 s54, 847872
 buffer_load_dwordx4 v2, s[20:23], s54 offen lds
 s_waitcnt vmcnt(30)
 ds_read_b64_tr_b16 a[16:17], v3 offset:0
 ds_read_b64_tr_b16 a[18:19], v3 offset:768
 ds_read_b64_tr_b16 a[20:21], v3 offset:32
 ds_read_b64_tr_b16 a[22:23], v3 offset:800
 ds_read_b64_tr_b16 a[24:25], v3 offset:64
 ds_read_b64_tr_b16 a[26:27], v3 offset:832
 ds_read_b64_tr_b16 a[28:29], v3 offset:3072
 ds_read_b64_tr_b16 a[30:31], v3 offset:3840
 ds_read_b64_tr_b16 a[32:33], v3 offset:3104
 ds_read_b64_tr_b16 a[34:35], v3 offset:3872
 ds_read_b64_tr_b16 a[36:37], v3 offset:3136
 ds_read_b64_tr_b16 a[38:39], v3 offset:3904
 s_waitcnt lgkmcnt(0)
 s_add_u32 m0, s43, 0
 s_mov_b32 s54, 884736
 buffer_load_dwordx4 v0, s[20:23], s54 offen lds
 s_add_u32 m0, s43, 1024
 s_mov_b32 s54, 884736
 buffer_load_dwordx4 v1, s[20:23], s54 offen lds
 s_add_u32 m0, s43, 2048
 s_mov_b32 s54, 884736
 buffer_load_dwordx4 v2, s[20:23], s54 offen lds
 s_add_u32 m0, s43, 3072
 s_mov_b32 s54, 921600
 buffer_load_dwordx4 v0, s[20:23], s54 offen lds
 s_add_u32 m0, s43, 4096
 s_mov_b32 s54, 921600
 buffer_load_dwordx4 v1, s[20:23], s54 offen lds
 s_add_u32 m0, s43, 5120
 s_mov_b32 s54, 921600
 buffer_load_dwordx4 v2, s[20:23], s54 offen lds
 s_waitcnt vmcnt(30)
 ds_read_b64_tr_b16 a[40:41], v3 offset:6144
 ds_read_b64_tr_b16 a[42:43], v3 offset:6912
 ds_read_b64_tr_b16 a[44:45], v3 offset:6176
 ds_read_b64_tr_b16 a[46:47], v3 offset:6944
 ds_read_b64_tr_b16 a[48:49], v3 offset:6208
 ds_read_b64_tr_b16 a[50:51], v3 offset:6976
 ds_read_b64_tr_b16 a[52:53], v3 offset:9216
 ds_read_b64_tr_b16 a[54:55], v3 offset:9984
 ds_read_b64_tr_b16 a[56:57], v3 offset:9248
 ds_read_b64_tr_b16 a[58:59], v3 offset:10016
 ds_read_b64_tr_b16 a[60:61], v3 offset:9280
 ds_read_b64_tr_b16 a[62:63], v3 offset:10048
 s_waitcnt lgkmcnt(0)
 s_add_u32 m0, s43, 6144
 s_mov_b32 s54, 958464
 buffer_load_dwordx4 v0, s[20:23], s54 offen lds
 s_add_u32 m0, s43, 7168
 s_mov_b32 s54, 958464
 buffer_load_dwordx4 v1, s[20:23], s54 offen lds
 s_add_u32 m0, s43, 8192
 s_mov_b32 s54, 958464
 buffer_load_dwordx4 v2, s[20:23], s54 offen lds
 s_add_u32 m0, s43, 9216
 s_mov_b32 s54, 995328
 buffer_load_dwordx4 v0, s[20:23], s54 offen lds
 s_add_u32 m0, s43, 10240
 s_mov_b32 s54, 995328
 buffer_load_dwordx4 v1, s[20:23], s54 offen lds
 s_add_u32 m0, s43, 11264
 s_mov_b32 s54, 995328
 buffer_load_dwordx4 v2, s[20:23], s54 offen lds
 s_waitcnt vmcnt(30)
 ds_read_b64_tr_b16 a[64:65], v3 offset:12288
 ds_read_b64_tr_b16 a[66:67], v3 offset:13056
 ds_read_b64_tr_b16 a[68:69], v3 offset:12320
 ds_read_b64_tr_b16 a[70:71], v3 offset:13088
 ds_read_b64_tr_b16 a[72:73], v3 offset:12352
 ds_read_b64_tr_b16 a[74:75], v3 offset:13120
 ds_read_b64_tr_b16 a[76:77], v3 offset:15360
 ds_read_b64_tr_b16 a[78:79], v3 offset:16128
 ds_read_b64_tr_b16 a[80:81], v3 offset:15392
 ds_read_b64_tr_b16 a[82:83], v3 offset:16160
 ds_read_b64_tr_b16 a[84:85], v3 offset:15424
 ds_read_b64_tr_b16 a[86:87], v3 offset:16192
 s_waitcnt lgkmcnt(0)
 s_add_u32 m0, s43, 12288
 s_mov_b32 s54, 1032192
 buffer_load_dwordx4 v0, s[20:23], s54 offen lds
 s_add_u32 m0, s43, 13312
 s_mov_b32 s54, 1032192
 buffer_load_dwordx4 v1, s[20:23], s54 offen lds
 s_add_u32 m0, s43, 14336
 s_mov_b32 s54, 1032192
 buffer_load_dwordx4 v2, s[20:23], s54 offen lds
 s_add_u32 m0, s43, 15360
 s_mov_b32 s54, 1069056
 buffer_load_dwordx4 v0, s[20:23], s54 offen lds
 s_add_u32 m0, s43, 16384
 s_mov_b32 s54, 1069056
 buffer_load_dwordx4 v1, s[20:23], s54 offen lds
 s_add_u32 m0, s43, 17408
 s_mov_b32 s54, 1069056
 buffer_load_dwordx4 v2, s[20:23], s54 offen lds
 s_waitcnt vmcnt(30)
 ds_read_b64_tr_b16 a[88:89], v3 offset:18432
 ds_read_b64_tr_b16 a[90:91], v3 offset:19200
 ds_read_b64_tr_b16 a[92:93], v3 offset:18464
 ds_read_b64_tr_b16 a[94:95], v3 offset:19232
 ds_read_b64_tr_b16 a[96:97], v3 offset:18496
 ds_read_b64_tr_b16 a[98:99], v3 offset:19264
 ds_read_b64_tr_b16 a[100:101], v3 offset:21504
 ds_read_b64_tr_b16 a[102:103], v3 offset:22272
 ds_read_b64_tr_b16 a[104:105], v3 offset:21536
 ds_read_b64_tr_b16 a[106:107], v3 offset:22304
 ds_read_b64_tr_b16 a[108:109], v3 offset:21568
 ds_read_b64_tr_b16 a[110:111], v3 offset:22336
 s_waitcnt lgkmcnt(0)
 s_add_u32 m0, s43, 18432
 s_mov_b32 s54, 1105920
 buffer_load_dwordx4 v0, s[20:23], s54 offen lds
 s_add_u32 m0, s43, 19456
 s_mov_b32 s54, 1105920
 buffer_load_dwordx4 v1, s[20:23], s54 offen lds
 s_add_u32 m0, s43, 20480
 s_mov_b32 s54, 1105920
 buffer_load_dwordx4 v2, s[20:23], s54 offen lds
 s_add_u32 m0, s43, 21504
 s_mov_b32 s54, 1142784
 buffer_load_dwordx4 v0, s[20:23], s54 offen lds
 s_add_u32 m0, s43, 22528
 s_mov_b32 s54, 1142784
 buffer_load_dwordx4 v1, s[20:23], s54 offen lds
 s_add_u32 m0, s43, 23552
 s_mov_b32 s54, 1142784
 buffer_load_dwordx4 v2, s[20:23], s54 offen lds
 s_waitcnt vmcnt(30)
 ds_read_b64_tr_b16 a[112:113], v3 offset:24576
 ds_read_b64_tr_b16 a[114:115], v3 offset:25344
 ds_read_b64_tr_b16 a[116:117], v3 offset:24608
 ds_read_b64_tr_b16 a[118:119], v3 offset:25376
 ds_read_b64_tr_b16 a[120:121], v3 offset:24640
 ds_read_b64_tr_b16 a[122:123], v3 offset:25408
 ds_read_b64_tr_b16 a[124:125], v3 offset:27648
 ds_read_b64_tr_b16 a[126:127], v3 offset:28416
 ds_read_b64_tr_b16 a[128:129], v3 offset:27680
 ds_read_b64_tr_b16 a[130:131], v3 offset:28448
 ds_read_b64_tr_b16 a[132:133], v3 offset:27712
 ds_read_b64_tr_b16 a[134:135], v3 offset:28480
 s_waitcnt lgkmcnt(0)
 s_waitcnt vmcnt(24)
 ds_read_b64_tr_b16 a[136:137], v3 offset:30720
 ds_read_b64_tr_b16 a[138:139], v3 offset:31488
 ds_read_b64_tr_b16 a[140:141], v3 offset:30752
 ds_read_b64_tr_b16 a[142:143], v3 offset:31520
 ds_read_b64_tr_b16 a[144:145], v3 offset:30784
 ds_read_b64_tr_b16 a[146:147], v3 offset:31552
 ds_read_b64_tr_b16 a[148:149], v3 offset:33792
 ds_read_b64_tr_b16 a[150:151], v3 offset:34560
 ds_read_b64_tr_b16 a[152:153], v3 offset:33824
 ds_read_b64_tr_b16 a[154:155], v3 offset:34592
 ds_read_b64_tr_b16 a[156:157], v3 offset:33856
 ds_read_b64_tr_b16 a[158:159], v3 offset:34624
 s_waitcnt lgkmcnt(0)
 s_waitcnt vmcnt(18)
 ds_read_b64_tr_b16 a[160:161], v3 offset:0
 ds_read_b64_tr_b16 a[162:163], v3 offset:768
 ds_read_b64_tr_b16 a[164:165], v3 offset:32
 ds_read_b64_tr_b16 a[166:167], v3 offset:800
 ds_read_b64_tr_b16 a[168:169], v3 offset:64
 ds_read_b64_tr_b16 a[170:171], v3 offset:832
 ds_read_b64_tr_b16 a[172:173], v3 offset:3072
 ds_read_b64_tr_b16 a[174:175], v3 offset:3840
 ds_read_b64_tr_b16 a[176:177], v3 offset:3104
 ds_read_b64_tr_b16 a[178:179], v3 offset:3872
 ds_read_b64_tr_b16 a[180:181], v3 offset:3136
 ds_read_b64_tr_b16 a[182:183], v3 offset:3904
 s_waitcnt lgkmcnt(0)
 s_waitcnt vmcnt(12)
 ds_read_b64_tr_b16 a[184:185], v3 offset:6144
 ds_read_b64_tr_b16 a[186:187], v3 offset:6912
 ds_read_b64_tr_b16 a[188:189], v3 offset:6176
 ds_read_b64_tr_b16 a[190:191], v3 offset:6944
 ds_read_b64_tr_b16 a[192:193], v3 offset:6208
 ds_read_b64_tr_b16 a[194:195], v3 offset:6976
 ds_read_b64_tr_b16 a[196:197], v3 offset:9216
 ds_read_b64_tr_b16 a[198:199], v3 offset:9984
 ds_read_b64_tr_b16 a[200:201], v3 offset:9248
 ds_read_b64_tr_b16 a[202:203], v3 offset:10016
 ds_read_b64_tr_b16 a[204:205], v3 offset:9280
 ds_read_b64_tr_b16 a[206:207], v3 offset:10048
 s_waitcnt lgkmcnt(0)
 s_waitcnt vmcnt(6)
 ds_read_b64_tr_b16 a[208:209], v3 offset:12288
 ds_read_b64_tr_b16 a[210:211], v3 offset:13056
 ds_read_b64_tr_b16 a[212:213], v3 offset:12320
 ds_read_b64_tr_b16 a[214:215], v3 offset:13088
 ds_read_b64_tr_b16 a[216:217], v3 offset:12352
 ds_read_b64_tr_b16 a[218:219], v3 offset:13120
 ds_read_b64_tr_b16 a[220:221], v3 offset:15360
 ds_read_b64_tr_b16 a[222:223], v3 offset:16128
 ds_read_b64_tr_b16 a[224:225], v3 offset:15392
 ds_read_b64_tr_b16 a[226:227], v3 offset:16160
 ds_read_b64_tr_b16 a[228:229], v3 offset:15424
 ds_read_b64_tr_b16 a[230:231], v3 offset:16192
 s_waitcnt lgkmcnt(0)
 s_waitcnt vmcnt(0)
 ds_read_b64_tr_b16 a[232:233], v3 offset:18432
 ds_read_b64_tr_b16 a[234:235], v3 offset:19200
 ds_read_b64_tr_b16 a[236:237], v3 offset:18464
 ds_read_b64_tr_b16 a[238:239], v3 offset:19232
 ds_read_b64_tr_b16 a[240:241], v3 offset:18496
 ds_read_b64_tr_b16 a[242:243], v3 offset:19264
 ds_read_b64_tr_b16 a[244:245], v3 offset:21504
 ds_read_b64_tr_b16 a[246:247], v3 offset:22272
 ds_read_b64_tr_b16 a[248:249], v3 offset:21536
 ds_read_b64_tr_b16 a[250:251], v3 offset:22304
 ds_read_b64_tr_b16 a[252:253], v3 offset:21568
 ds_read_b64_tr_b16 a[254:255], v3 offset:22336
 s_waitcnt lgkmcnt(0)
 v_mov_b32 v0, 0
 v_bfe_u32 v9, v8, 0, 2
 v_lshl_add_u32 v0, v9, 4, v0
 v_mov_b32 v1, v0
 v_bfe_u32 v9, v8, 2, 4
 s_mov_b32 s101, 1152
 v_mad_u32_u24 v1, v9, s101, v1
 s_lshl_b32 s54, s4, 5
 s_add_u32 s54, s54, s6
 s_mul_i32 s55, s54, 18432
 v_mov_b32 v12, 0
 v_mov_b32 v13, 0
 v_mov_b32 v14, 0
 v_mov_b32 v15, 0
 buffer_load_dwordx4 v[16:19], v0, s[28:31], 0 offen offset:0
 buffer_load_dwordx4 v[20:23], v0, s[28:31], 0 offen offset:64
 buffer_load_dwordx4 v[24:27], v0, s[28:31], 0 offen offset:128
 buffer_load_dwordx4 v[28:31], v0, s[28:31], 0 offen offset:192
 buffer_load_dwordx4 v[32:35], v0, s[28:31], 0 offen offset:256
 buffer_load_dwordx4 v[36:39], v0, s[28:31], 0 offen offset:320
 buffer_load_dwordx4 v[40:43], v0, s[28:31], 0 offen offset:384
 buffer_load_dwordx4 v[44:47], v0, s[28:31], 0 offen offset:448
 buffer_load_dwordx4 v[48:51], v0, s[28:31], 0 offen offset:512
 s_add_u32 s54, s55, 0
 buffer_load_dwordx4 v[52:55], v1, s[16:19], s54 offen offset:0
 buffer_load_dwordx4 v[56:59], v1, s[16:19], s54 offen offset:64
 buffer_load_dwordx4 v[60:63], v1, s[16:19], s54 offen offset:128
 buffer_load_dwordx4 v[64:67], v1, s[16:19], s54 offen offset:192
 buffer_load_dwordx4 v[68:71], v1, s[16:19], s54 offen offset:256
 buffer_load_dwordx4 v[72:75], v1, s[16:19], s54 offen offset:320
 buffer_load_dwordx4 v[76:79], v1, s[16:19], s54 offen offset:384
 buffer_load_dwordx4 v[80:83], v1, s[16:19], s54 offen offset:448
 buffer_load_dwordx4 v[84:87], v1, s[16:19], s54 offen offset:512
 s_add_u32 s54, s55, 147456
 buffer_load_dwordx4 v[88:91], v1, s[16:19], s54 offen offset:0
 buffer_load_dwordx4 v[92:95], v1, s[16:19], s54 offen offset:64
 buffer_load_dwordx4 v[96:99], v1, s[16:19], s54 offen offset:128
 buffer_load_dwordx4 v[100:103], v1, s[16:19], s54 offen offset:192
 buffer_load_dwordx4 v[104:107], v1, s[16:19], s54 offen offset:256
 buffer_load_dwordx4 v[108:111], v1, s[16:19], s54 offen offset:320
 buffer_load_dwordx4 v[112:115], v1, s[16:19], s54 offen offset:384
 buffer_load_dwordx4 v[116:119], v1, s[16:19], s54 offen offset:448
 buffer_load_dwordx4 v[120:123], v1, s[16:19], s54 offen offset:512
 s_waitcnt vmcnt(17)
 v_dot2_f32_bf16 v12, v52, v16, v12
 v_dot2_f32_bf16 v12, v53, v17, v12
 v_dot2_f32_bf16 v12, v54, v18, v12
 v_dot2_f32_bf16 v12, v55, v19, v12
 s_waitcnt vmcnt(16)
 v_dot2_f32_bf16 v12, v56, v20, v12
 v_dot2_f32_bf16 v12, v57, v21, v12
 v_dot2_f32_bf16 v12, v58, v22, v12
 v_dot2_f32_bf16 v12, v59, v23, v12
 s_waitcnt vmcnt(15)
 v_dot2_f32_bf16 v12, v60, v24, v12
 v_dot2_f32_bf16 v12, v61, v25, v12
 v_dot2_f32_bf16 v12, v62, v26, v12
 v_dot2_f32_bf16 v12, v63, v27, v12
 s_waitcnt vmcnt(14)
 v_dot2_f32_bf16 v12, v64, v28, v12
 v_dot2_f32_bf16 v12, v65, v29, v12
 v_dot2_f32_bf16 v12, v66, v30, v12
 v_dot2_f32_bf16 v12, v67, v31, v12
 s_waitcnt vmcnt(13)
 v_dot2_f32_bf16 v12, v68, v32, v12
 v_dot2_f32_bf16 v12, v69, v33, v12
 v_dot2_f32_bf16 v12, v70, v34, v12
 v_dot2_f32_bf16 v12, v71, v35, v12
 s_waitcnt vmcnt(12)
 v_dot2_f32_bf16 v12, v72, v36, v12
 v_dot2_f32_bf16 v12, v73, v37, v12
 v_dot2_f32_bf16 v12, v74, v38, v12
 v_dot2_f32_bf16 v12, v75, v39, v12
 s_waitcnt vmcnt(11)
 v_dot2_f32_bf16 v12, v76, v40, v12
 v_dot2_f32_bf16 v12, v77, v41, v12
 v_dot2_f32_bf16 v12, v78, v42, v12
 v_dot2_f32_bf16 v12, v79, v43, v12
 s_waitcnt vmcnt(10)
 v_dot2_f32_bf16 v12, v80, v44, v12
 v_dot2_f32_bf16 v12, v81, v45, v12
 v_dot2_f32_bf16 v12, v82, v46, v12
 v_dot2_f32_bf16 v12, v83, v47, v12
 s_waitcnt vmcnt(9)
 v_dot2_f32_bf16 v12, v84, v48, v12
 v_dot2_f32_bf16 v12, v85, v49, v12
 v_dot2_f32_bf16 v12, v86, v50, v12
 v_dot2_f32_bf16 v12, v87, v51, v12
 s_waitcnt vmcnt(8)
 v_dot2_f32_bf16 v13, v88, v16, v13
 v_dot2_f32_bf16 v13, v89, v17, v13
 v_dot2_f32_bf16 v13, v90, v18, v13
 v_dot2_f32_bf16 v13, v91, v19, v13
 s_waitcnt vmcnt(7)
 v_dot2_f32_bf16 v13, v92, v20, v13
 v_dot2_f32_bf16 v13, v93, v21, v13
 v_dot2_f32_bf16 v13, v94, v22, v13
 v_dot2_f32_bf16 v13, v95, v23, v13
 s_waitcnt vmcnt(6)
 v_dot2_f32_bf16 v13, v96, v24, v13
 v_dot2_f32_bf16 v13, v97, v25, v13
 v_dot2_f32_bf16 v13, v98, v26, v13
 v_dot2_f32_bf16 v13, v99, v27, v13
 s_waitcnt vmcnt(5)
 v_dot2_f32_bf16 v13, v100, v28, v13
 v_dot2_f32_bf16 v13, v101, v29, v13
 v_dot2_f32_bf16 v13, v102, v30, v13
 v_dot2_f32_bf16 v13, v103, v31, v13
 s_waitcnt vmcnt(4)
 v_dot2_f32_bf16 v13, v104, v32, v13
 v_dot2_f32_bf16 v13, v105, v33, v13
 v_dot2_f32_bf16 v13, v106, v34, v13
 v_dot2_f32_bf16 v13, v107, v35, v13
 s_waitcnt vmcnt(3)
 v_dot2_f32_bf16 v13, v108, v36, v13
 v_dot2_f32_bf16 v13, v109, v37, v13
 v_dot2_f32_bf16 v13, v110, v38, v13
 v_dot2_f32_bf16 v13, v111, v39, v13
 s_waitcnt vmcnt(2)
 v_dot2_f32_bf16 v13, v112, v40, v13
 v_dot2_f32_bf16 v13, v113, v41, v13
 v_dot2_f32_bf16 v13, v114, v42, v13
 v_dot2_f32_bf16 v13, v115, v43, v13
 s_waitcnt vmcnt(1)
 v_dot2_f32_bf16 v13, v116, v44, v13
 v_dot2_f32_bf16 v13, v117, v45, v13
 v_dot2_f32_bf16 v13, v118, v46, v13
 v_dot2_f32_bf16 v13, v119, v47, v13
 s_waitcnt vmcnt(0)
 v_dot2_f32_bf16 v13, v120, v48, v13
 v_dot2_f32_bf16 v13, v121, v49, v13
 v_dot2_f32_bf16 v13, v122, v50, v13
 v_dot2_f32_bf16 v13, v123, v51, v13
 s_add_u32 s54, s55, 294912
 buffer_load_dwordx4 v[52:55], v1, s[16:19], s54 offen offset:0
 buffer_load_dwordx4 v[56:59], v1, s[16:19], s54 offen offset:64
 buffer_load_dwordx4 v[60:63], v1, s[16:19], s54 offen offset:128
 buffer_load_dwordx4 v[64:67], v1, s[16:19], s54 offen offset:192
 buffer_load_dwordx4 v[68:71], v1, s[16:19], s54 offen offset:256
 buffer_load_dwordx4 v[72:75], v1, s[16:19], s54 offen offset:320
 buffer_load_dwordx4 v[76:79], v1, s[16:19], s54 offen offset:384
 buffer_load_dwordx4 v[80:83], v1, s[16:19], s54 offen offset:448
 buffer_load_dwordx4 v[84:87], v1, s[16:19], s54 offen offset:512
 s_add_u32 s54, s55, 442368
 buffer_load_dwordx4 v[88:91], v1, s[16:19], s54 offen offset:0
 buffer_load_dwordx4 v[92:95], v1, s[16:19], s54 offen offset:64
 buffer_load_dwordx4 v[96:99], v1, s[16:19], s54 offen offset:128
 buffer_load_dwordx4 v[100:103], v1, s[16:19], s54 offen offset:192
 buffer_load_dwordx4 v[104:107], v1, s[16:19], s54 offen offset:256
 buffer_load_dwordx4 v[108:111], v1, s[16:19], s54 offen offset:320
 buffer_load_dwordx4 v[112:115], v1, s[16:19], s54 offen offset:384
 buffer_load_dwordx4 v[116:119], v1, s[16:19], s54 offen offset:448
 buffer_load_dwordx4 v[120:123], v1, s[16:19], s54 offen offset:512
 s_waitcnt vmcnt(17)
 v_dot2_f32_bf16 v14, v52, v16, v14
 v_dot2_f32_bf16 v14, v53, v17, v14
 v_dot2_f32_bf16 v14, v54, v18, v14
 v_dot2_f32_bf16 v14, v55, v19, v14
 s_waitcnt vmcnt(16)
 v_dot2_f32_bf16 v14, v56, v20, v14
 v_dot2_f32_bf16 v14, v57, v21, v14
 v_dot2_f32_bf16 v14, v58, v22, v14
 v_dot2_f32_bf16 v14, v59, v23, v14
 s_waitcnt vmcnt(15)
 v_dot2_f32_bf16 v14, v60, v24, v14
 v_dot2_f32_bf16 v14, v61, v25, v14
 v_dot2_f32_bf16 v14, v62, v26, v14
 v_dot2_f32_bf16 v14, v63, v27, v14
 s_waitcnt vmcnt(14)
 v_dot2_f32_bf16 v14, v64, v28, v14
 v_dot2_f32_bf16 v14, v65, v29, v14
 v_dot2_f32_bf16 v14, v66, v30, v14
 v_dot2_f32_bf16 v14, v67, v31, v14
 s_waitcnt vmcnt(13)
 v_dot2_f32_bf16 v14, v68, v32, v14
 v_dot2_f32_bf16 v14, v69, v33, v14
 v_dot2_f32_bf16 v14, v70, v34, v14
 v_dot2_f32_bf16 v14, v71, v35, v14
 s_waitcnt vmcnt(12)
 v_dot2_f32_bf16 v14, v72, v36, v14
 v_dot2_f32_bf16 v14, v73, v37, v14
 v_dot2_f32_bf16 v14, v74, v38, v14
 v_dot2_f32_bf16 v14, v75, v39, v14
 s_waitcnt vmcnt(11)
 v_dot2_f32_bf16 v14, v76, v40, v14
 v_dot2_f32_bf16 v14, v77, v41, v14
 v_dot2_f32_bf16 v14, v78, v42, v14
 v_dot2_f32_bf16 v14, v79, v43, v14
 s_waitcnt vmcnt(10)
 v_dot2_f32_bf16 v14, v80, v44, v14
 v_dot2_f32_bf16 v14, v81, v45, v14
 v_dot2_f32_bf16 v14, v82, v46, v14
 v_dot2_f32_bf16 v14, v83, v47, v14
 s_waitcnt vmcnt(9)
 v_dot2_f32_bf16 v14, v84, v48, v14
 v_dot2_f32_bf16 v14, v85, v49, v14
 v_dot2_f32_bf16 v14, v86, v50, v14
 v_dot2_f32_bf16 v14, v87, v51, v14
 s_waitcnt vmcnt(8)
 v_dot2_f32_bf16 v15, v88, v16, v15
 v_dot2_f32_bf16 v15, v89, v17, v15
 v_dot2_f32_bf16 v15, v90, v18, v15
 v_dot2_f32_bf16 v15, v91, v19, v15
 s_waitcnt vmcnt(7)
 v_dot2_f32_bf16 v15, v92, v20, v15
 v_dot2_f32_bf16 v15, v93, v21, v15
 v_dot2_f32_bf16 v15, v94, v22, v15
 v_dot2_f32_bf16 v15, v95, v23, v15
 s_waitcnt vmcnt(6)
 v_dot2_f32_bf16 v15, v96, v24, v15
 v_dot2_f32_bf16 v15, v97, v25, v15
 v_dot2_f32_bf16 v15, v98, v26, v15
 v_dot2_f32_bf16 v15, v99, v27, v15
 s_waitcnt vmcnt(5)
 v_dot2_f32_bf16 v15, v100, v28, v15
 v_dot2_f32_bf16 v15, v101, v29, v15
 v_dot2_f32_bf16 v15, v102, v30, v15
 v_dot2_f32_bf16 v15, v103, v31, v15
 s_waitcnt vmcnt(4)
 v_dot2_f32_bf16 v15, v104, v32, v15
 v_dot2_f32_bf16 v15, v105, v33, v15
 v_dot2_f32_bf16 v15, v106, v34, v15
 v_dot2_f32_bf16 v15, v107, v35, v15
 s_waitcnt vmcnt(3)
 v_dot2_f32_bf16 v15, v108, v36, v15
 v_dot2_f32_bf16 v15, v109, v37, v15
 v_dot2_f32_bf16 v15, v110, v38, v15
 v_dot2_f32_bf16 v15, v111, v39, v15
 s_waitcnt vmcnt(2)
 v_dot2_f32_bf16 v15, v112, v40, v15
 v_dot2_f32_bf16 v15, v113, v41, v15
 v_dot2_f32_bf16 v15, v114, v42, v15
 v_dot2_f32_bf16 v15, v115, v43, v15
 s_waitcnt vmcnt(1)
 v_dot2_f32_bf16 v15, v116, v44, v15
 v_dot2_f32_bf16 v15, v117, v45, v15
 v_dot2_f32_bf16 v15, v118, v46, v15
 v_dot2_f32_bf16 v15, v119, v47, v15
 s_waitcnt vmcnt(0)
 v_dot2_f32_bf16 v15, v120, v48, v15
 v_dot2_f32_bf16 v15, v121, v49, v15
 v_dot2_f32_bf16 v15, v122, v50, v15
 v_dot2_f32_bf16 v15, v123, v51, v15
 buffer_load_dwordx4 v[16:19], v0, s[28:31], 0 offen offset:576
 buffer_load_dwordx4 v[20:23], v0, s[28:31], 0 offen offset:640
 buffer_load_dwordx4 v[24:27], v0, s[28:31], 0 offen offset:704
 buffer_load_dwordx4 v[28:31], v0, s[28:31], 0 offen offset:768
 buffer_load_dwordx4 v[32:35], v0, s[28:31], 0 offen offset:832
 buffer_load_dwordx4 v[36:39], v0, s[28:31], 0 offen offset:896
 buffer_load_dwordx4 v[40:43], v0, s[28:31], 0 offen offset:960
 buffer_load_dwordx4 v[44:47], v0, s[28:31], 0 offen offset:1024
 buffer_load_dwordx4 v[48:51], v0, s[28:31], 0 offen offset:1088
 s_add_u32 s54, s55, 0
 buffer_load_dwordx4 v[52:55], v1, s[16:19], s54 offen offset:576
 buffer_load_dwordx4 v[56:59], v1, s[16:19], s54 offen offset:640
 buffer_load_dwordx4 v[60:63], v1, s[16:19], s54 offen offset:704
 buffer_load_dwordx4 v[64:67], v1, s[16:19], s54 offen offset:768
 buffer_load_dwordx4 v[68:71], v1, s[16:19], s54 offen offset:832
 buffer_load_dwordx4 v[72:75], v1, s[16:19], s54 offen offset:896
 buffer_load_dwordx4 v[76:79], v1, s[16:19], s54 offen offset:960
 buffer_load_dwordx4 v[80:83], v1, s[16:19], s54 offen offset:1024
 buffer_load_dwordx4 v[84:87], v1, s[16:19], s54 offen offset:1088
 s_add_u32 s54, s55, 147456
 buffer_load_dwordx4 v[88:91], v1, s[16:19], s54 offen offset:576
 buffer_load_dwordx4 v[92:95], v1, s[16:19], s54 offen offset:640
 buffer_load_dwordx4 v[96:99], v1, s[16:19], s54 offen offset:704
 buffer_load_dwordx4 v[100:103], v1, s[16:19], s54 offen offset:768
 buffer_load_dwordx4 v[104:107], v1, s[16:19], s54 offen offset:832
 buffer_load_dwordx4 v[108:111], v1, s[16:19], s54 offen offset:896
 buffer_load_dwordx4 v[112:115], v1, s[16:19], s54 offen offset:960
 buffer_load_dwordx4 v[116:119], v1, s[16:19], s54 offen offset:1024
 buffer_load_dwordx4 v[120:123], v1, s[16:19], s54 offen offset:1088
 s_waitcnt vmcnt(17)
 v_dot2_f32_bf16 v12, v52, v16, v12
 v_dot2_f32_bf16 v12, v53, v17, v12
 v_dot2_f32_bf16 v12, v54, v18, v12
 v_dot2_f32_bf16 v12, v55, v19, v12
 s_waitcnt vmcnt(16)
 v_dot2_f32_bf16 v12, v56, v20, v12
 v_dot2_f32_bf16 v12, v57, v21, v12
 v_dot2_f32_bf16 v12, v58, v22, v12
 v_dot2_f32_bf16 v12, v59, v23, v12
 s_waitcnt vmcnt(15)
 v_dot2_f32_bf16 v12, v60, v24, v12
 v_dot2_f32_bf16 v12, v61, v25, v12
 v_dot2_f32_bf16 v12, v62, v26, v12
 v_dot2_f32_bf16 v12, v63, v27, v12
 s_waitcnt vmcnt(14)
 v_dot2_f32_bf16 v12, v64, v28, v12
 v_dot2_f32_bf16 v12, v65, v29, v12
 v_dot2_f32_bf16 v12, v66, v30, v12
 v_dot2_f32_bf16 v12, v67, v31, v12
 s_waitcnt vmcnt(13)
 v_dot2_f32_bf16 v12, v68, v32, v12
 v_dot2_f32_bf16 v12, v69, v33, v12
 v_dot2_f32_bf16 v12, v70, v34, v12
 v_dot2_f32_bf16 v12, v71, v35, v12
 s_waitcnt vmcnt(12)
 v_dot2_f32_bf16 v12, v72, v36, v12
 v_dot2_f32_bf16 v12, v73, v37, v12
 v_dot2_f32_bf16 v12, v74, v38, v12
 v_dot2_f32_bf16 v12, v75, v39, v12
 s_waitcnt vmcnt(11)
 v_dot2_f32_bf16 v12, v76, v40, v12
 v_dot2_f32_bf16 v12, v77, v41, v12
 v_dot2_f32_bf16 v12, v78, v42, v12
 v_dot2_f32_bf16 v12, v79, v43, v12
 s_waitcnt vmcnt(10)
 v_dot2_f32_bf16 v12, v80, v44, v12
 v_dot2_f32_bf16 v12, v81, v45, v12
 v_dot2_f32_bf16 v12, v82, v46, v12
 v_dot2_f32_bf16 v12, v83, v47, v12
 s_waitcnt vmcnt(9)
 v_dot2_f32_bf16 v12, v84, v48, v12
 v_dot2_f32_bf16 v12, v85, v49, v12
 v_dot2_f32_bf16 v12, v86, v50, v12
 v_dot2_f32_bf16 v12, v87, v51, v12
 s_waitcnt vmcnt(8)
 v_dot2_f32_bf16 v13, v88, v16, v13
 v_dot2_f32_bf16 v13, v89, v17, v13
 v_dot2_f32_bf16 v13, v90, v18, v13
 v_dot2_f32_bf16 v13, v91, v19, v13
 s_waitcnt vmcnt(7)
 v_dot2_f32_bf16 v13, v92, v20, v13
 v_dot2_f32_bf16 v13, v93, v21, v13
 v_dot2_f32_bf16 v13, v94, v22, v13
 v_dot2_f32_bf16 v13, v95, v23, v13
 s_waitcnt vmcnt(6)
 v_dot2_f32_bf16 v13, v96, v24, v13
 v_dot2_f32_bf16 v13, v97, v25, v13
 v_dot2_f32_bf16 v13, v98, v26, v13
 v_dot2_f32_bf16 v13, v99, v27, v13
 s_waitcnt vmcnt(5)
 v_dot2_f32_bf16 v13, v100, v28, v13
 v_dot2_f32_bf16 v13, v101, v29, v13
 v_dot2_f32_bf16 v13, v102, v30, v13
 v_dot2_f32_bf16 v13, v103, v31, v13
 s_waitcnt vmcnt(4)
 v_dot2_f32_bf16 v13, v104, v32, v13
 v_dot2_f32_bf16 v13, v105, v33, v13
 v_dot2_f32_bf16 v13, v106, v34, v13
 v_dot2_f32_bf16 v13, v107, v35, v13
 s_waitcnt vmcnt(3)
 v_dot2_f32_bf16 v13, v108, v36, v13
 v_dot2_f32_bf16 v13, v109, v37, v13
 v_dot2_f32_bf16 v13, v110, v38, v13
 v_dot2_f32_bf16 v13, v111, v39, v13
 s_waitcnt vmcnt(2)
 v_dot2_f32_bf16 v13, v112, v40, v13
 v_dot2_f32_bf16 v13, v113, v41, v13
 v_dot2_f32_bf16 v13, v114, v42, v13
 v_dot2_f32_bf16 v13, v115, v43, v13
 s_waitcnt vmcnt(1)
 v_dot2_f32_bf16 v13, v116, v44, v13
 v_dot2_f32_bf16 v13, v117, v45, v13
 v_dot2_f32_bf16 v13, v118, v46, v13
 v_dot2_f32_bf16 v13, v119, v47, v13
 s_waitcnt vmcnt(0)
 v_dot2_f32_bf16 v13, v120, v48, v13
 v_dot2_f32_bf16 v13, v121, v49, v13
 v_dot2_f32_bf16 v13, v122, v50, v13
 v_dot2_f32_bf16 v13, v123, v51, v13
 s_add_u32 s54, s55, 294912
 buffer_load_dwordx4 v[52:55], v1, s[16:19], s54 offen offset:576
 buffer_load_dwordx4 v[56:59], v1, s[16:19], s54 offen offset:640
 buffer_load_dwordx4 v[60:63], v1, s[16:19], s54 offen offset:704
 buffer_load_dwordx4 v[64:67], v1, s[16:19], s54 offen offset:768
 buffer_load_dwordx4 v[68:71], v1, s[16:19], s54 offen offset:832
 buffer_load_dwordx4 v[72:75], v1, s[16:19], s54 offen offset:896
 buffer_load_dwordx4 v[76:79], v1, s[16:19], s54 offen offset:960
 buffer_load_dwordx4 v[80:83], v1, s[16:19], s54 offen offset:1024
 buffer_load_dwordx4 v[84:87], v1, s[16:19], s54 offen offset:1088
 s_add_u32 s54, s55, 442368
 buffer_load_dwordx4 v[88:91], v1, s[16:19], s54 offen offset:576
 buffer_load_dwordx4 v[92:95], v1, s[16:19], s54 offen offset:640
 buffer_load_dwordx4 v[96:99], v1, s[16:19], s54 offen offset:704
 buffer_load_dwordx4 v[100:103], v1, s[16:19], s54 offen offset:768
 buffer_load_dwordx4 v[104:107], v1, s[16:19], s54 offen offset:832
 buffer_load_dwordx4 v[108:111], v1, s[16:19], s54 offen offset:896
 buffer_load_dwordx4 v[112:115], v1, s[16:19], s54 offen offset:960
 buffer_load_dwordx4 v[116:119], v1, s[16:19], s54 offen offset:1024
 buffer_load_dwordx4 v[120:123], v1, s[16:19], s54 offen offset:1088
 s_waitcnt vmcnt(17)
 v_dot2_f32_bf16 v14, v52, v16, v14
 v_dot2_f32_bf16 v14, v53, v17, v14
 v_dot2_f32_bf16 v14, v54, v18, v14
 v_dot2_f32_bf16 v14, v55, v19, v14
 s_waitcnt vmcnt(16)
 v_dot2_f32_bf16 v14, v56, v20, v14
 v_dot2_f32_bf16 v14, v57, v21, v14
 v_dot2_f32_bf16 v14, v58, v22, v14
 v_dot2_f32_bf16 v14, v59, v23, v14
 s_waitcnt vmcnt(15)
 v_dot2_f32_bf16 v14, v60, v24, v14
 v_dot2_f32_bf16 v14, v61, v25, v14
 v_dot2_f32_bf16 v14, v62, v26, v14
 v_dot2_f32_bf16 v14, v63, v27, v14
 s_waitcnt vmcnt(14)
 v_dot2_f32_bf16 v14, v64, v28, v14
 v_dot2_f32_bf16 v14, v65, v29, v14
 v_dot2_f32_bf16 v14, v66, v30, v14
 v_dot2_f32_bf16 v14, v67, v31, v14
 s_waitcnt vmcnt(13)
 v_dot2_f32_bf16 v14, v68, v32, v14
 v_dot2_f32_bf16 v14, v69, v33, v14
 v_dot2_f32_bf16 v14, v70, v34, v14
 v_dot2_f32_bf16 v14, v71, v35, v14
 s_waitcnt vmcnt(12)
 v_dot2_f32_bf16 v14, v72, v36, v14
 v_dot2_f32_bf16 v14, v73, v37, v14
 v_dot2_f32_bf16 v14, v74, v38, v14
 v_dot2_f32_bf16 v14, v75, v39, v14
 s_waitcnt vmcnt(11)
 v_dot2_f32_bf16 v14, v76, v40, v14
 v_dot2_f32_bf16 v14, v77, v41, v14
 v_dot2_f32_bf16 v14, v78, v42, v14
 v_dot2_f32_bf16 v14, v79, v43, v14
 s_waitcnt vmcnt(10)
 v_dot2_f32_bf16 v14, v80, v44, v14
 v_dot2_f32_bf16 v14, v81, v45, v14
 v_dot2_f32_bf16 v14, v82, v46, v14
 v_dot2_f32_bf16 v14, v83, v47, v14
 s_waitcnt vmcnt(9)
 v_dot2_f32_bf16 v14, v84, v48, v14
 v_dot2_f32_bf16 v14, v85, v49, v14
 v_dot2_f32_bf16 v14, v86, v50, v14
 v_dot2_f32_bf16 v14, v87, v51, v14
 s_waitcnt vmcnt(8)
 v_dot2_f32_bf16 v15, v88, v16, v15
 v_dot2_f32_bf16 v15, v89, v17, v15
 v_dot2_f32_bf16 v15, v90, v18, v15
 v_dot2_f32_bf16 v15, v91, v19, v15
 s_waitcnt vmcnt(7)
 v_dot2_f32_bf16 v15, v92, v20, v15
 v_dot2_f32_bf16 v15, v93, v21, v15
 v_dot2_f32_bf16 v15, v94, v22, v15
 v_dot2_f32_bf16 v15, v95, v23, v15
 s_waitcnt vmcnt(6)
 v_dot2_f32_bf16 v15, v96, v24, v15
 v_dot2_f32_bf16 v15, v97, v25, v15
 v_dot2_f32_bf16 v15, v98, v26, v15
 v_dot2_f32_bf16 v15, v99, v27, v15
 s_waitcnt vmcnt(5)
 v_dot2_f32_bf16 v15, v100, v28, v15
 v_dot2_f32_bf16 v15, v101, v29, v15
 v_dot2_f32_bf16 v15, v102, v30, v15
 v_dot2_f32_bf16 v15, v103, v31, v15
 s_waitcnt vmcnt(4)
 v_dot2_f32_bf16 v15, v104, v32, v15
 v_dot2_f32_bf16 v15, v105, v33, v15
 v_dot2_f32_bf16 v15, v106, v34, v15
 v_dot2_f32_bf16 v15, v107, v35, v15
 s_waitcnt vmcnt(3)
 v_dot2_f32_bf16 v15, v108, v36, v15
 v_dot2_f32_bf16 v15, v109, v37, v15
 v_dot2_f32_bf16 v15, v110, v38, v15
 v_dot2_f32_bf16 v15, v111, v39, v15
 s_waitcnt vmcnt(2)
 v_dot2_f32_bf16 v15, v112, v40, v15
 v_dot2_f32_bf16 v15, v113, v41, v15
 v_dot2_f32_bf16 v15, v114, v42, v15
 v_dot2_f32_bf16 v15, v115, v43, v15
 s_waitcnt vmcnt(1)
 v_dot2_f32_bf16 v15, v116, v44, v15
 v_dot2_f32_bf16 v15, v117, v45, v15
 v_dot2_f32_bf16 v15, v118, v46, v15
 v_dot2_f32_bf16 v15, v119, v47, v15
 s_waitcnt vmcnt(0)
 v_dot2_f32_bf16 v15, v120, v48, v15
 v_dot2_f32_bf16 v15, v121, v49, v15
 v_dot2_f32_bf16 v15, v122, v50, v15
 v_dot2_f32_bf16 v15, v123, v51, v15
 s_nop 2
 v_add_f32_dpp v12, v12, v12 quad_perm:[1,0,3,2] row_mask:0xf bank_mask:0xf
 v_add_f32_dpp v13, v13, v13 quad_perm:[1,0,3,2] row_mask:0xf bank_mask:0xf
 v_add_f32_dpp v14, v14, v14 quad_perm:[1,0,3,2] row_mask:0xf bank_mask:0xf
 v_add_f32_dpp v15, v15, v15 quad_perm:[1,0,3,2] row_mask:0xf bank_mask:0xf
 v_add_f32_dpp v12, v12, v12 quad_perm:[2,3,0,1] row_mask:0xf bank_mask:0xf
 v_add_f32_dpp v13, v13, v13 quad_perm:[2,3,0,1] row_mask:0xf bank_mask:0xf
 v_add_f32_dpp v14, v14, v14 quad_perm:[2,3,0,1] row_mask:0xf bank_mask:0xf
 v_add_f32_dpp v15, v15, v15 quad_perm:[2,3,0,1] row_mask:0xf bank_mask:0xf
 v_mul_f32 v12, 3216550459, v12
 v_exp_f32 v12, v12
 s_nop 0
 v_add_f32 v12, 1.0, v12
 v_rcp_f32 v12, v12
 v_mul_f32 v13, 3216550459, v13
 v_exp_f32 v13, v13
 s_nop 0
 v_add_f32 v13, 1.0, v13
 v_rcp_f32 v13, v13
 v_mul_f32 v14, 3216550459, v14
 v_exp_f32 v14, v14
 s_nop 0
 v_add_f32 v14, 1.0, v14
 v_rcp_f32 v14, v14
 v_mul_f32 v15, 3216550459, v15
 v_exp_f32 v15, v15
 s_nop 0
 v_add_f32 v15, 1.0, v15
 v_rcp_f32 v15, v15
 s_lshl_b32 s54, s4, 8
 s_add_u32 s54, s54, 147456
 v_mov_b32 v2, s54
 v_bfe_u32 v9, v8, 2, 4
 v_lshl_add_u32 v2, v9, 2, v2
 ds_write_b32 v2, v12 offset:0
 ds_write_b32 v2, v13 offset:64
 ds_write_b32 v2, v14 offset:128
 ds_write_b32 v2, v15 offset:192
 v_lshlrev_b32 v0, 2, v8
 v_mov_b32 v1, 72
 v_mov_b32 v2, 0x10101010
 v_cmp_gt_u32 vcc, 32, v8
 s_nop 1
 v_cndmask_b32 v1, v1, v2, vcc
 s_mov_b32 s49, 400000
 s_mov_b32 exec_hi, 0x100
 s_cmp_eq_u32 s4, 0
 s_cbranch_scc0 OUTX
 s_mov_b32 exec_lo, 0
OUTV:
 buffer_load_dword v2, v0, s[12:15], 0 offen sc1
 s_sub_u32 s49, s49, 1
 s_cselect_b32 s49, 0, s49
 s_cbranch_scc1 OUTX
 s_waitcnt vmcnt(0)
 v_cmp_gt_u32 vcc, v1, v2
 s_cbranch_vccnz OUTV
 s_mov_b32 exec_lo, -1
OUTW:
 buffer_load_dword v2, v0, s[12:15], 0 offen sc1
 s_sub_u32 s49, s49, 1
 s_cselect_b32 s49, 0, s49
 s_cbranch_scc1 OUTX
 s_waitcnt vmcnt(0)
 v_cmp_gt_u32 vcc, v1, v2
 s_cbranch_vccnz OUTW
OUTX:
 s_mov_b64 exec, -1
 s_waitcnt vmcnt(0)
 s_waitcnt lgkmcnt(0)
 s_barrier
 s_lshl_b32 s37, s6, 17
 s_lshl_b32 s54, s4, 15
 s_add_u32 s37, s37, s54
 s_add_u32 s37, s37, 67108864
 s_mul_i32 s54, s7, 3
 s_min_u32 s55, s4, 2
 s_add_u32 s54, s54, s55
 s_lshl_b32 s38, s54, 16
 s_lshl_b32 s56, s6, 5
 s_add_u32 s38, s38, s56
 s_add_u32 s38, s38, 93323264
 s_lshl_b32 s39, s54, 5
 s_mul_i32 s56, s6, 18432
 s_add_u32 s39, s39, s56
 v_lshlrev_b32 v0, 4, v8
 v_mov_b32 v1, 496
 v_bfe_u32 v9, v8, 0, 6
 v_lshl_add_u32 v1, v9, 9, v1
 s_and_b32 s54, s7, 3
 s_lshl_b32 s54, s54, 7
 v_subrev_u32 v1, s54, v1
 v_mov_b32 v2, 0
 v_bfe_u32 v9, v8, 0, 2
 v_lshl_add_u32 v2, v9, 3, v2
 v_bfe_u32 v9, v8, 2, 4
 v_lshl_add_u32 v2, v9, 12, v2
 s_lshl_b32 s54, s4, 9
 s_add_u32 s54, s54, 160768
 v_mov_b32 v3, s54
 v_bfe_u32 v9, v8, 0, 6
 v_lshl_add_u32 v3, v9, 3, v3
 v_mov_b32 v5, 147456
 v_bfe_u32 v9, v8, 0, 4
 v_lshl_add_u32 v5, v9, 2, v5
 s_mul_i32 s54, s4, 3072
 s_add_u32 s54, s54, 148480
 v_add_u32 v6, s54, v0
 s_lshl_b32 s55, s55, 10
 s_add_u32 s55, s55, 148480
 v_add_u32 v7, s55, v0
 v_mov_b32 v4, 0
 v_bfe_u32 v9, v8, 0, 4
 s_mov_b32 s101, 1152
 v_mad_u32_u24 v4, v9, s101, v4
 v_bfe_u32 v9, v8, 4, 2
 v_lshl_add_u32 v4, v9, 3, v4
 s_mov_b32 s36, 0
OUTT:
 buffer_load_dwordx2 v[10:11], v2, s[8:11], s38 offen sc1
 s_cmp_eq_u32 s4, 3
 s_cbranch_scc0 OUTB
 s_cmp_ge_u32 s37, 83623936
 s_cselect_b32 s54, 0x40000, 0
 s_sub_u32 s54, s37, s54
OUTL:
 buffer_load_dword v12, off, s[8:11], s54 offset:496 sc1
 s_sub_u32 s49, s49, 1
 s_cselect_b32 s49, 0, s49
 s_cselect_b32 s66, -1, -2
 s_waitcnt vmcnt(0)
 v_cmp_lt_u32 vcc, s66, v12
 s_cbranch_vccnz OUTL
OUTB:
 s_waitcnt vmcnt(0)
 s_barrier
 ds_read_b32 v9, v5
 v_add_u32 v5, 64, v5
 ds_write_b64 v3, v[10:11]
 s_waitcnt lgkmcnt(0)
 ds_read_b64_tr_b16 v[10:11], v3
 v_sub_f32 v12, 1.0, v9
 s_waitcnt lgkmcnt(0)
 v_lshlrev_b32 v28, 16, v10
 v_and_b32 v29, 0xffff0000, v10
 v_lshlrev_b32 v30, 16, v11
 v_and_b32 v31, 0xffff0000, v11
 v_mul_f32 v28, v28, v12
 v_mul_f32 v29, v29, v12
 v_mul_f32 v30, v30, v12
 v_mul_f32 v31, v31, v12
OUTP:
 buffer_load_dword v10, v1, s[8:11], s37 offen sc1
 s_sub_u32 s49, s49, 1
 s_cselect_b32 s49, 0, s49
 s_cselect_b32 s66, -1, -2
 s_waitcnt vmcnt(0)
 v_cmp_lt_u32 vcc, s66, v10
 s_cbranch_vccnz OUTP
 s_add_u32 s59, s37, 4096
 s_add_u32 s60, s37, 8192
 s_add_u32 s61, s37, 12288
 s_add_u32 s62, s37, 16384
 s_add_u32 s63, s37, 20480
 s_add_u32 s64, s37, 24576
 s_add_u32 s65, s37, 28672
 buffer_load_dwordx4 v[32:35], v0, s[8:11], s37 offen offset:0 sc1
 buffer_load_dwordx4 v[36:39], v0, s[8:11], s37 offen offset:1024 sc1
 buffer_load_dwordx4 v[40:43], v0, s[8:11], s37 offen offset:2048 sc1
 buffer_load_dwordx4 v[44:47], v0, s[8:11], s37 offen offset:3072 sc1
 buffer_load_dwordx4 v[48:51], v0, s[8:11], s59 offen offset:0 sc1
 buffer_load_dwordx4 v[52:55], v0, s[8:11], s59 offen offset:1024 sc1
 buffer_load_dwordx4 v[56:59], v0, s[8:11], s59 offen offset:2048 sc1
 buffer_load_dwordx4 v[60:63], v0, s[8:11], s59 offen offset:3072 sc1
 buffer_load_dwordx4 v[64:67], v0, s[8:11], s60 offen offset:0 sc1
 buffer_load_dwordx4 v[68:71], v0, s[8:11], s60 offen offset:1024 sc1
 buffer_load_dwordx4 v[72:75], v0, s[8:11], s60 offen offset:2048 sc1
 buffer_load_dwordx4 v[76:79], v0, s[8:11], s60 offen offset:3072 sc1
 buffer_load_dwordx4 v[80:83], v0, s[8:11], s61 offen offset:0 sc1
 buffer_load_dwordx4 v[84:87], v0, s[8:11], s61 offen offset:1024 sc1
 buffer_load_dwordx4 v[88:91], v0, s[8:11], s61 offen offset:2048 sc1
 buffer_load_dwordx4 v[92:95], v0, s[8:11], s61 offen offset:3072 sc1
 buffer_load_dwordx4 v[96:99], v0, s[8:11], s62 offen offset:0 sc1
 buffer_load_dwordx4 v[100:103], v0, s[8:11], s62 offen offset:1024 sc1
 buffer_load_dwordx4 v[104:107], v0, s[8:11], s62 offen offset:2048 sc1
 buffer_load_dwordx4 v[108:111], v0, s[8:11], s62 offen offset:3072 sc1
 buffer_load_dwordx4 v[112:115], v0, s[8:11], s63 offen offset:0 sc1
 buffer_load_dwordx4 v[116:119], v0, s[8:11], s63 offen offset:1024 sc1
 buffer_load_dwordx4 v[120:123], v0, s[8:11], s63 offen offset:2048 sc1
 buffer_load_dwordx4 v[124:127], v0, s[8:11], s63 offen offset:3072 sc1
 s_waitcnt vmcnt(23)
 v_mov_b32 v10, 0
 v_mfma_f32_16x16x32_bf16 v[16:19], v[128:131], v[32:35], 0
 v_max_u32 v10, v10, v32
 v_mfma_f32_16x16x32_bf16 v[20:23], v[132:135], v[32:35], 0
 v_mfma_f32_16x16x32_bf16 v[24:27], v[136:139], v[32:35], 0
 buffer_load_dwordx4 v[32:35], v0, s[8:11], s64 offen offset:0 sc1
 s_waitcnt vmcnt(23)
 v_mfma_f32_16x16x32_bf16 v[16:19], v[140:143], v[36:39], v[16:19]
 v_max_u32 v10, v10, v36
 v_mfma_f32_16x16x32_bf16 v[20:23], v[144:147], v[36:39], v[20:23]
 v_mfma_f32_16x16x32_bf16 v[24:27], v[148:151], v[36:39], v[24:27]
 buffer_load_dwordx4 v[36:39], v0, s[8:11], s64 offen offset:1024 sc1
 s_waitcnt vmcnt(23)
 v_mfma_f32_16x16x32_bf16 v[16:19], v[152:155], v[40:43], v[16:19]
 v_max_u32 v10, v10, v40
 v_mfma_f32_16x16x32_bf16 v[20:23], v[156:159], v[40:43], v[20:23]
 v_mfma_f32_16x16x32_bf16 v[24:27], v[160:163], v[40:43], v[24:27]
 buffer_load_dwordx4 v[40:43], v0, s[8:11], s64 offen offset:2048 sc1
 s_waitcnt vmcnt(23)
 v_mfma_f32_16x16x32_bf16 v[16:19], v[164:167], v[44:47], v[16:19]
 v_max_u32 v10, v10, v44
 v_mfma_f32_16x16x32_bf16 v[20:23], v[168:171], v[44:47], v[20:23]
 v_mfma_f32_16x16x32_bf16 v[24:27], v[172:175], v[44:47], v[24:27]
 buffer_load_dwordx4 v[44:47], v0, s[8:11], s64 offen offset:3072 sc1
 s_waitcnt vmcnt(23)
 v_mfma_f32_16x16x32_bf16 v[16:19], v[176:179], v[48:51], v[16:19]
 v_max_u32 v10, v10, v48
 v_mfma_f32_16x16x32_bf16 v[20:23], v[180:183], v[48:51], v[20:23]
 v_mfma_f32_16x16x32_bf16 v[24:27], v[184:187], v[48:51], v[24:27]
 buffer_load_dwordx4 v[48:51], v0, s[8:11], s65 offen offset:0 sc1
 s_waitcnt vmcnt(23)
 v_mfma_f32_16x16x32_bf16 v[16:19], v[188:191], v[52:55], v[16:19]
 v_max_u32 v10, v10, v52
 v_mfma_f32_16x16x32_bf16 v[20:23], v[192:195], v[52:55], v[20:23]
 v_mfma_f32_16x16x32_bf16 v[24:27], v[196:199], v[52:55], v[24:27]
 buffer_load_dwordx4 v[52:55], v0, s[8:11], s65 offen offset:1024 sc1
 s_waitcnt vmcnt(23)
 v_mfma_f32_16x16x32_bf16 v[16:19], v[200:203], v[56:59], v[16:19]
 v_max_u32 v10, v10, v56
 v_mfma_f32_16x16x32_bf16 v[20:23], v[204:207], v[56:59], v[20:23]
 v_mfma_f32_16x16x32_bf16 v[24:27], v[208:211], v[56:59], v[24:27]
 buffer_load_dwordx4 v[56:59], v0, s[8:11], s65 offen offset:2048 sc1
 s_waitcnt vmcnt(23)
 v_mfma_f32_16x16x32_bf16 v[16:19], v[212:215], v[60:63], v[16:19]
 v_max_u32 v10, v10, v60
 v_mfma_f32_16x16x32_bf16 v[20:23], v[216:219], v[60:63], v[20:23]
 v_mfma_f32_16x16x32_bf16 v[24:27], v[220:223], v[60:63], v[24:27]
 buffer_load_dwordx4 v[60:63], v0, s[8:11], s65 offen offset:3072 sc1
 s_waitcnt vmcnt(23)
 v_mfma_f32_16x16x32_bf16 v[16:19], v[224:227], v[64:67], v[16:19]
 v_max_u32 v10, v10, v64
 v_mfma_f32_16x16x32_bf16 v[20:23], v[228:231], v[64:67], v[20:23]
 v_mfma_f32_16x16x32_bf16 v[24:27], v[232:235], v[64:67], v[24:27]
 s_waitcnt vmcnt(22)
 v_mfma_f32_16x16x32_bf16 v[16:19], v[236:239], v[68:71], v[16:19]
 v_max_u32 v10, v10, v68
 v_mfma_f32_16x16x32_bf16 v[20:23], v[240:243], v[68:71], v[20:23]
 v_mfma_f32_16x16x32_bf16 v[24:27], v[244:247], v[68:71], v[24:27]
 s_waitcnt vmcnt(21)
 v_mfma_f32_16x16x32_bf16 v[16:19], v[248:251], v[72:75], v[16:19]
 v_max_u32 v10, v10, v72
 v_mfma_f32_16x16x32_bf16 v[20:23], v[252:255], v[72:75], v[20:23]
 v_mfma_f32_16x16x32_bf16 v[24:27], a[0:3], v[72:75], v[24:27]
 s_waitcnt vmcnt(20)
 v_mfma_f32_16x16x32_bf16 v[16:19], a[4:7], v[76:79], v[16:19]
 v_max_u32 v10, v10, v76
 v_mfma_f32_16x16x32_bf16 v[20:23], a[8:11], v[76:79], v[20:23]
 v_mfma_f32_16x16x32_bf16 v[24:27], a[12:15], v[76:79], v[24:27]
 s_waitcnt vmcnt(19)
 v_mfma_f32_16x16x32_bf16 v[16:19], a[16:19], v[80:83], v[16:19]
 v_max_u32 v10, v10, v80
 v_mfma_f32_16x16x32_bf16 v[20:23], a[20:23], v[80:83], v[20:23]
 v_mfma_f32_16x16x32_bf16 v[24:27], a[24:27], v[80:83], v[24:27]
 s_waitcnt vmcnt(18)
 v_mfma_f32_16x16x32_bf16 v[16:19], a[28:31], v[84:87], v[16:19]
 v_max_u32 v10, v10, v84
 v_mfma_f32_16x16x32_bf16 v[20:23], a[32:35], v[84:87], v[20:23]
 v_mfma_f32_16x16x32_bf16 v[24:27], a[36:39], v[84:87], v[24:27]
 s_waitcnt vmcnt(17)
 v_mfma_f32_16x16x32_bf16 v[16:19], a[40:43], v[88:91], v[16:19]
 v_max_u32 v10, v10, v88
 v_mfma_f32_16x16x32_bf16 v[20:23], a[44:47], v[88:91], v[20:23]
 v_mfma_f32_16x16x32_bf16 v[24:27], a[48:51], v[88:91], v[24:27]
 s_waitcnt vmcnt(16)
 v_mfma_f32_16x16x32_bf16 v[16:19], a[52:55], v[92:95], v[16:19]
 v_max_u32 v10, v10, v92
 v_mfma_f32_16x16x32_bf16 v[20:23], a[56:59], v[92:95], v[20:23]
 v_mfma_f32_16x16x32_bf16 v[24:27], a[60:63], v[92:95], v[24:27]
 s_waitcnt vmcnt(15)
 v_mfma_f32_16x16x32_bf16 v[16:19], a[64:67], v[96:99], v[16:19]
 v_max_u32 v10, v10, v96
 v_mfma_f32_16x16x32_bf16 v[20:23], a[68:71], v[96:99], v[20:23]
 v_mfma_f32_16x16x32_bf16 v[24:27], a[72:75], v[96:99], v[24:27]
 s_waitcnt vmcnt(14)
 v_mfma_f32_16x16x32_bf16 v[16:19], a[76:79], v[100:103], v[16:19]
 v_max_u32 v10, v10, v100
 v_mfma_f32_16x16x32_bf16 v[20:23], a[80:83], v[100:103], v[20:23]
 v_mfma_f32_16x16x32_bf16 v[24:27], a[84:87], v[100:103], v[24:27]
 s_waitcnt vmcnt(13)
 v_mfma_f32_16x16x32_bf16 v[16:19], a[88:91], v[104:107], v[16:19]
 v_max_u32 v10, v10, v104
 v_mfma_f32_16x16x32_bf16 v[20:23], a[92:95], v[104:107], v[20:23]
 v_mfma_f32_16x16x32_bf16 v[24:27], a[96:99], v[104:107], v[24:27]
 s_waitcnt vmcnt(12)
 v_mfma_f32_16x16x32_bf16 v[16:19], a[100:103], v[108:111], v[16:19]
 v_max_u32 v10, v10, v108
 v_mfma_f32_16x16x32_bf16 v[20:23], a[104:107], v[108:111], v[20:23]
 v_mfma_f32_16x16x32_bf16 v[24:27], a[108:111], v[108:111], v[24:27]
 s_waitcnt vmcnt(11)
 v_mfma_f32_16x16x32_bf16 v[16:19], a[112:115], v[112:115], v[16:19]
 v_max_u32 v10, v10, v112
 v_mfma_f32_16x16x32_bf16 v[20:23], a[116:119], v[112:115], v[20:23]
 v_mfma_f32_16x16x32_bf16 v[24:27], a[120:123], v[112:115], v[24:27]
 s_waitcnt vmcnt(10)
 v_mfma_f32_16x16x32_bf16 v[16:19], a[124:127], v[116:119], v[16:19]
 v_max_u32 v10, v10, v116
 v_mfma_f32_16x16x32_bf16 v[20:23], a[128:131], v[116:119], v[20:23]
 v_mfma_f32_16x16x32_bf16 v[24:27], a[132:135], v[116:119], v[24:27]
 s_waitcnt vmcnt(9)
 v_mfma_f32_16x16x32_bf16 v[16:19], a[136:139], v[120:123], v[16:19]
 v_max_u32 v10, v10, v120
 v_mfma_f32_16x16x32_bf16 v[20:23], a[140:143], v[120:123], v[20:23]
 v_mfma_f32_16x16x32_bf16 v[24:27], a[144:147], v[120:123], v[24:27]
 s_waitcnt vmcnt(8)
 v_mfma_f32_16x16x32_bf16 v[16:19], a[148:151], v[124:127], v[16:19]
 v_max_u32 v10, v10, v124
 v_mfma_f32_16x16x32_bf16 v[20:23], a[152:155], v[124:127], v[20:23]
 v_mfma_f32_16x16x32_bf16 v[24:27], a[156:159], v[124:127], v[24:27]
 s_waitcnt vmcnt(7)
 v_mfma_f32_16x16x32_bf16 v[16:19], a[160:163], v[32:35], v[16:19]
 v_max_u32 v10, v10, v32
 v_mfma_f32_16x16x32_bf16 v[20:23], a[164:167], v[32:35], v[20:23]
 v_mfma_f32_16x16x32_bf16 v[24:27], a[168:171], v[32:35], v[24:27]
 s_waitcnt vmcnt(6)
 v_mfma_f32_16x16x32_bf16 v[16:19], a[172:175], v[36:39], v[16:19]
 v_max_u32 v10, v10, v36
 v_mfma_f32_16x16x32_bf16 v[20:23], a[176:179], v[36:39], v[20:23]
 v_mfma_f32_16x16x32_bf16 v[24:27], a[180:183], v[36:39], v[24:27]
 s_waitcnt vmcnt(5)
 v_mfma_f32_16x16x32_bf16 v[16:19], a[184:187], v[40:43], v[16:19]
 v_max_u32 v10, v10, v40
 v_mfma_f32_16x16x32_bf16 v[20:23], a[188:191], v[40:43], v[20:23]
 v_mfma_f32_16x16x32_bf16 v[24:27], a[192:195], v[40:43], v[24:27]
 s_waitcnt vmcnt(4)
 v_mfma_f32_16x16x32_bf16 v[16:19], a[196:199], v[44:47], v[16:19]
 v_max_u32 v10, v10, v44
 v_mfma_f32_16x16x32_bf16 v[20:23], a[200:203], v[44:47], v[20:23]
 v_mfma_f32_16x16x32_bf16 v[24:27], a[204:207], v[44:47], v[24:27]
 s_waitcnt vmcnt(3)
 v_mfma_f32_16x16x32_bf16 v[16:19], a[208:211], v[48:51], v[16:19]
 v_max_u32 v10, v10, v48
 v_mfma_f32_16x16x32_bf16 v[20:23], a[212:215], v[48:51], v[20:23]
 v_mfma_f32_16x16x32_bf16 v[24:27], a[216:219], v[48:51], v[24:27]
 s_waitcnt vmcnt(2)
 v_mfma_f32_16x16x32_bf16 v[16:19], a[220:223], v[52:55], v[16:19]
 v_max_u32 v10, v10, v52
 v_mfma_f32_16x16x32_bf16 v[20:23], a[224:227], v[52:55], v[20:23]
 v_mfma_f32_16x16x32_bf16 v[24:27], a[228:231], v[52:55], v[24:27]
 s_waitcnt vmcnt(1)
 v_mfma_f32_16x16x32_bf16 v[16:19], a[232:235], v[56:59], v[16:19]
 v_max_u32 v10, v10, v56
 v_mfma_f32_16x16x32_bf16 v[20:23], a[236:239], v[56:59], v[20:23]
 v_mfma_f32_16x16x32_bf16 v[24:27], a[240:243], v[56:59], v[24:27]
 s_waitcnt vmcnt(0)
 v_mfma_f32_16x16x32_bf16 v[16:19], a[244:247], v[60:63], v[16:19]
 v_max_u32 v10, v10, v60
 v_mfma_f32_16x16x32_bf16 v[20:23], a[248:251], v[60:63], v[20:23]
 v_mfma_f32_16x16x32_bf16 v[24:27], a[252:255], v[60:63], v[24:27]
 v_cmp_lt_u32 vcc, s66, v10
 s_cbranch_vccnz OUTP
 ds_write_b128 v6, v[16:19] offset:0
 s_nop 0
 ds_write_b128 v6, v[20:23] offset:1024
 s_nop 2
 ds_write_b128 v6, v[24:27] offset:2048
 s_add_u32 s37, s37, 0x100000
 s_add_u32 s38, s38, 256
 s_add_u32 s36, s36, 1
 s_cmp_eq_u32 s4, 3
 s_waitcnt lgkmcnt(0)
 s_barrier
 s_cbranch_scc1 OUTN
 ds_read_b128 v[32:35], v7 offset:0
 ds_read_b128 v[36:39], v7 offset:3072
 ds_read_b128 v[40:43], v7 offset:6144
 ds_read_b128 v[44:47], v7 offset:9216
 s_waitcnt lgkmcnt(2)
 v_add_f32 v32, v32, v36
 v_add_f32 v33, v33, v37
 v_add_f32 v34, v34, v38
 v_add_f32 v35, v35, v39
 s_waitcnt lgkmcnt(0)
 v_add_f32 v40, v40, v44
 v_add_f32 v41, v41, v45
 v_add_f32 v42, v42, v46
 v_add_f32 v43, v43, v47
 v_add_f32 v32, v32, v40
 v_add_f32 v33, v33, v41
 v_add_f32 v34, v34, v42
 v_add_f32 v35, v35, v43
 v_fmac_f32 v28, v32, v9
 v_fmac_f32 v29, v33, v9
 v_fmac_f32 v30, v34, v9
 v_fmac_f32 v31, v35, v9
 v_cvt_pk_bf16_f32 v28, v28, v29
 v_cvt_pk_bf16_f32 v29, v30, v31
 buffer_store_dwordx2 v[28:29], v4, s[24:27], s39 offen
OUTN:
 s_add_u32 s39, s39, 147456
 s_cmp_lt_u32 s36, 16
 s_cbranch_scc1 OUTT
 s_waitcnt vmcnt(0)
 s_endpgm
REC:
 s_load_dwordx2 s[8:9], s[0:1], 136
 s_load_dwordx2 s[12:13], s[0:1], 128
 s_load_dwordx2 s[16:17], s[0:1], 16
 s_load_dwordx2 s[20:21], s[0:1], 24
 s_load_dwordx2 s[24:25], s[0:1], 32
 s_load_dwordx2 s[28:29], s[0:1], 40
 s_load_dwordx2 s[32:33], s[0:1], 8
 s_mov_b32 s10, 100663296
 s_mov_b32 s11, 0x20000
 s_mov_b32 s14, 256
 s_mov_b32 s15, 0x20000
 s_mov_b32 s18, 4718592
 s_mov_b32 s19, 0x20000
 s_mov_b32 s22, 4718592
 s_mov_b32 s23, 0x20000
 s_mov_b32 s26, 4718592
 s_mov_b32 s27, 0x20000
 s_mov_b32 s30, 4718592
 s_mov_b32 s31, 0x20000
 s_mov_b32 s34, 9216
 s_mov_b32 s35, 0x20000
 s_waitcnt lgkmcnt(0)
 s_cmp_eq_u32 s4, 1
 s_cbranch_scc1 RECW1
 s_cmp_eq_u32 s4, 2
 s_cbranch_scc1 RECW2
 s_cmp_eq_u32 s4, 3
 s_cbranch_scc1 RECW3
RECW0:
 v_mbcnt_lo_u32_b32 v8, -1, 0
 v_mbcnt_hi_u32_b32 v8, -1, v8
 v_mov_b32 v4, 0
 v_bfe_u32 v9, v8, 5, 1
 v_lshl_add_u32 v4, v9, 6, v4
 v_mov_b32 v1, 0
 v_bfe_u32 v9, v8, 0, 5
 v_lshl_add_u32 v1, v9, 4, v1
 v_xor_b32 v4, v4, v1
 v_mov_b32 v1, 0
 v_bfe_u32 v9, v8, 5, 1
 s_mov_b32 s101, 1152
 v_mad_u32_u24 v1, v9, s101, v1
 v_add_u32 v4, v4, v1
 v_mov_b32 v7, 0
 v_bfe_u32 v9, v8, 4, 1
 v_lshl_add_u32 v7, v9, 5, v7
 v_mov_b32 v1, 0
 v_bfe_u32 v9, v8, 0, 3
 v_lshl_add_u32 v1, v9, 4, v1
 v_xor_b32 v7, v7, v1
 v_mov_b32 v1, 0
 v_bfe_u32 v9, v8, 3, 1
 s_mov_b32 s101, 1152
 v_mad_u32_u24 v1, v9, s101, v1
 v_bfe_u32 v9, v8, 4, 1
 s_mov_b32 s101, 9216
 v_mad_u32_u24 v1, v9, s101, v1
 v_bfe_u32 v9, v8, 5, 1
 s_mov_b32 s101, 73728
 v_mad_u32_u24 v1, v9, s101, v1
 v_add_u32 v7, v7, v1
 s_lshl_b32 s62, s3, 8
 s_mul_i32 s63, s3, 147456
 s_mov_b32 m0, 36864
 s_add_u32 s54, s63, 1024
 buffer_load_dwordx4 v7, s[28:31], s54 offen lds
 s_mov_b32 m0, 37888
 s_add_u32 s54, s63, 3328
 buffer_load_dwordx4 v7, s[28:31], s54 offen lds
 s_mov_b32 m0, 38912
 s_add_u32 s54, s63, 19456
 buffer_load_dwordx4 v7, s[28:31], s54 offen lds
 s_mov_b32 m0, 39936
 s_add_u32 s54, s63, 21760
 buffer_load_dwordx4 v7, s[28:31], s54 offen lds
 s_mov_b32 m0, 40960
 s_add_u32 s54, s63, 0
 buffer_load_dwordx4 v4, s[28:31], s54 offen lds
 s_mov_b32 m0, 41984
 s_add_u32 s54, s63, 2304
 buffer_load_dwordx4 v4, s[28:31], s54 offen lds
 s_mov_b32 m0, 43008
 s_add_u32 s54, s63, 18432
 buffer_load_dwordx4 v4, s[28:31], s54 offen lds
 s_mov_b32 m0, 44032
 s_add_u32 s54, s63, 20736
 buffer_load_dwordx4 v4, s[28:31], s54 offen lds
 s_mov_b32 m0, 45056
 s_add_u32 s54, s63, 512
 buffer_load_dwordx4 v4, s[28:31], s54 offen lds
 s_mov_b32 m0, 46080
 s_add_u32 s54, s63, 2816
 buffer_load_dwordx4 v4, s[28:31], s54 offen lds
 s_mov_b32 m0, 47104
 s_add_u32 s54, s63, 18944
 buffer_load_dwordx4 v4, s[28:31], s54 offen lds
 s_mov_b32 m0, 48128
 s_add_u32 s54, s63, 21248
 buffer_load_dwordx4 v4, s[28:31], s54 offen lds
 s_mul_i32 s54, s3, 9344
 s_add_u32 s37, s54, 0
 s_add_u32 s38, s54, 8192
 s_mov_b32 s39, 0
 s_mov_b32 s40, 74752
 s_mov_b32 s41, 149504
 s_mov_b32 s42, 224256
 s_mov_b32 s45, 1048576
 s_mov_b32 s46, 1081344
 s_lshl_b32 s54, s3, 14
 s_add_u32 s47, s54, 16777216
 s_add_u32 s58, s54, 16777216
 s_lshl_b32 s54, s3, 12
 s_add_u32 s48, s54, 83886080
 s_mov_b32 s49, 400000
 s_mov_b32 s36, 0
 s_mov_b32 s50, 1040356334
 s_mov_b32 s51, 1040356334
 s_mov_b32 s52, 662700032
 s_mov_b32 s53, 939524096
 s_lshl_b32 s57, s3, 2
 s_lshr_b32 s59, s3, 3
 s_lshl_b32 s59, s59, 11
 s_add_u32 s59, s59, 1024
 s_and_b32 s60, s3, 7
 s_lshl_b32 s54, s60, 7
 s_add_u32 s54, s54, s59
 v_mov_b32 v7, s54
 v_bfe_u32 v9, v8, 3, 3
 s_mov_b32 s101, 9344
 v_mad_u32_u24 v7, v9, s101, v7
 v_bfe_u32 v9, v8, 0, 3
 v_lshl_add_u32 v7, v9, 4, v7
 s_and_b32 s54, s60, 1
 s_lshl_b32 s54, s54, 8
 s_lshr_b32 s61, s60, 1
 s_lshl_b32 s61, s61, 6
 s_add_u32 s54, s54, s61
 s_lshr_b32 s61, s3, 3
 s_lshl_b32 s61, s61, 10
 s_add_u32 s54, s54, s61
 s_add_u32 s54, s54, 4096
 v_mov_b32 v10, s54
 v_bfe_u32 v9, v8, 1, 1
 v_lshl_add_u32 v10, v9, 9, v10
 v_bfe_u32 v9, v8, 2, 1
 v_lshl_add_u32 v10, v9, 5, v10
 v_bfe_u32 v9, v8, 0, 1
 v_lshl_add_u32 v10, v9, 4, v10
 v_bfe_u32 v9, v8, 4, 1
 v_lshl_add_u32 v10, v9, 3, v10
 v_bfe_u32 v9, v8, 5, 1
 v_lshl_add_u32 v10, v9, 2, v10
 v_bfe_u32 v9, v8, 3, 1
 v_lshl_add_u32 v10, v9, 30, v10
 v_mov_b64 v[12:13], -1
 v_mov_b64 v[14:15], -1
 s_mov_b32 s54, 0
 buffer_store_dwordx4 v[12:15], v7, s[8:11], s54 offen sc1
 s_mov_b32 s54, 74752
 buffer_store_dwordx4 v[12:15], v7, s[8:11], s54 offen sc1
 s_mov_b32 s54, 149504
 buffer_store_dwordx4 v[12:15], v7, s[8:11], s54 offen sc1
 s_mov_b32 s54, 224256
 buffer_store_dwordx4 v[12:15], v7, s[8:11], s54 offen sc1
 s_mov_b32 s54, 1048576
 buffer_store_dword v12, v10, s[8:11], s54 offen sc1
 s_mov_b32 s54, 1064960
 buffer_store_dword v12, v10, s[8:11], s54 offen sc1
 s_mov_b32 s54, 1081344
 buffer_store_dword v12, v10, s[8:11], s54 offen sc1
 s_mov_b32 s54, 1097728
 buffer_store_dword v12, v10, s[8:11], s54 offen sc1
 v_lshlrev_b32 v11, 4, v8
 ds_write_b32 v11, v10 offset:13312
 v_mov_b32 v0, 0
 v_bfe_u32 v9, v8, 4, 2
 v_lshl_add_u32 v0, v9, 6, v0
 v_mov_b32 v1, 0
 v_bfe_u32 v9, v8, 0, 4
 v_lshl_add_u32 v1, v9, 4, v1
 v_xor_b32 v0, v0, v1
 v_mov_b32 v1, 0
 v_bfe_u32 v9, v8, 4, 1
 v_lshl_add_u32 v1, v9, 13, v1
 v_bfe_u32 v9, v8, 5, 1
 v_lshl_add_u32 v1, v9, 18, v1
 v_add_u32 v0, v0, v1
 v_mov_b32 v2, 0
 v_bfe_u32 v9, v8, 1, 1
 v_lshl_add_u32 v2, v9, 5, v2
 v_mov_b32 v1, 0
 v_bfe_u32 v9, v8, 4, 1
 v_lshl_add_u32 v1, v9, 4, v1
 v_bfe_u32 v9, v8, 2, 2
 v_lshl_add_u32 v1, v9, 6, v1
 v_xor_b32 v2, v2, v1
 v_mov_b32 v1, 16384
 v_bfe_u32 v9, v8, 4, 2
 s_mov_b32 s101, 36864
 v_mad_u32_u24 v1, v9, s101, v1
 v_bfe_u32 v9, v8, 0, 1
 v_lshl_add_u32 v1, v9, 3, v1
 v_bfe_u32 v9, v8, 2, 2
 v_lshl_add_u32 v1, v9, 8, v1
 v_add_u32 v2, v2, v1
 v_mov_b32 v3, 0
 v_bfe_u32 v9, v8, 1, 1
 v_lshl_add_u32 v3, v9, 4, v3
 v_mov_b32 v1, 0
 v_bfe_u32 v9, v8, 3, 1
 v_lshl_add_u32 v1, v9, 5, v1
 v_bfe_u32 v9, v8, 4, 1
 v_lshl_add_u32 v1, v9, 6, v1
 v_xor_b32 v3, v3, v1
 v_mov_b32 v1, 16384
 v_bfe_u32 v9, v8, 4, 2
 s_mov_b32 s101, 36864
 v_mad_u32_u24 v1, v9, s101, v1
 v_bfe_u32 v9, v8, 0, 1
 v_lshl_add_u32 v1, v9, 3, v1
 v_bfe_u32 v9, v8, 2, 2
 v_lshl_add_u32 v1, v9, 7, v1
 v_add_u32 v3, v3, v1
 v_mov_b32 v5, 0
 v_bfe_u32 v9, v8, 1, 1
 v_lshl_add_u32 v5, v9, 4, v5
 v_bfe_u32 v9, v8, 3, 1
 v_lshl_add_u32 v5, v9, 5, v5
 v_mov_b32 v1, 0
 v_bfe_u32 v9, v8, 2, 1
 v_lshl_add_u32 v1, v9, 6, v1
 v_bfe_u32 v9, v8, 4, 1
 v_lshl_add_u32 v1, v9, 7, v1
 v_xor_b32 v5, v5, v1
 v_mov_b32 v1, 16384
 v_bfe_u32 v9, v8, 4, 2
 s_mov_b32 s101, 36864
 v_mad_u32_u24 v1, v9, s101, v1
 v_bfe_u32 v9, v8, 0, 1
 v_lshl_add_u32 v1, v9, 3, v1
 v_bfe_u32 v9, v8, 2, 1
 v_lshl_add_u32 v1, v9, 9, v1
 v_add_u32 v5, v5, v1
 v_xor_b32 v6, 64, v5
 v_mov_b32 v1, 16384
 v_bfe_u32 v9, v8, 0, 6
 v_lshl_add_u32 v1, v9, 4, v1
 s_waitcnt vmcnt(16) lgkmcnt(0)
 s_barrier
 s_mov_b32 m0, 49152
 s_add_u32 s54, s63, 9216
 buffer_load_dwordx4 v4, s[28:31], s54 offen lds
 s_mov_b32 m0, 50176
 s_add_u32 s54, s63, 11520
 buffer_load_dwordx4 v4, s[28:31], s54 offen lds
 s_mov_b32 m0, 51200
 s_add_u32 s54, s63, 27648
 buffer_load_dwordx4 v4, s[28:31], s54 offen lds
 s_mov_b32 m0, 52224
 s_add_u32 s54, s63, 29952
 buffer_load_dwordx4 v4, s[28:31], s54 offen lds
 ds_read_b64_tr_b16 a[216:217], v3 offset:20480
 ds_read_b64_tr_b16 a[218:219], v3 offset:21504
 ds_read_b64_tr_b16 a[220:221], v3 offset:22528
 ds_read_b64_tr_b16 a[222:223], v3 offset:23552
 ds_read_b64_tr_b16 a[224:225], v3 offset:20992
 ds_read_b64_tr_b16 a[226:227], v3 offset:22016
 ds_read_b64_tr_b16 a[228:229], v3 offset:23040
 ds_read_b64_tr_b16 a[230:231], v3 offset:24064
 s_waitcnt vmcnt(16) lgkmcnt(0)
 s_barrier
 s_mov_b32 m0, 36864
 s_add_u32 s54, s63, 9728
 buffer_load_dwordx4 v4, s[28:31], s54 offen lds
 s_mov_b32 m0, 37888
 s_add_u32 s54, s63, 12032
 buffer_load_dwordx4 v4, s[28:31], s54 offen lds
 s_mov_b32 m0, 38912
 s_add_u32 s54, s63, 28160
 buffer_load_dwordx4 v4, s[28:31], s54 offen lds
 s_mov_b32 m0, 39936
 s_add_u32 s54, s63, 30464
 buffer_load_dwordx4 v4, s[28:31], s54 offen lds
 v_xor_b32 v3, 64, v2
 ds_read_b64_tr_b16 v[48:49], v5 offset:24576
 ds_read_b64_tr_b16 v[50:51], v5 offset:25600
 ds_read_b64_tr_b16 v[52:53], v5 offset:26624
 ds_read_b64_tr_b16 v[54:55], v5 offset:27648
 ds_read_b64_tr_b16 a[144:145], v6 offset:24576
 ds_read_b64_tr_b16 a[146:147], v6 offset:25600
 ds_read_b64_tr_b16 a[148:149], v6 offset:26624
 ds_read_b64_tr_b16 a[150:151], v6 offset:27648
 s_waitcnt vmcnt(16) lgkmcnt(0)
 s_barrier
 s_mov_b32 m0, 40960
 s_add_u32 s54, s63, 73728
 buffer_load_dwordx4 v4, s[28:31], s54 offen lds
 s_mov_b32 m0, 41984
 s_add_u32 s54, s63, 76032
 buffer_load_dwordx4 v4, s[28:31], s54 offen lds
 s_mov_b32 m0, 43008
 s_add_u32 s54, s63, 92160
 buffer_load_dwordx4 v4, s[28:31], s54 offen lds
 s_mov_b32 m0, 44032
 s_add_u32 s54, s63, 94464
 buffer_load_dwordx4 v4, s[28:31], s54 offen lds
 ds_read_b64_tr_b16 a[152:153], v5 offset:28672
 ds_read_b64_tr_b16 a[154:155], v5 offset:29696
 ds_read_b64_tr_b16 a[156:157], v5 offset:30720
 ds_read_b64_tr_b16 a[158:159], v5 offset:31744
 ds_read_b64_tr_b16 a[160:161], v6 offset:28672
 ds_read_b64_tr_b16 a[162:163], v6 offset:29696
 ds_read_b64_tr_b16 a[164:165], v6 offset:30720
 ds_read_b64_tr_b16 a[166:167], v6 offset:31744
 s_waitcnt vmcnt(8) lgkmcnt(0)
 s_barrier
 s_getreg_b32 s64, hwreg(HW_REG_XCC_ID,0,3)
 s_lshl_b32 s54, s64, 2
 s_add_u32 s54, s54, 128
 v_mov_b32 v8, 1
 s_mov_b64 exec, 1
 buffer_atomic_add v8, off, s[12:15], s54 sc1
 s_mov_b64 exec, -1
 s_mov_b32 m0, 45056
 s_add_u32 s54, s63, 74240
 buffer_load_dwordx4 v4, s[28:31], s54 offen lds
 s_mov_b32 m0, 46080
 s_add_u32 s54, s63, 76544
 buffer_load_dwordx4 v4, s[28:31], s54 offen lds
 s_mov_b32 m0, 47104
 s_add_u32 s54, s63, 92672
 buffer_load_dwordx4 v4, s[28:31], s54 offen lds
 s_mov_b32 m0, 48128
 s_add_u32 s54, s63, 94976
 buffer_load_dwordx4 v4, s[28:31], s54 offen lds
 ds_read_b64_tr_b16 a[168:169], v5 offset:32768
 ds_read_b64_tr_b16 a[170:171], v5 offset:33792
 ds_read_b64_tr_b16 a[172:173], v5 offset:34816
 ds_read_b64_tr_b16 a[174:175], v5 offset:35840
 ds_read_b64_tr_b16 a[192:193], v6 offset:32768
 ds_read_b64_tr_b16 a[194:195], v6 offset:33792
 ds_read_b64_tr_b16 a[196:197], v6 offset:34816
 ds_read_b64_tr_b16 a[198:199], v6 offset:35840
 s_waitcnt vmcnt(9) lgkmcnt(0)
 s_barrier
 s_mov_b32 m0, 49152
 s_add_u32 s54, s63, 82944
 buffer_load_dwordx4 v4, s[28:31], s54 offen lds
 s_mov_b32 m0, 50176
 s_add_u32 s54, s63, 85248
 buffer_load_dwordx4 v4, s[28:31], s54 offen lds
 s_mov_b32 m0, 51200
 s_add_u32 s54, s63, 101376
 buffer_load_dwordx4 v4, s[28:31], s54 offen lds
 s_mov_b32 m0, 52224
 s_add_u32 s54, s63, 103680
 buffer_load_dwordx4 v4, s[28:31], s54 offen lds
 ds_read_b64_tr_b16 a[232:233], v5 offset:20480
 ds_read_b64_tr_b16 a[234:235], v5 offset:21504
 ds_read_b64_tr_b16 a[236:237], v5 offset:22528
 ds_read_b64_tr_b16 a[238:239], v5 offset:23552
 ds_read_b64_tr_b16 v[64:65], v6 offset:20480
 ds_read_b64_tr_b16 v[66:67], v6 offset:21504
 ds_read_b64_tr_b16 v[68:69], v6 offset:22528
 ds_read_b64_tr_b16 v[70:71], v6 offset:23552
 s_waitcnt vmcnt(9) lgkmcnt(0)
 s_barrier
 s_mov_b32 m0, 36864
 s_add_u32 s54, s63, 83456
 buffer_load_dwordx4 v4, s[28:31], s54 offen lds
 s_mov_b32 m0, 37888
 s_add_u32 s54, s63, 85760
 buffer_load_dwordx4 v4, s[28:31], s54 offen lds
 s_mov_b32 m0, 38912
 s_add_u32 s54, s63, 101888
 buffer_load_dwordx4 v4, s[28:31], s54 offen lds
 s_mov_b32 m0, 39936
 s_add_u32 s54, s63, 104192
 buffer_load_dwordx4 v4, s[28:31], s54 offen lds
 ds_read_b64_tr_b16 a[176:177], v5 offset:24576
 ds_read_b64_tr_b16 a[178:179], v5 offset:25600
 ds_read_b64_tr_b16 a[180:181], v5 offset:26624
 ds_read_b64_tr_b16 a[182:183], v5 offset:27648
 ds_read_b64_tr_b16 a[200:201], v6 offset:24576
 ds_read_b64_tr_b16 a[202:203], v6 offset:25600
 ds_read_b64_tr_b16 a[204:205], v6 offset:26624
 ds_read_b64_tr_b16 a[206:207], v6 offset:27648
 s_waitcnt vmcnt(8) lgkmcnt(0)
 s_barrier
 s_mov_b32 m0, 40960
 s_add_u32 s54, s62, 0
 buffer_load_dwordx4 v0, s[16:19], s54 offen lds
 s_mov_b32 m0, 41984
 s_add_u32 s54, s62, 16384
 buffer_load_dwordx4 v0, s[16:19], s54 offen lds
 s_mov_b32 m0, 43008
 s_add_u32 s54, s62, 131072
 buffer_load_dwordx4 v0, s[16:19], s54 offen lds
 s_mov_b32 m0, 44032
 s_add_u32 s54, s62, 147456
 buffer_load_dwordx4 v0, s[16:19], s54 offen lds
 ds_read_b64_tr_b16 v[56:57], v5 offset:28672
 ds_read_b64_tr_b16 v[58:59], v5 offset:29696
 ds_read_b64_tr_b16 v[60:61], v5 offset:30720
 ds_read_b64_tr_b16 v[62:63], v5 offset:31744
 ds_read_b64_tr_b16 a[248:249], v6 offset:28672
 ds_read_b64_tr_b16 a[250:251], v6 offset:29696
 ds_read_b64_tr_b16 a[252:253], v6 offset:30720
 ds_read_b64_tr_b16 a[254:255], v6 offset:31744
 s_waitcnt vmcnt(8) lgkmcnt(0)
 s_barrier
 s_mov_b32 m0, 45056
 s_add_u32 s54, s62, 524288
 buffer_load_dwordx4 v0, s[16:19], s54 offen lds
 s_mov_b32 m0, 46080
 s_add_u32 s54, s62, 540672
 buffer_load_dwordx4 v0, s[16:19], s54 offen lds
 s_mov_b32 m0, 47104
 s_add_u32 s54, s62, 655360
 buffer_load_dwordx4 v0, s[16:19], s54 offen lds
 s_mov_b32 m0, 48128
 s_add_u32 s54, s62, 671744
 buffer_load_dwordx4 v0, s[16:19], s54 offen lds
 ds_read_b64_tr_b16 a[184:185], v5 offset:32768
 ds_read_b64_tr_b16 a[186:187], v5 offset:33792
 ds_read_b64_tr_b16 a[188:189], v5 offset:34816
 ds_read_b64_tr_b16 a[190:191], v5 offset:35840
 ds_read_b64_tr_b16 a[208:209], v6 offset:32768
 ds_read_b64_tr_b16 a[210:211], v6 offset:33792
 ds_read_b64_tr_b16 a[212:213], v6 offset:34816
 ds_read_b64_tr_b16 a[214:215], v6 offset:35840
 s_waitcnt vmcnt(8) lgkmcnt(0)
 s_barrier
 s_mov_b32 m0, 49152
 s_add_u32 s54, s62, 1048576
 buffer_load_dwordx4 v0, s[16:19], s54 offen lds
 s_mov_b32 m0, 50176
 s_add_u32 s54, s62, 1064960
 buffer_load_dwordx4 v0, s[16:19], s54 offen lds
 s_mov_b32 m0, 51200
 s_add_u32 s54, s62, 1179648
 buffer_load_dwordx4 v0, s[16:19], s54 offen lds
 s_mov_b32 m0, 52224
 s_add_u32 s54, s62, 1196032
 buffer_load_dwordx4 v0, s[16:19], s54 offen lds
 ds_read_b64_tr_b16 a[240:241], v5 offset:20480
 ds_read_b64_tr_b16 a[242:243], v5 offset:21504
 ds_read_b64_tr_b16 a[244:245], v5 offset:22528
 ds_read_b64_tr_b16 a[246:247], v5 offset:23552
 ds_read_b64_tr_b16 v[72:73], v6 offset:20480
 ds_read_b64_tr_b16 v[74:75], v6 offset:21504
 ds_read_b64_tr_b16 v[76:77], v6 offset:22528
 ds_read_b64_tr_b16 v[78:79], v6 offset:23552
 s_waitcnt vmcnt(8) lgkmcnt(0)
 s_barrier
 s_mov_b32 m0, 36864
 s_add_u32 s54, s62, 1572864
 buffer_load_dwordx4 v0, s[16:19], s54 offen lds
 s_mov_b32 m0, 37888
 s_add_u32 s54, s62, 1589248
 buffer_load_dwordx4 v0, s[16:19], s54 offen lds
 s_mov_b32 m0, 38912
 s_add_u32 s54, s62, 1703936
 buffer_load_dwordx4 v0, s[16:19], s54 offen lds
 s_mov_b32 m0, 39936
 s_add_u32 s54, s62, 1720320
 buffer_load_dwordx4 v0, s[16:19], s54 offen lds
 ds_read_b64_tr_b16 v[8:9], v2 offset:24576
 ds_read_b64_tr_b16 v[10:11], v2 offset:25600
 ds_read_b64_tr_b16 v[12:13], v2 offset:26624
 ds_read_b64_tr_b16 v[14:15], v2 offset:27648
 s_waitcnt lgkmcnt(2)
 ds_write_b128 v1, v[8:11] offset:0
 s_waitcnt lgkmcnt(1)
 ds_write_b128 v1, v[12:15] offset:1024
 ds_read_b64_tr_b16 v[8:9], v3 offset:24576
 ds_read_b64_tr_b16 v[10:11], v3 offset:25600
 ds_read_b64_tr_b16 v[12:13], v3 offset:26624
 ds_read_b64_tr_b16 v[14:15], v3 offset:27648
 s_waitcnt lgkmcnt(2)
 ds_write_b128 v1, v[8:11] offset:2048
 s_waitcnt lgkmcnt(1)
 ds_write_b128 v1, v[12:15] offset:3072
 s_waitcnt vmcnt(8) lgkmcnt(0)
 s_barrier
 s_mov_b32 m0, 40960
 s_add_u32 s54, s62, 4194304
 buffer_load_dwordx4 v0, s[16:19], s54 offen lds
 s_mov_b32 m0, 41984
 s_add_u32 s54, s62, 4210688
 buffer_load_dwordx4 v0, s[16:19], s54 offen lds
 s_mov_b32 m0, 43008
 s_add_u32 s54, s62, 4325376
 buffer_load_dwordx4 v0, s[16:19], s54 offen lds
 s_mov_b32 m0, 44032
 s_add_u32 s54, s62, 4341760
 buffer_load_dwordx4 v0, s[16:19], s54 offen lds
 ds_read_b64_tr_b16 v[96:97], v2 offset:28672
 ds_read_b64_tr_b16 v[98:99], v2 offset:29696
 ds_read_b64_tr_b16 v[100:101], v2 offset:30720
 ds_read_b64_tr_b16 v[102:103], v2 offset:31744
 ds_read_b64_tr_b16 v[104:105], v3 offset:28672
 ds_read_b64_tr_b16 v[106:107], v3 offset:29696
 ds_read_b64_tr_b16 v[108:109], v3 offset:30720
 ds_read_b64_tr_b16 v[110:111], v3 offset:31744
 s_waitcnt vmcnt(8) lgkmcnt(0)
 s_barrier
 s_mov_b32 m0, 45056
 s_add_u32 s54, s62, 0
 buffer_load_dwordx4 v0, s[20:23], s54 offen lds
 s_mov_b32 m0, 46080
 s_add_u32 s54, s62, 16384
 buffer_load_dwordx4 v0, s[20:23], s54 offen lds
 s_mov_b32 m0, 47104
 s_add_u32 s54, s62, 131072
 buffer_load_dwordx4 v0, s[20:23], s54 offen lds
 s_mov_b32 m0, 48128
 s_add_u32 s54, s62, 147456
 buffer_load_dwordx4 v0, s[20:23], s54 offen lds
 ds_read_b64_tr_b16 v[128:129], v2 offset:32768
 ds_read_b64_tr_b16 v[130:131], v2 offset:33792
 ds_read_b64_tr_b16 v[132:133], v2 offset:34816
 ds_read_b64_tr_b16 v[134:135], v2 offset:35840
 ds_read_b64_tr_b16 v[136:137], v3 offset:32768
 ds_read_b64_tr_b16 v[138:139], v3 offset:33792
 ds_read_b64_tr_b16 v[140:141], v3 offset:34816
 ds_read_b64_tr_b16 v[142:143], v3 offset:35840
 s_waitcnt vmcnt(8) lgkmcnt(0)
 s_barrier
 s_mov_b32 m0, 49152
 s_add_u32 s54, s62, 524288
 buffer_load_dwordx4 v0, s[20:23], s54 offen lds
 s_mov_b32 m0, 50176
 s_add_u32 s54, s62, 540672
 buffer_load_dwordx4 v0, s[20:23], s54 offen lds
 s_mov_b32 m0, 51200
 s_add_u32 s54, s62, 655360
 buffer_load_dwordx4 v0, s[20:23], s54 offen lds
 s_mov_b32 m0, 52224
 s_add_u32 s54, s62, 671744
 buffer_load_dwordx4 v0, s[20:23], s54 offen lds
 ds_read_b64_tr_b16 v[168:169], v2 offset:20480
 ds_read_b64_tr_b16 v[170:171], v2 offset:21504
 ds_read_b64_tr_b16 v[172:173], v2 offset:22528
 ds_read_b64_tr_b16 v[174:175], v2 offset:23552
 ds_read_b64_tr_b16 v[8:9], v3 offset:20480
 ds_read_b64_tr_b16 v[10:11], v3 offset:21504
 ds_read_b64_tr_b16 v[12:13], v3 offset:22528
 ds_read_b64_tr_b16 v[14:15], v3 offset:23552
 s_waitcnt lgkmcnt(2)
 ds_write_b128 v1, v[8:11] offset:14336
 s_waitcnt lgkmcnt(1)
 ds_write_b128 v1, v[12:15] offset:15360
 s_waitcnt vmcnt(8) lgkmcnt(0)
 s_barrier
 s_mov_b32 m0, 36864
 s_add_u32 s54, s62, 1048576
 buffer_load_dwordx4 v0, s[20:23], s54 offen lds
 s_mov_b32 m0, 37888
 s_add_u32 s54, s62, 1064960
 buffer_load_dwordx4 v0, s[20:23], s54 offen lds
 s_mov_b32 m0, 38912
 s_add_u32 s54, s62, 1179648
 buffer_load_dwordx4 v0, s[20:23], s54 offen lds
 s_mov_b32 m0, 39936
 s_add_u32 s54, s62, 1196032
 buffer_load_dwordx4 v0, s[20:23], s54 offen lds
 ds_read_b64_tr_b16 v[216:217], v2 offset:24576
 ds_read_b64_tr_b16 v[218:219], v2 offset:25600
 ds_read_b64_tr_b16 v[220:221], v2 offset:26624
 ds_read_b64_tr_b16 v[222:223], v2 offset:27648
 ds_read_b64_tr_b16 v[8:9], v3 offset:24576
 ds_read_b64_tr_b16 v[10:11], v3 offset:25600
 ds_read_b64_tr_b16 v[12:13], v3 offset:26624
 ds_read_b64_tr_b16 v[14:15], v3 offset:27648
 s_waitcnt lgkmcnt(2)
 ds_write_b128 v1, v[8:11] offset:18432
 s_waitcnt lgkmcnt(1)
 ds_write_b128 v1, v[12:15] offset:19456
 s_waitcnt vmcnt(8) lgkmcnt(0)
 s_barrier
 s_mov_b32 m0, 40960
 s_add_u32 s54, s62, 1572864
 buffer_load_dwordx4 v0, s[20:23], s54 offen lds
 s_mov_b32 m0, 41984
 s_add_u32 s54, s62, 1589248
 buffer_load_dwordx4 v0, s[20:23], s54 offen lds
 s_mov_b32 m0, 43008
 s_add_u32 s54, s62, 1703936
 buffer_load_dwordx4 v0, s[20:23], s54 offen lds
 s_mov_b32 m0, 44032
 s_add_u32 s54, s62, 1720320
 buffer_load_dwordx4 v0, s[20:23], s54 offen lds
 ds_read_b64_tr_b16 v[8:9], v2 offset:28672
 ds_read_b64_tr_b16 v[10:11], v2 offset:29696
 ds_read_b64_tr_b16 v[12:13], v2 offset:30720
 ds_read_b64_tr_b16 v[14:15], v2 offset:31744
 s_waitcnt lgkmcnt(2)
 ds_write_b128 v1, v[8:11] offset:4096
 s_waitcnt lgkmcnt(1)
 ds_write_b128 v1, v[12:15] offset:5120
 ds_read_b64_tr_b16 v[8:9], v3 offset:28672
 ds_read_b64_tr_b16 v[10:11], v3 offset:29696
 ds_read_b64_tr_b16 v[12:13], v3 offset:30720
 ds_read_b64_tr_b16 v[14:15], v3 offset:31744
 s_waitcnt lgkmcnt(2)
 ds_write_b128 v1, v[8:11] offset:6144
 s_waitcnt lgkmcnt(1)
 ds_write_b128 v1, v[12:15] offset:7168
 s_waitcnt vmcnt(8) lgkmcnt(0)
 s_barrier
 s_mov_b32 m0, 45056
 s_add_u32 s54, s62, 0
 buffer_load_dwordx4 v0, s[24:27], s54 offen lds
 s_mov_b32 m0, 46080
 s_add_u32 s54, s62, 16384
 buffer_load_dwordx4 v0, s[24:27], s54 offen lds
 s_mov_b32 m0, 47104
 s_add_u32 s54, s62, 131072
 buffer_load_dwordx4 v0, s[24:27], s54 offen lds
 s_mov_b32 m0, 48128
 s_add_u32 s54, s62, 147456
 buffer_load_dwordx4 v0, s[24:27], s54 offen lds
 ds_read_b64_tr_b16 v[112:113], v2 offset:32768
 ds_read_b64_tr_b16 v[114:115], v2 offset:33792
 ds_read_b64_tr_b16 v[116:117], v2 offset:34816
 ds_read_b64_tr_b16 v[118:119], v2 offset:35840
 ds_read_b64_tr_b16 v[8:9], v3 offset:32768
 ds_read_b64_tr_b16 v[10:11], v3 offset:33792
 ds_read_b64_tr_b16 v[12:13], v3 offset:34816
 ds_read_b64_tr_b16 v[14:15], v3 offset:35840
 s_waitcnt lgkmcnt(2)
 ds_write_b128 v1, v[8:11] offset:8192
 s_waitcnt lgkmcnt(1)
 ds_write_b128 v1, v[12:15] offset:9216
 s_waitcnt vmcnt(8) lgkmcnt(0)
 s_barrier
 s_mov_b32 m0, 49152
 s_add_u32 s54, s62, 524288
 buffer_load_dwordx4 v0, s[24:27], s54 offen lds
 s_mov_b32 m0, 50176
 s_add_u32 s54, s62, 540672
 buffer_load_dwordx4 v0, s[24:27], s54 offen lds
 s_mov_b32 m0, 51200
 s_add_u32 s54, s62, 655360
 buffer_load_dwordx4 v0, s[24:27], s54 offen lds
 s_mov_b32 m0, 52224
 s_add_u32 s54, s62, 671744
 buffer_load_dwordx4 v0, s[24:27], s54 offen lds
 ds_read_b64_tr_b16 v[144:145], v2 offset:20480
 ds_read_b64_tr_b16 v[146:147], v2 offset:21504
 ds_read_b64_tr_b16 v[148:149], v2 offset:22528
 ds_read_b64_tr_b16 v[150:151], v2 offset:23552
 ds_read_b64_tr_b16 v[152:153], v3 offset:20480
 ds_read_b64_tr_b16 v[154:155], v3 offset:21504
 ds_read_b64_tr_b16 v[156:157], v3 offset:22528
 ds_read_b64_tr_b16 v[158:159], v3 offset:23552
 s_waitcnt vmcnt(8) lgkmcnt(0)
 s_barrier
 s_mov_b32 m0, 36864
 s_add_u32 s54, s62, 1048576
 buffer_load_dwordx4 v0, s[24:27], s54 offen lds
 s_mov_b32 m0, 37888
 s_add_u32 s54, s62, 1064960
 buffer_load_dwordx4 v0, s[24:27], s54 offen lds
 s_mov_b32 m0, 38912
 s_add_u32 s54, s62, 1179648
 buffer_load_dwordx4 v0, s[24:27], s54 offen lds
 s_mov_b32 m0, 39936
 s_add_u32 s54, s62, 1196032
 buffer_load_dwordx4 v0, s[24:27], s54 offen lds
 ds_read_b64_tr_b16 v[176:177], v2 offset:24576
 ds_read_b64_tr_b16 v[178:179], v2 offset:25600
 ds_read_b64_tr_b16 v[180:181], v2 offset:26624
 ds_read_b64_tr_b16 v[182:183], v2 offset:27648
 ds_read_b64_tr_b16 v[184:185], v3 offset:24576
 ds_read_b64_tr_b16 v[186:187], v3 offset:25600
 ds_read_b64_tr_b16 v[188:189], v3 offset:26624
 ds_read_b64_tr_b16 v[190:191], v3 offset:27648
 s_waitcnt vmcnt(8) lgkmcnt(0)
 s_barrier
 s_mov_b32 m0, 40960
 s_add_u32 s54, s62, 1572864
 buffer_load_dwordx4 v0, s[24:27], s54 offen lds
 s_mov_b32 m0, 41984
 s_add_u32 s54, s62, 1589248
 buffer_load_dwordx4 v0, s[24:27], s54 offen lds
 s_mov_b32 m0, 43008
 s_add_u32 s54, s62, 1703936
 buffer_load_dwordx4 v0, s[24:27], s54 offen lds
 s_mov_b32 m0, 44032
 s_add_u32 s54, s62, 1720320
 buffer_load_dwordx4 v0, s[24:27], s54 offen lds
 ds_read_b64_tr_b16 v[80:81], v2 offset:28672
 ds_read_b64_tr_b16 v[82:83], v2 offset:29696
 ds_read_b64_tr_b16 v[84:85], v2 offset:30720
 ds_read_b64_tr_b16 v[86:87], v2 offset:31744
 ds_read_b64_tr_b16 v[88:89], v3 offset:28672
 ds_read_b64_tr_b16 v[90:91], v3 offset:29696
 ds_read_b64_tr_b16 v[92:93], v3 offset:30720
 ds_read_b64_tr_b16 v[94:95], v3 offset:31744
 s_waitcnt vmcnt(8) lgkmcnt(0)
 s_barrier
 s_mov_b32 m0, 45056
 s_add_u32 s54, s62, 2097152
 buffer_load_dwordx4 v0, s[16:19], s54 offen lds
 s_mov_b32 m0, 46080
 s_add_u32 s54, s62, 2113536
 buffer_load_dwordx4 v0, s[16:19], s54 offen lds
 s_mov_b32 m0, 47104
 s_add_u32 s54, s62, 2228224
 buffer_load_dwordx4 v0, s[16:19], s54 offen lds
 s_mov_b32 m0, 48128
 s_add_u32 s54, s62, 2244608
 buffer_load_dwordx4 v0, s[16:19], s54 offen lds
 ds_read_b64_tr_b16 v[120:121], v2 offset:32768
 ds_read_b64_tr_b16 v[122:123], v2 offset:33792
 ds_read_b64_tr_b16 v[124:125], v2 offset:34816
 ds_read_b64_tr_b16 v[126:127], v2 offset:35840
 ds_read_b64_tr_b16 v[8:9], v3 offset:32768
 ds_read_b64_tr_b16 v[10:11], v3 offset:33792
 ds_read_b64_tr_b16 v[12:13], v3 offset:34816
 ds_read_b64_tr_b16 v[14:15], v3 offset:35840
 s_waitcnt lgkmcnt(2)
 ds_write_b128 v1, v[8:11] offset:10240
 s_waitcnt lgkmcnt(1)
 ds_write_b128 v1, v[12:15] offset:11264
 s_waitcnt vmcnt(8) lgkmcnt(0)
 s_barrier
 s_mov_b32 m0, 49152
 s_add_u32 s54, s62, 2621440
 buffer_load_dwordx4 v0, s[16:19], s54 offen lds
 s_mov_b32 m0, 50176
 s_add_u32 s54, s62, 2637824
 buffer_load_dwordx4 v0, s[16:19], s54 offen lds
 s_mov_b32 m0, 51200
 s_add_u32 s54, s62, 2752512
 buffer_load_dwordx4 v0, s[16:19], s54 offen lds
 s_mov_b32 m0, 52224
 s_add_u32 s54, s62, 2768896
 buffer_load_dwordx4 v0, s[16:19], s54 offen lds
 ds_read_b64_tr_b16 v[8:9], v2 offset:20480
 ds_read_b64_tr_b16 v[10:11], v2 offset:21504
 ds_read_b64_tr_b16 v[12:13], v2 offset:22528
 ds_read_b64_tr_b16 v[14:15], v2 offset:23552
 s_waitcnt lgkmcnt(2)
 ds_write_b128 v1, v[8:11] offset:12288
 s_waitcnt lgkmcnt(1)
 ds_write_b128 v1, v[12:15] offset:13312
 ds_read_b64_tr_b16 v[160:161], v3 offset:20480
 ds_read_b64_tr_b16 v[162:163], v3 offset:21504
 ds_read_b64_tr_b16 v[164:165], v3 offset:22528
 ds_read_b64_tr_b16 v[166:167], v3 offset:23552
 s_waitcnt vmcnt(8) lgkmcnt(0)
 s_barrier
 s_mov_b32 m0, 36864
 s_add_u32 s54, s62, 3145728
 buffer_load_dwordx4 v0, s[16:19], s54 offen lds
 s_mov_b32 m0, 37888
 s_add_u32 s54, s62, 3162112
 buffer_load_dwordx4 v0, s[16:19], s54 offen lds
 s_mov_b32 m0, 38912
 s_add_u32 s54, s62, 3276800
 buffer_load_dwordx4 v0, s[16:19], s54 offen lds
 s_mov_b32 m0, 39936
 s_add_u32 s54, s62, 3293184
 buffer_load_dwordx4 v0, s[16:19], s54 offen lds
 ds_read_b64_tr_b16 v[192:193], v2 offset:24576
 ds_read_b64_tr_b16 v[194:195], v2 offset:25600
 ds_read_b64_tr_b16 v[196:197], v2 offset:26624
 ds_read_b64_tr_b16 v[198:199], v2 offset:27648
 ds_read_b64_tr_b16 v[8:9], v3 offset:24576
 ds_read_b64_tr_b16 v[10:11], v3 offset:25600
 ds_read_b64_tr_b16 v[12:13], v3 offset:26624
 ds_read_b64_tr_b16 v[14:15], v3 offset:27648
 s_waitcnt lgkmcnt(2)
 ds_write_b128 v1, v[8:11] offset:16384
 s_waitcnt lgkmcnt(1)
 ds_write_b128 v1, v[12:15] offset:17408
 s_waitcnt vmcnt(8) lgkmcnt(0)
 s_barrier
 s_mov_b32 m0, 40960
 s_add_u32 s54, s62, 3670016
 buffer_load_dwordx4 v0, s[16:19], s54 offen lds
 s_mov_b32 m0, 41984
 s_add_u32 s54, s62, 3686400
 buffer_load_dwordx4 v0, s[16:19], s54 offen lds
 s_mov_b32 m0, 43008
 s_add_u32 s54, s62, 3801088
 buffer_load_dwordx4 v0, s[16:19], s54 offen lds
 s_mov_b32 m0, 44032
 s_add_u32 s54, s62, 3817472
 buffer_load_dwordx4 v0, s[16:19], s54 offen lds
 ds_read_b64_tr_b16 v[200:201], v2 offset:28672
 ds_read_b64_tr_b16 v[202:203], v2 offset:29696
 ds_read_b64_tr_b16 v[204:205], v2 offset:30720
 ds_read_b64_tr_b16 v[206:207], v2 offset:31744
 ds_read_b64_tr_b16 v[208:209], v3 offset:28672
 ds_read_b64_tr_b16 v[210:211], v3 offset:29696
 ds_read_b64_tr_b16 v[212:213], v3 offset:30720
 ds_read_b64_tr_b16 v[214:215], v3 offset:31744
 s_waitcnt vmcnt(8) lgkmcnt(0)
 s_barrier
 s_mov_b32 m0, 45056
 s_add_u32 s54, s62, 2097152
 buffer_load_dwordx4 v0, s[20:23], s54 offen lds
 s_mov_b32 m0, 46080
 s_add_u32 s54, s62, 2113536
 buffer_load_dwordx4 v0, s[20:23], s54 offen lds
 s_mov_b32 m0, 47104
 s_add_u32 s54, s62, 2228224
 buffer_load_dwordx4 v0, s[20:23], s54 offen lds
 s_mov_b32 m0, 48128
 s_add_u32 s54, s62, 2244608
 buffer_load_dwordx4 v0, s[20:23], s54 offen lds
 ds_read_b64_tr_b16 v[224:225], v2 offset:32768
 ds_read_b64_tr_b16 v[226:227], v2 offset:33792
 ds_read_b64_tr_b16 v[228:229], v2 offset:34816
 ds_read_b64_tr_b16 v[230:231], v2 offset:35840
 ds_read_b64_tr_b16 v[248:249], v3 offset:32768
 ds_read_b64_tr_b16 v[250:251], v3 offset:33792
 ds_read_b64_tr_b16 v[252:253], v3 offset:34816
 ds_read_b64_tr_b16 v[254:255], v3 offset:35840
 s_waitcnt vmcnt(8) lgkmcnt(0)
 s_barrier
 s_mov_b32 m0, 49152
 s_add_u32 s54, s62, 2621440
 buffer_load_dwordx4 v0, s[20:23], s54 offen lds
 s_mov_b32 m0, 50176
 s_add_u32 s54, s62, 2637824
 buffer_load_dwordx4 v0, s[20:23], s54 offen lds
 s_mov_b32 m0, 51200
 s_add_u32 s54, s62, 2752512
 buffer_load_dwordx4 v0, s[20:23], s54 offen lds
 s_mov_b32 m0, 52224
 s_add_u32 s54, s62, 2768896
 buffer_load_dwordx4 v0, s[20:23], s54 offen lds
 ds_read_b64_tr_b16 v[232:233], v2 offset:20480
 ds_read_b64_tr_b16 v[234:235], v2 offset:21504
 ds_read_b64_tr_b16 v[236:237], v2 offset:22528
 ds_read_b64_tr_b16 v[238:239], v2 offset:23552
 ds_read_b64_tr_b16 a[0:1], v3 offset:20480
 ds_read_b64_tr_b16 a[2:3], v3 offset:21504
 ds_read_b64_tr_b16 a[4:5], v3 offset:22528
 ds_read_b64_tr_b16 a[6:7], v3 offset:23552
 s_waitcnt vmcnt(8) lgkmcnt(0)
 s_barrier
 s_mov_b32 m0, 36864
 s_add_u32 s54, s62, 3145728
 buffer_load_dwordx4 v0, s[20:23], s54 offen lds
 s_mov_b32 m0, 37888
 s_add_u32 s54, s62, 3162112
 buffer_load_dwordx4 v0, s[20:23], s54 offen lds
 s_mov_b32 m0, 38912
 s_add_u32 s54, s62, 3276800
 buffer_load_dwordx4 v0, s[20:23], s54 offen lds
 s_mov_b32 m0, 39936
 s_add_u32 s54, s62, 3293184
 buffer_load_dwordx4 v0, s[20:23], s54 offen lds
 ds_read_b64_tr_b16 v[240:241], v2 offset:24576
 ds_read_b64_tr_b16 v[242:243], v2 offset:25600
 ds_read_b64_tr_b16 v[244:245], v2 offset:26624
 ds_read_b64_tr_b16 v[246:247], v2 offset:27648
 ds_read_b64_tr_b16 a[8:9], v3 offset:24576
 ds_read_b64_tr_b16 a[10:11], v3 offset:25600
 ds_read_b64_tr_b16 a[12:13], v3 offset:26624
 ds_read_b64_tr_b16 a[14:15], v3 offset:27648
 s_waitcnt vmcnt(8) lgkmcnt(0)
 s_barrier
 s_mov_b32 m0, 40960
 s_add_u32 s54, s62, 3670016
 buffer_load_dwordx4 v0, s[20:23], s54 offen lds
 s_mov_b32 m0, 41984
 s_add_u32 s54, s62, 3686400
 buffer_load_dwordx4 v0, s[20:23], s54 offen lds
 s_mov_b32 m0, 43008
 s_add_u32 s54, s62, 3801088
 buffer_load_dwordx4 v0, s[20:23], s54 offen lds
 s_mov_b32 m0, 44032
 s_add_u32 s54, s62, 3817472
 buffer_load_dwordx4 v0, s[20:23], s54 offen lds
 ds_read_b64_tr_b16 v[16:17], v2 offset:28672
 ds_read_b64_tr_b16 v[18:19], v2 offset:29696
 ds_read_b64_tr_b16 v[20:21], v2 offset:30720
 ds_read_b64_tr_b16 v[22:23], v2 offset:31744
 ds_read_b64_tr_b16 a[48:49], v3 offset:28672
 ds_read_b64_tr_b16 a[50:51], v3 offset:29696
 ds_read_b64_tr_b16 a[52:53], v3 offset:30720
 ds_read_b64_tr_b16 a[54:55], v3 offset:31744
 s_waitcnt vmcnt(8) lgkmcnt(0)
 s_barrier
 s_mov_b32 m0, 45056
 s_add_u32 s54, s62, 4194304
 buffer_load_dwordx4 v0, s[20:23], s54 offen lds
 s_mov_b32 m0, 46080
 s_add_u32 s54, s62, 4210688
 buffer_load_dwordx4 v0, s[20:23], s54 offen lds
 s_mov_b32 m0, 47104
 s_add_u32 s54, s62, 4325376
 buffer_load_dwordx4 v0, s[20:23], s54 offen lds
 s_mov_b32 m0, 48128
 s_add_u32 s54, s62, 4341760
 buffer_load_dwordx4 v0, s[20:23], s54 offen lds
 v_mbcnt_lo_u32_b32 v8, -1, 0
 v_mbcnt_hi_u32_b32 v8, -1, v8
 v_lshlrev_b32 v4, 7, v8
 v_mov_b32 v5, 0
 v_bfe_u32 v9, v8, 2, 2
 s_mov_b32 s101, 2304
 v_mad_u32_u24 v5, v9, s101, v5
 v_bfe_u32 v9, v8, 0, 1
 s_mov_b32 s101, 1152
 v_mad_u32_u24 v5, v9, s101, v5
 v_bfe_u32 v9, v8, 1, 1
 v_lshl_add_u32 v5, v9, 6, v5
 v_bfe_u32 v9, v8, 4, 2
 v_lshl_add_u32 v5, v9, 4, v5
 s_mov_b32 m0, 0
 s_mov_b32 s54, 0
 buffer_load_dwordx4 v5, s[32:35], s54 offen lds
 s_mov_b32 m0, 1024
 s_mov_b32 s54, 512
 buffer_load_dwordx4 v5, s[32:35], s54 offen lds
 s_mov_b32 m0, 8192
 s_mov_b32 s54, 1024
 buffer_load_dwordx4 v5, s[32:35], s54 offen lds
 ds_read_b64_tr_b16 a[24:25], v2 offset:32768
 ds_read_b64_tr_b16 a[26:27], v2 offset:33792
 ds_read_b64_tr_b16 a[28:29], v2 offset:34816
 ds_read_b64_tr_b16 a[30:31], v2 offset:35840
 ds_read_b64_tr_b16 v[24:25], v3 offset:32768
 ds_read_b64_tr_b16 v[26:27], v3 offset:33792
 ds_read_b64_tr_b16 v[28:29], v3 offset:34816
 ds_read_b64_tr_b16 v[30:31], v3 offset:35840
 s_waitcnt vmcnt(11) lgkmcnt(0)
 s_barrier
 s_mov_b32 m0, 49152
 s_add_u32 s54, s62, 2097152
 buffer_load_dwordx4 v0, s[24:27], s54 offen lds
 s_mov_b32 m0, 50176
 s_add_u32 s54, s62, 2113536
 buffer_load_dwordx4 v0, s[24:27], s54 offen lds
 s_mov_b32 m0, 51200
 s_add_u32 s54, s62, 2228224
 buffer_load_dwordx4 v0, s[24:27], s54 offen lds
 s_mov_b32 m0, 52224
 s_add_u32 s54, s62, 2244608
 buffer_load_dwordx4 v0, s[24:27], s54 offen lds
 s_mov_b32 s54, 128
 buffer_load_dwordx4 v[8:11], off, s[12:15], s54 sc1
 buffer_load_dwordx4 v[12:15], off, s[12:15], s54 offset:16 sc1
 ds_read_b64_tr_b16 a[32:33], v2 offset:20480
 ds_read_b64_tr_b16 a[34:35], v2 offset:21504
 ds_read_b64_tr_b16 a[36:37], v2 offset:22528
 ds_read_b64_tr_b16 a[38:39], v2 offset:23552
 ds_read_b64_tr_b16 a[64:65], v3 offset:20480
 ds_read_b64_tr_b16 a[66:67], v3 offset:21504
 ds_read_b64_tr_b16 a[68:69], v3 offset:22528
 ds_read_b64_tr_b16 a[70:71], v3 offset:23552
 s_waitcnt vmcnt(13) lgkmcnt(0)
 s_barrier
 s_mov_b32 m0, 36864
 s_add_u32 s54, s62, 2621440
 buffer_load_dwordx4 v0, s[24:27], s54 offen lds
 s_mov_b32 m0, 37888
 s_add_u32 s54, s62, 2637824
 buffer_load_dwordx4 v0, s[24:27], s54 offen lds
 s_mov_b32 m0, 38912
 s_add_u32 s54, s62, 2752512
 buffer_load_dwordx4 v0, s[24:27], s54 offen lds
 s_mov_b32 m0, 39936
 s_add_u32 s54, s62, 2768896
 buffer_load_dwordx4 v0, s[24:27], s54 offen lds
 ds_read_b64_tr_b16 a[40:41], v2 offset:24576
 ds_read_b64_tr_b16 a[42:43], v2 offset:25600
 ds_read_b64_tr_b16 a[44:45], v2 offset:26624
 ds_read_b64_tr_b16 a[46:47], v2 offset:27648
 ds_read_b64_tr_b16 a[72:73], v3 offset:24576
 ds_read_b64_tr_b16 a[74:75], v3 offset:25600
 ds_read_b64_tr_b16 a[76:77], v3 offset:26624
 ds_read_b64_tr_b16 a[78:79], v3 offset:27648
 s_waitcnt vmcnt(13) lgkmcnt(0)
 s_barrier
 s_mov_b32 m0, 40960
 s_add_u32 s54, s62, 3145728
 buffer_load_dwordx4 v0, s[24:27], s54 offen lds
 s_mov_b32 m0, 41984
 s_add_u32 s54, s62, 3162112
 buffer_load_dwordx4 v0, s[24:27], s54 offen lds
 s_mov_b32 m0, 43008
 s_add_u32 s54, s62, 3276800
 buffer_load_dwordx4 v0, s[24:27], s54 offen lds
 s_mov_b32 m0, 44032
 s_add_u32 s54, s62, 3293184
 buffer_load_dwordx4 v0, s[24:27], s54 offen lds
 ds_read_b64_tr_b16 a[16:17], v2 offset:28672
 ds_read_b64_tr_b16 a[18:19], v2 offset:29696
 ds_read_b64_tr_b16 a[20:21], v2 offset:30720
 ds_read_b64_tr_b16 a[22:23], v2 offset:31744
 ds_read_b64_tr_b16 a[56:57], v3 offset:28672
 ds_read_b64_tr_b16 a[58:59], v3 offset:29696
 ds_read_b64_tr_b16 a[60:61], v3 offset:30720
 ds_read_b64_tr_b16 a[62:63], v3 offset:31744
 s_waitcnt vmcnt(10) lgkmcnt(0)
 s_barrier
 s_mov_b32 m0, 45056
 s_add_u32 s54, s62, 3670016
 buffer_load_dwordx4 v0, s[24:27], s54 offen lds
 s_mov_b32 m0, 46080
 s_add_u32 s54, s62, 3686400
 buffer_load_dwordx4 v0, s[24:27], s54 offen lds
 s_mov_b32 m0, 47104
 s_add_u32 s54, s62, 3801088
 buffer_load_dwordx4 v0, s[24:27], s54 offen lds
 s_mov_b32 m0, 48128
 s_add_u32 s54, s62, 3817472
 buffer_load_dwordx4 v0, s[24:27], s54 offen lds
 ds_read_b64_tr_b16 a[80:81], v2 offset:32768
 ds_read_b64_tr_b16 a[82:83], v2 offset:33792
 ds_read_b64_tr_b16 a[84:85], v2 offset:34816
 ds_read_b64_tr_b16 a[86:87], v2 offset:35840
 ds_read_b64_tr_b16 a[88:89], v3 offset:32768
 ds_read_b64_tr_b16 a[90:91], v3 offset:33792
 ds_read_b64_tr_b16 a[92:93], v3 offset:34816
 ds_read_b64_tr_b16 a[94:95], v3 offset:35840
 s_waitcnt vmcnt(8) lgkmcnt(0)
 s_barrier
 s_mov_b32 m0, 49152
 s_add_u32 s54, s62, 4194304
 buffer_load_dwordx4 v0, s[24:27], s54 offen lds
 s_mov_b32 m0, 50176
 s_add_u32 s54, s62, 4210688
 buffer_load_dwordx4 v0, s[24:27], s54 offen lds
 s_mov_b32 m0, 51200
 s_add_u32 s54, s62, 4325376
 buffer_load_dwordx4 v0, s[24:27], s54 offen lds
 s_mov_b32 m0, 52224
 s_add_u32 s54, s62, 4341760
 buffer_load_dwordx4 v0, s[24:27], s54 offen lds
 s_branch RSC_3
RSB_1:
 s_cmp_lt_u32 s49, 1
 s_cbranch_scc1 RSE_2
 s_sub_u32 s49, s49, 1
 s_mov_b32 s54, 128
 buffer_load_dwordx4 v[8:11], off, s[12:15], s54 sc1
 buffer_load_dwordx4 v[12:15], off, s[12:15], s54 offset:16 sc1
 s_waitcnt vmcnt(0)
RSC_3:
 v_add3_u32 v7, v8, v9, v10
 v_add3_u32 v7, v7, v11, v12
 v_add3_u32 v7, v7, v13, v14
 v_add_u32 v7, v7, v15
 v_cmp_gt_u32 vcc, 32, v7
 s_cbranch_vccnz RSB_1
RSE_2:
 v_max3_u32 v8, v8, v9, v10
 v_max3_u32 v8, v8, v11, v12
 v_max3_u32 v8, v8, v13, v14
 v_max_u32 v8, v8, v15
 s_nop 0
 v_readfirstlane_b32 s64, v8
 s_mov_b32 m0, 10240
 s_sub_u32 s54, s37, 0
 buffer_load_dword v4, s[8:11], s54 offen sc1 lds
 ds_read_b64_tr_b16 a[104:105], v2 offset:20480
 ds_read_b64_tr_b16 a[106:107], v2 offset:21504
 ds_read_b64_tr_b16 a[108:109], v2 offset:22528
 ds_read_b64_tr_b16 a[110:111], v2 offset:23552
 ds_read_b64_tr_b16 a[112:113], v3 offset:20480
 ds_read_b64_tr_b16 a[114:115], v3 offset:21504
 ds_read_b64_tr_b16 a[116:117], v3 offset:22528
 ds_read_b64_tr_b16 a[118:119], v3 offset:23552
 s_waitcnt vmcnt(9) lgkmcnt(0)
 s_barrier
 ds_read_b64_tr_b16 a[120:121], v2 offset:24576
 ds_read_b64_tr_b16 a[122:123], v2 offset:25600
 ds_read_b64_tr_b16 a[124:125], v2 offset:26624
 ds_read_b64_tr_b16 a[126:127], v2 offset:27648
 ds_read_b64_tr_b16 v[40:41], v3 offset:24576
 ds_read_b64_tr_b16 v[42:43], v3 offset:25600
 ds_read_b64_tr_b16 v[44:45], v3 offset:26624
 ds_read_b64_tr_b16 v[46:47], v3 offset:27648
 s_waitcnt vmcnt(5) lgkmcnt(0)
 s_barrier
 ds_read_b64_tr_b16 a[128:129], v2 offset:28672
 ds_read_b64_tr_b16 a[130:131], v2 offset:29696
 ds_read_b64_tr_b16 a[132:133], v2 offset:30720
 ds_read_b64_tr_b16 a[134:135], v2 offset:31744
 ds_read_b64_tr_b16 a[136:137], v3 offset:28672
 ds_read_b64_tr_b16 a[138:139], v3 offset:29696
 ds_read_b64_tr_b16 a[140:141], v3 offset:30720
 ds_read_b64_tr_b16 a[142:143], v3 offset:31744
 s_waitcnt vmcnt(1) lgkmcnt(0)
 s_barrier
 ds_read_b64_tr_b16 v[32:33], v2 offset:32768
 ds_read_b64_tr_b16 v[34:35], v2 offset:33792
 ds_read_b64_tr_b16 v[36:37], v2 offset:34816
 ds_read_b64_tr_b16 v[38:39], v2 offset:35840
 ds_read_b64_tr_b16 a[96:97], v3 offset:32768
 ds_read_b64_tr_b16 a[98:99], v3 offset:33792
 ds_read_b64_tr_b16 a[100:101], v3 offset:34816
 ds_read_b64_tr_b16 a[102:103], v3 offset:35840
 s_waitcnt lgkmcnt(0)
 s_barrier
 ds_write_b128 v1, v[16:19] offset:20480
 ds_write_b128 v1, v[20:23] offset:21504
 ds_write_b128 v1, v[24:27] offset:22528
 ds_write_b128 v1, v[28:31] offset:23552
 ds_write_b128 v1, v[32:35] offset:24576
 ds_write_b128 v1, v[36:39] offset:25600
 ds_write_b128 v1, v[40:43] offset:26624
 ds_write_b128 v1, v[44:47] offset:27648
 ds_write_b128 v1, v[48:51] offset:28672
 ds_write_b128 v1, v[52:55] offset:29696
 ds_write_b128 v1, v[56:59] offset:30720
 ds_write_b128 v1, v[60:63] offset:31744
 ds_write_b128 v1, v[64:67] offset:32768
 ds_write_b128 v1, v[68:71] offset:33792
 ds_write_b128 v1, v[72:75] offset:34816
 ds_write_b128 v1, v[76:79] offset:35840
 v_mbcnt_lo_u32_b32 v8, -1, 0
 v_mbcnt_hi_u32_b32 v8, -1, v8
 v_lshlrev_b32 v0, 4, v8
 v_lshrrev_b32 v6, 4, v8
 v_xor_b32 v6, v6, v8
 v_lshlrev_b32 v6, 3, v6
 ds_read_b128 v[32:35], v0 offset:0
 ds_read_b128 v[36:39], v0 offset:1024
 ds_read_b128 v[40:43], v0 offset:8192
 v_mov_b32 v2, 17476
 v_bfe_u32 v9, v8, 1, 1
 s_mov_b32 s101, 43690
 v_mad_u32_u24 v2, v9, s101, v2
 v_mov_b32 v4, 0
 v_bfe_u32 v9, v8, 4, 2
 v_lshl_add_u32 v4, v9, 8, v4
 v_bfe_u32 v9, v8, 2, 2
 v_lshl_add_u32 v4, v9, 5, v4
 v_bfe_u32 v9, v8, 0, 1
 v_lshl_add_u32 v4, v9, 4, v4
 v_mov_b32 v3, v4
 v_bfe_u32 v9, v8, 1, 1
 v_lshl_add_u32 v3, v9, 7, v3
 v_mov_b32 v5, 0
 v_bfe_u32 v9, v8, 0, 4
 v_lshl_add_u32 v5, v9, 5, v5
 v_bfe_u32 v9, v8, 4, 2
 v_lshl_add_u32 v5, v9, 3, v5
 v_mov_b32 v10, 0
 v_bfe_u32 v9, v8, 2, 2
 v_lshl_add_u32 v10, v9, 3, v10
 v_xor_b32 v5, v5, v10
 s_lshl_b32 s54, s60, 7
 s_add_u32 s54, s54, s59
 v_mov_b32 v7, s54
 v_bfe_u32 v9, v8, 3, 3
 s_mov_b32 s101, 9344
 v_mad_u32_u24 v7, v9, s101, v7
 v_bfe_u32 v9, v8, 0, 3
 v_lshl_add_u32 v7, v9, 4, v7
 s_cmp_eq_u32 s64, 32
 s_cbranch_scc0 RECM0
 ds_read_b128 v[8:11], v1 offset:0
 ds_read_b128 v[12:15], v1 offset:1024
 ds_read_b128 v[16:19], v1 offset:2048
 ds_read_b128 v[20:23], v1 offset:3072
 ds_read_b128 v[24:27], v1 offset:4096
 ds_read_b128 v[28:31], v1 offset:5120
 ds_read_b128 v[44:47], v1 offset:6144
 ds_read_b128 v[48:51], v1 offset:7168
 v_mov_b64 v[60:61], 0
 v_mov_b64 v[62:63], 0
 v_mov_b64 v[64:65], 0
 v_mov_b64 v[66:67], 0
 v_mov_b64 v[68:69], 0
 v_mov_b64 v[70:71], 0
 v_mov_b64 v[72:73], 0
 v_mov_b64 v[74:75], 0
 v_mov_b64 v[52:53], 0
 v_mov_b64 v[54:55], 0
 v_mov_b64 v[56:57], 0
 v_mov_b64 v[58:59], 0
 ds_read_b32 v76, v0 offset:13312
 s_mov_b32 s66, -1
 s_waitcnt lgkmcnt(0)
 s_branch R00STEP
.p2align 8
 s_nop 0
 s_nop 0
 s_nop 0
 s_nop 0
 s_nop 0
R00TOP:
 buffer_load_dwordx4 v[32:35], v0, s[8:11], s43 offen sc1
 s_sub_u32 s49, s49, 1
 s_cselect_b32 s49, 0, s49
 s_cselect_b32 s66, -1, -2
 s_cselect_b32 s67, 1, 0
R00TW:
 s_waitcnt vmcnt(1) lgkmcnt(0)
 v_max3_u32 v77, v32, v33, v34
 v_max_u32 v77, v35, v77
 ds_write_b128 v0, v[32:35] offset:0
 v_cmp_lt_u32 vcc, s66, v77
 s_cbranch_vccnz R00TOP
 buffer_load_dwordx4 v[36:39], v0, s[8:11], s63 offen sc1
 buffer_load_dwordx4 v[40:43], v0, s[8:11], s44 offen sc1
R00STEP:
 v_smfmac_f32_16x16x64_bf16 v[60:63], v[32:35], v[8:15], v2
 v_smfmac_f32_16x16x64_bf16 v[64:67], v[32:35], v[16:23], v2
 s_waitcnt lgkmcnt(0)
 s_barrier
 ds_read_b128 v[8:11], v0 offset:2048
 v_smfmac_f32_16x16x64_bf16 v[68:71], v[32:35], v[24:31], v2
 ds_read_b128 v[12:15], v0 offset:4096
 ds_read_b128 v[16:19], v0 offset:6144
 v_smfmac_f32_16x16x64_bf16 v[72:75], v[32:35], v[44:51], v2
 ds_read_b128 v[24:27], v1 offset:8192
 v_mov_b64 v[20:21], -1
 v_smfmac_f32_16x16x64_bf16 v[52:55], v[32:35], v[80:87], v2
 ds_read_b128 v[28:31], v1 offset:9216
 ds_read_b128 v[44:47], v1 offset:10240
 v_smfmac_f32_16x16x64_bf16 v[56:59], v[32:35], v[88:95], v2
 ds_read_b128 v[48:51], v1 offset:11264
 s_waitcnt lgkmcnt(6)
 v_smfmac_f32_16x16x64_bf16 v[60:63], v[8:11], v[96:103], v2
 buffer_load_dwordx4 v[32:35], v3, s[8:11], s47 offen offset:0 sc1
 v_smfmac_f32_16x16x64_bf16 v[64:67], v[8:11], v[104:111], v2
 buffer_store_dword v20, v76, s[8:11], s46 offen
 v_smfmac_f32_16x16x64_bf16 v[68:71], v[8:11], v[112:119], v2
 s_waitcnt lgkmcnt(2)
 v_smfmac_f32_16x16x64_bf16 v[72:75], v[8:11], v[24:31], v2
 v_smfmac_f32_16x16x64_bf16 v[52:55], v[8:11], v[120:127], v2
 ds_read_b128 v[24:27], v1 offset:12288
 s_waitcnt lgkmcnt(1)
 v_smfmac_f32_16x16x64_bf16 v[56:59], v[8:11], v[44:51], v2
 ds_read_b128 v[28:31], v1 offset:13312
 v_smfmac_f32_16x16x64_bf16 v[60:63], v[12:15], v[128:135], v2
 buffer_load_dwordx4 v[8:11], v3, s[8:11], s47 offen offset:1024 sc1
 ds_read_b128 v[44:47], v1 offset:14336
 v_smfmac_f32_16x16x64_bf16 v[64:67], v[12:15], v[136:143], v2
 ds_read_b128 v[48:51], v1 offset:15360
 v_smfmac_f32_16x16x64_bf16 v[68:71], v[12:15], v[144:151], v2
 ds_read_b64_tr_b16 v[76:77], v6 offset:10240
 v_smfmac_f32_16x16x64_bf16 v[72:75], v[12:15], v[152:159], v2
 s_waitcnt lgkmcnt(3)
 v_smfmac_f32_16x16x64_bf16 v[52:55], v[12:15], v[24:31], v2
 v_smfmac_f32_16x16x64_bf16 v[56:59], v[12:15], v[160:167], v2
 ds_read_b128 v[24:27], v1 offset:16384
 v_smfmac_f32_16x16x64_bf16 v[60:63], v[16:19], v[168:175], v2
 buffer_load_dwordx4 v[12:15], v0, s[8:11], s47 offen offset:2048 sc1
 ds_read_b128 v[28:31], v1 offset:17408
 s_waitcnt lgkmcnt(3)
 v_smfmac_f32_16x16x64_bf16 v[64:67], v[16:19], v[44:51], v2
 s_waitcnt vmcnt(5)
 ds_write_b128 v0, v[36:39] offset:1024
 v_max3_u32 v20, v36, v37, v38
 v_smfmac_f32_16x16x64_bf16 v[68:71], v[16:19], v[176:183], v2
 ds_read_b128 v[44:47], v1 offset:18432
 v_smfmac_f32_16x16x64_bf16 v[72:75], v[16:19], v[184:191], v2
 ds_read_b128 v[48:51], v1 offset:19456
 s_waitcnt vmcnt(4)
 v_max3_u32 v20, v39, v40, v20
 v_max3_u32 v21, v41, v42, v43
 v_smfmac_f32_16x16x64_bf16 v[52:55], v[16:19], v[192:199], v2
 s_waitcnt lgkmcnt(3)
 v_max_u32 v20, v21, v20
 v_cmp_lt_u32 vcc, s66, v20
 v_smfmac_f32_16x16x64_bf16 v[56:59], v[16:19], v[24:31], v2
 s_cbranch_vccnz R00PB
R00B:
 v_smfmac_f32_16x16x64_bf16 v[60:63], v[36:39], v[200:207], v2
 buffer_load_dwordx4 v[16:19], v0, s[8:11], s47 offen offset:3072 sc1
 s_waitcnt lgkmcnt(2)
 s_barrier
 ds_read_b128 v[20:23], v0 offset:3072
 v_smfmac_f32_16x16x64_bf16 v[64:67], v[36:39], v[208:215], v2
 ds_read_b128 v[24:27], v0 offset:5120
 ds_read_b128 v[28:31], v0 offset:7168
 v_smfmac_f32_16x16x64_bf16 v[60:63], v[40:43], v[216:223], v2
 s_add_u32 s47, s47, 524288
 s_waitcnt lgkmcnt(3)
 v_smfmac_f32_16x16x64_bf16 v[64:67], v[40:43], v[44:51], v2
 s_add_u32 s45, s45, 0x4000
 s_waitcnt lgkmcnt(2)
 v_smfmac_f32_16x16x64_bf16 v[60:63], v[20:23], v[224:231], v2
 ds_read_b128 v[44:47], v1 offset:20480
 s_waitcnt lgkmcnt(2)
 v_smfmac_f32_16x16x64_bf16 v[60:63], v[24:27], v[232:239], v2
 ds_read_b128 v[48:51], v1 offset:21504
 s_waitcnt lgkmcnt(2)
 v_smfmac_f32_16x16x64_bf16 v[60:63], v[28:31], v[240:247], v2
 s_cmp_ge_u32 s36, 62
 s_cbranch_scc1 R00KS
 buffer_store_dwordx4 v[76:79], v0, s[8:11], s48 offen nt
R00KR:
 v_smfmac_f32_16x16x64_bf16 v[64:67], v[20:23], v[248:255], v2
 s_bitset0_b32 s45, 16
 s_add_u32 s44, s45, 8192
 v_smfmac_f32_16x16x64_bf16 v[64:67], v[24:27], a[0:7], v2
 v_mul_f32 v60, s50, v60
 v_mul_f32 v61, s50, v61
 v_smfmac_f32_16x16x64_bf16 v[64:67], v[28:31], a[8:15], v2
 s_add_u32 s43, s45, 0
 s_add_u32 s63, s45, 4096
 v_fmac_f32 v60, s50, v62
 v_fmac_f32 v61, s50, v63
 s_waitcnt lgkmcnt(0)
 v_smfmac_f32_16x16x64_bf16 v[68:71], v[36:39], v[44:51], v2
 v_cvt_pk_bf16_f32 v60, v60, v61
 v_smfmac_f32_16x16x64_bf16 v[68:71], v[40:43], a[16:23], v2
 ds_read_b128 v[44:47], v1 offset:22528
 v_mul_f32 v64, s50, v64
 v_mul_f32 v65, s50, v65
 v_fmac_f32 v64, s50, v66
 v_smfmac_f32_16x16x64_bf16 v[68:71], v[20:23], a[24:31], v2
 ds_read_b128 v[48:51], v1 offset:23552
 v_fmac_f32 v65, s50, v67
 v_cvt_pk_bf16_f32 v61, v64, v65
 ds_write_b64 v5, v[60:61] offset:8192
 v_smfmac_f32_16x16x64_bf16 v[68:71], v[24:27], a[32:39], v2
 v_smfmac_f32_16x16x64_bf16 v[68:71], v[28:31], a[40:47], v2
 s_xor_b32 s46, s45, 0x8000
 s_and_b32 s65, s36, 1
 v_smfmac_f32_16x16x64_bf16 v[72:75], v[36:39], a[48:55], v2
 v_smfmac_f32_16x16x64_bf16 v[72:75], v[40:43], a[56:63], v2
 s_waitcnt lgkmcnt(1)
 v_add_f32 v68, v68, v70
 v_smfmac_f32_16x16x64_bf16 v[72:75], v[20:23], v[44:51], v2
 s_waitcnt lgkmcnt(0)
 s_barrier
 ds_read_b64_tr_b16 v[60:61], v6 offset:8192
 ds_read_b64_tr_b16 v[62:63], v6 offset:8704
 v_add_f32 v69, v69, v71
 v_smfmac_f32_16x16x64_bf16 v[72:75], v[24:27], a[64:71], v2
 ds_read_b64_tr_b16 v[64:65], v6 offset:9216
 ds_read_b64_tr_b16 v[66:67], v6 offset:9728
 ds_read_b128 v[44:47], v1 offset:24576
 v_cvt_pk_bf16_f32 v68, v68, v69
 v_smfmac_f32_16x16x64_bf16 v[72:75], v[28:31], a[72:79], v2
 ds_read_b128 v[48:51], v1 offset:25600
 v_smfmac_f32_16x16x64_bf16 v[52:55], v[36:39], a[80:87], v2
 s_waitcnt vmcnt(5) lgkmcnt(4)
 v_mfma_f32_16x16x32_bf16 v[76:79], v[32:35], v[60:63], 0
 s_waitcnt vmcnt(3) lgkmcnt(2)
 v_add_f32 v72, v72, v74
 v_add_f32 v73, v73, v75
 v_mfma_f32_16x16x32_bf16 v[76:79], v[8:11], v[64:67], v[76:79]
 v_cvt_pk_bf16_f32 v69, v72, v73
 ds_write_b64 v5, v[68:69] offset:10240
 v_smfmac_f32_16x16x64_bf16 v[56:59], v[36:39], a[88:95], v2
 s_add_u32 s48, s48, 131072
 s_waitcnt lgkmcnt(1)
 v_smfmac_f32_16x16x64_bf16 v[52:55], v[40:43], v[44:51], v2
 ds_read_b128 v[36:39], v0 offset:15360
 v_add_f32_dpp v76, v78, v76 quad_perm:[2,3,0,1] row_mask:0xf bank_mask:0xf
 v_add_f32_dpp v77, v79, v77 quad_perm:[2,3,0,1] row_mask:0xf bank_mask:0xf
 v_smfmac_f32_16x16x64_bf16 v[56:59], v[40:43], a[96:103], v2
 ds_read_b128 v[44:47], v1 offset:26624
 v_exp_f32_dpp v78, v76 quad_perm:[0,1,0,1] row_mask:0xf bank_mask:0xf
 v_exp_f32_dpp v79, v77 quad_perm:[0,1,0,1] row_mask:0xf bank_mask:0xf
 v_smfmac_f32_16x16x64_bf16 v[52:55], v[20:23], a[104:111], v2
 ds_read_b128 v[48:51], v1 offset:27648
 v_cvt_pk_bf16_f32 v78, v78, v79
 ds_write_b32 v0, v78 offset:14336
 v_smfmac_f32_16x16x64_bf16 v[56:59], v[20:23], a[112:119], v2
 s_waitcnt lgkmcnt(4)
 s_barrier
 ds_read_b64_tr_b16 v[68:69], v6 offset:10240
 ds_read_b64_tr_b16 v[70:71], v6 offset:10752
 v_mov_b32 v33, 0
 v_smfmac_f32_16x16x64_bf16 v[52:55], v[24:27], a[120:127], v2
 ds_read_b64_tr_b16 v[72:73], v6 offset:11264
 ds_read_b64_tr_b16 v[74:75], v6 offset:11776
 v_mov_b32 v34, 0
 v_smfmac_f32_16x16x64_bf16 v[52:55], v[28:31], a[128:135], v2
 s_waitcnt lgkmcnt(5)
 v_smfmac_f32_16x16x64_bf16 v[56:59], v[24:27], v[44:51], v2
 s_waitcnt lgkmcnt(2)
 v_mfma_f32_16x16x32_bf16 v[40:43], v[68:71], v[60:63], 0
 s_barrier
 ds_read_b128 v[8:11], v0 offset:14336
 v_add_f32 v52, v52, v54
 v_add_f32 v53, v53, v55
 s_waitcnt lgkmcnt(1)
 v_mfma_f32_16x16x32_bf16 v[40:43], v[72:75], v[64:67], v[40:43]
 s_cmp_eq_u32 s36, 63
 v_cvt_pk_bf16_f32 v78, v52, v53
 v_smfmac_f32_16x16x64_bf16 v[56:59], v[28:31], a[136:143], v2
 s_waitcnt lgkmcnt(0)
 s_nop 2
 v_add_f32_dpp v40, v42, v40 quad_perm:[2,3,0,1] row_mask:0xf bank_mask:0xf
 v_add_f32_dpp v41, v43, v41 quad_perm:[2,3,0,1] row_mask:0xf bank_mask:0xf
 v_mfma_f32_16x16x32_bf16 v[72:75], v[36:39], v[8:11], 0
 ds_read_b128 v[24:27], v1 offset:28672
 v_exp_f32_dpp v42, v40 quad_perm:[0,1,0,1] row_mask:0xf bank_mask:0xf
 v_exp_f32_dpp v43, v41 quad_perm:[0,1,0,1] row_mask:0xf bank_mask:0xf
 s_waitcnt vmcnt(2)
 v_mfma_f32_16x16x32_bf16 v[44:47], v[12:15], v[8:11], 0
 ds_read_b128 v[28:31], v1 offset:29696
 v_cvt_pk_bf16_f32 v32, v42, v43
 v_cvt_pk_bf16_f32 v35, v42, v43
 v_add_f32 v56, v56, v58
 v_add_f32 v57, v57, v59
 v_mfma_f32_16x16x16_bf16 v[72:75], v[36:37], v[32:33], v[72:75]
 s_waitcnt vmcnt(1)
 v_cvt_pk_bf16_f32 v79, v56, v57
 v_mfma_f32_16x16x32_bf16 v[48:51], v[16:19], v[8:11], 0
 s_cbranch_scc1 R00TAIL
 v_mov_b64 v[68:69], 0
 v_mov_b64 v[70:71], 0
 v_mfma_f32_16x16x16_bf16 v[44:47], v[78:79], v[32:33], v[44:47]
 v_rcp_f32 v72, v72
 v_subrev_u32 v74, s52, v74
 v_mfma_f32_16x16x16_bf16 v[48:51], v[78:79], v[34:35], v[48:51]
 v_cmp_le_u32 vcc, s53, v74
 v_mov_b64 v[52:53], 0
 v_mov_b64 v[54:55], 0
R00RJ:
 s_nop 0
 v_pk_mul_f32 v[44:45], v[44:45], v[72:73] op_sel_hi:[1,0]
 v_pk_mul_f32 v[46:47], v[46:47], v[72:73] op_sel_hi:[1,0]
 s_cbranch_vccnz R00FB
 v_cvt_pk_bf16_f32 v40, v44, v45
 v_cvt_pk_bf16_f32 v41, v46, v47
 v_pk_mul_f32 v[48:49], v[48:49], v[72:73] op_sel_hi:[1,0]
 v_pk_mul_f32 v[50:51], v[50:51], v[72:73] op_sel_hi:[1,0]
 v_cvt_pk_bf16_f32 v42, v48, v49
 v_cvt_pk_bf16_f32 v43, v50, v51
 ds_write_b128 v4, v[40:43] offset:8192
 s_waitcnt lgkmcnt(1)
 v_smfmac_f32_16x16x64_bf16 v[68:71], v[40:43], v[24:31], v2
 v_mov_b64 v[56:57], 0
 v_mov_b64 v[58:59], 0
 v_smfmac_f32_16x16x64_bf16 v[52:55], v[40:43], a[144:151], v2
 v_mov_b64 v[64:65], 0
 v_mov_b64 v[66:67], 0
 v_smfmac_f32_16x16x64_bf16 v[56:59], v[40:43], a[152:159], v2
 s_waitcnt lgkmcnt(0)
 s_barrier
 ds_read_b128 v[32:35], v4 offset:8320
 ds_read_b128 v[36:39], v4 offset:9216
 ds_read_b128 v[72:75], v4 offset:9344
 v_mov_b64 v[60:61], 0
 v_mov_b64 v[62:63], 0
 v_smfmac_f32_16x16x64_bf16 v[64:67], v[40:43], a[160:167], v2
 s_waitcnt lgkmcnt(2)
 v_smfmac_f32_16x16x64_bf16 v[68:71], v[32:35], a[168:175], v2
 ds_read_b128 v[44:47], v3 offset:8192
 s_waitcnt lgkmcnt(2)
 v_lshrrev_b32 v40, 2, v0
 v_smfmac_f32_16x16x64_bf16 v[68:71], v[36:39], a[176:183], v2
 ds_read_b128 v[48:51], v3 offset:9216
 s_waitcnt lgkmcnt(2)
 v_smfmac_f32_16x16x64_bf16 v[68:71], v[72:75], a[184:191], v2
 ds_read_b128 v[24:27], v1 offset:30720
 v_smfmac_f32_16x16x64_bf16 v[52:55], v[32:35], a[192:199], v2
 ds_read_b128 v[28:31], v1 offset:31744
 v_smfmac_f32_16x16x64_bf16 v[52:55], v[36:39], a[200:207], v2
 ds_read_b128 v[8:11], v1 offset:32768
 v_cvt_pk_bf16_f32 v68, v68, v69
 v_smfmac_f32_16x16x64_bf16 v[52:55], v[72:75], a[208:215], v2
 ds_read_b128 v[12:15], v1 offset:33792
 s_waitcnt lgkmcnt(5)
 v_cvt_pk_bf16_f32 v69, v70, v71
 v_smfmac_f32_16x16x64_bf16 v[60:63], v[44:47], a[216:223], v2
 ds_read_b128 v[16:19], v1 offset:34816
 s_waitcnt lgkmcnt(5)
 v_and_or_b32 v68, v68, -2, s65
 v_smfmac_f32_16x16x64_bf16 v[60:63], v[48:51], a[224:231], v2
 ds_read_b128 v[20:23], v1 offset:35840
 v_cvt_pk_bf16_f32 v70, v52, v53
 v_cvt_pk_bf16_f32 v71, v54, v55
 buffer_store_dwordx4 v[68:71], v0, s[8:11], s37 offen
 v_smfmac_f32_16x16x64_bf16 v[56:59], v[32:35], a[232:239], v2
 ds_read_b32 v76, v0 offset:13312
 s_waitcnt lgkmcnt(5)
 v_smfmac_f32_16x16x64_bf16 v[56:59], v[36:39], v[24:31], v2
 s_add_u32 s36, s36, 1
 v_add_f32 v60, v60, v62
 v_smfmac_f32_16x16x64_bf16 v[56:59], v[72:75], a[240:247], v2
 s_waitcnt lgkmcnt(3)
 v_add_f32 v61, v61, v63
 v_smfmac_f32_16x16x64_bf16 v[64:67], v[32:35], v[8:15], v2
 v_cvt_pk_bf16_f32 v41, v60, v61
 v_smfmac_f32_16x16x64_bf16 v[64:67], v[36:39], a[248:255], v2
 s_waitcnt lgkmcnt(1)
 v_and_or_b32 v41, v41, -2, s65
 v_smfmac_f32_16x16x64_bf16 v[64:67], v[72:75], v[16:23], v2
 buffer_store_dword v41, v40, s[8:11], s38 offen
 v_cvt_pk_bf16_f32 v56, v56, v57
 v_cvt_pk_bf16_f32 v57, v58, v59
 v_and_or_b32 v56, v56, -2, s65
 s_nop 3
 v_cvt_pk_bf16_f32 v58, v64, v65
 v_cvt_pk_bf16_f32 v59, v66, v67
 buffer_store_dwordx4 v[56:59], v0, s[8:11], s37 offen offset:1024
R00HOP:
 ds_read_b128 v[40:43], v0 offset:12288
 s_sub_u32 s49, s49, 1
 s_cselect_b32 s49, 0, s49
 s_cselect_b32 s66, -1, -2
 s_cselect_b32 s67, 1, 0
 s_waitcnt vmcnt(0)
 ds_read_b128 v[8:11], v1 offset:0
 ds_read_b128 v[12:15], v1 offset:1024
 ds_read_b128 v[16:19], v1 offset:2048
 ds_read_b128 v[20:23], v1 offset:3072
 buffer_load_dwordx4 v[60:63], v7, s[8:11], s39 offen sc1
 buffer_load_dwordx4 v[64:67], v7, s[8:11], s40 offen sc1
 buffer_load_dwordx4 v[68:71], v7, s[8:11], s41 offen sc1
 buffer_load_dwordx4 v[72:75], v7, s[8:11], s42 offen sc1
R00P1:
 s_waitcnt vmcnt(3)
 s_waitcnt lgkmcnt(4)
 v_mfma_f32_16x16x32_bf16 v[36:39], v[60:63], v[40:43], 0
 s_waitcnt vmcnt(2)
 v_mfma_f32_16x16x32_bf16 v[36:39], v[64:67], v[40:43], v[36:39]
 v_bitop3_b32 v60, v60, v64, s65 bitop3:0x7e
 s_waitcnt vmcnt(1)
 v_mfma_f32_16x16x32_bf16 v[36:39], v[68:71], v[40:43], v[36:39]
 s_waitcnt vmcnt(0)
 v_mfma_f32_16x16x32_bf16 v[36:39], v[72:75], v[40:43], v[36:39]
 v_bitop3_b32 v64, v68, v72, s65 bitop3:0x7e
 v_bitop3_b32 v60, v60, v64, 1 bitop3:0xa8
 v_cmp_lt_u32 vcc, s67, v60
 s_cbranch_vccnz R00R1
 s_nop 3
 v_permlane32_swap_b32 v36, v38
 v_permlane32_swap_b32 v37, v39
 v_add_f32 v36, v36, v38
 v_add_f32 v37, v37, v39
 v_cvt_pk_bf16_f32 v36, v36, v37
 buffer_store_dword v36, v76, s[8:11], s45 offen
 s_barrier
 v_mov_b64 v[60:61], 0
 v_mov_b64 v[62:63], 0
 v_mov_b64 v[64:65], 0
 v_mov_b64 v[66:67], 0
 v_mov_b64 v[68:69], 0
 v_mov_b64 v[70:71], 0
 v_mov_b64 v[72:73], 0
 v_mov_b64 v[74:75], 0
 buffer_load_dwordx4 v[32:35], v0, s[8:11], s43 offen sc1
 ds_read_b128 v[24:27], v1 offset:4096
 ds_read_b128 v[28:31], v1 offset:5120
 v_mov_b64 v[52:53], 0
 v_mov_b64 v[54:55], 0
 ds_read_b128 v[44:47], v1 offset:6144
 ds_read_b128 v[48:51], v1 offset:7168
 v_mov_b64 v[56:57], 0
 v_mov_b64 v[58:59], 0
 s_branch R00TOP
R00PB:
 buffer_load_dwordx4 v[36:39], v0, s[8:11], s63 offen sc1
 buffer_load_dwordx4 v[40:43], v0, s[8:11], s44 offen sc1
 s_sub_u32 s49, s49, 1
 s_cselect_b32 s49, 0, s49
 s_cselect_b32 s66, -1, -2
 s_cselect_b32 s67, 1, 0
 s_waitcnt vmcnt(0)
 v_max3_u32 v20, v36, v37, v38
 v_max3_u32 v20, v39, v40, v20
 v_max3_u32 v21, v41, v42, v43
 v_max_u32 v20, v21, v20
 v_cmp_lt_u32 vcc, s66, v20
 ds_write_b128 v0, v[36:39] offset:1024
 s_cbranch_vccnz R00PB
 s_waitcnt lgkmcnt(0)
 s_branch R00B
R00KS:
 s_waitcnt lgkmcnt(0)
 buffer_store_dwordx4 v[76:79], v0, s[8:11], s48 offen sc1
 s_branch R00KR
R00R1:
 buffer_load_dwordx4 v[60:63], v7, s[8:11], s39 offen sc1
 buffer_load_dwordx4 v[64:67], v7, s[8:11], s40 offen sc1
 buffer_load_dwordx4 v[68:71], v7, s[8:11], s41 offen sc1
 buffer_load_dwordx4 v[72:75], v7, s[8:11], s42 offen sc1
 s_sub_u32 s49, s49, 1
 s_cselect_b32 s49, 0, s49
 s_cselect_b32 s66, -1, -2
 s_cselect_b32 s67, 1, 0
 s_waitcnt vmcnt(0)
 s_branch R00P1
R00TAIL:
 s_waitcnt lgkmcnt(0)
 ds_read_b64_tr_b16 v[76:77], v6 offset:10240
 s_waitcnt lgkmcnt(0)
 buffer_store_dwordx4 v[76:79], v0, s[8:11], s48 offen sc1
 s_waitcnt vmcnt(0)
 s_endpgm
R00FB:
 s_waitcnt vmcnt(0) lgkmcnt(0)
 ds_write_b64 v6, v[76:77] offset:8192
 s_waitcnt lgkmcnt(0)
 s_barrier
 ds_read_b64 v[44:45], v6 offset:8192
 ds_read_b64 v[46:47], v6 offset:8704
 ds_read_b64 v[48:49], v6 offset:9216
 ds_read_b64 v[50:51], v6 offset:9728
 s_waitcnt lgkmcnt(0)
 s_barrier
 v_max3_f32 v72, v44, v45, v46
 v_max3_f32 v72, v72, v47, v48
 v_max3_f32 v72, v72, v49, v50
 v_max3_f32 v72, v72, v51, v40
 v_max_f32 v72, v72, v41
 v_mov_b32 v73, v72
 s_nop 1
 v_permlane16_swap_b32 v72, v73
 v_max_f32 v72, v72, v73
 v_mov_b32 v73, v72
 s_nop 1
 v_permlane32_swap_b32 v72, v73
 v_max_f32 v72, v72, v73
 v_sub_f32 v44, v44, v72
 v_sub_f32 v45, v45, v72
 v_sub_f32 v46, v46, v72
 v_sub_f32 v47, v47, v72
 v_sub_f32 v48, v48, v72
 v_sub_f32 v49, v49, v72
 v_sub_f32 v50, v50, v72
 v_sub_f32 v51, v51, v72
 v_sub_f32 v40, v40, v72
 v_sub_f32 v41, v41, v72
 v_exp_f32_dpp v44, v44 quad_perm:[0,1,0,1] row_mask:0xf bank_mask:0xf
 v_exp_f32_dpp v45, v45 quad_perm:[0,1,0,1] row_mask:0xf bank_mask:0xf
 v_exp_f32_dpp v46, v46 quad_perm:[0,1,0,1] row_mask:0xf bank_mask:0xf
 v_exp_f32_dpp v47, v47 quad_perm:[0,1,0,1] row_mask:0xf bank_mask:0xf
 v_exp_f32_dpp v48, v48 quad_perm:[0,1,0,1] row_mask:0xf bank_mask:0xf
 v_exp_f32_dpp v49, v49 quad_perm:[0,1,0,1] row_mask:0xf bank_mask:0xf
 v_exp_f32_dpp v50, v50 quad_perm:[0,1,0,1] row_mask:0xf bank_mask:0xf
 v_exp_f32_dpp v51, v51 quad_perm:[0,1,0,1] row_mask:0xf bank_mask:0xf
 v_exp_f32_dpp v40, v40 quad_perm:[0,1,0,1] row_mask:0xf bank_mask:0xf
 v_exp_f32_dpp v41, v41 quad_perm:[0,1,0,1] row_mask:0xf bank_mask:0xf
 v_cvt_pk_bf16_f32 v8, v44, v45
 v_cvt_pk_bf16_f32 v9, v46, v47
 v_cvt_pk_bf16_f32 v10, v48, v49
 v_cvt_pk_bf16_f32 v11, v50, v51
 v_cvt_pk_bf16_f32 v32, v40, v41
 v_cvt_pk_bf16_f32 v35, v40, v41
 v_mfma_f32_16x16x32_bf16 v[72:75], v[36:39], v[8:11], 0
 v_mfma_f32_16x16x32_bf16 v[44:47], v[12:15], v[8:11], 0
 v_mfma_f32_16x16x32_bf16 v[48:51], v[16:19], v[8:11], 0
 v_mfma_f32_16x16x16_bf16 v[72:75], v[36:37], v[32:33], v[72:75]
 v_mfma_f32_16x16x16_bf16 v[44:47], v[78:79], v[32:33], v[44:47]
 v_mfma_f32_16x16x16_bf16 v[48:51], v[78:79], v[34:35], v[48:51]
 v_rcp_f32 v72, v72
 s_mov_b64 vcc, 0
 s_nop 7
 s_branch R00RJ
RECM0:
 ds_read_b128 v[8:11], v1 offset:0
 ds_read_b128 v[12:15], v1 offset:1024
 ds_read_b128 v[16:19], v1 offset:2048
 ds_read_b128 v[20:23], v1 offset:3072
 ds_read_b128 v[24:27], v1 offset:4096
 ds_read_b128 v[28:31], v1 offset:5120
 ds_read_b128 v[44:47], v1 offset:6144
 ds_read_b128 v[48:51], v1 offset:7168
 v_mov_b64 v[60:61], 0
 v_mov_b64 v[62:63], 0
 v_mov_b64 v[64:65], 0
 v_mov_b64 v[66:67], 0
 v_mov_b64 v[68:69], 0
 v_mov_b64 v[70:71], 0
 v_mov_b64 v[72:73], 0
 v_mov_b64 v[74:75], 0
 v_mov_b64 v[52:53], 0
 v_mov_b64 v[54:55], 0
 v_mov_b64 v[56:57], 0
 v_mov_b64 v[58:59], 0
 ds_read_b32 v76, v0 offset:13312
 s_mov_b32 s66, -1
 s_waitcnt lgkmcnt(0)
 s_branch R01STEP
.p2align 8
 s_nop 0
 s_nop 0
 s_nop 0
 s_nop 0
 s_nop 0
R01TOP:
 buffer_load_dwordx4 v[32:35], v0, s[8:11], s43 offen sc1
 s_sub_u32 s49, s49, 1
 s_cselect_b32 s49, 0, s49
 s_cselect_b32 s66, -1, -2
 s_cselect_b32 s67, 1, 0
R01TW:
 s_waitcnt vmcnt(1) lgkmcnt(0)
 v_max3_u32 v77, v32, v33, v34
 v_max_u32 v77, v35, v77
 ds_write_b128 v0, v[32:35] offset:0
 v_cmp_lt_u32 vcc, s66, v77
 s_cbranch_vccnz R01TOP
 buffer_load_dwordx4 v[36:39], v0, s[8:11], s63 offen sc1
 buffer_load_dwordx4 v[40:43], v0, s[8:11], s44 offen sc1
R01STEP:
 v_smfmac_f32_16x16x64_bf16 v[60:63], v[32:35], v[8:15], v2
 v_smfmac_f32_16x16x64_bf16 v[64:67], v[32:35], v[16:23], v2
 s_waitcnt lgkmcnt(0)
 s_barrier
 ds_read_b128 v[8:11], v0 offset:2048
 v_smfmac_f32_16x16x64_bf16 v[68:71], v[32:35], v[24:31], v2
 ds_read_b128 v[12:15], v0 offset:4096
 ds_read_b128 v[16:19], v0 offset:6144
 v_smfmac_f32_16x16x64_bf16 v[72:75], v[32:35], v[44:51], v2
 ds_read_b128 v[24:27], v1 offset:8192
 v_mov_b64 v[20:21], -1
 v_smfmac_f32_16x16x64_bf16 v[52:55], v[32:35], v[80:87], v2
 ds_read_b128 v[28:31], v1 offset:9216
 ds_read_b128 v[44:47], v1 offset:10240
 v_smfmac_f32_16x16x64_bf16 v[56:59], v[32:35], v[88:95], v2
 ds_read_b128 v[48:51], v1 offset:11264
 s_waitcnt lgkmcnt(6)
 v_smfmac_f32_16x16x64_bf16 v[60:63], v[8:11], v[96:103], v2
 buffer_load_dwordx4 v[32:35], v3, s[8:11], s47 offen offset:0 sc1
 v_smfmac_f32_16x16x64_bf16 v[64:67], v[8:11], v[104:111], v2
 buffer_store_dword v20, v76, s[8:11], s46 offen sc1
 v_smfmac_f32_16x16x64_bf16 v[68:71], v[8:11], v[112:119], v2
 s_waitcnt lgkmcnt(2)
 v_smfmac_f32_16x16x64_bf16 v[72:75], v[8:11], v[24:31], v2
 v_smfmac_f32_16x16x64_bf16 v[52:55], v[8:11], v[120:127], v2
 ds_read_b128 v[24:27], v1 offset:12288
 s_waitcnt lgkmcnt(1)
 v_smfmac_f32_16x16x64_bf16 v[56:59], v[8:11], v[44:51], v2
 ds_read_b128 v[28:31], v1 offset:13312
 v_smfmac_f32_16x16x64_bf16 v[60:63], v[12:15], v[128:135], v2
 buffer_load_dwordx4 v[8:11], v3, s[8:11], s47 offen offset:1024 sc1
 ds_read_b128 v[44:47], v1 offset:14336
 v_smfmac_f32_16x16x64_bf16 v[64:67], v[12:15], v[136:143], v2
 ds_read_b128 v[48:51], v1 offset:15360
 v_smfmac_f32_16x16x64_bf16 v[68:71], v[12:15], v[144:151], v2
 ds_read_b64_tr_b16 v[76:77], v6 offset:10240
 v_smfmac_f32_16x16x64_bf16 v[72:75], v[12:15], v[152:159], v2
 s_waitcnt lgkmcnt(3)
 v_smfmac_f32_16x16x64_bf16 v[52:55], v[12:15], v[24:31], v2
 v_smfmac_f32_16x16x64_bf16 v[56:59], v[12:15], v[160:167], v2
 ds_read_b128 v[24:27], v1 offset:16384
 v_smfmac_f32_16x16x64_bf16 v[60:63], v[16:19], v[168:175], v2
 buffer_load_dwordx4 v[12:15], v0, s[8:11], s47 offen offset:2048 sc1
 ds_read_b128 v[28:31], v1 offset:17408
 s_waitcnt lgkmcnt(3)
 v_smfmac_f32_16x16x64_bf16 v[64:67], v[16:19], v[44:51], v2
 s_waitcnt vmcnt(5)
 ds_write_b128 v0, v[36:39] offset:1024
 v_max3_u32 v20, v36, v37, v38
 v_smfmac_f32_16x16x64_bf16 v[68:71], v[16:19], v[176:183], v2
 ds_read_b128 v[44:47], v1 offset:18432
 v_smfmac_f32_16x16x64_bf16 v[72:75], v[16:19], v[184:191], v2
 ds_read_b128 v[48:51], v1 offset:19456
 s_waitcnt vmcnt(4)
 v_max3_u32 v20, v39, v40, v20
 v_max3_u32 v21, v41, v42, v43
 v_smfmac_f32_16x16x64_bf16 v[52:55], v[16:19], v[192:199], v2
 s_waitcnt lgkmcnt(3)
 v_max_u32 v20, v21, v20
 v_cmp_lt_u32 vcc, s66, v20
 v_smfmac_f32_16x16x64_bf16 v[56:59], v[16:19], v[24:31], v2
 s_cbranch_vccnz R01PB
R01B:
 v_smfmac_f32_16x16x64_bf16 v[60:63], v[36:39], v[200:207], v2
 buffer_load_dwordx4 v[16:19], v0, s[8:11], s47 offen offset:3072 sc1
 s_waitcnt lgkmcnt(2)
 s_barrier
 ds_read_b128 v[20:23], v0 offset:3072
 v_smfmac_f32_16x16x64_bf16 v[64:67], v[36:39], v[208:215], v2
 ds_read_b128 v[24:27], v0 offset:5120
 ds_read_b128 v[28:31], v0 offset:7168
 v_smfmac_f32_16x16x64_bf16 v[60:63], v[40:43], v[216:223], v2
 s_add_u32 s47, s47, 524288
 s_waitcnt lgkmcnt(3)
 v_smfmac_f32_16x16x64_bf16 v[64:67], v[40:43], v[44:51], v2
 s_add_u32 s45, s45, 0x4000
 s_waitcnt lgkmcnt(2)
 v_smfmac_f32_16x16x64_bf16 v[60:63], v[20:23], v[224:231], v2
 ds_read_b128 v[44:47], v1 offset:20480
 s_waitcnt lgkmcnt(2)
 v_smfmac_f32_16x16x64_bf16 v[60:63], v[24:27], v[232:239], v2
 ds_read_b128 v[48:51], v1 offset:21504
 s_waitcnt lgkmcnt(2)
 v_smfmac_f32_16x16x64_bf16 v[60:63], v[28:31], v[240:247], v2
 buffer_store_dwordx4 v[76:79], v0, s[8:11], s48 offen sc1
 v_smfmac_f32_16x16x64_bf16 v[64:67], v[20:23], v[248:255], v2
 s_bitset0_b32 s45, 16
 s_add_u32 s44, s45, 8192
 v_smfmac_f32_16x16x64_bf16 v[64:67], v[24:27], a[0:7], v2
 v_mul_f32 v60, s50, v60
 v_mul_f32 v61, s50, v61
 v_smfmac_f32_16x16x64_bf16 v[64:67], v[28:31], a[8:15], v2
 s_add_u32 s43, s45, 0
 s_add_u32 s63, s45, 4096
 v_fmac_f32 v60, s50, v62
 v_fmac_f32 v61, s50, v63
 s_waitcnt lgkmcnt(0)
 v_smfmac_f32_16x16x64_bf16 v[68:71], v[36:39], v[44:51], v2
 v_cvt_pk_bf16_f32 v60, v60, v61
 v_smfmac_f32_16x16x64_bf16 v[68:71], v[40:43], a[16:23], v2
 ds_read_b128 v[44:47], v1 offset:22528
 v_mul_f32 v64, s50, v64
 v_mul_f32 v65, s50, v65
 v_fmac_f32 v64, s50, v66
 v_smfmac_f32_16x16x64_bf16 v[68:71], v[20:23], a[24:31], v2
 ds_read_b128 v[48:51], v1 offset:23552
 v_fmac_f32 v65, s50, v67
 v_cvt_pk_bf16_f32 v61, v64, v65
 ds_write_b64 v5, v[60:61] offset:8192
 v_smfmac_f32_16x16x64_bf16 v[68:71], v[24:27], a[32:39], v2
 v_smfmac_f32_16x16x64_bf16 v[68:71], v[28:31], a[40:47], v2
 s_xor_b32 s46, s45, 0x8000
 s_and_b32 s65, s36, 1
 v_smfmac_f32_16x16x64_bf16 v[72:75], v[36:39], a[48:55], v2
 v_smfmac_f32_16x16x64_bf16 v[72:75], v[40:43], a[56:63], v2
 s_waitcnt lgkmcnt(1)
 v_add_f32 v68, v68, v70
 v_smfmac_f32_16x16x64_bf16 v[72:75], v[20:23], v[44:51], v2
 s_waitcnt lgkmcnt(0)
 s_barrier
 ds_read_b64_tr_b16 v[60:61], v6 offset:8192
 ds_read_b64_tr_b16 v[62:63], v6 offset:8704
 v_add_f32 v69, v69, v71
 v_smfmac_f32_16x16x64_bf16 v[72:75], v[24:27], a[64:71], v2
 ds_read_b64_tr_b16 v[64:65], v6 offset:9216
 ds_read_b64_tr_b16 v[66:67], v6 offset:9728
 ds_read_b128 v[44:47], v1 offset:24576
 v_cvt_pk_bf16_f32 v68, v68, v69
 v_smfmac_f32_16x16x64_bf16 v[72:75], v[28:31], a[72:79], v2
 ds_read_b128 v[48:51], v1 offset:25600
 v_smfmac_f32_16x16x64_bf16 v[52:55], v[36:39], a[80:87], v2
 s_waitcnt vmcnt(5) lgkmcnt(4)
 v_mfma_f32_16x16x32_bf16 v[76:79], v[32:35], v[60:63], 0
 s_waitcnt vmcnt(3) lgkmcnt(2)
 v_add_f32 v72, v72, v74
 v_add_f32 v73, v73, v75
 v_mfma_f32_16x16x32_bf16 v[76:79], v[8:11], v[64:67], v[76:79]
 v_cvt_pk_bf16_f32 v69, v72, v73
 ds_write_b64 v5, v[68:69] offset:10240
 v_smfmac_f32_16x16x64_bf16 v[56:59], v[36:39], a[88:95], v2
 s_add_u32 s48, s48, 131072
 s_waitcnt lgkmcnt(1)
 v_smfmac_f32_16x16x64_bf16 v[52:55], v[40:43], v[44:51], v2
 ds_read_b128 v[36:39], v0 offset:15360
 v_add_f32_dpp v76, v78, v76 quad_perm:[2,3,0,1] row_mask:0xf bank_mask:0xf
 v_add_f32_dpp v77, v79, v77 quad_perm:[2,3,0,1] row_mask:0xf bank_mask:0xf
 v_smfmac_f32_16x16x64_bf16 v[56:59], v[40:43], a[96:103], v2
 ds_read_b128 v[44:47], v1 offset:26624
 v_exp_f32_dpp v78, v76 quad_perm:[0,1,0,1] row_mask:0xf bank_mask:0xf
 v_exp_f32_dpp v79, v77 quad_perm:[0,1,0,1] row_mask:0xf bank_mask:0xf
 v_smfmac_f32_16x16x64_bf16 v[52:55], v[20:23], a[104:111], v2
 ds_read_b128 v[48:51], v1 offset:27648
 v_cvt_pk_bf16_f32 v78, v78, v79
 ds_write_b32 v0, v78 offset:14336
 v_smfmac_f32_16x16x64_bf16 v[56:59], v[20:23], a[112:119], v2
 s_waitcnt lgkmcnt(4)
 s_barrier
 ds_read_b64_tr_b16 v[68:69], v6 offset:10240
 ds_read_b64_tr_b16 v[70:71], v6 offset:10752
 v_mov_b32 v33, 0
 v_smfmac_f32_16x16x64_bf16 v[52:55], v[24:27], a[120:127], v2
 ds_read_b64_tr_b16 v[72:73], v6 offset:11264
 ds_read_b64_tr_b16 v[74:75], v6 offset:11776
 v_mov_b32 v34, 0
 v_smfmac_f32_16x16x64_bf16 v[52:55], v[28:31], a[128:135], v2
 s_waitcnt lgkmcnt(5)
 v_smfmac_f32_16x16x64_bf16 v[56:59], v[24:27], v[44:51], v2
 s_waitcnt lgkmcnt(2)
 v_mfma_f32_16x16x32_bf16 v[40:43], v[68:71], v[60:63], 0
 s_barrier
 ds_read_b128 v[8:11], v0 offset:14336
 v_add_f32 v52, v52, v54
 v_add_f32 v53, v53, v55
 s_waitcnt lgkmcnt(1)
 v_mfma_f32_16x16x32_bf16 v[40:43], v[72:75], v[64:67], v[40:43]
 s_cmp_eq_u32 s36, 63
 v_cvt_pk_bf16_f32 v78, v52, v53
 v_smfmac_f32_16x16x64_bf16 v[56:59], v[28:31], a[136:143], v2
 s_waitcnt lgkmcnt(0)
 s_nop 2
 v_add_f32_dpp v40, v42, v40 quad_perm:[2,3,0,1] row_mask:0xf bank_mask:0xf
 v_add_f32_dpp v41, v43, v41 quad_perm:[2,3,0,1] row_mask:0xf bank_mask:0xf
 v_mfma_f32_16x16x32_bf16 v[72:75], v[36:39], v[8:11], 0
 ds_read_b128 v[24:27], v1 offset:28672
 v_exp_f32_dpp v42, v40 quad_perm:[0,1,0,1] row_mask:0xf bank_mask:0xf
 v_exp_f32_dpp v43, v41 quad_perm:[0,1,0,1] row_mask:0xf bank_mask:0xf
 s_waitcnt vmcnt(2)
 v_mfma_f32_16x16x32_bf16 v[44:47], v[12:15], v[8:11], 0
 ds_read_b128 v[28:31], v1 offset:29696
 v_cvt_pk_bf16_f32 v32, v42, v43
 v_cvt_pk_bf16_f32 v35, v42, v43
 v_add_f32 v56, v56, v58
 v_add_f32 v57, v57, v59
 v_mfma_f32_16x16x16_bf16 v[72:75], v[36:37], v[32:33], v[72:75]
 s_waitcnt vmcnt(1)
 v_cvt_pk_bf16_f32 v79, v56, v57
 v_mfma_f32_16x16x32_bf16 v[48:51], v[16:19], v[8:11], 0
 s_cbranch_scc1 R01TAIL
 v_mov_b64 v[68:69], 0
 v_mov_b64 v[70:71], 0
 v_mfma_f32_16x16x16_bf16 v[44:47], v[78:79], v[32:33], v[44:47]
 v_rcp_f32 v72, v72
 v_subrev_u32 v74, s52, v74
 v_mfma_f32_16x16x16_bf16 v[48:51], v[78:79], v[34:35], v[48:51]
 v_cmp_le_u32 vcc, s53, v74
 v_mov_b64 v[52:53], 0
 v_mov_b64 v[54:55], 0
R01RJ:
 s_nop 0
 v_pk_mul_f32 v[44:45], v[44:45], v[72:73] op_sel_hi:[1,0]
 v_pk_mul_f32 v[46:47], v[46:47], v[72:73] op_sel_hi:[1,0]
 s_cbranch_vccnz R01FB
 v_cvt_pk_bf16_f32 v40, v44, v45
 v_cvt_pk_bf16_f32 v41, v46, v47
 v_pk_mul_f32 v[48:49], v[48:49], v[72:73] op_sel_hi:[1,0]
 v_pk_mul_f32 v[50:51], v[50:51], v[72:73] op_sel_hi:[1,0]
 v_cvt_pk_bf16_f32 v42, v48, v49
 v_cvt_pk_bf16_f32 v43, v50, v51
 ds_write_b128 v4, v[40:43] offset:8192
 s_waitcnt lgkmcnt(1)
 v_smfmac_f32_16x16x64_bf16 v[68:71], v[40:43], v[24:31], v2
 v_mov_b64 v[56:57], 0
 v_mov_b64 v[58:59], 0
 v_smfmac_f32_16x16x64_bf16 v[52:55], v[40:43], a[144:151], v2
 v_mov_b64 v[64:65], 0
 v_mov_b64 v[66:67], 0
 v_smfmac_f32_16x16x64_bf16 v[56:59], v[40:43], a[152:159], v2
 s_waitcnt lgkmcnt(0)
 s_barrier
 ds_read_b128 v[32:35], v4 offset:8320
 ds_read_b128 v[36:39], v4 offset:9216
 ds_read_b128 v[72:75], v4 offset:9344
 v_mov_b64 v[60:61], 0
 v_mov_b64 v[62:63], 0
 v_smfmac_f32_16x16x64_bf16 v[64:67], v[40:43], a[160:167], v2
 s_waitcnt lgkmcnt(2)
 v_smfmac_f32_16x16x64_bf16 v[68:71], v[32:35], a[168:175], v2
 ds_read_b128 v[44:47], v3 offset:8192
 s_waitcnt lgkmcnt(2)
 v_lshrrev_b32 v40, 2, v0
 v_smfmac_f32_16x16x64_bf16 v[68:71], v[36:39], a[176:183], v2
 ds_read_b128 v[48:51], v3 offset:9216
 s_waitcnt lgkmcnt(2)
 v_smfmac_f32_16x16x64_bf16 v[68:71], v[72:75], a[184:191], v2
 ds_read_b128 v[24:27], v1 offset:30720
 v_smfmac_f32_16x16x64_bf16 v[52:55], v[32:35], a[192:199], v2
 ds_read_b128 v[28:31], v1 offset:31744
 v_smfmac_f32_16x16x64_bf16 v[52:55], v[36:39], a[200:207], v2
 ds_read_b128 v[8:11], v1 offset:32768
 v_cvt_pk_bf16_f32 v68, v68, v69
 v_smfmac_f32_16x16x64_bf16 v[52:55], v[72:75], a[208:215], v2
 ds_read_b128 v[12:15], v1 offset:33792
 s_waitcnt lgkmcnt(5)
 v_cvt_pk_bf16_f32 v69, v70, v71
 v_smfmac_f32_16x16x64_bf16 v[60:63], v[44:47], a[216:223], v2
 ds_read_b128 v[16:19], v1 offset:34816
 s_waitcnt lgkmcnt(5)
 v_and_or_b32 v68, v68, -2, s65
 v_smfmac_f32_16x16x64_bf16 v[60:63], v[48:51], a[224:231], v2
 ds_read_b128 v[20:23], v1 offset:35840
 v_cvt_pk_bf16_f32 v70, v52, v53
 v_cvt_pk_bf16_f32 v71, v54, v55
 buffer_store_dwordx4 v[68:71], v0, s[8:11], s37 offen sc1
 v_smfmac_f32_16x16x64_bf16 v[56:59], v[32:35], a[232:239], v2
 ds_read_b32 v76, v0 offset:13312
 s_waitcnt lgkmcnt(5)
 v_smfmac_f32_16x16x64_bf16 v[56:59], v[36:39], v[24:31], v2
 s_add_u32 s36, s36, 1
 v_add_f32 v60, v60, v62
 v_smfmac_f32_16x16x64_bf16 v[56:59], v[72:75], a[240:247], v2
 s_waitcnt lgkmcnt(3)
 v_add_f32 v61, v61, v63
 v_smfmac_f32_16x16x64_bf16 v[64:67], v[32:35], v[8:15], v2
 v_cvt_pk_bf16_f32 v41, v60, v61
 v_smfmac_f32_16x16x64_bf16 v[64:67], v[36:39], a[248:255], v2
 s_waitcnt lgkmcnt(1)
 v_and_or_b32 v41, v41, -2, s65
 v_smfmac_f32_16x16x64_bf16 v[64:67], v[72:75], v[16:23], v2
 buffer_store_dword v41, v40, s[8:11], s38 offen sc1
 v_cvt_pk_bf16_f32 v56, v56, v57
 v_cvt_pk_bf16_f32 v57, v58, v59
 v_and_or_b32 v56, v56, -2, s65
 s_nop 3
 v_cvt_pk_bf16_f32 v58, v64, v65
 v_cvt_pk_bf16_f32 v59, v66, v67
 buffer_store_dwordx4 v[56:59], v0, s[8:11], s37 offen offset:1024 sc1
R01HOP:
 ds_read_b128 v[40:43], v0 offset:12288
 s_sub_u32 s49, s49, 1
 s_cselect_b32 s49, 0, s49
 s_cselect_b32 s66, -1, -2
 s_cselect_b32 s67, 1, 0
 s_waitcnt vmcnt(0)
 ds_read_b128 v[8:11], v1 offset:0
 ds_read_b128 v[12:15], v1 offset:1024
 ds_read_b128 v[16:19], v1 offset:2048
 ds_read_b128 v[20:23], v1 offset:3072
 buffer_load_dwordx4 v[60:63], v7, s[8:11], s39 offen sc1
 buffer_load_dwordx4 v[64:67], v7, s[8:11], s40 offen sc1
 buffer_load_dwordx4 v[68:71], v7, s[8:11], s41 offen sc1
 buffer_load_dwordx4 v[72:75], v7, s[8:11], s42 offen sc1
R01P1:
 s_waitcnt vmcnt(3)
 s_waitcnt lgkmcnt(4)
 v_mfma_f32_16x16x32_bf16 v[36:39], v[60:63], v[40:43], 0
 s_waitcnt vmcnt(2)
 v_mfma_f32_16x16x32_bf16 v[36:39], v[64:67], v[40:43], v[36:39]
 v_bitop3_b32 v60, v60, v64, s65 bitop3:0x7e
 s_waitcnt vmcnt(1)
 v_mfma_f32_16x16x32_bf16 v[36:39], v[68:71], v[40:43], v[36:39]
 s_waitcnt vmcnt(0)
 v_mfma_f32_16x16x32_bf16 v[36:39], v[72:75], v[40:43], v[36:39]
 v_bitop3_b32 v64, v68, v72, s65 bitop3:0x7e
 v_bitop3_b32 v60, v60, v64, 1 bitop3:0xa8
 v_cmp_lt_u32 vcc, s67, v60
 s_cbranch_vccnz R01R1
 s_nop 3
 v_permlane32_swap_b32 v36, v38
 v_permlane32_swap_b32 v37, v39
 v_add_f32 v36, v36, v38
 v_add_f32 v37, v37, v39
 v_cvt_pk_bf16_f32 v36, v36, v37
 buffer_store_dword v36, v76, s[8:11], s45 offen sc1
 s_barrier
 v_mov_b64 v[60:61], 0
 v_mov_b64 v[62:63], 0
 v_mov_b64 v[64:65], 0
 v_mov_b64 v[66:67], 0
 v_mov_b64 v[68:69], 0
 v_mov_b64 v[70:71], 0
 v_mov_b64 v[72:73], 0
 v_mov_b64 v[74:75], 0
 buffer_load_dwordx4 v[32:35], v0, s[8:11], s43 offen sc1
 ds_read_b128 v[24:27], v1 offset:4096
 ds_read_b128 v[28:31], v1 offset:5120
 v_mov_b64 v[52:53], 0
 v_mov_b64 v[54:55], 0
 ds_read_b128 v[44:47], v1 offset:6144
 ds_read_b128 v[48:51], v1 offset:7168
 v_mov_b64 v[56:57], 0
 v_mov_b64 v[58:59], 0
 s_branch R01TOP
R01PB:
 buffer_load_dwordx4 v[36:39], v0, s[8:11], s63 offen sc1
 buffer_load_dwordx4 v[40:43], v0, s[8:11], s44 offen sc1
 s_sub_u32 s49, s49, 1
 s_cselect_b32 s49, 0, s49
 s_cselect_b32 s66, -1, -2
 s_cselect_b32 s67, 1, 0
 s_waitcnt vmcnt(0)
 v_max3_u32 v20, v36, v37, v38
 v_max3_u32 v20, v39, v40, v20
 v_max3_u32 v21, v41, v42, v43
 v_max_u32 v20, v21, v20
 v_cmp_lt_u32 vcc, s66, v20
 ds_write_b128 v0, v[36:39] offset:1024
 s_cbranch_vccnz R01PB
 s_waitcnt lgkmcnt(0)
 s_branch R01B
R01R1:
 buffer_load_dwordx4 v[60:63], v7, s[8:11], s39 offen sc1
 buffer_load_dwordx4 v[64:67], v7, s[8:11], s40 offen sc1
 buffer_load_dwordx4 v[68:71], v7, s[8:11], s41 offen sc1
 buffer_load_dwordx4 v[72:75], v7, s[8:11], s42 offen sc1
 s_sub_u32 s49, s49, 1
 s_cselect_b32 s49, 0, s49
 s_cselect_b32 s66, -1, -2
 s_cselect_b32 s67, 1, 0
 s_waitcnt vmcnt(0)
 s_branch R01P1
R01TAIL:
 s_waitcnt lgkmcnt(0)
 ds_read_b64_tr_b16 v[76:77], v6 offset:10240
 s_waitcnt lgkmcnt(0)
 buffer_store_dwordx4 v[76:79], v0, s[8:11], s48 offen sc1
 s_waitcnt vmcnt(0)
 s_endpgm
R01FB:
 s_waitcnt vmcnt(0) lgkmcnt(0)
 ds_write_b64 v6, v[76:77] offset:8192
 s_waitcnt lgkmcnt(0)
 s_barrier
 ds_read_b64 v[44:45], v6 offset:8192
 ds_read_b64 v[46:47], v6 offset:8704
 ds_read_b64 v[48:49], v6 offset:9216
 ds_read_b64 v[50:51], v6 offset:9728
 s_waitcnt lgkmcnt(0)
 s_barrier
 v_max3_f32 v72, v44, v45, v46
 v_max3_f32 v72, v72, v47, v48
 v_max3_f32 v72, v72, v49, v50
 v_max3_f32 v72, v72, v51, v40
 v_max_f32 v72, v72, v41
 v_mov_b32 v73, v72
 s_nop 1
 v_permlane16_swap_b32 v72, v73
 v_max_f32 v72, v72, v73
 v_mov_b32 v73, v72
 s_nop 1
 v_permlane32_swap_b32 v72, v73
 v_max_f32 v72, v72, v73
 v_sub_f32 v44, v44, v72
 v_sub_f32 v45, v45, v72
 v_sub_f32 v46, v46, v72
 v_sub_f32 v47, v47, v72
 v_sub_f32 v48, v48, v72
 v_sub_f32 v49, v49, v72
 v_sub_f32 v50, v50, v72
 v_sub_f32 v51, v51, v72
 v_sub_f32 v40, v40, v72
 v_sub_f32 v41, v41, v72
 v_exp_f32_dpp v44, v44 quad_perm:[0,1,0,1] row_mask:0xf bank_mask:0xf
 v_exp_f32_dpp v45, v45 quad_perm:[0,1,0,1] row_mask:0xf bank_mask:0xf
 v_exp_f32_dpp v46, v46 quad_perm:[0,1,0,1] row_mask:0xf bank_mask:0xf
 v_exp_f32_dpp v47, v47 quad_perm:[0,1,0,1] row_mask:0xf bank_mask:0xf
 v_exp_f32_dpp v48, v48 quad_perm:[0,1,0,1] row_mask:0xf bank_mask:0xf
 v_exp_f32_dpp v49, v49 quad_perm:[0,1,0,1] row_mask:0xf bank_mask:0xf
 v_exp_f32_dpp v50, v50 quad_perm:[0,1,0,1] row_mask:0xf bank_mask:0xf
 v_exp_f32_dpp v51, v51 quad_perm:[0,1,0,1] row_mask:0xf bank_mask:0xf
 v_exp_f32_dpp v40, v40 quad_perm:[0,1,0,1] row_mask:0xf bank_mask:0xf
 v_exp_f32_dpp v41, v41 quad_perm:[0,1,0,1] row_mask:0xf bank_mask:0xf
 v_cvt_pk_bf16_f32 v8, v44, v45
 v_cvt_pk_bf16_f32 v9, v46, v47
 v_cvt_pk_bf16_f32 v10, v48, v49
 v_cvt_pk_bf16_f32 v11, v50, v51
 v_cvt_pk_bf16_f32 v32, v40, v41
 v_cvt_pk_bf16_f32 v35, v40, v41
 v_mfma_f32_16x16x32_bf16 v[72:75], v[36:39], v[8:11], 0
 v_mfma_f32_16x16x32_bf16 v[44:47], v[12:15], v[8:11], 0
 v_mfma_f32_16x16x32_bf16 v[48:51], v[16:19], v[8:11], 0
 v_mfma_f32_16x16x16_bf16 v[72:75], v[36:37], v[32:33], v[72:75]
 v_mfma_f32_16x16x16_bf16 v[44:47], v[78:79], v[32:33], v[44:47]
 v_mfma_f32_16x16x16_bf16 v[48:51], v[78:79], v[34:35], v[48:51]
 v_rcp_f32 v72, v72
 s_mov_b64 vcc, 0
 s_nop 7
 s_branch R01RJ
RECW1:
 v_mbcnt_lo_u32_b32 v8, -1, 0
 v_mbcnt_hi_u32_b32 v8, -1, v8
 v_mov_b32 v4, 128
 v_bfe_u32 v9, v8, 5, 1
 v_lshl_add_u32 v4, v9, 6, v4
 v_mov_b32 v1, 0
 v_bfe_u32 v9, v8, 0, 5
 v_lshl_add_u32 v1, v9, 4, v1
 v_xor_b32 v4, v4, v1
 v_mov_b32 v1, 36864
 v_bfe_u32 v9, v8, 5, 1
 s_mov_b32 s101, 1152
 v_mad_u32_u24 v1, v9, s101, v1
 v_add_u32 v4, v4, v1
 v_mov_b32 v7, 64
 v_bfe_u32 v9, v8, 4, 1
 v_lshl_add_u32 v7, v9, 5, v7
 v_mov_b32 v1, 0
 v_bfe_u32 v9, v8, 0, 3
 v_lshl_add_u32 v1, v9, 4, v1
 v_xor_b32 v7, v7, v1
 v_mov_b32 v1, 36864
 v_bfe_u32 v9, v8, 3, 1
 s_mov_b32 s101, 1152
 v_mad_u32_u24 v1, v9, s101, v1
 v_bfe_u32 v9, v8, 4, 1
 s_mov_b32 s101, 9216
 v_mad_u32_u24 v1, v9, s101, v1
 v_bfe_u32 v9, v8, 5, 1
 s_mov_b32 s101, 73728
 v_mad_u32_u24 v1, v9, s101, v1
 v_add_u32 v7, v7, v1
 s_lshl_b32 s62, s3, 8
 s_mul_i32 s63, s3, 147456
 s_mov_b32 m0, 73728
 s_add_u32 s54, s63, 1024
 buffer_load_dwordx4 v7, s[28:31], s54 offen lds
 s_mov_b32 m0, 74752
 s_add_u32 s54, s63, 3328
 buffer_load_dwordx4 v7, s[28:31], s54 offen lds
 s_mov_b32 m0, 75776
 s_add_u32 s54, s63, 19456
 buffer_load_dwordx4 v7, s[28:31], s54 offen lds
 s_mov_b32 m0, 76800
 s_add_u32 s54, s63, 21760
 buffer_load_dwordx4 v7, s[28:31], s54 offen lds
 s_mov_b32 m0, 77824
 s_add_u32 s54, s63, 0
 buffer_load_dwordx4 v4, s[28:31], s54 offen lds
 s_mov_b32 m0, 78848
 s_add_u32 s54, s63, 2304
 buffer_load_dwordx4 v4, s[28:31], s54 offen lds
 s_mov_b32 m0, 79872
 s_add_u32 s54, s63, 18432
 buffer_load_dwordx4 v4, s[28:31], s54 offen lds
 s_mov_b32 m0, 80896
 s_add_u32 s54, s63, 20736
 buffer_load_dwordx4 v4, s[28:31], s54 offen lds
 s_mov_b32 m0, 81920
 s_add_u32 s54, s63, 512
 buffer_load_dwordx4 v4, s[28:31], s54 offen lds
 s_mov_b32 m0, 82944
 s_add_u32 s54, s63, 2816
 buffer_load_dwordx4 v4, s[28:31], s54 offen lds
 s_mov_b32 m0, 83968
 s_add_u32 s54, s63, 18944
 buffer_load_dwordx4 v4, s[28:31], s54 offen lds
 s_mov_b32 m0, 84992
 s_add_u32 s54, s63, 21248
 buffer_load_dwordx4 v4, s[28:31], s54 offen lds
 s_mul_i32 s54, s3, 9344
 s_add_u32 s37, s54, 2048
 s_add_u32 s38, s54, 8448
 s_mov_b32 s39, 0
 s_mov_b32 s40, 74752
 s_mov_b32 s41, 149504
 s_mov_b32 s42, 224256
 s_mov_b32 s45, 1048576
 s_mov_b32 s46, 1081344
 s_lshl_b32 s54, s3, 14
 s_add_u32 s47, s54, 16781312
 s_add_u32 s58, s54, 16777216
 s_lshl_b32 s54, s3, 12
 s_add_u32 s48, s54, 83887104
 s_mov_b32 s49, 400000
 s_mov_b32 s36, 0
 s_mov_b32 s50, 1040356334
 s_mov_b32 s51, 1040356334
 s_mov_b32 s52, 662700032
 s_mov_b32 s53, 939524096
 s_lshl_b32 s57, s3, 2
 s_lshr_b32 s59, s3, 3
 s_lshl_b32 s59, s59, 11
 s_add_u32 s59, s59, 0
 s_and_b32 s60, s3, 7
 s_lshl_b32 s54, s60, 7
 s_add_u32 s54, s54, s59
 v_mov_b32 v7, s54
 v_bfe_u32 v9, v8, 3, 3
 s_mov_b32 s101, 9344
 v_mad_u32_u24 v7, v9, s101, v7
 v_bfe_u32 v9, v8, 0, 3
 v_lshl_add_u32 v7, v9, 4, v7
 s_and_b32 s54, s60, 1
 s_lshl_b32 s54, s54, 8
 s_lshr_b32 s61, s60, 1
 s_lshl_b32 s61, s61, 6
 s_add_u32 s54, s54, s61
 s_lshr_b32 s61, s3, 3
 s_lshl_b32 s61, s61, 10
 s_add_u32 s54, s54, s61
 s_add_u32 s54, s54, 0
 v_mov_b32 v10, s54
 v_bfe_u32 v9, v8, 1, 1
 v_lshl_add_u32 v10, v9, 9, v10
 v_bfe_u32 v9, v8, 2, 1
 v_lshl_add_u32 v10, v9, 5, v10
 v_bfe_u32 v9, v8, 0, 1
 v_lshl_add_u32 v10, v9, 4, v10
 v_bfe_u32 v9, v8, 4, 1
 v_lshl_add_u32 v10, v9, 3, v10
 v_bfe_u32 v9, v8, 5, 1
 v_lshl_add_u32 v10, v9, 2, v10
 v_bfe_u32 v9, v8, 3, 1
 v_lshl_add_u32 v10, v9, 30, v10
 v_mov_b64 v[12:13], -1
 v_mov_b64 v[14:15], -1
 s_mov_b32 s54, 0
 buffer_store_dwordx4 v[12:15], v7, s[8:11], s54 offen sc1
 s_mov_b32 s54, 74752
 buffer_store_dwordx4 v[12:15], v7, s[8:11], s54 offen sc1
 s_mov_b32 s54, 149504
 buffer_store_dwordx4 v[12:15], v7, s[8:11], s54 offen sc1
 s_mov_b32 s54, 224256
 buffer_store_dwordx4 v[12:15], v7, s[8:11], s54 offen sc1
 s_mov_b32 s54, 1048576
 buffer_store_dword v12, v10, s[8:11], s54 offen sc1
 s_mov_b32 s54, 1064960
 buffer_store_dword v12, v10, s[8:11], s54 offen sc1
 s_mov_b32 s54, 1081344
 buffer_store_dword v12, v10, s[8:11], s54 offen sc1
 s_mov_b32 s54, 1097728
 buffer_store_dword v12, v10, s[8:11], s54 offen sc1
 v_lshlrev_b32 v11, 4, v8
 ds_write_b32 v11, v10 offset:13316
 s_add_u32 s57, s57, 1187840
 s_and_b32 s58, s3, 3
 s_lshl_b32 s58, s58, 8
 s_add_u32 s58, s58, 1187840
 v_and_b32 v11, 0x300, v11
 buffer_store_dword v12, v11, s[8:11], s57 offen sc1
 v_mov_b32 v0, 16
 v_bfe_u32 v9, v8, 4, 2
 v_lshl_add_u32 v0, v9, 6, v0
 v_mov_b32 v1, 0
 v_bfe_u32 v9, v8, 0, 4
 v_lshl_add_u32 v1, v9, 4, v1
 v_xor_b32 v0, v0, v1
 v_mov_b32 v1, 32768
 v_bfe_u32 v9, v8, 4, 1
 v_lshl_add_u32 v1, v9, 13, v1
 v_bfe_u32 v9, v8, 5, 1
 v_lshl_add_u32 v1, v9, 18, v1
 v_add_u32 v0, v0, v1
 v_mov_b32 v2, 16
 v_bfe_u32 v9, v8, 1, 1
 v_lshl_add_u32 v2, v9, 5, v2
 v_mov_b32 v1, 0
 v_bfe_u32 v9, v8, 4, 1
 v_lshl_add_u32 v1, v9, 4, v1
 v_bfe_u32 v9, v8, 2, 2
 v_lshl_add_u32 v1, v9, 6, v1
 v_xor_b32 v2, v2, v1
 v_mov_b32 v1, 16384
 v_bfe_u32 v9, v8, 4, 2
 s_mov_b32 s101, 36864
 v_mad_u32_u24 v1, v9, s101, v1
 v_bfe_u32 v9, v8, 0, 1
 v_lshl_add_u32 v1, v9, 3, v1
 v_bfe_u32 v9, v8, 2, 2
 v_lshl_add_u32 v1, v9, 8, v1
 v_add_u32 v2, v2, v1
 v_mov_b32 v3, 32
 v_bfe_u32 v9, v8, 1, 1
 v_lshl_add_u32 v3, v9, 4, v3
 v_mov_b32 v1, 0
 v_bfe_u32 v9, v8, 3, 1
 v_lshl_add_u32 v1, v9, 5, v1
 v_bfe_u32 v9, v8, 4, 1
 v_lshl_add_u32 v1, v9, 6, v1
 v_xor_b32 v3, v3, v1
 v_mov_b32 v1, 16384
 v_bfe_u32 v9, v8, 4, 2
 s_mov_b32 s101, 36864
 v_mad_u32_u24 v1, v9, s101, v1
 v_bfe_u32 v9, v8, 0, 1
 v_lshl_add_u32 v1, v9, 3, v1
 v_bfe_u32 v9, v8, 2, 2
 v_lshl_add_u32 v1, v9, 7, v1
 v_add_u32 v3, v3, v1
 v_mov_b32 v5, 128
 v_bfe_u32 v9, v8, 1, 1
 v_lshl_add_u32 v5, v9, 4, v5
 v_bfe_u32 v9, v8, 3, 1
 v_lshl_add_u32 v5, v9, 5, v5
 v_mov_b32 v1, 0
 v_bfe_u32 v9, v8, 2, 1
 v_lshl_add_u32 v1, v9, 6, v1
 v_bfe_u32 v9, v8, 4, 1
 v_lshl_add_u32 v1, v9, 7, v1
 v_xor_b32 v5, v5, v1
 v_mov_b32 v1, 16384
 v_bfe_u32 v9, v8, 4, 2
 s_mov_b32 s101, 36864
 v_mad_u32_u24 v1, v9, s101, v1
 v_bfe_u32 v9, v8, 0, 1
 v_lshl_add_u32 v1, v9, 3, v1
 v_bfe_u32 v9, v8, 2, 1
 v_lshl_add_u32 v1, v9, 9, v1
 v_add_u32 v5, v5, v1
 v_xor_b32 v6, 64, v5
 v_mov_b32 v1, 53248
 v_bfe_u32 v9, v8, 0, 6
 v_lshl_add_u32 v1, v9, 4, v1
 s_waitcnt vmcnt(17) lgkmcnt(0)
 s_barrier
 s_mov_b32 m0, 86016
 s_add_u32 s54, s63, 9216
 buffer_load_dwordx4 v4, s[28:31], s54 offen lds
 s_mov_b32 m0, 87040
 s_add_u32 s54, s63, 11520
 buffer_load_dwordx4 v4, s[28:31], s54 offen lds
 s_mov_b32 m0, 88064
 s_add_u32 s54, s63, 27648
 buffer_load_dwordx4 v4, s[28:31], s54 offen lds
 s_mov_b32 m0, 89088
 s_add_u32 s54, s63, 29952
 buffer_load_dwordx4 v4, s[28:31], s54 offen lds
 ds_read_b64_tr_b16 a[216:217], v3 offset:20480
 ds_read_b64_tr_b16 a[218:219], v3 offset:21504
 ds_read_b64_tr_b16 a[220:221], v3 offset:22528
 ds_read_b64_tr_b16 a[222:223], v3 offset:23552
 ds_read_b64_tr_b16 a[224:225], v3 offset:20992
 ds_read_b64_tr_b16 a[226:227], v3 offset:22016
 ds_read_b64_tr_b16 a[228:229], v3 offset:23040
 ds_read_b64_tr_b16 a[230:231], v3 offset:24064
 s_waitcnt vmcnt(17) lgkmcnt(0)
 s_barrier
 s_mov_b32 m0, 73728
 s_add_u32 s54, s63, 9728
 buffer_load_dwordx4 v4, s[28:31], s54 offen lds
 s_mov_b32 m0, 74752
 s_add_u32 s54, s63, 12032
 buffer_load_dwordx4 v4, s[28:31], s54 offen lds
 s_mov_b32 m0, 75776
 s_add_u32 s54, s63, 28160
 buffer_load_dwordx4 v4, s[28:31], s54 offen lds
 s_mov_b32 m0, 76800
 s_add_u32 s54, s63, 30464
 buffer_load_dwordx4 v4, s[28:31], s54 offen lds
 v_xor_b32 v3, 64, v2
 ds_read_b64_tr_b16 a[168:169], v5 offset:24576
 ds_read_b64_tr_b16 a[170:171], v5 offset:25600
 ds_read_b64_tr_b16 a[172:173], v5 offset:26624
 ds_read_b64_tr_b16 a[174:175], v5 offset:27648
 ds_read_b64_tr_b16 a[192:193], v6 offset:24576
 ds_read_b64_tr_b16 a[194:195], v6 offset:25600
 ds_read_b64_tr_b16 a[196:197], v6 offset:26624
 ds_read_b64_tr_b16 a[198:199], v6 offset:27648
 s_waitcnt vmcnt(17) lgkmcnt(0)
 s_barrier
 s_mov_b32 m0, 77824
 s_add_u32 s54, s63, 73728
 buffer_load_dwordx4 v4, s[28:31], s54 offen lds
 s_mov_b32 m0, 78848
 s_add_u32 s54, s63, 76032
 buffer_load_dwordx4 v4, s[28:31], s54 offen lds
 s_mov_b32 m0, 79872
 s_add_u32 s54, s63, 92160
 buffer_load_dwordx4 v4, s[28:31], s54 offen lds
 s_mov_b32 m0, 80896
 s_add_u32 s54, s63, 94464
 buffer_load_dwordx4 v4, s[28:31], s54 offen lds
 ds_read_b64_tr_b16 a[232:233], v5 offset:28672
 ds_read_b64_tr_b16 a[234:235], v5 offset:29696
 ds_read_b64_tr_b16 a[236:237], v5 offset:30720
 ds_read_b64_tr_b16 a[238:239], v5 offset:31744
 ds_read_b64_tr_b16 v[64:65], v6 offset:28672
 ds_read_b64_tr_b16 v[66:67], v6 offset:29696
 ds_read_b64_tr_b16 v[68:69], v6 offset:30720
 ds_read_b64_tr_b16 v[70:71], v6 offset:31744
 s_waitcnt vmcnt(8) lgkmcnt(0)
 s_barrier
 s_mov_b32 m0, 81920
 s_add_u32 s54, s63, 74240
 buffer_load_dwordx4 v4, s[28:31], s54 offen lds
 s_mov_b32 m0, 82944
 s_add_u32 s54, s63, 76544
 buffer_load_dwordx4 v4, s[28:31], s54 offen lds
 s_mov_b32 m0, 83968
 s_add_u32 s54, s63, 92672
 buffer_load_dwordx4 v4, s[28:31], s54 offen lds
 s_mov_b32 m0, 84992
 s_add_u32 s54, s63, 94976
 buffer_load_dwordx4 v4, s[28:31], s54 offen lds
 ds_read_b64_tr_b16 v[48:49], v5 offset:32768
 ds_read_b64_tr_b16 v[50:51], v5 offset:33792
 ds_read_b64_tr_b16 v[52:53], v5 offset:34816
 ds_read_b64_tr_b16 v[54:55], v5 offset:35840
 ds_read_b64_tr_b16 a[144:145], v6 offset:32768
 ds_read_b64_tr_b16 a[146:147], v6 offset:33792
 ds_read_b64_tr_b16 a[148:149], v6 offset:34816
 ds_read_b64_tr_b16 a[150:151], v6 offset:35840
 s_waitcnt vmcnt(8) lgkmcnt(0)
 s_barrier
 s_mov_b32 m0, 86016
 s_add_u32 s54, s63, 82944
 buffer_load_dwordx4 v4, s[28:31], s54 offen lds
 s_mov_b32 m0, 87040
 s_add_u32 s54, s63, 85248
 buffer_load_dwordx4 v4, s[28:31], s54 offen lds
 s_mov_b32 m0, 88064
 s_add_u32 s54, s63, 101376
 buffer_load_dwordx4 v4, s[28:31], s54 offen lds
 s_mov_b32 m0, 89088
 s_add_u32 s54, s63, 103680
 buffer_load_dwordx4 v4, s[28:31], s54 offen lds
 ds_read_b64_tr_b16 a[152:153], v5 offset:20480
 ds_read_b64_tr_b16 a[154:155], v5 offset:21504
 ds_read_b64_tr_b16 a[156:157], v5 offset:22528
 ds_read_b64_tr_b16 a[158:159], v5 offset:23552
 ds_read_b64_tr_b16 a[160:161], v6 offset:20480
 ds_read_b64_tr_b16 a[162:163], v6 offset:21504
 ds_read_b64_tr_b16 a[164:165], v6 offset:22528
 ds_read_b64_tr_b16 a[166:167], v6 offset:23552
 s_waitcnt vmcnt(8) lgkmcnt(0)
 s_barrier
 s_mov_b32 m0, 73728
 s_add_u32 s54, s63, 83456
 buffer_load_dwordx4 v4, s[28:31], s54 offen lds
 s_mov_b32 m0, 74752
 s_add_u32 s54, s63, 85760
 buffer_load_dwordx4 v4, s[28:31], s54 offen lds
 s_mov_b32 m0, 75776
 s_add_u32 s54, s63, 101888
 buffer_load_dwordx4 v4, s[28:31], s54 offen lds
 s_mov_b32 m0, 76800
 s_add_u32 s54, s63, 104192
 buffer_load_dwordx4 v4, s[28:31], s54 offen lds
 ds_read_b64_tr_b16 a[176:177], v5 offset:24576
 ds_read_b64_tr_b16 a[178:179], v5 offset:25600
 ds_read_b64_tr_b16 a[180:181], v5 offset:26624
 ds_read_b64_tr_b16 a[182:183], v5 offset:27648
 ds_read_b64_tr_b16 a[200:201], v6 offset:24576
 ds_read_b64_tr_b16 a[202:203], v6 offset:25600
 ds_read_b64_tr_b16 a[204:205], v6 offset:26624
 ds_read_b64_tr_b16 a[206:207], v6 offset:27648
 s_waitcnt vmcnt(8) lgkmcnt(0)
 s_barrier
 s_mov_b32 m0, 77824
 s_add_u32 s54, s62, 0
 buffer_load_dwordx4 v0, s[16:19], s54 offen lds
 s_mov_b32 m0, 78848
 s_add_u32 s54, s62, 16384
 buffer_load_dwordx4 v0, s[16:19], s54 offen lds
 s_mov_b32 m0, 79872
 s_add_u32 s54, s62, 131072
 buffer_load_dwordx4 v0, s[16:19], s54 offen lds
 s_mov_b32 m0, 80896
 s_add_u32 s54, s62, 147456
 buffer_load_dwordx4 v0, s[16:19], s54 offen lds
 ds_read_b64_tr_b16 v[56:57], v5 offset:28672
 ds_read_b64_tr_b16 v[58:59], v5 offset:29696
 ds_read_b64_tr_b16 v[60:61], v5 offset:30720
 ds_read_b64_tr_b16 v[62:63], v5 offset:31744
 ds_read_b64_tr_b16 a[248:249], v6 offset:28672
 ds_read_b64_tr_b16 a[250:251], v6 offset:29696
 ds_read_b64_tr_b16 a[252:253], v6 offset:30720
 ds_read_b64_tr_b16 a[254:255], v6 offset:31744
 s_waitcnt vmcnt(8) lgkmcnt(0)
 s_barrier
 s_mov_b32 m0, 81920
 s_add_u32 s54, s62, 524288
 buffer_load_dwordx4 v0, s[16:19], s54 offen lds
 s_mov_b32 m0, 82944
 s_add_u32 s54, s62, 540672
 buffer_load_dwordx4 v0, s[16:19], s54 offen lds
 s_mov_b32 m0, 83968
 s_add_u32 s54, s62, 655360
 buffer_load_dwordx4 v0, s[16:19], s54 offen lds
 s_mov_b32 m0, 84992
 s_add_u32 s54, s62, 671744
 buffer_load_dwordx4 v0, s[16:19], s54 offen lds
 ds_read_b64_tr_b16 a[184:185], v5 offset:32768
 ds_read_b64_tr_b16 a[186:187], v5 offset:33792
 ds_read_b64_tr_b16 a[188:189], v5 offset:34816
 ds_read_b64_tr_b16 a[190:191], v5 offset:35840
 ds_read_b64_tr_b16 a[208:209], v6 offset:32768
 ds_read_b64_tr_b16 a[210:211], v6 offset:33792
 ds_read_b64_tr_b16 a[212:213], v6 offset:34816
 ds_read_b64_tr_b16 a[214:215], v6 offset:35840
 s_waitcnt vmcnt(8) lgkmcnt(0)
 s_barrier
 s_mov_b32 m0, 86016
 s_add_u32 s54, s62, 1048576
 buffer_load_dwordx4 v0, s[16:19], s54 offen lds
 s_mov_b32 m0, 87040
 s_add_u32 s54, s62, 1064960
 buffer_load_dwordx4 v0, s[16:19], s54 offen lds
 s_mov_b32 m0, 88064
 s_add_u32 s54, s62, 1179648
 buffer_load_dwordx4 v0, s[16:19], s54 offen lds
 s_mov_b32 m0, 89088
 s_add_u32 s54, s62, 1196032
 buffer_load_dwordx4 v0, s[16:19], s54 offen lds
 ds_read_b64_tr_b16 a[240:241], v5 offset:20480
 ds_read_b64_tr_b16 a[242:243], v5 offset:21504
 ds_read_b64_tr_b16 a[244:245], v5 offset:22528
 ds_read_b64_tr_b16 a[246:247], v5 offset:23552
 ds_read_b64_tr_b16 v[72:73], v6 offset:20480
 ds_read_b64_tr_b16 v[74:75], v6 offset:21504
 ds_read_b64_tr_b16 v[76:77], v6 offset:22528
 ds_read_b64_tr_b16 v[78:79], v6 offset:23552
 s_waitcnt vmcnt(8) lgkmcnt(0)
 s_barrier
 s_mov_b32 m0, 73728
 s_add_u32 s54, s62, 1572864
 buffer_load_dwordx4 v0, s[16:19], s54 offen lds
 s_mov_b32 m0, 74752
 s_add_u32 s54, s62, 1589248
 buffer_load_dwordx4 v0, s[16:19], s54 offen lds
 s_mov_b32 m0, 75776
 s_add_u32 s54, s62, 1703936
 buffer_load_dwordx4 v0, s[16:19], s54 offen lds
 s_mov_b32 m0, 76800
 s_add_u32 s54, s62, 1720320
 buffer_load_dwordx4 v0, s[16:19], s54 offen lds
 ds_read_b64_tr_b16 v[96:97], v2 offset:24576
 ds_read_b64_tr_b16 v[98:99], v2 offset:25600
 ds_read_b64_tr_b16 v[100:101], v2 offset:26624
 ds_read_b64_tr_b16 v[102:103], v2 offset:27648
 ds_read_b64_tr_b16 v[104:105], v3 offset:24576
 ds_read_b64_tr_b16 v[106:107], v3 offset:25600
 ds_read_b64_tr_b16 v[108:109], v3 offset:26624
 ds_read_b64_tr_b16 v[110:111], v3 offset:27648
 s_waitcnt vmcnt(8) lgkmcnt(0)
 s_barrier
 s_mov_b32 m0, 77824
 s_add_u32 s54, s62, 4194304
 buffer_load_dwordx4 v0, s[16:19], s54 offen lds
 s_mov_b32 m0, 78848
 s_add_u32 s54, s62, 4210688
 buffer_load_dwordx4 v0, s[16:19], s54 offen lds
 s_mov_b32 m0, 79872
 s_add_u32 s54, s62, 4325376
 buffer_load_dwordx4 v0, s[16:19], s54 offen lds
 s_mov_b32 m0, 80896
 s_add_u32 s54, s62, 4341760
 buffer_load_dwordx4 v0, s[16:19], s54 offen lds
 ds_read_b64_tr_b16 v[8:9], v2 offset:28672
 ds_read_b64_tr_b16 v[10:11], v2 offset:29696
 ds_read_b64_tr_b16 v[12:13], v2 offset:30720
 ds_read_b64_tr_b16 v[14:15], v2 offset:31744
 s_waitcnt lgkmcnt(2)
 ds_write_b128 v1, v[8:11] offset:0
 s_waitcnt lgkmcnt(1)
 ds_write_b128 v1, v[12:15] offset:1024
 ds_read_b64_tr_b16 v[8:9], v3 offset:28672
 ds_read_b64_tr_b16 v[10:11], v3 offset:29696
 ds_read_b64_tr_b16 v[12:13], v3 offset:30720
 ds_read_b64_tr_b16 v[14:15], v3 offset:31744
 s_waitcnt lgkmcnt(2)
 ds_write_b128 v1, v[8:11] offset:2048
 s_waitcnt lgkmcnt(1)
 ds_write_b128 v1, v[12:15] offset:3072
 s_waitcnt vmcnt(8) lgkmcnt(0)
 s_barrier
 s_mov_b32 m0, 81920
 s_add_u32 s54, s62, 0
 buffer_load_dwordx4 v0, s[20:23], s54 offen lds
 s_mov_b32 m0, 82944
 s_add_u32 s54, s62, 16384
 buffer_load_dwordx4 v0, s[20:23], s54 offen lds
 s_mov_b32 m0, 83968
 s_add_u32 s54, s62, 131072
 buffer_load_dwordx4 v0, s[20:23], s54 offen lds
 s_mov_b32 m0, 84992
 s_add_u32 s54, s62, 147456
 buffer_load_dwordx4 v0, s[20:23], s54 offen lds
 ds_read_b64_tr_b16 v[128:129], v2 offset:32768
 ds_read_b64_tr_b16 v[130:131], v2 offset:33792
 ds_read_b64_tr_b16 v[132:133], v2 offset:34816
 ds_read_b64_tr_b16 v[134:135], v2 offset:35840
 ds_read_b64_tr_b16 v[136:137], v3 offset:32768
 ds_read_b64_tr_b16 v[138:139], v3 offset:33792
 ds_read_b64_tr_b16 v[140:141], v3 offset:34816
 ds_read_b64_tr_b16 v[142:143], v3 offset:35840
 s_waitcnt vmcnt(8) lgkmcnt(0)
 s_barrier
 s_mov_b32 m0, 86016
 s_add_u32 s54, s62, 524288
 buffer_load_dwordx4 v0, s[20:23], s54 offen lds
 s_mov_b32 m0, 87040
 s_add_u32 s54, s62, 540672
 buffer_load_dwordx4 v0, s[20:23], s54 offen lds
 s_mov_b32 m0, 88064
 s_add_u32 s54, s62, 655360
 buffer_load_dwordx4 v0, s[20:23], s54 offen lds
 s_mov_b32 m0, 89088
 s_add_u32 s54, s62, 671744
 buffer_load_dwordx4 v0, s[20:23], s54 offen lds
 ds_read_b64_tr_b16 v[168:169], v2 offset:20480
 ds_read_b64_tr_b16 v[170:171], v2 offset:21504
 ds_read_b64_tr_b16 v[172:173], v2 offset:22528
 ds_read_b64_tr_b16 v[174:175], v2 offset:23552
 ds_read_b64_tr_b16 v[8:9], v3 offset:20480
 ds_read_b64_tr_b16 v[10:11], v3 offset:21504
 ds_read_b64_tr_b16 v[12:13], v3 offset:22528
 ds_read_b64_tr_b16 v[14:15], v3 offset:23552
 s_waitcnt lgkmcnt(2)
 ds_write_b128 v1, v[8:11] offset:14336
 s_waitcnt lgkmcnt(1)
 ds_write_b128 v1, v[12:15] offset:15360
 s_waitcnt vmcnt(8) lgkmcnt(0)
 s_barrier
 s_mov_b32 m0, 73728
 s_add_u32 s54, s62, 1048576
 buffer_load_dwordx4 v0, s[20:23], s54 offen lds
 s_mov_b32 m0, 74752
 s_add_u32 s54, s62, 1064960
 buffer_load_dwordx4 v0, s[20:23], s54 offen lds
 s_mov_b32 m0, 75776
 s_add_u32 s54, s62, 1179648
 buffer_load_dwordx4 v0, s[20:23], s54 offen lds
 s_mov_b32 m0, 76800
 s_add_u32 s54, s62, 1196032
 buffer_load_dwordx4 v0, s[20:23], s54 offen lds
 ds_read_b64_tr_b16 v[216:217], v2 offset:24576
 ds_read_b64_tr_b16 v[218:219], v2 offset:25600
 ds_read_b64_tr_b16 v[220:221], v2 offset:26624
 ds_read_b64_tr_b16 v[222:223], v2 offset:27648
 ds_read_b64_tr_b16 v[8:9], v3 offset:24576
 ds_read_b64_tr_b16 v[10:11], v3 offset:25600
 ds_read_b64_tr_b16 v[12:13], v3 offset:26624
 ds_read_b64_tr_b16 v[14:15], v3 offset:27648
 s_waitcnt lgkmcnt(2)
 ds_write_b128 v1, v[8:11] offset:18432
 s_waitcnt lgkmcnt(1)
 ds_write_b128 v1, v[12:15] offset:19456
 s_waitcnt vmcnt(8) lgkmcnt(0)
 s_barrier
 s_mov_b32 m0, 77824
 s_add_u32 s54, s62, 1572864
 buffer_load_dwordx4 v0, s[20:23], s54 offen lds
 s_mov_b32 m0, 78848
 s_add_u32 s54, s62, 1589248
 buffer_load_dwordx4 v0, s[20:23], s54 offen lds
 s_mov_b32 m0, 79872
 s_add_u32 s54, s62, 1703936
 buffer_load_dwordx4 v0, s[20:23], s54 offen lds
 s_mov_b32 m0, 80896
 s_add_u32 s54, s62, 1720320
 buffer_load_dwordx4 v0, s[20:23], s54 offen lds
 ds_read_b64_tr_b16 v[112:113], v2 offset:28672
 ds_read_b64_tr_b16 v[114:115], v2 offset:29696
 ds_read_b64_tr_b16 v[116:117], v2 offset:30720
 ds_read_b64_tr_b16 v[118:119], v2 offset:31744
 ds_read_b64_tr_b16 v[8:9], v3 offset:28672
 ds_read_b64_tr_b16 v[10:11], v3 offset:29696
 ds_read_b64_tr_b16 v[12:13], v3 offset:30720
 ds_read_b64_tr_b16 v[14:15], v3 offset:31744
 s_waitcnt lgkmcnt(2)
 ds_write_b128 v1, v[8:11] offset:8192
 s_waitcnt lgkmcnt(1)
 ds_write_b128 v1, v[12:15] offset:9216
 s_waitcnt vmcnt(8) lgkmcnt(0)
 s_barrier
 s_mov_b32 m0, 81920
 s_add_u32 s54, s62, 0
 buffer_load_dwordx4 v0, s[24:27], s54 offen lds
 s_mov_b32 m0, 82944
 s_add_u32 s54, s62, 16384
 buffer_load_dwordx4 v0, s[24:27], s54 offen lds
 s_mov_b32 m0, 83968
 s_add_u32 s54, s62, 131072
 buffer_load_dwordx4 v0, s[24:27], s54 offen lds
 s_mov_b32 m0, 84992
 s_add_u32 s54, s62, 147456
 buffer_load_dwordx4 v0, s[24:27], s54 offen lds
 ds_read_b64_tr_b16 v[8:9], v2 offset:32768
 ds_read_b64_tr_b16 v[10:11], v2 offset:33792
 ds_read_b64_tr_b16 v[12:13], v2 offset:34816
 ds_read_b64_tr_b16 v[14:15], v2 offset:35840
 s_waitcnt lgkmcnt(2)
 ds_write_b128 v1, v[8:11] offset:4096
 s_waitcnt lgkmcnt(1)
 ds_write_b128 v1, v[12:15] offset:5120
 ds_read_b64_tr_b16 v[8:9], v3 offset:32768
 ds_read_b64_tr_b16 v[10:11], v3 offset:33792
 ds_read_b64_tr_b16 v[12:13], v3 offset:34816
 ds_read_b64_tr_b16 v[14:15], v3 offset:35840
 s_waitcnt lgkmcnt(2)
 ds_write_b128 v1, v[8:11] offset:6144
 s_waitcnt lgkmcnt(1)
 ds_write_b128 v1, v[12:15] offset:7168
 s_waitcnt vmcnt(8) lgkmcnt(0)
 s_barrier
 s_mov_b32 m0, 86016
 s_add_u32 s54, s62, 524288
 buffer_load_dwordx4 v0, s[24:27], s54 offen lds
 s_mov_b32 m0, 87040
 s_add_u32 s54, s62, 540672
 buffer_load_dwordx4 v0, s[24:27], s54 offen lds
 s_mov_b32 m0, 88064
 s_add_u32 s54, s62, 655360
 buffer_load_dwordx4 v0, s[24:27], s54 offen lds
 s_mov_b32 m0, 89088
 s_add_u32 s54, s62, 671744
 buffer_load_dwordx4 v0, s[24:27], s54 offen lds
 ds_read_b64_tr_b16 v[144:145], v2 offset:20480
 ds_read_b64_tr_b16 v[146:147], v2 offset:21504
 ds_read_b64_tr_b16 v[148:149], v2 offset:22528
 ds_read_b64_tr_b16 v[150:151], v2 offset:23552
 ds_read_b64_tr_b16 v[152:153], v3 offset:20480
 ds_read_b64_tr_b16 v[154:155], v3 offset:21504
 ds_read_b64_tr_b16 v[156:157], v3 offset:22528
 ds_read_b64_tr_b16 v[158:159], v3 offset:23552
 s_waitcnt vmcnt(8) lgkmcnt(0)
 s_barrier
 s_mov_b32 m0, 73728
 s_add_u32 s54, s62, 1048576
 buffer_load_dwordx4 v0, s[24:27], s54 offen lds
 s_mov_b32 m0, 74752
 s_add_u32 s54, s62, 1064960
 buffer_load_dwordx4 v0, s[24:27], s54 offen lds
 s_mov_b32 m0, 75776
 s_add_u32 s54, s62, 1179648
 buffer_load_dwordx4 v0, s[24:27], s54 offen lds
 s_mov_b32 m0, 76800
 s_add_u32 s54, s62, 1196032
 buffer_load_dwordx4 v0, s[24:27], s54 offen lds
 ds_read_b64_tr_b16 v[176:177], v2 offset:24576
 ds_read_b64_tr_b16 v[178:179], v2 offset:25600
 ds_read_b64_tr_b16 v[180:181], v2 offset:26624
 ds_read_b64_tr_b16 v[182:183], v2 offset:27648
 ds_read_b64_tr_b16 v[184:185], v3 offset:24576
 ds_read_b64_tr_b16 v[186:187], v3 offset:25600
 ds_read_b64_tr_b16 v[188:189], v3 offset:26624
 ds_read_b64_tr_b16 v[190:191], v3 offset:27648
 s_waitcnt vmcnt(8) lgkmcnt(0)
 s_barrier
 s_mov_b32 m0, 77824
 s_add_u32 s54, s62, 1572864
 buffer_load_dwordx4 v0, s[24:27], s54 offen lds
 s_mov_b32 m0, 78848
 s_add_u32 s54, s62, 1589248
 buffer_load_dwordx4 v0, s[24:27], s54 offen lds
 s_mov_b32 m0, 79872
 s_add_u32 s54, s62, 1703936
 buffer_load_dwordx4 v0, s[24:27], s54 offen lds
 s_mov_b32 m0, 80896
 s_add_u32 s54, s62, 1720320
 buffer_load_dwordx4 v0, s[24:27], s54 offen lds
 ds_read_b64_tr_b16 v[120:121], v2 offset:28672
 ds_read_b64_tr_b16 v[122:123], v2 offset:29696
 ds_read_b64_tr_b16 v[124:125], v2 offset:30720
 ds_read_b64_tr_b16 v[126:127], v2 offset:31744
 ds_read_b64_tr_b16 v[8:9], v3 offset:28672
 ds_read_b64_tr_b16 v[10:11], v3 offset:29696
 ds_read_b64_tr_b16 v[12:13], v3 offset:30720
 ds_read_b64_tr_b16 v[14:15], v3 offset:31744
 s_waitcnt lgkmcnt(2)
 ds_write_b128 v1, v[8:11] offset:10240
 s_waitcnt lgkmcnt(1)
 ds_write_b128 v1, v[12:15] offset:11264
 s_waitcnt vmcnt(8) lgkmcnt(0)
 s_barrier
 s_mov_b32 m0, 81920
 s_add_u32 s54, s62, 2097152
 buffer_load_dwordx4 v0, s[16:19], s54 offen lds
 s_mov_b32 m0, 82944
 s_add_u32 s54, s62, 2113536
 buffer_load_dwordx4 v0, s[16:19], s54 offen lds
 s_mov_b32 m0, 83968
 s_add_u32 s54, s62, 2228224
 buffer_load_dwordx4 v0, s[16:19], s54 offen lds
 s_mov_b32 m0, 84992
 s_add_u32 s54, s62, 2244608
 buffer_load_dwordx4 v0, s[16:19], s54 offen lds
 ds_read_b64_tr_b16 v[80:81], v2 offset:32768
 ds_read_b64_tr_b16 v[82:83], v2 offset:33792
 ds_read_b64_tr_b16 v[84:85], v2 offset:34816
 ds_read_b64_tr_b16 v[86:87], v2 offset:35840
 ds_read_b64_tr_b16 v[88:89], v3 offset:32768
 ds_read_b64_tr_b16 v[90:91], v3 offset:33792
 ds_read_b64_tr_b16 v[92:93], v3 offset:34816
 ds_read_b64_tr_b16 v[94:95], v3 offset:35840
 s_waitcnt vmcnt(8) lgkmcnt(0)
 s_barrier
 s_mov_b32 m0, 86016
 s_add_u32 s54, s62, 2621440
 buffer_load_dwordx4 v0, s[16:19], s54 offen lds
 s_mov_b32 m0, 87040
 s_add_u32 s54, s62, 2637824
 buffer_load_dwordx4 v0, s[16:19], s54 offen lds
 s_mov_b32 m0, 88064
 s_add_u32 s54, s62, 2752512
 buffer_load_dwordx4 v0, s[16:19], s54 offen lds
 s_mov_b32 m0, 89088
 s_add_u32 s54, s62, 2768896
 buffer_load_dwordx4 v0, s[16:19], s54 offen lds
 ds_read_b64_tr_b16 v[8:9], v2 offset:20480
 ds_read_b64_tr_b16 v[10:11], v2 offset:21504
 ds_read_b64_tr_b16 v[12:13], v2 offset:22528
 ds_read_b64_tr_b16 v[14:15], v2 offset:23552
 s_waitcnt lgkmcnt(2)
 ds_write_b128 v1, v[8:11] offset:12288
 s_waitcnt lgkmcnt(1)
 ds_write_b128 v1, v[12:15] offset:13312
 ds_read_b64_tr_b16 v[160:161], v3 offset:20480
 ds_read_b64_tr_b16 v[162:163], v3 offset:21504
 ds_read_b64_tr_b16 v[164:165], v3 offset:22528
 ds_read_b64_tr_b16 v[166:167], v3 offset:23552
 s_waitcnt vmcnt(8) lgkmcnt(0)
 s_barrier
 s_mov_b32 m0, 73728
 s_add_u32 s54, s62, 3145728
 buffer_load_dwordx4 v0, s[16:19], s54 offen lds
 s_mov_b32 m0, 74752
 s_add_u32 s54, s62, 3162112
 buffer_load_dwordx4 v0, s[16:19], s54 offen lds
 s_mov_b32 m0, 75776
 s_add_u32 s54, s62, 3276800
 buffer_load_dwordx4 v0, s[16:19], s54 offen lds
 s_mov_b32 m0, 76800
 s_add_u32 s54, s62, 3293184
 buffer_load_dwordx4 v0, s[16:19], s54 offen lds
 ds_read_b64_tr_b16 v[192:193], v2 offset:24576
 ds_read_b64_tr_b16 v[194:195], v2 offset:25600
 ds_read_b64_tr_b16 v[196:197], v2 offset:26624
 ds_read_b64_tr_b16 v[198:199], v2 offset:27648
 ds_read_b64_tr_b16 v[8:9], v3 offset:24576
 ds_read_b64_tr_b16 v[10:11], v3 offset:25600
 ds_read_b64_tr_b16 v[12:13], v3 offset:26624
 ds_read_b64_tr_b16 v[14:15], v3 offset:27648
 s_waitcnt lgkmcnt(2)
 ds_write_b128 v1, v[8:11] offset:16384
 s_waitcnt lgkmcnt(1)
 ds_write_b128 v1, v[12:15] offset:17408
 s_waitcnt vmcnt(8) lgkmcnt(0)
 s_barrier
 s_mov_b32 m0, 77824
 s_add_u32 s54, s62, 3670016
 buffer_load_dwordx4 v0, s[16:19], s54 offen lds
 s_mov_b32 m0, 78848
 s_add_u32 s54, s62, 3686400
 buffer_load_dwordx4 v0, s[16:19], s54 offen lds
 s_mov_b32 m0, 79872
 s_add_u32 s54, s62, 3801088
 buffer_load_dwordx4 v0, s[16:19], s54 offen lds
 s_mov_b32 m0, 80896
 s_add_u32 s54, s62, 3817472
 buffer_load_dwordx4 v0, s[16:19], s54 offen lds
 ds_read_b64_tr_b16 v[224:225], v2 offset:28672
 ds_read_b64_tr_b16 v[226:227], v2 offset:29696
 ds_read_b64_tr_b16 v[228:229], v2 offset:30720
 ds_read_b64_tr_b16 v[230:231], v2 offset:31744
 ds_read_b64_tr_b16 v[248:249], v3 offset:28672
 ds_read_b64_tr_b16 v[250:251], v3 offset:29696
 ds_read_b64_tr_b16 v[252:253], v3 offset:30720
 ds_read_b64_tr_b16 v[254:255], v3 offset:31744
 s_waitcnt vmcnt(8) lgkmcnt(0)
 s_barrier
 s_mov_b32 m0, 81920
 s_add_u32 s54, s62, 2097152
 buffer_load_dwordx4 v0, s[20:23], s54 offen lds
 s_mov_b32 m0, 82944
 s_add_u32 s54, s62, 2113536
 buffer_load_dwordx4 v0, s[20:23], s54 offen lds
 s_mov_b32 m0, 83968
 s_add_u32 s54, s62, 2228224
 buffer_load_dwordx4 v0, s[20:23], s54 offen lds
 s_mov_b32 m0, 84992
 s_add_u32 s54, s62, 2244608
 buffer_load_dwordx4 v0, s[20:23], s54 offen lds
 ds_read_b64_tr_b16 v[200:201], v2 offset:32768
 ds_read_b64_tr_b16 v[202:203], v2 offset:33792
 ds_read_b64_tr_b16 v[204:205], v2 offset:34816
 ds_read_b64_tr_b16 v[206:207], v2 offset:35840
 ds_read_b64_tr_b16 v[208:209], v3 offset:32768
 ds_read_b64_tr_b16 v[210:211], v3 offset:33792
 ds_read_b64_tr_b16 v[212:213], v3 offset:34816
 ds_read_b64_tr_b16 v[214:215], v3 offset:35840
 s_waitcnt vmcnt(8) lgkmcnt(0)
 s_barrier
 s_mov_b32 m0, 86016
 s_add_u32 s54, s62, 2621440
 buffer_load_dwordx4 v0, s[20:23], s54 offen lds
 s_mov_b32 m0, 87040
 s_add_u32 s54, s62, 2637824
 buffer_load_dwordx4 v0, s[20:23], s54 offen lds
 s_mov_b32 m0, 88064
 s_add_u32 s54, s62, 2752512
 buffer_load_dwordx4 v0, s[20:23], s54 offen lds
 s_mov_b32 m0, 89088
 s_add_u32 s54, s62, 2768896
 buffer_load_dwordx4 v0, s[20:23], s54 offen lds
 ds_read_b64_tr_b16 v[232:233], v2 offset:20480
 ds_read_b64_tr_b16 v[234:235], v2 offset:21504
 ds_read_b64_tr_b16 v[236:237], v2 offset:22528
 ds_read_b64_tr_b16 v[238:239], v2 offset:23552
 ds_read_b64_tr_b16 a[0:1], v3 offset:20480
 ds_read_b64_tr_b16 a[2:3], v3 offset:21504
 ds_read_b64_tr_b16 a[4:5], v3 offset:22528
 ds_read_b64_tr_b16 a[6:7], v3 offset:23552
 s_waitcnt vmcnt(8) lgkmcnt(0)
 s_barrier
 s_mov_b32 m0, 73728
 s_add_u32 s54, s62, 3145728
 buffer_load_dwordx4 v0, s[20:23], s54 offen lds
 s_mov_b32 m0, 74752
 s_add_u32 s54, s62, 3162112
 buffer_load_dwordx4 v0, s[20:23], s54 offen lds
 s_mov_b32 m0, 75776
 s_add_u32 s54, s62, 3276800
 buffer_load_dwordx4 v0, s[20:23], s54 offen lds
 s_mov_b32 m0, 76800
 s_add_u32 s54, s62, 3293184
 buffer_load_dwordx4 v0, s[20:23], s54 offen lds
 ds_read_b64_tr_b16 v[240:241], v2 offset:24576
 ds_read_b64_tr_b16 v[242:243], v2 offset:25600
 ds_read_b64_tr_b16 v[244:245], v2 offset:26624
 ds_read_b64_tr_b16 v[246:247], v2 offset:27648
 ds_read_b64_tr_b16 a[8:9], v3 offset:24576
 ds_read_b64_tr_b16 a[10:11], v3 offset:25600
 ds_read_b64_tr_b16 a[12:13], v3 offset:26624
 ds_read_b64_tr_b16 a[14:15], v3 offset:27648
 s_waitcnt vmcnt(8) lgkmcnt(0)
 s_barrier
 s_mov_b32 m0, 77824
 s_add_u32 s54, s62, 3670016
 buffer_load_dwordx4 v0, s[20:23], s54 offen lds
 s_mov_b32 m0, 78848
 s_add_u32 s54, s62, 3686400
 buffer_load_dwordx4 v0, s[20:23], s54 offen lds
 s_mov_b32 m0, 79872
 s_add_u32 s54, s62, 3801088
 buffer_load_dwordx4 v0, s[20:23], s54 offen lds
 s_mov_b32 m0, 80896
 s_add_u32 s54, s62, 3817472
 buffer_load_dwordx4 v0, s[20:23], s54 offen lds
 ds_read_b64_tr_b16 a[24:25], v2 offset:28672
 ds_read_b64_tr_b16 a[26:27], v2 offset:29696
 ds_read_b64_tr_b16 a[28:29], v2 offset:30720
 ds_read_b64_tr_b16 a[30:31], v2 offset:31744
 ds_read_b64_tr_b16 v[24:25], v3 offset:28672
 ds_read_b64_tr_b16 v[26:27], v3 offset:29696
 ds_read_b64_tr_b16 v[28:29], v3 offset:30720
 ds_read_b64_tr_b16 v[30:31], v3 offset:31744
 s_waitcnt vmcnt(8) lgkmcnt(0)
 s_barrier
 s_mov_b32 m0, 81920
 s_add_u32 s54, s62, 4194304
 buffer_load_dwordx4 v0, s[20:23], s54 offen lds
 s_mov_b32 m0, 82944
 s_add_u32 s54, s62, 4210688
 buffer_load_dwordx4 v0, s[20:23], s54 offen lds
 s_mov_b32 m0, 83968
 s_add_u32 s54, s62, 4325376
 buffer_load_dwordx4 v0, s[20:23], s54 offen lds
 s_mov_b32 m0, 84992
 s_add_u32 s54, s62, 4341760
 buffer_load_dwordx4 v0, s[20:23], s54 offen lds
 v_mbcnt_lo_u32_b32 v8, -1, 0
 v_mbcnt_hi_u32_b32 v8, -1, v8
 v_lshlrev_b32 v4, 7, v8
 v_mov_b32 v5, 0
 v_bfe_u32 v9, v8, 2, 2
 s_mov_b32 s101, 2304
 v_mad_u32_u24 v5, v9, s101, v5
 v_bfe_u32 v9, v8, 0, 1
 s_mov_b32 s101, 1152
 v_mad_u32_u24 v5, v9, s101, v5
 v_bfe_u32 v9, v8, 1, 1
 v_lshl_add_u32 v5, v9, 6, v5
 v_bfe_u32 v9, v8, 4, 2
 v_lshl_add_u32 v5, v9, 4, v5
 s_mov_b32 m0, 2048
 s_mov_b32 s54, 128
 buffer_load_dwordx4 v5, s[32:35], s54 offen lds
 s_mov_b32 m0, 3072
 s_mov_b32 s54, 640
 buffer_load_dwordx4 v5, s[32:35], s54 offen lds
 s_mov_b32 m0, 8192
 s_mov_b32 s54, 1024
 buffer_load_dwordx4 v5, s[32:35], s54 offen lds
 ds_read_b64_tr_b16 v[16:17], v2 offset:32768
 ds_read_b64_tr_b16 v[18:19], v2 offset:33792
 ds_read_b64_tr_b16 v[20:21], v2 offset:34816
 ds_read_b64_tr_b16 v[22:23], v2 offset:35840
 ds_read_b64_tr_b16 a[48:49], v3 offset:32768
 ds_read_b64_tr_b16 a[50:51], v3 offset:33792
 ds_read_b64_tr_b16 a[52:53], v3 offset:34816
 ds_read_b64_tr_b16 a[54:55], v3 offset:35840
 s_waitcnt vmcnt(11) lgkmcnt(0)
 s_barrier
 s_mov_b32 m0, 86016
 s_add_u32 s54, s62, 2097152
 buffer_load_dwordx4 v0, s[24:27], s54 offen lds
 s_mov_b32 m0, 87040
 s_add_u32 s54, s62, 2113536
 buffer_load_dwordx4 v0, s[24:27], s54 offen lds
 s_mov_b32 m0, 88064
 s_add_u32 s54, s62, 2228224
 buffer_load_dwordx4 v0, s[24:27], s54 offen lds
 s_mov_b32 m0, 89088
 s_add_u32 s54, s62, 2244608
 buffer_load_dwordx4 v0, s[24:27], s54 offen lds
 s_mov_b32 s54, 128
 buffer_load_dwordx4 v[8:11], off, s[12:15], s54 sc1
 buffer_load_dwordx4 v[12:15], off, s[12:15], s54 offset:16 sc1
 ds_read_b64_tr_b16 a[32:33], v2 offset:20480
 ds_read_b64_tr_b16 a[34:35], v2 offset:21504
 ds_read_b64_tr_b16 a[36:37], v2 offset:22528
 ds_read_b64_tr_b16 a[38:39], v2 offset:23552
 ds_read_b64_tr_b16 a[64:65], v3 offset:20480
 ds_read_b64_tr_b16 a[66:67], v3 offset:21504
 ds_read_b64_tr_b16 a[68:69], v3 offset:22528
 ds_read_b64_tr_b16 a[70:71], v3 offset:23552
 s_waitcnt vmcnt(13) lgkmcnt(0)
 s_barrier
 s_mov_b32 m0, 73728
 s_add_u32 s54, s62, 2621440
 buffer_load_dwordx4 v0, s[24:27], s54 offen lds
 s_mov_b32 m0, 74752
 s_add_u32 s54, s62, 2637824
 buffer_load_dwordx4 v0, s[24:27], s54 offen lds
 s_mov_b32 m0, 75776
 s_add_u32 s54, s62, 2752512
 buffer_load_dwordx4 v0, s[24:27], s54 offen lds
 s_mov_b32 m0, 76800
 s_add_u32 s54, s62, 2768896
 buffer_load_dwordx4 v0, s[24:27], s54 offen lds
 ds_read_b64_tr_b16 a[40:41], v2 offset:24576
 ds_read_b64_tr_b16 a[42:43], v2 offset:25600
 ds_read_b64_tr_b16 a[44:45], v2 offset:26624
 ds_read_b64_tr_b16 a[46:47], v2 offset:27648
 ds_read_b64_tr_b16 a[72:73], v3 offset:24576
 ds_read_b64_tr_b16 a[74:75], v3 offset:25600
 ds_read_b64_tr_b16 a[76:77], v3 offset:26624
 ds_read_b64_tr_b16 a[78:79], v3 offset:27648
 s_waitcnt vmcnt(13) lgkmcnt(0)
 s_barrier
 s_mov_b32 m0, 77824
 s_add_u32 s54, s62, 3145728
 buffer_load_dwordx4 v0, s[24:27], s54 offen lds
 s_mov_b32 m0, 78848
 s_add_u32 s54, s62, 3162112
 buffer_load_dwordx4 v0, s[24:27], s54 offen lds
 s_mov_b32 m0, 79872
 s_add_u32 s54, s62, 3276800
 buffer_load_dwordx4 v0, s[24:27], s54 offen lds
 s_mov_b32 m0, 80896
 s_add_u32 s54, s62, 3293184
 buffer_load_dwordx4 v0, s[24:27], s54 offen lds
 ds_read_b64_tr_b16 a[16:17], v2 offset:28672
 ds_read_b64_tr_b16 a[18:19], v2 offset:29696
 ds_read_b64_tr_b16 a[20:21], v2 offset:30720
 ds_read_b64_tr_b16 a[22:23], v2 offset:31744
 ds_read_b64_tr_b16 a[56:57], v3 offset:28672
 ds_read_b64_tr_b16 a[58:59], v3 offset:29696
 ds_read_b64_tr_b16 a[60:61], v3 offset:30720
 ds_read_b64_tr_b16 a[62:63], v3 offset:31744
 s_waitcnt vmcnt(10) lgkmcnt(0)
 s_barrier
 s_mov_b32 m0, 81920
 s_add_u32 s54, s62, 3670016
 buffer_load_dwordx4 v0, s[24:27], s54 offen lds
 s_mov_b32 m0, 82944
 s_add_u32 s54, s62, 3686400
 buffer_load_dwordx4 v0, s[24:27], s54 offen lds
 s_mov_b32 m0, 83968
 s_add_u32 s54, s62, 3801088
 buffer_load_dwordx4 v0, s[24:27], s54 offen lds
 s_mov_b32 m0, 84992
 s_add_u32 s54, s62, 3817472
 buffer_load_dwordx4 v0, s[24:27], s54 offen lds
 ds_read_b64_tr_b16 a[104:105], v2 offset:32768
 ds_read_b64_tr_b16 a[106:107], v2 offset:33792
 ds_read_b64_tr_b16 a[108:109], v2 offset:34816
 ds_read_b64_tr_b16 a[110:111], v2 offset:35840
 ds_read_b64_tr_b16 a[112:113], v3 offset:32768
 ds_read_b64_tr_b16 a[114:115], v3 offset:33792
 ds_read_b64_tr_b16 a[116:117], v3 offset:34816
 ds_read_b64_tr_b16 a[118:119], v3 offset:35840
 s_waitcnt vmcnt(8) lgkmcnt(0)
 s_barrier
 s_mov_b32 m0, 86016
 s_add_u32 s54, s62, 4194304
 buffer_load_dwordx4 v0, s[24:27], s54 offen lds
 s_mov_b32 m0, 87040
 s_add_u32 s54, s62, 4210688
 buffer_load_dwordx4 v0, s[24:27], s54 offen lds
 s_mov_b32 m0, 88064
 s_add_u32 s54, s62, 4325376
 buffer_load_dwordx4 v0, s[24:27], s54 offen lds
 s_mov_b32 m0, 89088
 s_add_u32 s54, s62, 4341760
 buffer_load_dwordx4 v0, s[24:27], s54 offen lds
 s_branch RSC_103
RSB_101:
 s_cmp_lt_u32 s49, 1
 s_cbranch_scc1 RSE_102
 s_sub_u32 s49, s49, 1
 s_mov_b32 s54, 128
 buffer_load_dwordx4 v[8:11], off, s[12:15], s54 sc1
 buffer_load_dwordx4 v[12:15], off, s[12:15], s54 offset:16 sc1
 s_waitcnt vmcnt(0)
RSC_103:
 v_add3_u32 v7, v8, v9, v10
 v_add3_u32 v7, v7, v11, v12
 v_add3_u32 v7, v7, v13, v14
 v_add_u32 v7, v7, v15
 v_cmp_gt_u32 vcc, 32, v7
 s_cbranch_vccnz RSB_101
RSE_102:
 v_max3_u32 v8, v8, v9, v10
 v_max3_u32 v8, v8, v11, v12
 v_max3_u32 v8, v8, v13, v14
 v_max_u32 v8, v8, v15
 s_nop 0
 v_readfirstlane_b32 s64, v8
 s_mov_b32 m0, 10752
 s_sub_u32 s54, s37, 1024
 buffer_load_dword v4, s[8:11], s54 offen sc1 lds
 ds_read_b64_tr_b16 a[80:81], v2 offset:20480
 ds_read_b64_tr_b16 a[82:83], v2 offset:21504
 ds_read_b64_tr_b16 a[84:85], v2 offset:22528
 ds_read_b64_tr_b16 a[86:87], v2 offset:23552
 ds_read_b64_tr_b16 a[88:89], v3 offset:20480
 ds_read_b64_tr_b16 a[90:91], v3 offset:21504
 ds_read_b64_tr_b16 a[92:93], v3 offset:22528
 ds_read_b64_tr_b16 a[94:95], v3 offset:23552
 s_waitcnt vmcnt(9) lgkmcnt(0)
 s_barrier
 ds_read_b64_tr_b16 a[120:121], v2 offset:24576
 ds_read_b64_tr_b16 a[122:123], v2 offset:25600
 ds_read_b64_tr_b16 a[124:125], v2 offset:26624
 ds_read_b64_tr_b16 a[126:127], v2 offset:27648
 ds_read_b64_tr_b16 v[40:41], v3 offset:24576
 ds_read_b64_tr_b16 v[42:43], v3 offset:25600
 ds_read_b64_tr_b16 v[44:45], v3 offset:26624
 ds_read_b64_tr_b16 v[46:47], v3 offset:27648
 s_waitcnt vmcnt(5) lgkmcnt(0)
 s_barrier
 ds_read_b64_tr_b16 a[128:129], v2 offset:28672
 ds_read_b64_tr_b16 a[130:131], v2 offset:29696
 ds_read_b64_tr_b16 a[132:133], v2 offset:30720
 ds_read_b64_tr_b16 a[134:135], v2 offset:31744
 ds_read_b64_tr_b16 a[136:137], v3 offset:28672
 ds_read_b64_tr_b16 a[138:139], v3 offset:29696
 ds_read_b64_tr_b16 a[140:141], v3 offset:30720
 ds_read_b64_tr_b16 a[142:143], v3 offset:31744
 s_waitcnt vmcnt(1) lgkmcnt(0)
 s_barrier
 ds_read_b64_tr_b16 v[32:33], v2 offset:32768
 ds_read_b64_tr_b16 v[34:35], v2 offset:33792
 ds_read_b64_tr_b16 v[36:37], v2 offset:34816
 ds_read_b64_tr_b16 v[38:39], v2 offset:35840
 ds_read_b64_tr_b16 a[96:97], v3 offset:32768
 ds_read_b64_tr_b16 a[98:99], v3 offset:33792
 ds_read_b64_tr_b16 a[100:101], v3 offset:34816
 ds_read_b64_tr_b16 a[102:103], v3 offset:35840
 s_waitcnt lgkmcnt(0)
 s_barrier
 ds_write_b128 v1, v[16:19] offset:20480
 ds_write_b128 v1, v[20:23] offset:21504
 ds_write_b128 v1, v[24:27] offset:22528
 ds_write_b128 v1, v[28:31] offset:23552
 ds_write_b128 v1, v[32:35] offset:24576
 ds_write_b128 v1, v[36:39] offset:25600
 ds_write_b128 v1, v[40:43] offset:26624
 ds_write_b128 v1, v[44:47] offset:27648
 ds_write_b128 v1, v[48:51] offset:28672
 ds_write_b128 v1, v[52:55] offset:29696
 ds_write_b128 v1, v[56:59] offset:30720
 ds_write_b128 v1, v[60:63] offset:31744
 ds_write_b128 v1, v[64:67] offset:32768
 ds_write_b128 v1, v[68:71] offset:33792
 ds_write_b128 v1, v[72:75] offset:34816
 ds_write_b128 v1, v[76:79] offset:35840
 v_mbcnt_lo_u32_b32 v8, -1, 0
 v_mbcnt_hi_u32_b32 v8, -1, v8
 v_lshlrev_b32 v0, 4, v8
 v_lshrrev_b32 v6, 4, v8
 v_xor_b32 v6, v6, v8
 v_lshlrev_b32 v6, 3, v6
 ds_read_b128 v[32:35], v0 offset:2048
 ds_read_b128 v[36:39], v0 offset:3072
 ds_read_b128 v[40:43], v0 offset:8192
 v_mov_b32 v2, 17476
 v_bfe_u32 v9, v8, 1, 1
 s_mov_b32 s101, 43690
 v_mad_u32_u24 v2, v9, s101, v2
 v_mov_b32 v4, 0
 v_bfe_u32 v9, v8, 4, 2
 v_lshl_add_u32 v4, v9, 8, v4
 v_bfe_u32 v9, v8, 2, 2
 v_lshl_add_u32 v4, v9, 5, v4
 v_bfe_u32 v9, v8, 0, 1
 v_lshl_add_u32 v4, v9, 4, v4
 v_mov_b32 v3, v4
 v_bfe_u32 v9, v8, 1, 1
 v_lshl_add_u32 v3, v9, 7, v3
 v_mov_b32 v5, 0
 v_bfe_u32 v9, v8, 0, 4
 v_lshl_add_u32 v5, v9, 5, v5
 v_bfe_u32 v9, v8, 4, 2
 v_lshl_add_u32 v5, v9, 3, v5
 v_mov_b32 v10, 0
 v_bfe_u32 v9, v8, 2, 2
 v_lshl_add_u32 v10, v9, 3, v10
 v_xor_b32 v5, v5, v10
 s_lshl_b32 s54, s60, 7
 s_add_u32 s54, s54, s59
 v_mov_b32 v7, s54
 v_bfe_u32 v9, v8, 3, 3
 s_mov_b32 s101, 9344
 v_mad_u32_u24 v7, v9, s101, v7
 v_bfe_u32 v9, v8, 0, 3
 v_lshl_add_u32 v7, v9, 4, v7
 s_cmp_eq_u32 s64, 32
 s_cbranch_scc0 RECM1
 ds_read_b128 v[8:11], v1 offset:0
 ds_read_b128 v[12:15], v1 offset:1024
 ds_read_b128 v[16:19], v1 offset:2048
 ds_read_b128 v[20:23], v1 offset:3072
 ds_read_b128 v[24:27], v1 offset:4096
 ds_read_b128 v[28:31], v1 offset:5120
 ds_read_b128 v[44:47], v1 offset:6144
 ds_read_b128 v[48:51], v1 offset:7168
 v_mov_b64 v[60:61], 0
 v_mov_b64 v[62:63], 0
 v_mov_b64 v[64:65], 0
 v_mov_b64 v[66:67], 0
 v_mov_b64 v[68:69], 0
 v_mov_b64 v[70:71], 0
 v_mov_b64 v[72:73], 0
 v_mov_b64 v[74:75], 0
 v_mov_b64 v[52:53], 0
 v_mov_b64 v[54:55], 0
 v_mov_b64 v[56:57], 0
 v_mov_b64 v[58:59], 0
 ds_read_b32 v76, v0 offset:13316
 s_mov_b32 s66, -1
 s_waitcnt lgkmcnt(0)
 s_branch R10STEP
.p2align 8
 s_nop 0
 s_nop 0
 s_nop 0
 s_nop 0
 s_nop 0
R10TOP:
 buffer_load_dwordx4 v[32:35], v0, s[8:11], s43 offen sc1
 s_sub_u32 s49, s49, 1
 s_cselect_b32 s49, 0, s49
 s_cselect_b32 s66, -1, -2
 s_cselect_b32 s67, 1, 0
R10TW:
 s_waitcnt vmcnt(1) lgkmcnt(0)
 v_max3_u32 v77, v32, v33, v34
 v_max_u32 v77, v35, v77
 ds_write_b128 v0, v[32:35] offset:2048
 v_cmp_lt_u32 vcc, s66, v77
 s_cbranch_vccnz R10TOP
 buffer_load_dwordx4 v[36:39], v0, s[8:11], s63 offen sc1
 buffer_load_dwordx4 v[40:43], v0, s[8:11], s44 offen sc1
R10STEP:
 v_smfmac_f32_16x16x64_bf16 v[60:63], v[32:35], v[8:15], v2
 v_smfmac_f32_16x16x64_bf16 v[64:67], v[32:35], v[16:23], v2
 s_waitcnt lgkmcnt(0)
 s_barrier
 ds_read_b128 v[8:11], v0 offset:0
 v_smfmac_f32_16x16x64_bf16 v[68:71], v[32:35], v[24:31], v2
 ds_read_b128 v[12:15], v0 offset:4096
 ds_read_b128 v[16:19], v0 offset:6144
 v_smfmac_f32_16x16x64_bf16 v[72:75], v[32:35], v[44:51], v2
 ds_read_b128 v[24:27], v1 offset:8192
 v_mov_b64 v[20:21], -1
 v_smfmac_f32_16x16x64_bf16 v[52:55], v[32:35], v[80:87], v2
 ds_read_b128 v[28:31], v1 offset:9216
 ds_read_b128 v[44:47], v1 offset:10240
 v_smfmac_f32_16x16x64_bf16 v[56:59], v[32:35], v[88:95], v2
 ds_read_b128 v[48:51], v1 offset:11264
 s_waitcnt lgkmcnt(6)
 v_smfmac_f32_16x16x64_bf16 v[60:63], v[8:11], v[96:103], v2
 buffer_load_dwordx4 v[32:35], v3, s[8:11], s47 offen offset:0 sc1
 v_smfmac_f32_16x16x64_bf16 v[64:67], v[8:11], v[104:111], v2
 buffer_store_dword v20, v76, s[8:11], s46 offen
 v_smfmac_f32_16x16x64_bf16 v[68:71], v[8:11], v[112:119], v2
 s_waitcnt lgkmcnt(2)
 v_smfmac_f32_16x16x64_bf16 v[72:75], v[8:11], v[24:31], v2
 v_smfmac_f32_16x16x64_bf16 v[52:55], v[8:11], v[120:127], v2
 ds_read_b128 v[24:27], v1 offset:12288
 s_waitcnt lgkmcnt(1)
 v_smfmac_f32_16x16x64_bf16 v[56:59], v[8:11], v[44:51], v2
 ds_read_b128 v[28:31], v1 offset:13312
 v_smfmac_f32_16x16x64_bf16 v[60:63], v[12:15], v[128:135], v2
 buffer_load_dwordx4 v[8:11], v3, s[8:11], s47 offen offset:1024 sc1
 ds_read_b128 v[44:47], v1 offset:14336
 v_smfmac_f32_16x16x64_bf16 v[64:67], v[12:15], v[136:143], v2
 ds_read_b128 v[48:51], v1 offset:15360
 v_smfmac_f32_16x16x64_bf16 v[68:71], v[12:15], v[144:151], v2
 ds_read_b64_tr_b16 v[76:77], v6 offset:10752
 v_smfmac_f32_16x16x64_bf16 v[72:75], v[12:15], v[152:159], v2
 s_waitcnt lgkmcnt(3)
 v_smfmac_f32_16x16x64_bf16 v[52:55], v[12:15], v[24:31], v2
 v_smfmac_f32_16x16x64_bf16 v[56:59], v[12:15], v[160:167], v2
 ds_read_b128 v[24:27], v1 offset:16384
 v_smfmac_f32_16x16x64_bf16 v[60:63], v[16:19], v[168:175], v2
 buffer_load_dwordx4 v[12:15], v0, s[8:11], s47 offen offset:2048 sc1
 ds_read_b128 v[28:31], v1 offset:17408
 s_waitcnt lgkmcnt(3)
 v_smfmac_f32_16x16x64_bf16 v[64:67], v[16:19], v[44:51], v2
 s_waitcnt vmcnt(5)
 ds_write_b128 v0, v[36:39] offset:3072
 v_max3_u32 v20, v36, v37, v38
 v_smfmac_f32_16x16x64_bf16 v[68:71], v[16:19], v[176:183], v2
 ds_read_b128 v[44:47], v1 offset:18432
 v_smfmac_f32_16x16x64_bf16 v[72:75], v[16:19], v[184:191], v2
 ds_read_b128 v[48:51], v1 offset:19456
 s_waitcnt vmcnt(4)
 v_max3_u32 v20, v39, v40, v20
 v_max3_u32 v21, v41, v42, v43
 v_smfmac_f32_16x16x64_bf16 v[52:55], v[16:19], v[192:199], v2
 s_waitcnt lgkmcnt(3)
 v_max_u32 v20, v21, v20
 v_cmp_lt_u32 vcc, s66, v20
 v_smfmac_f32_16x16x64_bf16 v[56:59], v[16:19], v[24:31], v2
 s_cbranch_vccnz R10PB
R10B:
 v_smfmac_f32_16x16x64_bf16 v[60:63], v[36:39], v[200:207], v2
 buffer_load_dwordx4 v[16:19], v0, s[8:11], s47 offen offset:3072 sc1
 s_waitcnt lgkmcnt(2)
 s_barrier
 ds_read_b128 v[20:23], v0 offset:1024
 v_smfmac_f32_16x16x64_bf16 v[64:67], v[36:39], v[208:215], v2
 ds_read_b128 v[24:27], v0 offset:5120
 ds_read_b128 v[28:31], v0 offset:7168
 v_smfmac_f32_16x16x64_bf16 v[60:63], v[40:43], v[216:223], v2
 s_add_u32 s47, s47, 524288
 s_waitcnt lgkmcnt(3)
 v_smfmac_f32_16x16x64_bf16 v[64:67], v[40:43], v[44:51], v2
 s_add_u32 s45, s45, 0x4000
 s_waitcnt lgkmcnt(2)
 v_smfmac_f32_16x16x64_bf16 v[60:63], v[20:23], v[224:231], v2
 ds_read_b128 v[44:47], v1 offset:20480
 s_waitcnt lgkmcnt(2)
 v_smfmac_f32_16x16x64_bf16 v[60:63], v[24:27], v[232:239], v2
 ds_read_b128 v[48:51], v1 offset:21504
 s_waitcnt lgkmcnt(2)
 v_smfmac_f32_16x16x64_bf16 v[60:63], v[28:31], v[240:247], v2
 v_smfmac_f32_16x16x64_bf16 v[64:67], v[20:23], v[248:255], v2
 s_bitset0_b32 s45, 16
 s_add_u32 s44, s45, 8192
 v_smfmac_f32_16x16x64_bf16 v[64:67], v[24:27], a[0:7], v2
 s_cmp_ge_u32 s36, 62
 s_cbranch_scc1 R10KS
 buffer_store_dwordx4 v[76:79], v0, s[8:11], s48 offen nt
R10KR:
 v_mul_f32 v60, s50, v60
 v_mul_f32 v61, s50, v61
 v_smfmac_f32_16x16x64_bf16 v[64:67], v[28:31], a[8:15], v2
 s_add_u32 s43, s45, 1024
 s_add_u32 s63, s45, 5120
 v_fmac_f32 v60, s50, v62
 v_fmac_f32 v61, s50, v63
 s_waitcnt lgkmcnt(0)
 v_smfmac_f32_16x16x64_bf16 v[68:71], v[36:39], v[44:51], v2
 v_cvt_pk_bf16_f32 v60, v60, v61
 v_smfmac_f32_16x16x64_bf16 v[68:71], v[40:43], a[16:23], v2
 ds_read_b128 v[44:47], v1 offset:22528
 v_mul_f32 v64, s50, v64
 v_mul_f32 v65, s50, v65
 v_fmac_f32 v64, s50, v66
 v_smfmac_f32_16x16x64_bf16 v[68:71], v[20:23], a[24:31], v2
 ds_read_b128 v[48:51], v1 offset:23552
 v_fmac_f32 v65, s50, v67
 v_cvt_pk_bf16_f32 v61, v64, v65
 ds_write_b64 v5, v[60:61] offset:8704
 v_smfmac_f32_16x16x64_bf16 v[68:71], v[24:27], a[32:39], v2
 v_smfmac_f32_16x16x64_bf16 v[68:71], v[28:31], a[40:47], v2
 s_xor_b32 s46, s45, 0x8000
 s_and_b32 s65, s36, 1
 v_smfmac_f32_16x16x64_bf16 v[72:75], v[36:39], a[48:55], v2
 v_smfmac_f32_16x16x64_bf16 v[72:75], v[40:43], a[56:63], v2
 s_waitcnt lgkmcnt(1)
 v_add_f32 v68, v68, v70
 v_smfmac_f32_16x16x64_bf16 v[72:75], v[20:23], v[44:51], v2
 s_waitcnt lgkmcnt(0)
 s_barrier
 ds_read_b64_tr_b16 v[60:61], v6 offset:8192
 ds_read_b64_tr_b16 v[62:63], v6 offset:8704
 v_add_f32 v69, v69, v71
 v_smfmac_f32_16x16x64_bf16 v[72:75], v[24:27], a[64:71], v2
 ds_read_b64_tr_b16 v[64:65], v6 offset:9216
 ds_read_b64_tr_b16 v[66:67], v6 offset:9728
 ds_read_b128 v[44:47], v1 offset:24576
 v_cvt_pk_bf16_f32 v68, v68, v69
 v_smfmac_f32_16x16x64_bf16 v[72:75], v[28:31], a[72:79], v2
 ds_read_b128 v[48:51], v1 offset:25600
 v_smfmac_f32_16x16x64_bf16 v[52:55], v[36:39], a[80:87], v2
 s_waitcnt vmcnt(5) lgkmcnt(4)
 v_mfma_f32_16x16x32_bf16 v[76:79], v[32:35], v[60:63], 0
 s_waitcnt vmcnt(3) lgkmcnt(2)
 v_add_f32 v72, v72, v74
 v_add_f32 v73, v73, v75
 v_mfma_f32_16x16x32_bf16 v[76:79], v[8:11], v[64:67], v[76:79]
 v_cvt_pk_bf16_f32 v69, v72, v73
 ds_write_b64 v5, v[68:69] offset:10752
 v_smfmac_f32_16x16x64_bf16 v[56:59], v[36:39], a[88:95], v2
 s_add_u32 s48, s48, 131072
 s_waitcnt lgkmcnt(1)
 v_smfmac_f32_16x16x64_bf16 v[52:55], v[40:43], v[44:51], v2
 ds_read_b128 v[36:39], v0 offset:15360
 v_add_f32_dpp v76, v78, v76 quad_perm:[2,3,0,1] row_mask:0xf bank_mask:0xf
 v_add_f32_dpp v77, v79, v77 quad_perm:[2,3,0,1] row_mask:0xf bank_mask:0xf
 v_smfmac_f32_16x16x64_bf16 v[56:59], v[40:43], a[96:103], v2
 ds_read_b128 v[44:47], v1 offset:26624
 v_exp_f32_dpp v78, v76 quad_perm:[0,1,0,1] row_mask:0xf bank_mask:0xf
 v_exp_f32_dpp v79, v77 quad_perm:[0,1,0,1] row_mask:0xf bank_mask:0xf
 v_smfmac_f32_16x16x64_bf16 v[52:55], v[20:23], a[104:111], v2
 ds_read_b128 v[48:51], v1 offset:27648
 v_cvt_pk_bf16_f32 v78, v78, v79
 ds_write_b32 v0, v78 offset:14340
 v_smfmac_f32_16x16x64_bf16 v[56:59], v[20:23], a[112:119], v2
 s_waitcnt lgkmcnt(4)
 s_barrier
 ds_read_b64_tr_b16 v[68:69], v6 offset:10240
 ds_read_b64_tr_b16 v[70:71], v6 offset:10752
 v_mov_b32 v33, 0
 v_smfmac_f32_16x16x64_bf16 v[52:55], v[24:27], a[120:127], v2
 ds_read_b64_tr_b16 v[72:73], v6 offset:11264
 ds_read_b64_tr_b16 v[74:75], v6 offset:11776
 v_mov_b32 v34, 0
 v_smfmac_f32_16x16x64_bf16 v[52:55], v[28:31], a[128:135], v2
 s_waitcnt lgkmcnt(5)
 v_smfmac_f32_16x16x64_bf16 v[56:59], v[24:27], v[44:51], v2
 s_waitcnt lgkmcnt(2)
 v_mfma_f32_16x16x32_bf16 v[40:43], v[68:71], v[60:63], 0
 s_barrier
 ds_read_b128 v[8:11], v0 offset:14336
 v_add_f32 v52, v52, v54
 v_add_f32 v53, v53, v55
 s_waitcnt lgkmcnt(1)
 v_mfma_f32_16x16x32_bf16 v[40:43], v[72:75], v[64:67], v[40:43]
 s_cmp_eq_u32 s36, 63
 v_cvt_pk_bf16_f32 v78, v52, v53
 v_smfmac_f32_16x16x64_bf16 v[56:59], v[28:31], a[136:143], v2
 s_waitcnt lgkmcnt(0)
 s_nop 2
 v_add_f32_dpp v40, v42, v40 quad_perm:[2,3,0,1] row_mask:0xf bank_mask:0xf
 v_add_f32_dpp v41, v43, v41 quad_perm:[2,3,0,1] row_mask:0xf bank_mask:0xf
 v_mfma_f32_16x16x32_bf16 v[72:75], v[36:39], v[8:11], 0
 ds_read_b128 v[24:27], v1 offset:28672
 v_exp_f32_dpp v42, v40 quad_perm:[0,1,0,1] row_mask:0xf bank_mask:0xf
 v_exp_f32_dpp v43, v41 quad_perm:[0,1,0,1] row_mask:0xf bank_mask:0xf
 s_waitcnt vmcnt(2)
 v_mfma_f32_16x16x32_bf16 v[44:47], v[12:15], v[8:11], 0
 ds_read_b128 v[28:31], v1 offset:29696
 v_cvt_pk_bf16_f32 v32, v42, v43
 v_cvt_pk_bf16_f32 v35, v42, v43
 v_add_f32 v56, v56, v58
 v_add_f32 v57, v57, v59
 v_mfma_f32_16x16x16_bf16 v[72:75], v[36:37], v[32:33], v[72:75]
 s_waitcnt vmcnt(1)
 v_cvt_pk_bf16_f32 v79, v56, v57
 v_mfma_f32_16x16x32_bf16 v[48:51], v[16:19], v[8:11], 0
 s_cbranch_scc1 R10TAIL
 v_mov_b64 v[68:69], 0
 v_mov_b64 v[70:71], 0
 v_mfma_f32_16x16x16_bf16 v[44:47], v[78:79], v[32:33], v[44:47]
 v_rcp_f32 v72, v72
 v_subrev_u32 v74, s52, v74
 v_mfma_f32_16x16x16_bf16 v[48:51], v[78:79], v[34:35], v[48:51]
 v_cmp_le_u32 vcc, s53, v74
 v_mov_b64 v[52:53], 0
 v_mov_b64 v[54:55], 0
R10RJ:
 s_nop 0
 v_pk_mul_f32 v[44:45], v[44:45], v[72:73] op_sel_hi:[1,0]
 v_pk_mul_f32 v[46:47], v[46:47], v[72:73] op_sel_hi:[1,0]
 s_cbranch_vccnz R10FB
 v_cvt_pk_bf16_f32 v40, v44, v45
 v_cvt_pk_bf16_f32 v41, v46, v47
 v_pk_mul_f32 v[48:49], v[48:49], v[72:73] op_sel_hi:[1,0]
 v_pk_mul_f32 v[50:51], v[50:51], v[72:73] op_sel_hi:[1,0]
 v_cvt_pk_bf16_f32 v42, v48, v49
 v_cvt_pk_bf16_f32 v43, v50, v51
 ds_write_b128 v4, v[40:43] offset:8320
 s_waitcnt lgkmcnt(1)
 v_smfmac_f32_16x16x64_bf16 v[68:71], v[40:43], v[24:31], v2
 v_mov_b64 v[56:57], 0
 v_mov_b64 v[58:59], 0
 v_smfmac_f32_16x16x64_bf16 v[52:55], v[40:43], a[144:151], v2
 v_mov_b64 v[64:65], 0
 v_mov_b64 v[66:67], 0
 v_smfmac_f32_16x16x64_bf16 v[56:59], v[40:43], a[152:159], v2
 s_waitcnt lgkmcnt(0)
 s_barrier
 ds_read_b128 v[32:35], v4 offset:8192
 ds_read_b128 v[36:39], v4 offset:9216
 ds_read_b128 v[72:75], v4 offset:9344
 v_mov_b64 v[60:61], 0
 v_mov_b64 v[62:63], 0
 v_smfmac_f32_16x16x64_bf16 v[64:67], v[40:43], a[160:167], v2
 s_waitcnt lgkmcnt(2)
 v_smfmac_f32_16x16x64_bf16 v[68:71], v[32:35], a[168:175], v2
 ds_read_b128 v[44:47], v3 offset:8192
 s_waitcnt lgkmcnt(2)
 v_lshrrev_b32 v40, 2, v0
 v_smfmac_f32_16x16x64_bf16 v[68:71], v[36:39], a[176:183], v2
 ds_read_b128 v[48:51], v3 offset:9216
 s_waitcnt lgkmcnt(2)
 v_smfmac_f32_16x16x64_bf16 v[68:71], v[72:75], a[184:191], v2
 ds_read_b128 v[24:27], v1 offset:30720
 v_smfmac_f32_16x16x64_bf16 v[52:55], v[32:35], a[192:199], v2
 ds_read_b128 v[28:31], v1 offset:31744
 v_smfmac_f32_16x16x64_bf16 v[52:55], v[36:39], a[200:207], v2
 ds_read_b128 v[8:11], v1 offset:32768
 v_cvt_pk_bf16_f32 v68, v68, v69
 v_smfmac_f32_16x16x64_bf16 v[52:55], v[72:75], a[208:215], v2
 ds_read_b128 v[12:15], v1 offset:33792
 s_waitcnt lgkmcnt(5)
 v_cvt_pk_bf16_f32 v69, v70, v71
 v_smfmac_f32_16x16x64_bf16 v[60:63], v[44:47], a[216:223], v2
 ds_read_b128 v[16:19], v1 offset:34816
 s_waitcnt lgkmcnt(5)
 v_and_or_b32 v68, v68, -2, s65
 v_smfmac_f32_16x16x64_bf16 v[60:63], v[48:51], a[224:231], v2
 ds_read_b128 v[20:23], v1 offset:35840
 v_cvt_pk_bf16_f32 v70, v52, v53
 v_cvt_pk_bf16_f32 v71, v54, v55
 buffer_store_dwordx4 v[68:71], v0, s[8:11], s37 offen
 v_smfmac_f32_16x16x64_bf16 v[56:59], v[32:35], a[232:239], v2
 ds_read_b32 v76, v0 offset:13316
 s_waitcnt lgkmcnt(5)
 v_smfmac_f32_16x16x64_bf16 v[56:59], v[36:39], v[24:31], v2
 s_add_u32 s36, s36, 1
 v_add_f32 v60, v60, v62
 v_smfmac_f32_16x16x64_bf16 v[56:59], v[72:75], a[240:247], v2
 s_waitcnt lgkmcnt(3)
 v_add_f32 v61, v61, v63
 v_smfmac_f32_16x16x64_bf16 v[64:67], v[32:35], v[8:15], v2
 v_cvt_pk_bf16_f32 v41, v60, v61
 v_smfmac_f32_16x16x64_bf16 v[64:67], v[36:39], a[248:255], v2
 s_waitcnt lgkmcnt(1)
 v_and_or_b32 v41, v41, -2, s65
 v_smfmac_f32_16x16x64_bf16 v[64:67], v[72:75], v[16:23], v2
 buffer_store_dword v41, v40, s[8:11], s38 offen
 v_cvt_pk_bf16_f32 v56, v56, v57
 v_cvt_pk_bf16_f32 v57, v58, v59
 v_and_or_b32 v56, v56, -2, s65
 s_nop 3
 v_cvt_pk_bf16_f32 v58, v64, v65
 v_cvt_pk_bf16_f32 v59, v66, v67
 buffer_store_dwordx4 v[56:59], v0, s[8:11], s37 offen offset:1024
R10HOP:
 s_waitcnt vmcnt(0)
 buffer_load_dwordx4 v[60:63], v7, s[8:11], s39 offen sc1
 buffer_load_dwordx4 v[64:67], v7, s[8:11], s40 offen sc1
 buffer_load_dwordx4 v[68:71], v7, s[8:11], s41 offen sc1
 buffer_load_dwordx4 v[72:75], v7, s[8:11], s42 offen sc1
 ds_read_b128 v[40:43], v0 offset:12288
 s_sub_u32 s49, s49, 1
 s_cselect_b32 s49, 0, s49
 s_cselect_b32 s66, -1, -2
 s_cselect_b32 s67, 1, 0
R10P1:
 s_waitcnt vmcnt(3)
 s_waitcnt lgkmcnt(0)
 v_mfma_f32_16x16x32_bf16 v[36:39], v[60:63], v[40:43], 0
 s_waitcnt vmcnt(2)
 v_mfma_f32_16x16x32_bf16 v[36:39], v[64:67], v[40:43], v[36:39]
 v_bitop3_b32 v60, v60, v64, s65 bitop3:0x7e
 s_waitcnt vmcnt(1)
 v_mfma_f32_16x16x32_bf16 v[36:39], v[68:71], v[40:43], v[36:39]
 s_waitcnt vmcnt(0)
 v_mfma_f32_16x16x32_bf16 v[36:39], v[72:75], v[40:43], v[36:39]
 v_bitop3_b32 v64, v68, v72, s65 bitop3:0x7e
 v_bitop3_b32 v60, v60, v64, 1 bitop3:0xa8
 v_cmp_lt_u32 vcc, s67, v60
 s_cbranch_vccnz R10R1
 s_nop 3
 v_permlane32_swap_b32 v36, v38
 v_permlane32_swap_b32 v37, v39
 v_add_f32 v36, v36, v38
 v_add_f32 v37, v37, v39
 v_cvt_pk_bf16_f32 v36, v36, v37
 buffer_store_dword v36, v76, s[8:11], s45 offen
 s_barrier
 v_mov_b64 v[60:61], 0
 v_mov_b64 v[62:63], 0
 v_mov_b64 v[64:65], 0
 v_mov_b64 v[66:67], 0
 v_mov_b64 v[68:69], 0
 v_mov_b64 v[70:71], 0
 v_mov_b64 v[72:73], 0
 v_mov_b64 v[74:75], 0
 buffer_load_dwordx4 v[32:35], v0, s[8:11], s43 offen sc1
 ds_read_b128 v[8:11], v1 offset:0
 ds_read_b128 v[12:15], v1 offset:1024
 ds_read_b128 v[16:19], v1 offset:2048
 ds_read_b128 v[20:23], v1 offset:3072
 v_mov_b64 v[52:53], 0
 v_mov_b64 v[54:55], 0
 ds_read_b128 v[24:27], v1 offset:4096
 ds_read_b128 v[28:31], v1 offset:5120
 ds_read_b128 v[44:47], v1 offset:6144
 ds_read_b128 v[48:51], v1 offset:7168
 v_mov_b64 v[56:57], 0
 v_mov_b64 v[58:59], 0
 s_branch R10TOP
R10PB:
 buffer_load_dwordx4 v[36:39], v0, s[8:11], s63 offen sc1
 buffer_load_dwordx4 v[40:43], v0, s[8:11], s44 offen sc1
 s_sub_u32 s49, s49, 1
 s_cselect_b32 s49, 0, s49
 s_cselect_b32 s66, -1, -2
 s_cselect_b32 s67, 1, 0
 s_waitcnt vmcnt(0)
 v_max3_u32 v20, v36, v37, v38
 v_max3_u32 v20, v39, v40, v20
 v_max3_u32 v21, v41, v42, v43
 v_max_u32 v20, v21, v20
 v_cmp_lt_u32 vcc, s66, v20
 ds_write_b128 v0, v[36:39] offset:3072
 s_cbranch_vccnz R10PB
 s_waitcnt lgkmcnt(0)
 s_branch R10B
R10KS:
 s_waitcnt lgkmcnt(0)
 buffer_store_dwordx4 v[76:79], v0, s[8:11], s48 offen sc1
 s_branch R10KR
R10R1:
 buffer_load_dwordx4 v[60:63], v7, s[8:11], s39 offen sc1
 buffer_load_dwordx4 v[64:67], v7, s[8:11], s40 offen sc1
 buffer_load_dwordx4 v[68:71], v7, s[8:11], s41 offen sc1
 buffer_load_dwordx4 v[72:75], v7, s[8:11], s42 offen sc1
 s_sub_u32 s49, s49, 1
 s_cselect_b32 s49, 0, s49
 s_cselect_b32 s66, -1, -2
 s_cselect_b32 s67, 1, 0
 s_waitcnt vmcnt(0)
 s_branch R10P1
R10TAIL:
 s_waitcnt lgkmcnt(0)
 ds_read_b64_tr_b16 v[76:77], v6 offset:10752
 s_waitcnt lgkmcnt(0)
 buffer_store_dwordx4 v[76:79], v0, s[8:11], s48 offen sc1
 s_waitcnt vmcnt(0)
 s_endpgm
R10FB:
 s_waitcnt vmcnt(0) lgkmcnt(0)
 ds_write_b64 v6, v[76:77] offset:8704
 s_waitcnt lgkmcnt(0)
 s_barrier
 ds_read_b64 v[44:45], v6 offset:8192
 ds_read_b64 v[46:47], v6 offset:8704
 ds_read_b64 v[48:49], v6 offset:9216
 ds_read_b64 v[50:51], v6 offset:9728
 s_waitcnt lgkmcnt(0)
 s_barrier
 v_max3_f32 v72, v44, v45, v46
 v_max3_f32 v72, v72, v47, v48
 v_max3_f32 v72, v72, v49, v50
 v_max3_f32 v72, v72, v51, v40
 v_max_f32 v72, v72, v41
 v_mov_b32 v73, v72
 s_nop 1
 v_permlane16_swap_b32 v72, v73
 v_max_f32 v72, v72, v73
 v_mov_b32 v73, v72
 s_nop 1
 v_permlane32_swap_b32 v72, v73
 v_max_f32 v72, v72, v73
 v_sub_f32 v44, v44, v72
 v_sub_f32 v45, v45, v72
 v_sub_f32 v46, v46, v72
 v_sub_f32 v47, v47, v72
 v_sub_f32 v48, v48, v72
 v_sub_f32 v49, v49, v72
 v_sub_f32 v50, v50, v72
 v_sub_f32 v51, v51, v72
 v_sub_f32 v40, v40, v72
 v_sub_f32 v41, v41, v72
 v_exp_f32_dpp v44, v44 quad_perm:[0,1,0,1] row_mask:0xf bank_mask:0xf
 v_exp_f32_dpp v45, v45 quad_perm:[0,1,0,1] row_mask:0xf bank_mask:0xf
 v_exp_f32_dpp v46, v46 quad_perm:[0,1,0,1] row_mask:0xf bank_mask:0xf
 v_exp_f32_dpp v47, v47 quad_perm:[0,1,0,1] row_mask:0xf bank_mask:0xf
 v_exp_f32_dpp v48, v48 quad_perm:[0,1,0,1] row_mask:0xf bank_mask:0xf
 v_exp_f32_dpp v49, v49 quad_perm:[0,1,0,1] row_mask:0xf bank_mask:0xf
 v_exp_f32_dpp v50, v50 quad_perm:[0,1,0,1] row_mask:0xf bank_mask:0xf
 v_exp_f32_dpp v51, v51 quad_perm:[0,1,0,1] row_mask:0xf bank_mask:0xf
 v_exp_f32_dpp v40, v40 quad_perm:[0,1,0,1] row_mask:0xf bank_mask:0xf
 v_exp_f32_dpp v41, v41 quad_perm:[0,1,0,1] row_mask:0xf bank_mask:0xf
 v_cvt_pk_bf16_f32 v8, v44, v45
 v_cvt_pk_bf16_f32 v9, v46, v47
 v_cvt_pk_bf16_f32 v10, v48, v49
 v_cvt_pk_bf16_f32 v11, v50, v51
 v_cvt_pk_bf16_f32 v32, v40, v41
 v_cvt_pk_bf16_f32 v35, v40, v41
 v_mfma_f32_16x16x32_bf16 v[72:75], v[36:39], v[8:11], 0
 v_mfma_f32_16x16x32_bf16 v[44:47], v[12:15], v[8:11], 0
 v_mfma_f32_16x16x32_bf16 v[48:51], v[16:19], v[8:11], 0
 v_mfma_f32_16x16x16_bf16 v[72:75], v[36:37], v[32:33], v[72:75]
 v_mfma_f32_16x16x16_bf16 v[44:47], v[78:79], v[32:33], v[44:47]
 v_mfma_f32_16x16x16_bf16 v[48:51], v[78:79], v[34:35], v[48:51]
 v_rcp_f32 v72, v72
 s_mov_b64 vcc, 0
 s_nop 7
 s_branch R10RJ
RECM1:
 ds_read_b128 v[8:11], v1 offset:0
 ds_read_b128 v[12:15], v1 offset:1024
 ds_read_b128 v[16:19], v1 offset:2048
 ds_read_b128 v[20:23], v1 offset:3072
 ds_read_b128 v[24:27], v1 offset:4096
 ds_read_b128 v[28:31], v1 offset:5120
 ds_read_b128 v[44:47], v1 offset:6144
 ds_read_b128 v[48:51], v1 offset:7168
 v_mov_b64 v[60:61], 0
 v_mov_b64 v[62:63], 0
 v_mov_b64 v[64:65], 0
 v_mov_b64 v[66:67], 0
 v_mov_b64 v[68:69], 0
 v_mov_b64 v[70:71], 0
 v_mov_b64 v[72:73], 0
 v_mov_b64 v[74:75], 0
 v_mov_b64 v[52:53], 0
 v_mov_b64 v[54:55], 0
 v_mov_b64 v[56:57], 0
 v_mov_b64 v[58:59], 0
 ds_read_b32 v76, v0 offset:13316
 s_mov_b32 s66, -1
 s_waitcnt lgkmcnt(0)
 s_branch R11STEP
.p2align 8
 s_nop 0
 s_nop 0
 s_nop 0
 s_nop 0
 s_nop 0
R11TOP:
 buffer_load_dwordx4 v[32:35], v0, s[8:11], s43 offen sc1
 s_sub_u32 s49, s49, 1
 s_cselect_b32 s49, 0, s49
 s_cselect_b32 s66, -1, -2
 s_cselect_b32 s67, 1, 0
R11TW:
 s_waitcnt vmcnt(1) lgkmcnt(0)
 v_max3_u32 v77, v32, v33, v34
 v_max_u32 v77, v35, v77
 ds_write_b128 v0, v[32:35] offset:2048
 v_cmp_lt_u32 vcc, s66, v77
 s_cbranch_vccnz R11TOP
 buffer_load_dwordx4 v[36:39], v0, s[8:11], s63 offen sc1
 buffer_load_dwordx4 v[40:43], v0, s[8:11], s44 offen sc1
R11STEP:
 v_smfmac_f32_16x16x64_bf16 v[60:63], v[32:35], v[8:15], v2
 v_smfmac_f32_16x16x64_bf16 v[64:67], v[32:35], v[16:23], v2
 s_waitcnt lgkmcnt(0)
 s_barrier
 ds_read_b128 v[8:11], v0 offset:0
 v_smfmac_f32_16x16x64_bf16 v[68:71], v[32:35], v[24:31], v2
 ds_read_b128 v[12:15], v0 offset:4096
 ds_read_b128 v[16:19], v0 offset:6144
 v_smfmac_f32_16x16x64_bf16 v[72:75], v[32:35], v[44:51], v2
 ds_read_b128 v[24:27], v1 offset:8192
 v_mov_b64 v[20:21], -1
 v_smfmac_f32_16x16x64_bf16 v[52:55], v[32:35], v[80:87], v2
 ds_read_b128 v[28:31], v1 offset:9216
 ds_read_b128 v[44:47], v1 offset:10240
 v_smfmac_f32_16x16x64_bf16 v[56:59], v[32:35], v[88:95], v2
 ds_read_b128 v[48:51], v1 offset:11264
 s_waitcnt lgkmcnt(6)
 v_smfmac_f32_16x16x64_bf16 v[60:63], v[8:11], v[96:103], v2
 buffer_load_dwordx4 v[32:35], v3, s[8:11], s47 offen offset:0 sc1
 v_smfmac_f32_16x16x64_bf16 v[64:67], v[8:11], v[104:111], v2
 buffer_store_dword v20, v76, s[8:11], s46 offen sc1
 v_smfmac_f32_16x16x64_bf16 v[68:71], v[8:11], v[112:119], v2
 s_waitcnt lgkmcnt(2)
 v_smfmac_f32_16x16x64_bf16 v[72:75], v[8:11], v[24:31], v2
 v_smfmac_f32_16x16x64_bf16 v[52:55], v[8:11], v[120:127], v2
 ds_read_b128 v[24:27], v1 offset:12288
 s_waitcnt lgkmcnt(1)
 v_smfmac_f32_16x16x64_bf16 v[56:59], v[8:11], v[44:51], v2
 ds_read_b128 v[28:31], v1 offset:13312
 v_smfmac_f32_16x16x64_bf16 v[60:63], v[12:15], v[128:135], v2
 buffer_load_dwordx4 v[8:11], v3, s[8:11], s47 offen offset:1024 sc1
 ds_read_b128 v[44:47], v1 offset:14336
 v_smfmac_f32_16x16x64_bf16 v[64:67], v[12:15], v[136:143], v2
 ds_read_b128 v[48:51], v1 offset:15360
 v_smfmac_f32_16x16x64_bf16 v[68:71], v[12:15], v[144:151], v2
 ds_read_b64_tr_b16 v[76:77], v6 offset:10752
 v_smfmac_f32_16x16x64_bf16 v[72:75], v[12:15], v[152:159], v2
 s_waitcnt lgkmcnt(3)
 v_smfmac_f32_16x16x64_bf16 v[52:55], v[12:15], v[24:31], v2
 v_smfmac_f32_16x16x64_bf16 v[56:59], v[12:15], v[160:167], v2
 ds_read_b128 v[24:27], v1 offset:16384
 v_smfmac_f32_16x16x64_bf16 v[60:63], v[16:19], v[168:175], v2
 buffer_load_dwordx4 v[12:15], v0, s[8:11], s47 offen offset:2048 sc1
 ds_read_b128 v[28:31], v1 offset:17408
 s_waitcnt lgkmcnt(3)
 v_smfmac_f32_16x16x64_bf16 v[64:67], v[16:19], v[44:51], v2
 s_waitcnt vmcnt(5)
 ds_write_b128 v0, v[36:39] offset:3072
 v_max3_u32 v20, v36, v37, v38
 v_smfmac_f32_16x16x64_bf16 v[68:71], v[16:19], v[176:183], v2
 ds_read_b128 v[44:47], v1 offset:18432
 v_smfmac_f32_16x16x64_bf16 v[72:75], v[16:19], v[184:191], v2
 ds_read_b128 v[48:51], v1 offset:19456
 s_waitcnt vmcnt(4)
 v_max3_u32 v20, v39, v40, v20
 v_max3_u32 v21, v41, v42, v43
 v_smfmac_f32_16x16x64_bf16 v[52:55], v[16:19], v[192:199], v2
 s_waitcnt lgkmcnt(3)
 v_max_u32 v20, v21, v20
 v_cmp_lt_u32 vcc, s66, v20
 v_smfmac_f32_16x16x64_bf16 v[56:59], v[16:19], v[24:31], v2
 s_cbranch_vccnz R11PB
R11B:
 v_smfmac_f32_16x16x64_bf16 v[60:63], v[36:39], v[200:207], v2
 buffer_load_dwordx4 v[16:19], v0, s[8:11], s47 offen offset:3072 sc1
 s_waitcnt lgkmcnt(2)
 s_barrier
 ds_read_b128 v[20:23], v0 offset:1024
 v_smfmac_f32_16x16x64_bf16 v[64:67], v[36:39], v[208:215], v2
 ds_read_b128 v[24:27], v0 offset:5120
 ds_read_b128 v[28:31], v0 offset:7168
 v_smfmac_f32_16x16x64_bf16 v[60:63], v[40:43], v[216:223], v2
 s_add_u32 s47, s47, 524288
 s_waitcnt lgkmcnt(3)
 v_smfmac_f32_16x16x64_bf16 v[64:67], v[40:43], v[44:51], v2
 s_add_u32 s45, s45, 0x4000
 s_waitcnt lgkmcnt(2)
 v_smfmac_f32_16x16x64_bf16 v[60:63], v[20:23], v[224:231], v2
 ds_read_b128 v[44:47], v1 offset:20480
 s_waitcnt lgkmcnt(2)
 v_smfmac_f32_16x16x64_bf16 v[60:63], v[24:27], v[232:239], v2
 ds_read_b128 v[48:51], v1 offset:21504
 s_waitcnt lgkmcnt(2)
 v_smfmac_f32_16x16x64_bf16 v[60:63], v[28:31], v[240:247], v2
 v_smfmac_f32_16x16x64_bf16 v[64:67], v[20:23], v[248:255], v2
 s_bitset0_b32 s45, 16
 s_add_u32 s44, s45, 8192
 v_smfmac_f32_16x16x64_bf16 v[64:67], v[24:27], a[0:7], v2
 buffer_store_dwordx4 v[76:79], v0, s[8:11], s48 offen sc1
 v_mul_f32 v60, s50, v60
 v_mul_f32 v61, s50, v61
 v_smfmac_f32_16x16x64_bf16 v[64:67], v[28:31], a[8:15], v2
 s_add_u32 s43, s45, 1024
 s_add_u32 s63, s45, 5120
 v_fmac_f32 v60, s50, v62
 v_fmac_f32 v61, s50, v63
 s_waitcnt lgkmcnt(0)
 v_smfmac_f32_16x16x64_bf16 v[68:71], v[36:39], v[44:51], v2
 v_cvt_pk_bf16_f32 v60, v60, v61
 v_smfmac_f32_16x16x64_bf16 v[68:71], v[40:43], a[16:23], v2
 ds_read_b128 v[44:47], v1 offset:22528
 v_mul_f32 v64, s50, v64
 v_mul_f32 v65, s50, v65
 v_fmac_f32 v64, s50, v66
 v_smfmac_f32_16x16x64_bf16 v[68:71], v[20:23], a[24:31], v2
 ds_read_b128 v[48:51], v1 offset:23552
 v_fmac_f32 v65, s50, v67
 v_cvt_pk_bf16_f32 v61, v64, v65
 ds_write_b64 v5, v[60:61] offset:8704
 v_smfmac_f32_16x16x64_bf16 v[68:71], v[24:27], a[32:39], v2
 v_smfmac_f32_16x16x64_bf16 v[68:71], v[28:31], a[40:47], v2
 s_xor_b32 s46, s45, 0x8000
 s_and_b32 s65, s36, 1
 v_smfmac_f32_16x16x64_bf16 v[72:75], v[36:39], a[48:55], v2
 v_smfmac_f32_16x16x64_bf16 v[72:75], v[40:43], a[56:63], v2
 s_waitcnt lgkmcnt(1)
 v_add_f32 v68, v68, v70
 v_smfmac_f32_16x16x64_bf16 v[72:75], v[20:23], v[44:51], v2
 s_waitcnt lgkmcnt(0)
 s_barrier
 ds_read_b64_tr_b16 v[60:61], v6 offset:8192
 ds_read_b64_tr_b16 v[62:63], v6 offset:8704
 v_add_f32 v69, v69, v71
 v_smfmac_f32_16x16x64_bf16 v[72:75], v[24:27], a[64:71], v2
 ds_read_b64_tr_b16 v[64:65], v6 offset:9216
 ds_read_b64_tr_b16 v[66:67], v6 offset:9728
 ds_read_b128 v[44:47], v1 offset:24576
 v_cvt_pk_bf16_f32 v68, v68, v69
 v_smfmac_f32_16x16x64_bf16 v[72:75], v[28:31], a[72:79], v2
 ds_read_b128 v[48:51], v1 offset:25600
 v_smfmac_f32_16x16x64_bf16 v[52:55], v[36:39], a[80:87], v2
 s_waitcnt vmcnt(5) lgkmcnt(4)
 v_mfma_f32_16x16x32_bf16 v[76:79], v[32:35], v[60:63], 0
 s_waitcnt vmcnt(3) lgkmcnt(2)
 v_add_f32 v72, v72, v74
 v_add_f32 v73, v73, v75
 v_mfma_f32_16x16x32_bf16 v[76:79], v[8:11], v[64:67], v[76:79]
 v_cvt_pk_bf16_f32 v69, v72, v73
 ds_write_b64 v5, v[68:69] offset:10752
 v_smfmac_f32_16x16x64_bf16 v[56:59], v[36:39], a[88:95], v2
 s_add_u32 s48, s48, 131072
 s_waitcnt lgkmcnt(1)
 v_smfmac_f32_16x16x64_bf16 v[52:55], v[40:43], v[44:51], v2
 ds_read_b128 v[36:39], v0 offset:15360
 v_add_f32_dpp v76, v78, v76 quad_perm:[2,3,0,1] row_mask:0xf bank_mask:0xf
 v_add_f32_dpp v77, v79, v77 quad_perm:[2,3,0,1] row_mask:0xf bank_mask:0xf
 v_smfmac_f32_16x16x64_bf16 v[56:59], v[40:43], a[96:103], v2
 ds_read_b128 v[44:47], v1 offset:26624
 v_exp_f32_dpp v78, v76 quad_perm:[0,1,0,1] row_mask:0xf bank_mask:0xf
 v_exp_f32_dpp v79, v77 quad_perm:[0,1,0,1] row_mask:0xf bank_mask:0xf
 v_smfmac_f32_16x16x64_bf16 v[52:55], v[20:23], a[104:111], v2
 ds_read_b128 v[48:51], v1 offset:27648
 v_cvt_pk_bf16_f32 v78, v78, v79
 ds_write_b32 v0, v78 offset:14340
 v_smfmac_f32_16x16x64_bf16 v[56:59], v[20:23], a[112:119], v2
 s_waitcnt lgkmcnt(4)
 s_barrier
 ds_read_b64_tr_b16 v[68:69], v6 offset:10240
 ds_read_b64_tr_b16 v[70:71], v6 offset:10752
 v_mov_b32 v33, 0
 v_smfmac_f32_16x16x64_bf16 v[52:55], v[24:27], a[120:127], v2
 ds_read_b64_tr_b16 v[72:73], v6 offset:11264
 ds_read_b64_tr_b16 v[74:75], v6 offset:11776
 v_mov_b32 v34, 0
 v_smfmac_f32_16x16x64_bf16 v[52:55], v[28:31], a[128:135], v2
 s_waitcnt lgkmcnt(5)
 v_smfmac_f32_16x16x64_bf16 v[56:59], v[24:27], v[44:51], v2
 s_waitcnt lgkmcnt(2)
 v_mfma_f32_16x16x32_bf16 v[40:43], v[68:71], v[60:63], 0
 s_barrier
 ds_read_b128 v[8:11], v0 offset:14336
 v_add_f32 v52, v52, v54
 v_add_f32 v53, v53, v55
 s_waitcnt lgkmcnt(1)
 v_mfma_f32_16x16x32_bf16 v[40:43], v[72:75], v[64:67], v[40:43]
 s_cmp_eq_u32 s36, 63
 v_cvt_pk_bf16_f32 v78, v52, v53
 v_smfmac_f32_16x16x64_bf16 v[56:59], v[28:31], a[136:143], v2
 s_waitcnt lgkmcnt(0)
 s_nop 2
 v_add_f32_dpp v40, v42, v40 quad_perm:[2,3,0,1] row_mask:0xf bank_mask:0xf
 v_add_f32_dpp v41, v43, v41 quad_perm:[2,3,0,1] row_mask:0xf bank_mask:0xf
 v_mfma_f32_16x16x32_bf16 v[72:75], v[36:39], v[8:11], 0
 ds_read_b128 v[24:27], v1 offset:28672
 v_exp_f32_dpp v42, v40 quad_perm:[0,1,0,1] row_mask:0xf bank_mask:0xf
 v_exp_f32_dpp v43, v41 quad_perm:[0,1,0,1] row_mask:0xf bank_mask:0xf
 s_waitcnt vmcnt(2)
 v_mfma_f32_16x16x32_bf16 v[44:47], v[12:15], v[8:11], 0
 ds_read_b128 v[28:31], v1 offset:29696
 v_cvt_pk_bf16_f32 v32, v42, v43
 v_cvt_pk_bf16_f32 v35, v42, v43
 v_add_f32 v56, v56, v58
 v_add_f32 v57, v57, v59
 v_mfma_f32_16x16x16_bf16 v[72:75], v[36:37], v[32:33], v[72:75]
 s_waitcnt vmcnt(1)
 v_cvt_pk_bf16_f32 v79, v56, v57
 v_mfma_f32_16x16x32_bf16 v[48:51], v[16:19], v[8:11], 0
 s_cbranch_scc1 R11TAIL
 v_mov_b64 v[68:69], 0
 v_mov_b64 v[70:71], 0
 v_mfma_f32_16x16x16_bf16 v[44:47], v[78:79], v[32:33], v[44:47]
 v_rcp_f32 v72, v72
 v_subrev_u32 v74, s52, v74
 v_mfma_f32_16x16x16_bf16 v[48:51], v[78:79], v[34:35], v[48:51]
 v_cmp_le_u32 vcc, s53, v74
 v_mov_b64 v[52:53], 0
 v_mov_b64 v[54:55], 0
R11RJ:
 s_nop 0
 v_pk_mul_f32 v[44:45], v[44:45], v[72:73] op_sel_hi:[1,0]
 v_pk_mul_f32 v[46:47], v[46:47], v[72:73] op_sel_hi:[1,0]
 s_cbranch_vccnz R11FB
 v_cvt_pk_bf16_f32 v40, v44, v45
 v_cvt_pk_bf16_f32 v41, v46, v47
 v_pk_mul_f32 v[48:49], v[48:49], v[72:73] op_sel_hi:[1,0]
 v_pk_mul_f32 v[50:51], v[50:51], v[72:73] op_sel_hi:[1,0]
 v_cvt_pk_bf16_f32 v42, v48, v49
 v_cvt_pk_bf16_f32 v43, v50, v51
 ds_write_b128 v4, v[40:43] offset:8320
 s_waitcnt lgkmcnt(1)
 v_smfmac_f32_16x16x64_bf16 v[68:71], v[40:43], v[24:31], v2
 v_mov_b64 v[56:57], 0
 v_mov_b64 v[58:59], 0
 v_smfmac_f32_16x16x64_bf16 v[52:55], v[40:43], a[144:151], v2
 v_mov_b64 v[64:65], 0
 v_mov_b64 v[66:67], 0
 v_smfmac_f32_16x16x64_bf16 v[56:59], v[40:43], a[152:159], v2
 s_waitcnt lgkmcnt(0)
 s_barrier
 ds_read_b128 v[32:35], v4 offset:8192
 ds_read_b128 v[36:39], v4 offset:9216
 ds_read_b128 v[72:75], v4 offset:9344
 v_mov_b64 v[60:61], 0
 v_mov_b64 v[62:63], 0
 v_smfmac_f32_16x16x64_bf16 v[64:67], v[40:43], a[160:167], v2
 s_waitcnt lgkmcnt(2)
 v_smfmac_f32_16x16x64_bf16 v[68:71], v[32:35], a[168:175], v2
 ds_read_b128 v[44:47], v3 offset:8192
 s_waitcnt lgkmcnt(2)
 v_lshrrev_b32 v40, 2, v0
 v_smfmac_f32_16x16x64_bf16 v[68:71], v[36:39], a[176:183], v2
 ds_read_b128 v[48:51], v3 offset:9216
 s_waitcnt lgkmcnt(2)
 v_smfmac_f32_16x16x64_bf16 v[68:71], v[72:75], a[184:191], v2
 ds_read_b128 v[24:27], v1 offset:30720
 v_smfmac_f32_16x16x64_bf16 v[52:55], v[32:35], a[192:199], v2
 ds_read_b128 v[28:31], v1 offset:31744
 v_smfmac_f32_16x16x64_bf16 v[52:55], v[36:39], a[200:207], v2
 ds_read_b128 v[8:11], v1 offset:32768
 v_cvt_pk_bf16_f32 v68, v68, v69
 v_smfmac_f32_16x16x64_bf16 v[52:55], v[72:75], a[208:215], v2
 ds_read_b128 v[12:15], v1 offset:33792
 s_waitcnt lgkmcnt(5)
 v_cvt_pk_bf16_f32 v69, v70, v71
 v_smfmac_f32_16x16x64_bf16 v[60:63], v[44:47], a[216:223], v2
 ds_read_b128 v[16:19], v1 offset:34816
 s_waitcnt lgkmcnt(5)
 v_and_or_b32 v68, v68, -2, s65
 v_smfmac_f32_16x16x64_bf16 v[60:63], v[48:51], a[224:231], v2
 ds_read_b128 v[20:23], v1 offset:35840
 v_cvt_pk_bf16_f32 v70, v52, v53
 v_cvt_pk_bf16_f32 v71, v54, v55
 buffer_store_dwordx4 v[68:71], v0, s[8:11], s37 offen sc1
 v_smfmac_f32_16x16x64_bf16 v[56:59], v[32:35], a[232:239], v2
 ds_read_b32 v76, v0 offset:13316
 s_waitcnt lgkmcnt(5)
 v_smfmac_f32_16x16x64_bf16 v[56:59], v[36:39], v[24:31], v2
 s_add_u32 s36, s36, 1
 v_add_f32 v60, v60, v62
 v_smfmac_f32_16x16x64_bf16 v[56:59], v[72:75], a[240:247], v2
 s_waitcnt lgkmcnt(3)
 v_add_f32 v61, v61, v63
 v_smfmac_f32_16x16x64_bf16 v[64:67], v[32:35], v[8:15], v2
 v_cvt_pk_bf16_f32 v41, v60, v61
 v_smfmac_f32_16x16x64_bf16 v[64:67], v[36:39], a[248:255], v2
 s_waitcnt lgkmcnt(1)
 v_and_or_b32 v41, v41, -2, s65
 v_smfmac_f32_16x16x64_bf16 v[64:67], v[72:75], v[16:23], v2
 buffer_store_dword v41, v40, s[8:11], s38 offen sc1
 v_cvt_pk_bf16_f32 v56, v56, v57
 v_cvt_pk_bf16_f32 v57, v58, v59
 v_and_or_b32 v56, v56, -2, s65
 s_nop 3
 v_cvt_pk_bf16_f32 v58, v64, v65
 v_cvt_pk_bf16_f32 v59, v66, v67
 buffer_store_dwordx4 v[56:59], v0, s[8:11], s37 offen offset:1024 sc1
R11HOP:
 s_waitcnt vmcnt(0)
 buffer_load_dwordx4 v[60:63], v7, s[8:11], s39 offen sc1
 buffer_load_dwordx4 v[64:67], v7, s[8:11], s40 offen sc1
 buffer_load_dwordx4 v[68:71], v7, s[8:11], s41 offen sc1
 buffer_load_dwordx4 v[72:75], v7, s[8:11], s42 offen sc1
 ds_read_b128 v[40:43], v0 offset:12288
 s_sub_u32 s49, s49, 1
 s_cselect_b32 s49, 0, s49
 s_cselect_b32 s66, -1, -2
 s_cselect_b32 s67, 1, 0
R11P1:
 s_waitcnt vmcnt(3)
 s_waitcnt lgkmcnt(0)
 v_mfma_f32_16x16x32_bf16 v[36:39], v[60:63], v[40:43], 0
 s_waitcnt vmcnt(2)
 v_mfma_f32_16x16x32_bf16 v[36:39], v[64:67], v[40:43], v[36:39]
 v_bitop3_b32 v60, v60, v64, s65 bitop3:0x7e
 s_waitcnt vmcnt(1)
 v_mfma_f32_16x16x32_bf16 v[36:39], v[68:71], v[40:43], v[36:39]
 s_waitcnt vmcnt(0)
 v_mfma_f32_16x16x32_bf16 v[36:39], v[72:75], v[40:43], v[36:39]
 v_bitop3_b32 v64, v68, v72, s65 bitop3:0x7e
 v_bitop3_b32 v60, v60, v64, 1 bitop3:0xa8
 v_cmp_lt_u32 vcc, s67, v60
 s_cbranch_vccnz R11R1
 s_nop 3
 v_permlane32_swap_b32 v36, v38
 v_permlane32_swap_b32 v37, v39
 v_add_f32 v36, v36, v38
 v_add_f32 v37, v37, v39
 v_cvt_pk_bf16_f32 v36, v36, v37
 buffer_store_dword v36, v76, s[8:11], s45 offen sc1
 s_barrier
 v_mov_b64 v[60:61], 0
 v_mov_b64 v[62:63], 0
 v_mov_b64 v[64:65], 0
 v_mov_b64 v[66:67], 0
 v_mov_b64 v[68:69], 0
 v_mov_b64 v[70:71], 0
 v_mov_b64 v[72:73], 0
 v_mov_b64 v[74:75], 0
 buffer_load_dwordx4 v[32:35], v0, s[8:11], s43 offen sc1
 ds_read_b128 v[8:11], v1 offset:0
 ds_read_b128 v[12:15], v1 offset:1024
 ds_read_b128 v[16:19], v1 offset:2048
 ds_read_b128 v[20:23], v1 offset:3072
 v_mov_b64 v[52:53], 0
 v_mov_b64 v[54:55], 0
 ds_read_b128 v[24:27], v1 offset:4096
 ds_read_b128 v[28:31], v1 offset:5120
 ds_read_b128 v[44:47], v1 offset:6144
 ds_read_b128 v[48:51], v1 offset:7168
 v_mov_b64 v[56:57], 0
 v_mov_b64 v[58:59], 0
 s_branch R11TOP
R11PB:
 buffer_load_dwordx4 v[36:39], v0, s[8:11], s63 offen sc1
 buffer_load_dwordx4 v[40:43], v0, s[8:11], s44 offen sc1
 s_sub_u32 s49, s49, 1
 s_cselect_b32 s49, 0, s49
 s_cselect_b32 s66, -1, -2
 s_cselect_b32 s67, 1, 0
 s_waitcnt vmcnt(0)
 v_max3_u32 v20, v36, v37, v38
 v_max3_u32 v20, v39, v40, v20
 v_max3_u32 v21, v41, v42, v43
 v_max_u32 v20, v21, v20
 v_cmp_lt_u32 vcc, s66, v20
 ds_write_b128 v0, v[36:39] offset:3072
 s_cbranch_vccnz R11PB
 s_waitcnt lgkmcnt(0)
 s_branch R11B
R11R1:
 buffer_load_dwordx4 v[60:63], v7, s[8:11], s39 offen sc1
 buffer_load_dwordx4 v[64:67], v7, s[8:11], s40 offen sc1
 buffer_load_dwordx4 v[68:71], v7, s[8:11], s41 offen sc1
 buffer_load_dwordx4 v[72:75], v7, s[8:11], s42 offen sc1
 s_sub_u32 s49, s49, 1
 s_cselect_b32 s49, 0, s49
 s_cselect_b32 s66, -1, -2
 s_cselect_b32 s67, 1, 0
 s_waitcnt vmcnt(0)
 s_branch R11P1
R11TAIL:
 s_waitcnt lgkmcnt(0)
 ds_read_b64_tr_b16 v[76:77], v6 offset:10752
 s_waitcnt lgkmcnt(0)
 buffer_store_dwordx4 v[76:79], v0, s[8:11], s48 offen sc1
 s_waitcnt vmcnt(0)
 s_endpgm
R11FB:
 s_waitcnt vmcnt(0) lgkmcnt(0)
 ds_write_b64 v6, v[76:77] offset:8704
 s_waitcnt lgkmcnt(0)
 s_barrier
 ds_read_b64 v[44:45], v6 offset:8192
 ds_read_b64 v[46:47], v6 offset:8704
 ds_read_b64 v[48:49], v6 offset:9216
 ds_read_b64 v[50:51], v6 offset:9728
 s_waitcnt lgkmcnt(0)
 s_barrier
 v_max3_f32 v72, v44, v45, v46
 v_max3_f32 v72, v72, v47, v48
 v_max3_f32 v72, v72, v49, v50
 v_max3_f32 v72, v72, v51, v40
 v_max_f32 v72, v72, v41
 v_mov_b32 v73, v72
 s_nop 1
 v_permlane16_swap_b32 v72, v73
 v_max_f32 v72, v72, v73
 v_mov_b32 v73, v72
 s_nop 1
 v_permlane32_swap_b32 v72, v73
 v_max_f32 v72, v72, v73
 v_sub_f32 v44, v44, v72
 v_sub_f32 v45, v45, v72
 v_sub_f32 v46, v46, v72
 v_sub_f32 v47, v47, v72
 v_sub_f32 v48, v48, v72
 v_sub_f32 v49, v49, v72
 v_sub_f32 v50, v50, v72
 v_sub_f32 v51, v51, v72
 v_sub_f32 v40, v40, v72
 v_sub_f32 v41, v41, v72
 v_exp_f32_dpp v44, v44 quad_perm:[0,1,0,1] row_mask:0xf bank_mask:0xf
 v_exp_f32_dpp v45, v45 quad_perm:[0,1,0,1] row_mask:0xf bank_mask:0xf
 v_exp_f32_dpp v46, v46 quad_perm:[0,1,0,1] row_mask:0xf bank_mask:0xf
 v_exp_f32_dpp v47, v47 quad_perm:[0,1,0,1] row_mask:0xf bank_mask:0xf
 v_exp_f32_dpp v48, v48 quad_perm:[0,1,0,1] row_mask:0xf bank_mask:0xf
 v_exp_f32_dpp v49, v49 quad_perm:[0,1,0,1] row_mask:0xf bank_mask:0xf
 v_exp_f32_dpp v50, v50 quad_perm:[0,1,0,1] row_mask:0xf bank_mask:0xf
 v_exp_f32_dpp v51, v51 quad_perm:[0,1,0,1] row_mask:0xf bank_mask:0xf
 v_exp_f32_dpp v40, v40 quad_perm:[0,1,0,1] row_mask:0xf bank_mask:0xf
 v_exp_f32_dpp v41, v41 quad_perm:[0,1,0,1] row_mask:0xf bank_mask:0xf
 v_cvt_pk_bf16_f32 v8, v44, v45
 v_cvt_pk_bf16_f32 v9, v46, v47
 v_cvt_pk_bf16_f32 v10, v48, v49
 v_cvt_pk_bf16_f32 v11, v50, v51
 v_cvt_pk_bf16_f32 v32, v40, v41
 v_cvt_pk_bf16_f32 v35, v40, v41
 v_mfma_f32_16x16x32_bf16 v[72:75], v[36:39], v[8:11], 0
 v_mfma_f32_16x16x32_bf16 v[44:47], v[12:15], v[8:11], 0
 v_mfma_f32_16x16x32_bf16 v[48:51], v[16:19], v[8:11], 0
 v_mfma_f32_16x16x16_bf16 v[72:75], v[36:37], v[32:33], v[72:75]
 v_mfma_f32_16x16x16_bf16 v[44:47], v[78:79], v[32:33], v[44:47]
 v_mfma_f32_16x16x16_bf16 v[48:51], v[78:79], v[34:35], v[48:51]
 v_rcp_f32 v72, v72
 s_mov_b64 vcc, 0
 s_nop 7
 s_branch R11RJ
RECW2:
 v_mbcnt_lo_u32_b32 v8, -1, 0
 v_mbcnt_hi_u32_b32 v8, -1, v8
 v_mov_b32 v4, 0
 v_bfe_u32 v9, v8, 5, 1
 v_lshl_add_u32 v4, v9, 6, v4
 v_mov_b32 v1, 0
 v_bfe_u32 v9, v8, 0, 5
 v_lshl_add_u32 v1, v9, 4, v1
 v_xor_b32 v4, v4, v1
 v_mov_b32 v1, 4608
 v_bfe_u32 v9, v8, 5, 1
 s_mov_b32 s101, 1152
 v_mad_u32_u24 v1, v9, s101, v1
 v_add_u32 v4, v4, v1
 v_mov_b32 v7, 0
 v_bfe_u32 v9, v8, 4, 1
 v_lshl_add_u32 v7, v9, 5, v7
 v_mov_b32 v1, 0
 v_bfe_u32 v9, v8, 0, 3
 v_lshl_add_u32 v1, v9, 4, v1
 v_xor_b32 v7, v7, v1
 v_mov_b32 v1, 4608
 v_bfe_u32 v9, v8, 3, 1
 s_mov_b32 s101, 1152
 v_mad_u32_u24 v1, v9, s101, v1
 v_bfe_u32 v9, v8, 4, 1
 s_mov_b32 s101, 9216
 v_mad_u32_u24 v1, v9, s101, v1
 v_bfe_u32 v9, v8, 5, 1
 s_mov_b32 s101, 73728
 v_mad_u32_u24 v1, v9, s101, v1
 v_add_u32 v7, v7, v1
 s_lshl_b32 s62, s3, 8
 s_mul_i32 s63, s3, 147456
 s_mov_b32 m0, 110592
 s_add_u32 s54, s63, 1024
 buffer_load_dwordx4 v7, s[28:31], s54 offen lds
 s_mov_b32 m0, 111616
 s_add_u32 s54, s63, 3328
 buffer_load_dwordx4 v7, s[28:31], s54 offen lds
 s_mov_b32 m0, 112640
 s_add_u32 s54, s63, 19456
 buffer_load_dwordx4 v7, s[28:31], s54 offen lds
 s_mov_b32 m0, 113664
 s_add_u32 s54, s63, 21760
 buffer_load_dwordx4 v7, s[28:31], s54 offen lds
 s_mov_b32 m0, 114688
 s_add_u32 s54, s63, 0
 buffer_load_dwordx4 v4, s[28:31], s54 offen lds
 s_mov_b32 m0, 115712
 s_add_u32 s54, s63, 2304
 buffer_load_dwordx4 v4, s[28:31], s54 offen lds
 s_mov_b32 m0, 116736
 s_add_u32 s54, s63, 18432
 buffer_load_dwordx4 v4, s[28:31], s54 offen lds
 s_mov_b32 m0, 117760
 s_add_u32 s54, s63, 20736
 buffer_load_dwordx4 v4, s[28:31], s54 offen lds
 s_mov_b32 m0, 118784
 s_add_u32 s54, s63, 512
 buffer_load_dwordx4 v4, s[28:31], s54 offen lds
 s_mov_b32 m0, 119808
 s_add_u32 s54, s63, 2816
 buffer_load_dwordx4 v4, s[28:31], s54 offen lds
 s_mov_b32 m0, 120832
 s_add_u32 s54, s63, 18944
 buffer_load_dwordx4 v4, s[28:31], s54 offen lds
 s_mov_b32 m0, 121856
 s_add_u32 s54, s63, 21248
 buffer_load_dwordx4 v4, s[28:31], s54 offen lds
 s_mul_i32 s54, s3, 9344
 s_add_u32 s37, s54, 4096
 s_add_u32 s38, s54, 8704
 s_mov_b32 s39, 0
 s_mov_b32 s40, 74752
 s_mov_b32 s41, 149504
 s_mov_b32 s42, 224256
 s_mov_b32 s45, 1048576
 s_mov_b32 s46, 1081344
 s_lshl_b32 s54, s3, 14
 s_add_u32 s47, s54, 16785408
 s_add_u32 s58, s54, 16777216
 s_lshl_b32 s54, s3, 12
 s_add_u32 s48, s54, 83888128
 s_mov_b32 s49, 400000
 s_mov_b32 s36, 0
 s_mov_b32 s50, 1040356334
 s_mov_b32 s51, 1040356334
 s_mov_b32 s52, 662700032
 s_mov_b32 s53, 939524096
 s_lshl_b32 s57, s3, 2
 s_mov_b32 s59, 8192
 s_lshr_b32 s60, s3, 2
 s_and_b32 s55, s3, 3
 s_lshl_b32 s54, s60, 7
 s_add_u32 s54, s54, s59
 v_mov_b32 v7, s54
 v_bfe_u32 v9, v8, 3, 3
 s_mov_b32 s101, 9344
 v_mad_u32_u24 v7, v9, s101, v7
 v_bfe_u32 v9, v8, 0, 3
 v_lshl_add_u32 v7, v9, 4, v7
 s_lshl_b32 s54, s55, 29
 v_or_b32 v7, s54, v7
 s_and_b32 s54, s60, 1
 s_lshl_b32 s54, s54, 8
 s_lshr_b32 s61, s60, 1
 s_lshl_b32 s61, s61, 6
 s_add_u32 s54, s54, s61
 s_lshr_b32 s61, s3, 3
 s_lshl_b32 s61, s61, 10
 s_add_u32 s54, s54, s61
 s_add_u32 s54, s54, 0
 v_mov_b32 v10, s54
 v_bfe_u32 v9, v8, 1, 1
 v_lshl_add_u32 v10, v9, 9, v10
 v_bfe_u32 v9, v8, 2, 1
 v_lshl_add_u32 v10, v9, 5, v10
 v_bfe_u32 v9, v8, 0, 1
 v_lshl_add_u32 v10, v9, 4, v10
 v_bfe_u32 v9, v8, 4, 1
 v_lshl_add_u32 v10, v9, 3, v10
 v_bfe_u32 v9, v8, 5, 1
 v_lshl_add_u32 v10, v9, 2, v10
 v_bfe_u32 v9, v8, 3, 1
 v_lshl_add_u32 v10, v9, 30, v10
 s_lshr_b32 s54, s60, 2
 s_lshl_b32 s54, s54, 5
 s_bfe_u32 s61, s60, 0x10001
 s_lshl_b32 s61, s61, 9
 s_add_u32 s54, s54, s61
 s_and_b32 s61, s60, 1
 s_lshl_b32 s61, s61, 7
 s_add_u32 s54, s54, s61
 s_add_u32 s54, s54, 8192
 v_mov_b32 v10, s54
 v_bfe_u32 v9, v8, 0, 1
 v_lshl_add_u32 v10, v9, 3, v10
 v_bfe_u32 v9, v8, 1, 1
 v_lshl_add_u32 v10, v9, 8, v10
 v_bfe_u32 v9, v8, 2, 1
 v_lshl_add_u32 v10, v9, 6, v10
 v_bfe_u32 v9, v8, 4, 1
 v_lshl_add_u32 v10, v9, 4, v10
 v_bfe_u32 v9, v8, 3, 1
 v_lshl_add_u32 v10, v9, 30, v10
 v_bfe_u32 v9, v8, 5, 1
 v_lshl_add_u32 v10, v9, 28, v10
 v_xor_b32 v10, 0x10000000, v10
 s_lshl_b32 s54, s55, 29
 v_or_b32 v10, s54, v10
 v_mov_b64 v[12:13], -1
 v_mov_b64 v[14:15], -1
 s_mov_b32 s54, 0
 buffer_store_dwordx4 v[12:15], v7, s[8:11], s54 offen sc1
 s_mov_b32 s54, 74752
 buffer_store_dwordx4 v[12:15], v7, s[8:11], s54 offen sc1
 s_mov_b32 s54, 149504
 buffer_store_dwordx4 v[12:15], v7, s[8:11], s54 offen sc1
 s_mov_b32 s54, 224256
 buffer_store_dwordx4 v[12:15], v7, s[8:11], s54 offen sc1
 s_mov_b32 s54, 1048576
 buffer_store_dwordx2 v[12:13], v10, s[8:11], s54 offen sc1
 s_mov_b32 s54, 1064960
 buffer_store_dwordx2 v[12:13], v10, s[8:11], s54 offen sc1
 s_mov_b32 s54, 1081344
 buffer_store_dwordx2 v[12:13], v10, s[8:11], s54 offen sc1
 s_mov_b32 s54, 1097728
 buffer_store_dwordx2 v[12:13], v10, s[8:11], s54 offen sc1
 v_lshlrev_b32 v11, 4, v8
 ds_write_b32 v11, v10 offset:13320
 v_mov_b32 v0, 0
 v_bfe_u32 v9, v8, 4, 2
 v_lshl_add_u32 v0, v9, 6, v0
 v_mov_b32 v1, 0
 v_bfe_u32 v9, v8, 0, 4
 v_lshl_add_u32 v1, v9, 4, v1
 v_xor_b32 v0, v0, v1
 v_mov_b32 v1, 65536
 v_bfe_u32 v9, v8, 4, 1
 v_lshl_add_u32 v1, v9, 13, v1
 v_bfe_u32 v9, v8, 5, 1
 v_lshl_add_u32 v1, v9, 18, v1
 v_add_u32 v0, v0, v1
 v_mov_b32 v2, 128
 v_bfe_u32 v9, v8, 1, 1
 v_lshl_add_u32 v2, v9, 5, v2
 v_mov_b32 v1, 0
 v_bfe_u32 v9, v8, 4, 1
 v_lshl_add_u32 v1, v9, 4, v1
 v_bfe_u32 v9, v8, 2, 2
 v_lshl_add_u32 v1, v9, 6, v1
 v_xor_b32 v2, v2, v1
 v_mov_b32 v1, 16384
 v_bfe_u32 v9, v8, 4, 2
 s_mov_b32 s101, 36864
 v_mad_u32_u24 v1, v9, s101, v1
 v_bfe_u32 v9, v8, 0, 1
 v_lshl_add_u32 v1, v9, 3, v1
 v_bfe_u32 v9, v8, 2, 2
 v_lshl_add_u32 v1, v9, 8, v1
 v_add_u32 v2, v2, v1
 v_mov_b32 v3, 64
 v_bfe_u32 v9, v8, 1, 1
 v_lshl_add_u32 v3, v9, 4, v3
 v_mov_b32 v1, 0
 v_bfe_u32 v9, v8, 3, 1
 v_lshl_add_u32 v1, v9, 5, v1
 v_bfe_u32 v9, v8, 4, 1
 v_lshl_add_u32 v1, v9, 6, v1
 v_xor_b32 v3, v3, v1
 v_mov_b32 v1, 16384
 v_bfe_u32 v9, v8, 4, 2
 s_mov_b32 s101, 36864
 v_mad_u32_u24 v1, v9, s101, v1
 v_bfe_u32 v9, v8, 0, 1
 v_lshl_add_u32 v1, v9, 3, v1
 v_bfe_u32 v9, v8, 2, 2
 v_lshl_add_u32 v1, v9, 7, v1
 v_add_u32 v3, v3, v1
 v_mov_b32 v5, 256
 v_bfe_u32 v9, v8, 1, 1
 v_lshl_add_u32 v5, v9, 4, v5
 v_bfe_u32 v9, v8, 3, 1
 v_lshl_add_u32 v5, v9, 5, v5
 v_mov_b32 v1, 0
 v_bfe_u32 v9, v8, 2, 1
 v_lshl_add_u32 v1, v9, 6, v1
 v_bfe_u32 v9, v8, 4, 1
 v_lshl_add_u32 v1, v9, 7, v1
 v_xor_b32 v5, v5, v1
 v_mov_b32 v1, 16384
 v_bfe_u32 v9, v8, 4, 2
 s_mov_b32 s101, 36864
 v_mad_u32_u24 v1, v9, s101, v1
 v_bfe_u32 v9, v8, 0, 1
 v_lshl_add_u32 v1, v9, 3, v1
 v_bfe_u32 v9, v8, 2, 1
 v_lshl_add_u32 v1, v9, 9, v1
 v_add_u32 v5, v5, v1
 v_xor_b32 v6, 64, v5
 v_mov_b32 v1, 90112
 v_bfe_u32 v9, v8, 0, 6
 v_lshl_add_u32 v1, v9, 4, v1
 s_waitcnt vmcnt(16) lgkmcnt(0)
 s_barrier
 s_mov_b32 m0, 122880
 s_add_u32 s54, s63, 9216
 buffer_load_dwordx4 v4, s[28:31], s54 offen lds
 s_mov_b32 m0, 123904
 s_add_u32 s54, s63, 11520
 buffer_load_dwordx4 v4, s[28:31], s54 offen lds
 s_mov_b32 m0, 124928
 s_add_u32 s54, s63, 27648
 buffer_load_dwordx4 v4, s[28:31], s54 offen lds
 s_mov_b32 m0, 125952
 s_add_u32 s54, s63, 29952
 buffer_load_dwordx4 v4, s[28:31], s54 offen lds
 ds_read_b64_tr_b16 a[216:217], v3 offset:20480
 ds_read_b64_tr_b16 a[218:219], v3 offset:21504
 ds_read_b64_tr_b16 a[220:221], v3 offset:22528
 ds_read_b64_tr_b16 a[222:223], v3 offset:23552
 ds_read_b64_tr_b16 a[224:225], v3 offset:20992
 ds_read_b64_tr_b16 a[226:227], v3 offset:22016
 ds_read_b64_tr_b16 a[228:229], v3 offset:23040
 ds_read_b64_tr_b16 a[230:231], v3 offset:24064
 s_waitcnt vmcnt(16) lgkmcnt(0)
 s_barrier
 s_mov_b32 m0, 110592
 s_add_u32 s54, s63, 9728
 buffer_load_dwordx4 v4, s[28:31], s54 offen lds
 s_mov_b32 m0, 111616
 s_add_u32 s54, s63, 12032
 buffer_load_dwordx4 v4, s[28:31], s54 offen lds
 s_mov_b32 m0, 112640
 s_add_u32 s54, s63, 28160
 buffer_load_dwordx4 v4, s[28:31], s54 offen lds
 s_mov_b32 m0, 113664
 s_add_u32 s54, s63, 30464
 buffer_load_dwordx4 v4, s[28:31], s54 offen lds
 v_xor_b32 v3, 64, v2
 ds_read_b64_tr_b16 a[168:169], v5 offset:24576
 ds_read_b64_tr_b16 a[170:171], v5 offset:25600
 ds_read_b64_tr_b16 a[172:173], v5 offset:26624
 ds_read_b64_tr_b16 a[174:175], v5 offset:27648
 ds_read_b64_tr_b16 a[192:193], v6 offset:24576
 ds_read_b64_tr_b16 a[194:195], v6 offset:25600
 ds_read_b64_tr_b16 a[196:197], v6 offset:26624
 ds_read_b64_tr_b16 a[198:199], v6 offset:27648
 s_waitcnt vmcnt(16) lgkmcnt(0)
 s_barrier
 s_mov_b32 m0, 114688
 s_add_u32 s54, s63, 73728
 buffer_load_dwordx4 v4, s[28:31], s54 offen lds
 s_mov_b32 m0, 115712
 s_add_u32 s54, s63, 76032
 buffer_load_dwordx4 v4, s[28:31], s54 offen lds
 s_mov_b32 m0, 116736
 s_add_u32 s54, s63, 92160
 buffer_load_dwordx4 v4, s[28:31], s54 offen lds
 s_mov_b32 m0, 117760
 s_add_u32 s54, s63, 94464
 buffer_load_dwordx4 v4, s[28:31], s54 offen lds
 ds_read_b64_tr_b16 a[232:233], v5 offset:28672
 ds_read_b64_tr_b16 a[234:235], v5 offset:29696
 ds_read_b64_tr_b16 a[236:237], v5 offset:30720
 ds_read_b64_tr_b16 a[238:239], v5 offset:31744
 ds_read_b64_tr_b16 v[64:65], v6 offset:28672
 ds_read_b64_tr_b16 v[66:67], v6 offset:29696
 ds_read_b64_tr_b16 v[68:69], v6 offset:30720
 ds_read_b64_tr_b16 v[70:71], v6 offset:31744
 s_waitcnt vmcnt(8) lgkmcnt(0)
 s_barrier
 s_mov_b32 m0, 118784
 s_add_u32 s54, s63, 74240
 buffer_load_dwordx4 v4, s[28:31], s54 offen lds
 s_mov_b32 m0, 119808
 s_add_u32 s54, s63, 76544
 buffer_load_dwordx4 v4, s[28:31], s54 offen lds
 s_mov_b32 m0, 120832
 s_add_u32 s54, s63, 92672
 buffer_load_dwordx4 v4, s[28:31], s54 offen lds
 s_mov_b32 m0, 121856
 s_add_u32 s54, s63, 94976
 buffer_load_dwordx4 v4, s[28:31], s54 offen lds
 ds_read_b64_tr_b16 a[176:177], v5 offset:32768
 ds_read_b64_tr_b16 a[178:179], v5 offset:33792
 ds_read_b64_tr_b16 a[180:181], v5 offset:34816
 ds_read_b64_tr_b16 a[182:183], v5 offset:35840
 ds_read_b64_tr_b16 a[200:201], v6 offset:32768
 ds_read_b64_tr_b16 a[202:203], v6 offset:33792
 ds_read_b64_tr_b16 a[204:205], v6 offset:34816
 ds_read_b64_tr_b16 a[206:207], v6 offset:35840
 s_waitcnt vmcnt(8) lgkmcnt(0)
 s_barrier
 s_mov_b32 m0, 122880
 s_add_u32 s54, s63, 82944
 buffer_load_dwordx4 v4, s[28:31], s54 offen lds
 s_mov_b32 m0, 123904
 s_add_u32 s54, s63, 85248
 buffer_load_dwordx4 v4, s[28:31], s54 offen lds
 s_mov_b32 m0, 124928
 s_add_u32 s54, s63, 101376
 buffer_load_dwordx4 v4, s[28:31], s54 offen lds
 s_mov_b32 m0, 125952
 s_add_u32 s54, s63, 103680
 buffer_load_dwordx4 v4, s[28:31], s54 offen lds
 ds_read_b64_tr_b16 v[56:57], v5 offset:20480
 ds_read_b64_tr_b16 v[58:59], v5 offset:21504
 ds_read_b64_tr_b16 v[60:61], v5 offset:22528
 ds_read_b64_tr_b16 v[62:63], v5 offset:23552
 ds_read_b64_tr_b16 a[248:249], v6 offset:20480
 ds_read_b64_tr_b16 a[250:251], v6 offset:21504
 ds_read_b64_tr_b16 a[252:253], v6 offset:22528
 ds_read_b64_tr_b16 a[254:255], v6 offset:23552
 s_waitcnt vmcnt(8) lgkmcnt(0)
 s_barrier
 s_mov_b32 m0, 110592
 s_add_u32 s54, s63, 83456
 buffer_load_dwordx4 v4, s[28:31], s54 offen lds
 s_mov_b32 m0, 111616
 s_add_u32 s54, s63, 85760
 buffer_load_dwordx4 v4, s[28:31], s54 offen lds
 s_mov_b32 m0, 112640
 s_add_u32 s54, s63, 101888
 buffer_load_dwordx4 v4, s[28:31], s54 offen lds
 s_mov_b32 m0, 113664
 s_add_u32 s54, s63, 104192
 buffer_load_dwordx4 v4, s[28:31], s54 offen lds
 ds_read_b64_tr_b16 v[48:49], v5 offset:24576
 ds_read_b64_tr_b16 v[50:51], v5 offset:25600
 ds_read_b64_tr_b16 v[52:53], v5 offset:26624
 ds_read_b64_tr_b16 v[54:55], v5 offset:27648
 ds_read_b64_tr_b16 a[144:145], v6 offset:24576
 ds_read_b64_tr_b16 a[146:147], v6 offset:25600
 ds_read_b64_tr_b16 a[148:149], v6 offset:26624
 ds_read_b64_tr_b16 a[150:151], v6 offset:27648
 s_waitcnt vmcnt(8) lgkmcnt(0)
 s_barrier
 s_mov_b32 m0, 114688
 s_add_u32 s54, s62, 0
 buffer_load_dwordx4 v0, s[16:19], s54 offen lds
 s_mov_b32 m0, 115712
 s_add_u32 s54, s62, 16384
 buffer_load_dwordx4 v0, s[16:19], s54 offen lds
 s_mov_b32 m0, 116736
 s_add_u32 s54, s62, 131072
 buffer_load_dwordx4 v0, s[16:19], s54 offen lds
 s_mov_b32 m0, 117760
 s_add_u32 s54, s62, 147456
 buffer_load_dwordx4 v0, s[16:19], s54 offen lds
 ds_read_b64_tr_b16 a[152:153], v5 offset:28672
 ds_read_b64_tr_b16 a[154:155], v5 offset:29696
 ds_read_b64_tr_b16 a[156:157], v5 offset:30720
 ds_read_b64_tr_b16 a[158:159], v5 offset:31744
 ds_read_b64_tr_b16 a[160:161], v6 offset:28672
 ds_read_b64_tr_b16 a[162:163], v6 offset:29696
 ds_read_b64_tr_b16 a[164:165], v6 offset:30720
 ds_read_b64_tr_b16 a[166:167], v6 offset:31744
 s_waitcnt vmcnt(8) lgkmcnt(0)
 s_barrier
 s_mov_b32 m0, 118784
 s_add_u32 s54, s62, 524288
 buffer_load_dwordx4 v0, s[16:19], s54 offen lds
 s_mov_b32 m0, 119808
 s_add_u32 s54, s62, 540672
 buffer_load_dwordx4 v0, s[16:19], s54 offen lds
 s_mov_b32 m0, 120832
 s_add_u32 s54, s62, 655360
 buffer_load_dwordx4 v0, s[16:19], s54 offen lds
 s_mov_b32 m0, 121856
 s_add_u32 s54, s62, 671744
 buffer_load_dwordx4 v0, s[16:19], s54 offen lds
 ds_read_b64_tr_b16 a[184:185], v5 offset:32768
 ds_read_b64_tr_b16 a[186:187], v5 offset:33792
 ds_read_b64_tr_b16 a[188:189], v5 offset:34816
 ds_read_b64_tr_b16 a[190:191], v5 offset:35840
 ds_read_b64_tr_b16 a[208:209], v6 offset:32768
 ds_read_b64_tr_b16 a[210:211], v6 offset:33792
 ds_read_b64_tr_b16 a[212:213], v6 offset:34816
 ds_read_b64_tr_b16 a[214:215], v6 offset:35840
 s_waitcnt vmcnt(8) lgkmcnt(0)
 s_barrier
 s_mov_b32 m0, 122880
 s_add_u32 s54, s62, 1048576
 buffer_load_dwordx4 v0, s[16:19], s54 offen lds
 s_mov_b32 m0, 123904
 s_add_u32 s54, s62, 1064960
 buffer_load_dwordx4 v0, s[16:19], s54 offen lds
 s_mov_b32 m0, 124928
 s_add_u32 s54, s62, 1179648
 buffer_load_dwordx4 v0, s[16:19], s54 offen lds
 s_mov_b32 m0, 125952
 s_add_u32 s54, s62, 1196032
 buffer_load_dwordx4 v0, s[16:19], s54 offen lds
 ds_read_b64_tr_b16 a[240:241], v5 offset:20480
 ds_read_b64_tr_b16 a[242:243], v5 offset:21504
 ds_read_b64_tr_b16 a[244:245], v5 offset:22528
 ds_read_b64_tr_b16 a[246:247], v5 offset:23552
 ds_read_b64_tr_b16 v[72:73], v6 offset:20480
 ds_read_b64_tr_b16 v[74:75], v6 offset:21504
 ds_read_b64_tr_b16 v[76:77], v6 offset:22528
 ds_read_b64_tr_b16 v[78:79], v6 offset:23552
 s_waitcnt vmcnt(8) lgkmcnt(0)
 s_barrier
 s_mov_b32 m0, 110592
 s_add_u32 s54, s62, 1572864
 buffer_load_dwordx4 v0, s[16:19], s54 offen lds
 s_mov_b32 m0, 111616
 s_add_u32 s54, s62, 1589248
 buffer_load_dwordx4 v0, s[16:19], s54 offen lds
 s_mov_b32 m0, 112640
 s_add_u32 s54, s62, 1703936
 buffer_load_dwordx4 v0, s[16:19], s54 offen lds
 s_mov_b32 m0, 113664
 s_add_u32 s54, s62, 1720320
 buffer_load_dwordx4 v0, s[16:19], s54 offen lds
 ds_read_b64_tr_b16 v[96:97], v2 offset:24576
 ds_read_b64_tr_b16 v[98:99], v2 offset:25600
 ds_read_b64_tr_b16 v[100:101], v2 offset:26624
 ds_read_b64_tr_b16 v[102:103], v2 offset:27648
 ds_read_b64_tr_b16 v[104:105], v3 offset:24576
 ds_read_b64_tr_b16 v[106:107], v3 offset:25600
 ds_read_b64_tr_b16 v[108:109], v3 offset:26624
 ds_read_b64_tr_b16 v[110:111], v3 offset:27648
 s_waitcnt vmcnt(8) lgkmcnt(0)
 s_barrier
 s_mov_b32 m0, 114688
 s_add_u32 s54, s62, 4194304
 buffer_load_dwordx4 v0, s[16:19], s54 offen lds
 s_mov_b32 m0, 115712
 s_add_u32 s54, s62, 4210688
 buffer_load_dwordx4 v0, s[16:19], s54 offen lds
 s_mov_b32 m0, 116736
 s_add_u32 s54, s62, 4325376
 buffer_load_dwordx4 v0, s[16:19], s54 offen lds
 s_mov_b32 m0, 117760
 s_add_u32 s54, s62, 4341760
 buffer_load_dwordx4 v0, s[16:19], s54 offen lds
 ds_read_b64_tr_b16 v[128:129], v2 offset:28672
 ds_read_b64_tr_b16 v[130:131], v2 offset:29696
 ds_read_b64_tr_b16 v[132:133], v2 offset:30720
 ds_read_b64_tr_b16 v[134:135], v2 offset:31744
 ds_read_b64_tr_b16 v[136:137], v3 offset:28672
 ds_read_b64_tr_b16 v[138:139], v3 offset:29696
 ds_read_b64_tr_b16 v[140:141], v3 offset:30720
 ds_read_b64_tr_b16 v[142:143], v3 offset:31744
 s_waitcnt vmcnt(8) lgkmcnt(0)
 s_barrier
 s_mov_b32 m0, 118784
 s_add_u32 s54, s62, 0
 buffer_load_dwordx4 v0, s[20:23], s54 offen lds
 s_mov_b32 m0, 119808
 s_add_u32 s54, s62, 16384
 buffer_load_dwordx4 v0, s[20:23], s54 offen lds
 s_mov_b32 m0, 120832
 s_add_u32 s54, s62, 131072
 buffer_load_dwordx4 v0, s[20:23], s54 offen lds
 s_mov_b32 m0, 121856
 s_add_u32 s54, s62, 147456
 buffer_load_dwordx4 v0, s[20:23], s54 offen lds
 ds_read_b64_tr_b16 v[8:9], v2 offset:32768
 ds_read_b64_tr_b16 v[10:11], v2 offset:33792
 ds_read_b64_tr_b16 v[12:13], v2 offset:34816
 ds_read_b64_tr_b16 v[14:15], v2 offset:35840
 s_waitcnt lgkmcnt(2)
 ds_write_b128 v1, v[8:11] offset:0
 s_waitcnt lgkmcnt(1)
 ds_write_b128 v1, v[12:15] offset:1024
 ds_read_b64_tr_b16 v[8:9], v3 offset:32768
 ds_read_b64_tr_b16 v[10:11], v3 offset:33792
 ds_read_b64_tr_b16 v[12:13], v3 offset:34816
 ds_read_b64_tr_b16 v[14:15], v3 offset:35840
 s_waitcnt lgkmcnt(2)
 ds_write_b128 v1, v[8:11] offset:2048
 s_waitcnt lgkmcnt(1)
 ds_write_b128 v1, v[12:15] offset:3072
 s_waitcnt vmcnt(8) lgkmcnt(0)
 s_barrier
 s_mov_b32 m0, 122880
 s_add_u32 s54, s62, 524288
 buffer_load_dwordx4 v0, s[20:23], s54 offen lds
 s_mov_b32 m0, 123904
 s_add_u32 s54, s62, 540672
 buffer_load_dwordx4 v0, s[20:23], s54 offen lds
 s_mov_b32 m0, 124928
 s_add_u32 s54, s62, 655360
 buffer_load_dwordx4 v0, s[20:23], s54 offen lds
 s_mov_b32 m0, 125952
 s_add_u32 s54, s62, 671744
 buffer_load_dwordx4 v0, s[20:23], s54 offen lds
 ds_read_b64_tr_b16 v[168:169], v2 offset:20480
 ds_read_b64_tr_b16 v[170:171], v2 offset:21504
 ds_read_b64_tr_b16 v[172:173], v2 offset:22528
 ds_read_b64_tr_b16 v[174:175], v2 offset:23552
 ds_read_b64_tr_b16 v[8:9], v3 offset:20480
 ds_read_b64_tr_b16 v[10:11], v3 offset:21504
 ds_read_b64_tr_b16 v[12:13], v3 offset:22528
 ds_read_b64_tr_b16 v[14:15], v3 offset:23552
 s_waitcnt lgkmcnt(2)
 ds_write_b128 v1, v[8:11] offset:14336
 s_waitcnt lgkmcnt(1)
 ds_write_b128 v1, v[12:15] offset:15360
 s_waitcnt vmcnt(8) lgkmcnt(0)
 s_barrier
 s_mov_b32 m0, 110592
 s_add_u32 s54, s62, 1048576
 buffer_load_dwordx4 v0, s[20:23], s54 offen lds
 s_mov_b32 m0, 111616
 s_add_u32 s54, s62, 1064960
 buffer_load_dwordx4 v0, s[20:23], s54 offen lds
 s_mov_b32 m0, 112640
 s_add_u32 s54, s62, 1179648
 buffer_load_dwordx4 v0, s[20:23], s54 offen lds
 s_mov_b32 m0, 113664
 s_add_u32 s54, s62, 1196032
 buffer_load_dwordx4 v0, s[20:23], s54 offen lds
 ds_read_b64_tr_b16 v[216:217], v2 offset:24576
 ds_read_b64_tr_b16 v[218:219], v2 offset:25600
 ds_read_b64_tr_b16 v[220:221], v2 offset:26624
 ds_read_b64_tr_b16 v[222:223], v2 offset:27648
 ds_read_b64_tr_b16 v[8:9], v3 offset:24576
 ds_read_b64_tr_b16 v[10:11], v3 offset:25600
 ds_read_b64_tr_b16 v[12:13], v3 offset:26624
 ds_read_b64_tr_b16 v[14:15], v3 offset:27648
 s_waitcnt lgkmcnt(2)
 ds_write_b128 v1, v[8:11] offset:18432
 s_waitcnt lgkmcnt(1)
 ds_write_b128 v1, v[12:15] offset:19456
 s_waitcnt vmcnt(8) lgkmcnt(0)
 s_barrier
 s_mov_b32 m0, 114688
 s_add_u32 s54, s62, 1572864
 buffer_load_dwordx4 v0, s[20:23], s54 offen lds
 s_mov_b32 m0, 115712
 s_add_u32 s54, s62, 1589248
 buffer_load_dwordx4 v0, s[20:23], s54 offen lds
 s_mov_b32 m0, 116736
 s_add_u32 s54, s62, 1703936
 buffer_load_dwordx4 v0, s[20:23], s54 offen lds
 s_mov_b32 m0, 117760
 s_add_u32 s54, s62, 1720320
 buffer_load_dwordx4 v0, s[20:23], s54 offen lds
 ds_read_b64_tr_b16 v[112:113], v2 offset:28672
 ds_read_b64_tr_b16 v[114:115], v2 offset:29696
 ds_read_b64_tr_b16 v[116:117], v2 offset:30720
 ds_read_b64_tr_b16 v[118:119], v2 offset:31744
 ds_read_b64_tr_b16 v[8:9], v3 offset:28672
 ds_read_b64_tr_b16 v[10:11], v3 offset:29696
 ds_read_b64_tr_b16 v[12:13], v3 offset:30720
 ds_read_b64_tr_b16 v[14:15], v3 offset:31744
 s_waitcnt lgkmcnt(2)
 ds_write_b128 v1, v[8:11] offset:8192
 s_waitcnt lgkmcnt(1)
 ds_write_b128 v1, v[12:15] offset:9216
 s_waitcnt vmcnt(8) lgkmcnt(0)
 s_barrier
 s_mov_b32 m0, 118784
 s_add_u32 s54, s62, 0
 buffer_load_dwordx4 v0, s[24:27], s54 offen lds
 s_mov_b32 m0, 119808
 s_add_u32 s54, s62, 16384
 buffer_load_dwordx4 v0, s[24:27], s54 offen lds
 s_mov_b32 m0, 120832
 s_add_u32 s54, s62, 131072
 buffer_load_dwordx4 v0, s[24:27], s54 offen lds
 s_mov_b32 m0, 121856
 s_add_u32 s54, s62, 147456
 buffer_load_dwordx4 v0, s[24:27], s54 offen lds
 ds_read_b64_tr_b16 v[144:145], v2 offset:32768
 ds_read_b64_tr_b16 v[146:147], v2 offset:33792
 ds_read_b64_tr_b16 v[148:149], v2 offset:34816
 ds_read_b64_tr_b16 v[150:151], v2 offset:35840
 ds_read_b64_tr_b16 v[152:153], v3 offset:32768
 ds_read_b64_tr_b16 v[154:155], v3 offset:33792
 ds_read_b64_tr_b16 v[156:157], v3 offset:34816
 ds_read_b64_tr_b16 v[158:159], v3 offset:35840
 s_waitcnt vmcnt(8) lgkmcnt(0)
 s_barrier
 s_mov_b32 m0, 122880
 s_add_u32 s54, s62, 524288
 buffer_load_dwordx4 v0, s[24:27], s54 offen lds
 s_mov_b32 m0, 123904
 s_add_u32 s54, s62, 540672
 buffer_load_dwordx4 v0, s[24:27], s54 offen lds
 s_mov_b32 m0, 124928
 s_add_u32 s54, s62, 655360
 buffer_load_dwordx4 v0, s[24:27], s54 offen lds
 s_mov_b32 m0, 125952
 s_add_u32 s54, s62, 671744
 buffer_load_dwordx4 v0, s[24:27], s54 offen lds
 ds_read_b64_tr_b16 v[8:9], v2 offset:20480
 ds_read_b64_tr_b16 v[10:11], v2 offset:21504
 ds_read_b64_tr_b16 v[12:13], v2 offset:22528
 ds_read_b64_tr_b16 v[14:15], v2 offset:23552
 s_waitcnt lgkmcnt(2)
 ds_write_b128 v1, v[8:11] offset:4096
 s_waitcnt lgkmcnt(1)
 ds_write_b128 v1, v[12:15] offset:5120
 ds_read_b64_tr_b16 v[8:9], v3 offset:20480
 ds_read_b64_tr_b16 v[10:11], v3 offset:21504
 ds_read_b64_tr_b16 v[12:13], v3 offset:22528
 ds_read_b64_tr_b16 v[14:15], v3 offset:23552
 s_waitcnt lgkmcnt(2)
 ds_write_b128 v1, v[8:11] offset:6144
 s_waitcnt lgkmcnt(1)
 ds_write_b128 v1, v[12:15] offset:7168
 s_waitcnt vmcnt(8) lgkmcnt(0)
 s_barrier
 s_mov_b32 m0, 110592
 s_add_u32 s54, s62, 1048576
 buffer_load_dwordx4 v0, s[24:27], s54 offen lds
 s_mov_b32 m0, 111616
 s_add_u32 s54, s62, 1064960
 buffer_load_dwordx4 v0, s[24:27], s54 offen lds
 s_mov_b32 m0, 112640
 s_add_u32 s54, s62, 1179648
 buffer_load_dwordx4 v0, s[24:27], s54 offen lds
 s_mov_b32 m0, 113664
 s_add_u32 s54, s62, 1196032
 buffer_load_dwordx4 v0, s[24:27], s54 offen lds
 ds_read_b64_tr_b16 v[176:177], v2 offset:24576
 ds_read_b64_tr_b16 v[178:179], v2 offset:25600
 ds_read_b64_tr_b16 v[180:181], v2 offset:26624
 ds_read_b64_tr_b16 v[182:183], v2 offset:27648
 ds_read_b64_tr_b16 v[184:185], v3 offset:24576
 ds_read_b64_tr_b16 v[186:187], v3 offset:25600
 ds_read_b64_tr_b16 v[188:189], v3 offset:26624
 ds_read_b64_tr_b16 v[190:191], v3 offset:27648
 s_waitcnt vmcnt(8) lgkmcnt(0)
 s_barrier
 s_mov_b32 m0, 114688
 s_add_u32 s54, s62, 1572864
 buffer_load_dwordx4 v0, s[24:27], s54 offen lds
 s_mov_b32 m0, 115712
 s_add_u32 s54, s62, 1589248
 buffer_load_dwordx4 v0, s[24:27], s54 offen lds
 s_mov_b32 m0, 116736
 s_add_u32 s54, s62, 1703936
 buffer_load_dwordx4 v0, s[24:27], s54 offen lds
 s_mov_b32 m0, 117760
 s_add_u32 s54, s62, 1720320
 buffer_load_dwordx4 v0, s[24:27], s54 offen lds
 ds_read_b64_tr_b16 v[120:121], v2 offset:28672
 ds_read_b64_tr_b16 v[122:123], v2 offset:29696
 ds_read_b64_tr_b16 v[124:125], v2 offset:30720
 ds_read_b64_tr_b16 v[126:127], v2 offset:31744
 ds_read_b64_tr_b16 v[8:9], v3 offset:28672
 ds_read_b64_tr_b16 v[10:11], v3 offset:29696
 ds_read_b64_tr_b16 v[12:13], v3 offset:30720
 ds_read_b64_tr_b16 v[14:15], v3 offset:31744
 s_waitcnt lgkmcnt(2)
 ds_write_b128 v1, v[8:11] offset:10240
 s_waitcnt lgkmcnt(1)
 ds_write_b128 v1, v[12:15] offset:11264
 s_waitcnt vmcnt(8) lgkmcnt(0)
 s_barrier
 s_mov_b32 m0, 118784
 s_add_u32 s54, s62, 2097152
 buffer_load_dwordx4 v0, s[16:19], s54 offen lds
 s_mov_b32 m0, 119808
 s_add_u32 s54, s62, 2113536
 buffer_load_dwordx4 v0, s[16:19], s54 offen lds
 s_mov_b32 m0, 120832
 s_add_u32 s54, s62, 2228224
 buffer_load_dwordx4 v0, s[16:19], s54 offen lds
 s_mov_b32 m0, 121856
 s_add_u32 s54, s62, 2244608
 buffer_load_dwordx4 v0, s[16:19], s54 offen lds
 ds_read_b64_tr_b16 v[8:9], v2 offset:32768
 ds_read_b64_tr_b16 v[10:11], v2 offset:33792
 ds_read_b64_tr_b16 v[12:13], v2 offset:34816
 ds_read_b64_tr_b16 v[14:15], v2 offset:35840
 s_waitcnt lgkmcnt(2)
 ds_write_b128 v1, v[8:11] offset:12288
 s_waitcnt lgkmcnt(1)
 ds_write_b128 v1, v[12:15] offset:13312
 ds_read_b64_tr_b16 v[160:161], v3 offset:32768
 ds_read_b64_tr_b16 v[162:163], v3 offset:33792
 ds_read_b64_tr_b16 v[164:165], v3 offset:34816
 ds_read_b64_tr_b16 v[166:167], v3 offset:35840
 s_waitcnt vmcnt(8) lgkmcnt(0)
 s_barrier
 s_mov_b32 m0, 122880
 s_add_u32 s54, s62, 2621440
 buffer_load_dwordx4 v0, s[16:19], s54 offen lds
 s_mov_b32 m0, 123904
 s_add_u32 s54, s62, 2637824
 buffer_load_dwordx4 v0, s[16:19], s54 offen lds
 s_mov_b32 m0, 124928
 s_add_u32 s54, s62, 2752512
 buffer_load_dwordx4 v0, s[16:19], s54 offen lds
 s_mov_b32 m0, 125952
 s_add_u32 s54, s62, 2768896
 buffer_load_dwordx4 v0, s[16:19], s54 offen lds
 ds_read_b64_tr_b16 v[80:81], v2 offset:20480
 ds_read_b64_tr_b16 v[82:83], v2 offset:21504
 ds_read_b64_tr_b16 v[84:85], v2 offset:22528
 ds_read_b64_tr_b16 v[86:87], v2 offset:23552
 ds_read_b64_tr_b16 v[88:89], v3 offset:20480
 ds_read_b64_tr_b16 v[90:91], v3 offset:21504
 ds_read_b64_tr_b16 v[92:93], v3 offset:22528
 ds_read_b64_tr_b16 v[94:95], v3 offset:23552
 s_waitcnt vmcnt(8) lgkmcnt(0)
 s_barrier
 s_mov_b32 m0, 110592
 s_add_u32 s54, s62, 3145728
 buffer_load_dwordx4 v0, s[16:19], s54 offen lds
 s_mov_b32 m0, 111616
 s_add_u32 s54, s62, 3162112
 buffer_load_dwordx4 v0, s[16:19], s54 offen lds
 s_mov_b32 m0, 112640
 s_add_u32 s54, s62, 3276800
 buffer_load_dwordx4 v0, s[16:19], s54 offen lds
 s_mov_b32 m0, 113664
 s_add_u32 s54, s62, 3293184
 buffer_load_dwordx4 v0, s[16:19], s54 offen lds
 ds_read_b64_tr_b16 v[192:193], v2 offset:24576
 ds_read_b64_tr_b16 v[194:195], v2 offset:25600
 ds_read_b64_tr_b16 v[196:197], v2 offset:26624
 ds_read_b64_tr_b16 v[198:199], v2 offset:27648
 ds_read_b64_tr_b16 v[8:9], v3 offset:24576
 ds_read_b64_tr_b16 v[10:11], v3 offset:25600
 ds_read_b64_tr_b16 v[12:13], v3 offset:26624
 ds_read_b64_tr_b16 v[14:15], v3 offset:27648
 s_waitcnt lgkmcnt(2)
 ds_write_b128 v1, v[8:11] offset:16384
 s_waitcnt lgkmcnt(1)
 ds_write_b128 v1, v[12:15] offset:17408
 s_waitcnt vmcnt(8) lgkmcnt(0)
 s_barrier
 s_mov_b32 m0, 114688
 s_add_u32 s54, s62, 3670016
 buffer_load_dwordx4 v0, s[16:19], s54 offen lds
 s_mov_b32 m0, 115712
 s_add_u32 s54, s62, 3686400
 buffer_load_dwordx4 v0, s[16:19], s54 offen lds
 s_mov_b32 m0, 116736
 s_add_u32 s54, s62, 3801088
 buffer_load_dwordx4 v0, s[16:19], s54 offen lds
 s_mov_b32 m0, 117760
 s_add_u32 s54, s62, 3817472
 buffer_load_dwordx4 v0, s[16:19], s54 offen lds
 ds_read_b64_tr_b16 v[224:225], v2 offset:28672
 ds_read_b64_tr_b16 v[226:227], v2 offset:29696
 ds_read_b64_tr_b16 v[228:229], v2 offset:30720
 ds_read_b64_tr_b16 v[230:231], v2 offset:31744
 ds_read_b64_tr_b16 v[248:249], v3 offset:28672
 ds_read_b64_tr_b16 v[250:251], v3 offset:29696
 ds_read_b64_tr_b16 v[252:253], v3 offset:30720
 ds_read_b64_tr_b16 v[254:255], v3 offset:31744
 s_waitcnt vmcnt(8) lgkmcnt(0)
 s_barrier
 s_mov_b32 m0, 118784
 s_add_u32 s54, s62, 2097152
 buffer_load_dwordx4 v0, s[20:23], s54 offen lds
 s_mov_b32 m0, 119808
 s_add_u32 s54, s62, 2113536
 buffer_load_dwordx4 v0, s[20:23], s54 offen lds
 s_mov_b32 m0, 120832
 s_add_u32 s54, s62, 2228224
 buffer_load_dwordx4 v0, s[20:23], s54 offen lds
 s_mov_b32 m0, 121856
 s_add_u32 s54, s62, 2244608
 buffer_load_dwordx4 v0, s[20:23], s54 offen lds
 ds_read_b64_tr_b16 v[232:233], v2 offset:32768
 ds_read_b64_tr_b16 v[234:235], v2 offset:33792
 ds_read_b64_tr_b16 v[236:237], v2 offset:34816
 ds_read_b64_tr_b16 v[238:239], v2 offset:35840
 ds_read_b64_tr_b16 a[0:1], v3 offset:32768
 ds_read_b64_tr_b16 a[2:3], v3 offset:33792
 ds_read_b64_tr_b16 a[4:5], v3 offset:34816
 ds_read_b64_tr_b16 a[6:7], v3 offset:35840
 s_waitcnt vmcnt(8) lgkmcnt(0)
 s_barrier
 s_mov_b32 m0, 122880
 s_add_u32 s54, s62, 2621440
 buffer_load_dwordx4 v0, s[20:23], s54 offen lds
 s_mov_b32 m0, 123904
 s_add_u32 s54, s62, 2637824
 buffer_load_dwordx4 v0, s[20:23], s54 offen lds
 s_mov_b32 m0, 124928
 s_add_u32 s54, s62, 2752512
 buffer_load_dwordx4 v0, s[20:23], s54 offen lds
 s_mov_b32 m0, 125952
 s_add_u32 s54, s62, 2768896
 buffer_load_dwordx4 v0, s[20:23], s54 offen lds
 ds_read_b64_tr_b16 v[200:201], v2 offset:20480
 ds_read_b64_tr_b16 v[202:203], v2 offset:21504
 ds_read_b64_tr_b16 v[204:205], v2 offset:22528
 ds_read_b64_tr_b16 v[206:207], v2 offset:23552
 ds_read_b64_tr_b16 v[208:209], v3 offset:20480
 ds_read_b64_tr_b16 v[210:211], v3 offset:21504
 ds_read_b64_tr_b16 v[212:213], v3 offset:22528
 ds_read_b64_tr_b16 v[214:215], v3 offset:23552
 s_waitcnt vmcnt(8) lgkmcnt(0)
 s_barrier
 s_mov_b32 m0, 110592
 s_add_u32 s54, s62, 3145728
 buffer_load_dwordx4 v0, s[20:23], s54 offen lds
 s_mov_b32 m0, 111616
 s_add_u32 s54, s62, 3162112
 buffer_load_dwordx4 v0, s[20:23], s54 offen lds
 s_mov_b32 m0, 112640
 s_add_u32 s54, s62, 3276800
 buffer_load_dwordx4 v0, s[20:23], s54 offen lds
 s_mov_b32 m0, 113664
 s_add_u32 s54, s62, 3293184
 buffer_load_dwordx4 v0, s[20:23], s54 offen lds
 ds_read_b64_tr_b16 v[240:241], v2 offset:24576
 ds_read_b64_tr_b16 v[242:243], v2 offset:25600
 ds_read_b64_tr_b16 v[244:245], v2 offset:26624
 ds_read_b64_tr_b16 v[246:247], v2 offset:27648
 ds_read_b64_tr_b16 a[8:9], v3 offset:24576
 ds_read_b64_tr_b16 a[10:11], v3 offset:25600
 ds_read_b64_tr_b16 a[12:13], v3 offset:26624
 ds_read_b64_tr_b16 a[14:15], v3 offset:27648
 s_waitcnt vmcnt(8) lgkmcnt(0)
 s_barrier
 s_mov_b32 m0, 114688
 s_add_u32 s54, s62, 3670016
 buffer_load_dwordx4 v0, s[20:23], s54 offen lds
 s_mov_b32 m0, 115712
 s_add_u32 s54, s62, 3686400
 buffer_load_dwordx4 v0, s[20:23], s54 offen lds
 s_mov_b32 m0, 116736
 s_add_u32 s54, s62, 3801088
 buffer_load_dwordx4 v0, s[20:23], s54 offen lds
 s_mov_b32 m0, 117760
 s_add_u32 s54, s62, 3817472
 buffer_load_dwordx4 v0, s[20:23], s54 offen lds
 ds_read_b64_tr_b16 a[24:25], v2 offset:28672
 ds_read_b64_tr_b16 a[26:27], v2 offset:29696
 ds_read_b64_tr_b16 a[28:29], v2 offset:30720
 ds_read_b64_tr_b16 a[30:31], v2 offset:31744
 ds_read_b64_tr_b16 v[24:25], v3 offset:28672
 ds_read_b64_tr_b16 v[26:27], v3 offset:29696
 ds_read_b64_tr_b16 v[28:29], v3 offset:30720
 ds_read_b64_tr_b16 v[30:31], v3 offset:31744
 s_waitcnt vmcnt(8) lgkmcnt(0)
 s_barrier
 s_mov_b32 m0, 118784
 s_add_u32 s54, s62, 4194304
 buffer_load_dwordx4 v0, s[20:23], s54 offen lds
 s_mov_b32 m0, 119808
 s_add_u32 s54, s62, 4210688
 buffer_load_dwordx4 v0, s[20:23], s54 offen lds
 s_mov_b32 m0, 120832
 s_add_u32 s54, s62, 4325376
 buffer_load_dwordx4 v0, s[20:23], s54 offen lds
 s_mov_b32 m0, 121856
 s_add_u32 s54, s62, 4341760
 buffer_load_dwordx4 v0, s[20:23], s54 offen lds
 v_mbcnt_lo_u32_b32 v8, -1, 0
 v_mbcnt_hi_u32_b32 v8, -1, v8
 v_lshlrev_b32 v4, 7, v8
 v_mov_b32 v5, 0
 v_bfe_u32 v9, v8, 2, 2
 s_mov_b32 s101, 2304
 v_mad_u32_u24 v5, v9, s101, v5
 v_bfe_u32 v9, v8, 0, 1
 s_mov_b32 s101, 1152
 v_mad_u32_u24 v5, v9, s101, v5
 v_bfe_u32 v9, v8, 1, 1
 v_lshl_add_u32 v5, v9, 6, v5
 v_bfe_u32 v9, v8, 4, 2
 v_lshl_add_u32 v5, v9, 4, v5
 s_mov_b32 m0, 4096
 s_mov_b32 s54, 256
 buffer_load_dwordx4 v5, s[32:35], s54 offen lds
 s_mov_b32 m0, 5120
 s_mov_b32 s54, 768
 buffer_load_dwordx4 v5, s[32:35], s54 offen lds
 s_mov_b32 m0, 8192
 s_mov_b32 s54, 1024
 buffer_load_dwordx4 v5, s[32:35], s54 offen lds
 ds_read_b64_tr_b16 a[32:33], v2 offset:32768
 ds_read_b64_tr_b16 a[34:35], v2 offset:33792
 ds_read_b64_tr_b16 a[36:37], v2 offset:34816
 ds_read_b64_tr_b16 a[38:39], v2 offset:35840
 ds_read_b64_tr_b16 a[64:65], v3 offset:32768
 ds_read_b64_tr_b16 a[66:67], v3 offset:33792
 ds_read_b64_tr_b16 a[68:69], v3 offset:34816
 ds_read_b64_tr_b16 a[70:71], v3 offset:35840
 s_waitcnt vmcnt(11) lgkmcnt(0)
 s_barrier
 s_mov_b32 m0, 122880
 s_add_u32 s54, s62, 2097152
 buffer_load_dwordx4 v0, s[24:27], s54 offen lds
 s_mov_b32 m0, 123904
 s_add_u32 s54, s62, 2113536
 buffer_load_dwordx4 v0, s[24:27], s54 offen lds
 s_mov_b32 m0, 124928
 s_add_u32 s54, s62, 2228224
 buffer_load_dwordx4 v0, s[24:27], s54 offen lds
 s_mov_b32 m0, 125952
 s_add_u32 s54, s62, 2244608
 buffer_load_dwordx4 v0, s[24:27], s54 offen lds
 s_mov_b32 s54, 128
 buffer_load_dwordx4 v[8:11], off, s[12:15], s54 sc1
 buffer_load_dwordx4 v[12:15], off, s[12:15], s54 offset:16 sc1
 ds_read_b64_tr_b16 v[16:17], v2 offset:20480
 ds_read_b64_tr_b16 v[18:19], v2 offset:21504
 ds_read_b64_tr_b16 v[20:21], v2 offset:22528
 ds_read_b64_tr_b16 v[22:23], v2 offset:23552
 ds_read_b64_tr_b16 a[48:49], v3 offset:20480
 ds_read_b64_tr_b16 a[50:51], v3 offset:21504
 ds_read_b64_tr_b16 a[52:53], v3 offset:22528
 ds_read_b64_tr_b16 a[54:55], v3 offset:23552
 s_waitcnt vmcnt(13) lgkmcnt(0)
 s_barrier
 s_mov_b32 m0, 110592
 s_add_u32 s54, s62, 2621440
 buffer_load_dwordx4 v0, s[24:27], s54 offen lds
 s_mov_b32 m0, 111616
 s_add_u32 s54, s62, 2637824
 buffer_load_dwordx4 v0, s[24:27], s54 offen lds
 s_mov_b32 m0, 112640
 s_add_u32 s54, s62, 2752512
 buffer_load_dwordx4 v0, s[24:27], s54 offen lds
 s_mov_b32 m0, 113664
 s_add_u32 s54, s62, 2768896
 buffer_load_dwordx4 v0, s[24:27], s54 offen lds
 ds_read_b64_tr_b16 a[40:41], v2 offset:24576
 ds_read_b64_tr_b16 a[42:43], v2 offset:25600
 ds_read_b64_tr_b16 a[44:45], v2 offset:26624
 ds_read_b64_tr_b16 a[46:47], v2 offset:27648
 ds_read_b64_tr_b16 a[72:73], v3 offset:24576
 ds_read_b64_tr_b16 a[74:75], v3 offset:25600
 ds_read_b64_tr_b16 a[76:77], v3 offset:26624
 ds_read_b64_tr_b16 a[78:79], v3 offset:27648
 s_waitcnt vmcnt(13) lgkmcnt(0)
 s_barrier
 s_mov_b32 m0, 114688
 s_add_u32 s54, s62, 3145728
 buffer_load_dwordx4 v0, s[24:27], s54 offen lds
 s_mov_b32 m0, 115712
 s_add_u32 s54, s62, 3162112
 buffer_load_dwordx4 v0, s[24:27], s54 offen lds
 s_mov_b32 m0, 116736
 s_add_u32 s54, s62, 3276800
 buffer_load_dwordx4 v0, s[24:27], s54 offen lds
 s_mov_b32 m0, 117760
 s_add_u32 s54, s62, 3293184
 buffer_load_dwordx4 v0, s[24:27], s54 offen lds
 ds_read_b64_tr_b16 a[16:17], v2 offset:28672
 ds_read_b64_tr_b16 a[18:19], v2 offset:29696
 ds_read_b64_tr_b16 a[20:21], v2 offset:30720
 ds_read_b64_tr_b16 a[22:23], v2 offset:31744
 ds_read_b64_tr_b16 a[56:57], v3 offset:28672
 ds_read_b64_tr_b16 a[58:59], v3 offset:29696
 ds_read_b64_tr_b16 a[60:61], v3 offset:30720
 ds_read_b64_tr_b16 a[62:63], v3 offset:31744
 s_waitcnt vmcnt(10) lgkmcnt(0)
 s_barrier
 s_mov_b32 m0, 118784
 s_add_u32 s54, s62, 3670016
 buffer_load_dwordx4 v0, s[24:27], s54 offen lds
 s_mov_b32 m0, 119808
 s_add_u32 s54, s62, 3686400
 buffer_load_dwordx4 v0, s[24:27], s54 offen lds
 s_mov_b32 m0, 120832
 s_add_u32 s54, s62, 3801088
 buffer_load_dwordx4 v0, s[24:27], s54 offen lds
 s_mov_b32 m0, 121856
 s_add_u32 s54, s62, 3817472
 buffer_load_dwordx4 v0, s[24:27], s54 offen lds
 ds_read_b64_tr_b16 a[104:105], v2 offset:32768
 ds_read_b64_tr_b16 a[106:107], v2 offset:33792
 ds_read_b64_tr_b16 a[108:109], v2 offset:34816
 ds_read_b64_tr_b16 a[110:111], v2 offset:35840
 ds_read_b64_tr_b16 a[112:113], v3 offset:32768
 ds_read_b64_tr_b16 a[114:115], v3 offset:33792
 ds_read_b64_tr_b16 a[116:117], v3 offset:34816
 ds_read_b64_tr_b16 a[118:119], v3 offset:35840
 s_waitcnt vmcnt(8) lgkmcnt(0)
 s_barrier
 s_mov_b32 m0, 122880
 s_add_u32 s54, s62, 4194304
 buffer_load_dwordx4 v0, s[24:27], s54 offen lds
 s_mov_b32 m0, 123904
 s_add_u32 s54, s62, 4210688
 buffer_load_dwordx4 v0, s[24:27], s54 offen lds
 s_mov_b32 m0, 124928
 s_add_u32 s54, s62, 4325376
 buffer_load_dwordx4 v0, s[24:27], s54 offen lds
 s_mov_b32 m0, 125952
 s_add_u32 s54, s62, 4341760
 buffer_load_dwordx4 v0, s[24:27], s54 offen lds
 s_branch RSC_203
RSB_201:
 s_cmp_lt_u32 s49, 1
 s_cbranch_scc1 RSE_202
 s_sub_u32 s49, s49, 1
 s_mov_b32 s54, 128
 buffer_load_dwordx4 v[8:11], off, s[12:15], s54 sc1
 buffer_load_dwordx4 v[12:15], off, s[12:15], s54 offset:16 sc1
 s_waitcnt vmcnt(0)
RSC_203:
 v_add3_u32 v7, v8, v9, v10
 v_add3_u32 v7, v7, v11, v12
 v_add3_u32 v7, v7, v13, v14
 v_add_u32 v7, v7, v15
 v_cmp_gt_u32 vcc, 32, v7
 s_cbranch_vccnz RSB_201
RSE_202:
 v_max3_u32 v8, v8, v9, v10
 v_max3_u32 v8, v8, v11, v12
 v_max3_u32 v8, v8, v13, v14
 v_max_u32 v8, v8, v15
 s_nop 0
 v_readfirstlane_b32 s64, v8
 s_mov_b32 m0, 11264
 v_and_b32 v4, 0x780, v4
 s_lshl_b32 s54, s3, 11
 s_add_u32 s54, s54, 1048576
 buffer_load_dword v4, s[8:11], s54 offen sc1 lds
 ds_read_b64_tr_b16 a[120:121], v2 offset:20480
 ds_read_b64_tr_b16 a[122:123], v2 offset:21504
 ds_read_b64_tr_b16 a[124:125], v2 offset:22528
 ds_read_b64_tr_b16 a[126:127], v2 offset:23552
 ds_read_b64_tr_b16 v[40:41], v3 offset:20480
 ds_read_b64_tr_b16 v[42:43], v3 offset:21504
 ds_read_b64_tr_b16 v[44:45], v3 offset:22528
 ds_read_b64_tr_b16 v[46:47], v3 offset:23552
 s_waitcnt vmcnt(9) lgkmcnt(0)
 s_barrier
 ds_read_b64_tr_b16 a[80:81], v2 offset:24576
 ds_read_b64_tr_b16 a[82:83], v2 offset:25600
 ds_read_b64_tr_b16 a[84:85], v2 offset:26624
 ds_read_b64_tr_b16 a[86:87], v2 offset:27648
 ds_read_b64_tr_b16 a[88:89], v3 offset:24576
 ds_read_b64_tr_b16 a[90:91], v3 offset:25600
 ds_read_b64_tr_b16 a[92:93], v3 offset:26624
 ds_read_b64_tr_b16 a[94:95], v3 offset:27648
 s_waitcnt vmcnt(5) lgkmcnt(0)
 s_barrier
 ds_read_b64_tr_b16 a[128:129], v2 offset:28672
 ds_read_b64_tr_b16 a[130:131], v2 offset:29696
 ds_read_b64_tr_b16 a[132:133], v2 offset:30720
 ds_read_b64_tr_b16 a[134:135], v2 offset:31744
 ds_read_b64_tr_b16 a[136:137], v3 offset:28672
 ds_read_b64_tr_b16 a[138:139], v3 offset:29696
 ds_read_b64_tr_b16 a[140:141], v3 offset:30720
 ds_read_b64_tr_b16 a[142:143], v3 offset:31744
 s_waitcnt vmcnt(1) lgkmcnt(0)
 s_barrier
 ds_read_b64_tr_b16 v[32:33], v2 offset:32768
 ds_read_b64_tr_b16 v[34:35], v2 offset:33792
 ds_read_b64_tr_b16 v[36:37], v2 offset:34816
 ds_read_b64_tr_b16 v[38:39], v2 offset:35840
 ds_read_b64_tr_b16 a[96:97], v3 offset:32768
 ds_read_b64_tr_b16 a[98:99], v3 offset:33792
 ds_read_b64_tr_b16 a[100:101], v3 offset:34816
 ds_read_b64_tr_b16 a[102:103], v3 offset:35840
 s_waitcnt lgkmcnt(0)
 s_barrier
 ds_write_b128 v1, v[16:19] offset:20480
 ds_write_b128 v1, v[20:23] offset:21504
 ds_write_b128 v1, v[24:27] offset:22528
 ds_write_b128 v1, v[28:31] offset:23552
 ds_write_b128 v1, v[32:35] offset:24576
 ds_write_b128 v1, v[36:39] offset:25600
 ds_write_b128 v1, v[40:43] offset:26624
 ds_write_b128 v1, v[44:47] offset:27648
 ds_write_b128 v1, v[48:51] offset:28672
 ds_write_b128 v1, v[52:55] offset:29696
 ds_write_b128 v1, v[56:59] offset:30720
 ds_write_b128 v1, v[60:63] offset:31744
 ds_write_b128 v1, v[64:67] offset:32768
 ds_write_b128 v1, v[68:71] offset:33792
 ds_write_b128 v1, v[72:75] offset:34816
 ds_write_b128 v1, v[76:79] offset:35840
 v_mbcnt_lo_u32_b32 v8, -1, 0
 v_mbcnt_hi_u32_b32 v8, -1, v8
 v_lshlrev_b32 v0, 4, v8
 v_lshrrev_b32 v6, 4, v8
 v_xor_b32 v6, v6, v8
 v_lshlrev_b32 v6, 3, v6
 ds_read_b128 v[32:35], v0 offset:4096
 ds_read_b128 v[36:39], v0 offset:5120
 ds_read_b128 v[40:43], v0 offset:8192
 v_mov_b32 v2, 17476
 v_bfe_u32 v9, v8, 1, 1
 s_mov_b32 s101, 43690
 v_mad_u32_u24 v2, v9, s101, v2
 v_mov_b32 v4, 0
 v_bfe_u32 v9, v8, 4, 2
 v_lshl_add_u32 v4, v9, 8, v4
 v_bfe_u32 v9, v8, 2, 2
 v_lshl_add_u32 v4, v9, 5, v4
 v_bfe_u32 v9, v8, 0, 1
 v_lshl_add_u32 v4, v9, 4, v4
 v_mov_b32 v3, v4
 v_bfe_u32 v9, v8, 1, 1
 v_lshl_add_u32 v3, v9, 7, v3
 v_mov_b32 v5, 0
 v_bfe_u32 v9, v8, 0, 4
 v_lshl_add_u32 v5, v9, 5, v5
 v_bfe_u32 v9, v8, 4, 2
 v_lshl_add_u32 v5, v9, 3, v5
 v_mov_b32 v10, 0
 v_bfe_u32 v9, v8, 2, 2
 v_lshl_add_u32 v10, v9, 3, v10
 v_xor_b32 v5, v5, v10
 s_lshl_b32 s54, s60, 7
 s_add_u32 s54, s54, s59
 v_mov_b32 v7, s54
 v_bfe_u32 v9, v8, 3, 3
 s_mov_b32 s101, 9344
 v_mad_u32_u24 v7, v9, s101, v7
 v_bfe_u32 v9, v8, 0, 3
 v_lshl_add_u32 v7, v9, 4, v7
 s_lshl_b32 s54, s55, 29
 v_or_b32 v7, s54, v7
 s_cmp_eq_u32 s64, 32
 s_cbranch_scc0 RECM2
 ds_read_b128 v[8:11], v1 offset:0
 ds_read_b128 v[12:15], v1 offset:1024
 ds_read_b128 v[16:19], v1 offset:2048
 ds_read_b128 v[20:23], v1 offset:3072
 ds_read_b128 v[24:27], v1 offset:4096
 ds_read_b128 v[28:31], v1 offset:5120
 ds_read_b128 v[44:47], v1 offset:6144
 ds_read_b128 v[48:51], v1 offset:7168
 v_mov_b64 v[60:61], 0
 v_mov_b64 v[62:63], 0
 v_mov_b64 v[64:65], 0
 v_mov_b64 v[66:67], 0
 v_mov_b64 v[68:69], 0
 v_mov_b64 v[70:71], 0
 v_mov_b64 v[72:73], 0
 v_mov_b64 v[74:75], 0
 v_mov_b64 v[52:53], 0
 v_mov_b64 v[54:55], 0
 v_mov_b64 v[56:57], 0
 v_mov_b64 v[58:59], 0
 ds_read_b32 v76, v0 offset:13320
 s_mov_b32 s66, -1
 s_waitcnt lgkmcnt(0)
 s_branch R20STEP
.p2align 8
 s_nop 0
 s_nop 0
 s_nop 0
 s_nop 0
 s_nop 0
R20TOP:
 buffer_load_dwordx4 v[32:35], v0, s[8:11], s43 offen sc1
 s_sub_u32 s49, s49, 1
 s_cselect_b32 s49, 0, s49
 s_cselect_b32 s66, -1, -2
 s_cselect_b32 s67, 1, 0
R20TW:
 s_waitcnt vmcnt(1) lgkmcnt(0)
 v_max3_u32 v77, v32, v33, v34
 v_max_u32 v77, v35, v77
 ds_write_b128 v0, v[32:35] offset:4096
 v_cmp_lt_u32 vcc, s66, v77
 s_cbranch_vccnz R20TOP
 buffer_load_dwordx4 v[36:39], v0, s[8:11], s63 offen sc1
 buffer_load_dwordx4 v[40:43], v0, s[8:11], s44 offen sc1
R20STEP:
 v_smfmac_f32_16x16x64_bf16 v[60:63], v[32:35], v[8:15], v2
 v_smfmac_f32_16x16x64_bf16 v[64:67], v[32:35], v[16:23], v2
 s_waitcnt lgkmcnt(0)
 s_barrier
 ds_read_b128 v[8:11], v0 offset:0
 v_smfmac_f32_16x16x64_bf16 v[68:71], v[32:35], v[24:31], v2
 ds_read_b128 v[12:15], v0 offset:2048
 ds_read_b128 v[16:19], v0 offset:6144
 v_smfmac_f32_16x16x64_bf16 v[72:75], v[32:35], v[44:51], v2
 ds_read_b128 v[24:27], v1 offset:8192
 v_mov_b64 v[20:21], -1
 v_smfmac_f32_16x16x64_bf16 v[52:55], v[32:35], v[80:87], v2
 ds_read_b128 v[28:31], v1 offset:9216
 ds_read_b128 v[44:47], v1 offset:10240
 v_smfmac_f32_16x16x64_bf16 v[56:59], v[32:35], v[88:95], v2
 ds_read_b128 v[48:51], v1 offset:11264
 s_waitcnt lgkmcnt(6)
 v_smfmac_f32_16x16x64_bf16 v[60:63], v[8:11], v[96:103], v2
 buffer_load_dwordx4 v[32:35], v3, s[8:11], s47 offen offset:0 sc1
 v_smfmac_f32_16x16x64_bf16 v[64:67], v[8:11], v[104:111], v2
 buffer_store_dwordx2 v[20:21], v76, s[8:11], s46 offen
 v_smfmac_f32_16x16x64_bf16 v[68:71], v[8:11], v[112:119], v2
 s_waitcnt lgkmcnt(2)
 v_smfmac_f32_16x16x64_bf16 v[72:75], v[8:11], v[24:31], v2
 v_smfmac_f32_16x16x64_bf16 v[52:55], v[8:11], v[120:127], v2
 ds_read_b128 v[24:27], v1 offset:12288
 s_waitcnt lgkmcnt(1)
 v_smfmac_f32_16x16x64_bf16 v[56:59], v[8:11], v[44:51], v2
 ds_read_b128 v[28:31], v1 offset:13312
 v_smfmac_f32_16x16x64_bf16 v[60:63], v[12:15], v[128:135], v2
 buffer_load_dwordx4 v[8:11], v3, s[8:11], s47 offen offset:1024 sc1
 ds_read_b128 v[44:47], v1 offset:14336
 v_smfmac_f32_16x16x64_bf16 v[64:67], v[12:15], v[136:143], v2
 ds_read_b128 v[48:51], v1 offset:15360
 v_smfmac_f32_16x16x64_bf16 v[68:71], v[12:15], v[144:151], v2
 ds_read_b64_tr_b16 v[76:77], v6 offset:11264
 v_smfmac_f32_16x16x64_bf16 v[72:75], v[12:15], v[152:159], v2
 s_waitcnt lgkmcnt(3)
 v_smfmac_f32_16x16x64_bf16 v[52:55], v[12:15], v[24:31], v2
 v_smfmac_f32_16x16x64_bf16 v[56:59], v[12:15], v[160:167], v2
 ds_read_b128 v[24:27], v1 offset:16384
 v_smfmac_f32_16x16x64_bf16 v[60:63], v[16:19], v[168:175], v2
 buffer_load_dwordx4 v[12:15], v0, s[8:11], s47 offen offset:2048 sc1
 ds_read_b128 v[28:31], v1 offset:17408
 s_waitcnt lgkmcnt(3)
 v_smfmac_f32_16x16x64_bf16 v[64:67], v[16:19], v[44:51], v2
 s_waitcnt vmcnt(5)
 ds_write_b128 v0, v[36:39] offset:5120
 v_max3_u32 v20, v36, v37, v38
 v_smfmac_f32_16x16x64_bf16 v[68:71], v[16:19], v[176:183], v2
 ds_read_b128 v[44:47], v1 offset:18432
 v_smfmac_f32_16x16x64_bf16 v[72:75], v[16:19], v[184:191], v2
 ds_read_b128 v[48:51], v1 offset:19456
 s_waitcnt vmcnt(4)
 v_max3_u32 v20, v39, v40, v20
 v_max3_u32 v21, v41, v42, v43
 v_smfmac_f32_16x16x64_bf16 v[52:55], v[16:19], v[192:199], v2
 s_waitcnt lgkmcnt(3)
 v_max_u32 v20, v21, v20
 v_cmp_lt_u32 vcc, s66, v20
 v_smfmac_f32_16x16x64_bf16 v[56:59], v[16:19], v[24:31], v2
 s_cbranch_vccnz R20PB
R20B:
 v_smfmac_f32_16x16x64_bf16 v[60:63], v[36:39], v[200:207], v2
 buffer_load_dwordx4 v[16:19], v0, s[8:11], s47 offen offset:3072 sc1
 s_waitcnt lgkmcnt(2)
 s_barrier
 ds_read_b128 v[20:23], v0 offset:1024
 v_smfmac_f32_16x16x64_bf16 v[64:67], v[36:39], v[208:215], v2
 ds_read_b128 v[24:27], v0 offset:3072
 ds_read_b128 v[28:31], v0 offset:7168
 v_smfmac_f32_16x16x64_bf16 v[60:63], v[40:43], v[216:223], v2
 s_add_u32 s47, s47, 524288
 s_waitcnt lgkmcnt(3)
 v_smfmac_f32_16x16x64_bf16 v[64:67], v[40:43], v[44:51], v2
 s_add_u32 s45, s45, 0x4000
 s_waitcnt lgkmcnt(2)
 v_smfmac_f32_16x16x64_bf16 v[60:63], v[20:23], v[224:231], v2
 ds_read_b128 v[44:47], v1 offset:20480
 s_waitcnt lgkmcnt(2)
 v_smfmac_f32_16x16x64_bf16 v[60:63], v[24:27], v[232:239], v2
 ds_read_b128 v[48:51], v1 offset:21504
 s_waitcnt lgkmcnt(2)
 v_smfmac_f32_16x16x64_bf16 v[60:63], v[28:31], v[240:247], v2
 v_smfmac_f32_16x16x64_bf16 v[64:67], v[20:23], v[248:255], v2
 s_bitset0_b32 s45, 16
 s_add_u32 s44, s45, 8192
 v_smfmac_f32_16x16x64_bf16 v[64:67], v[24:27], a[0:7], v2
 v_mul_f32 v60, s50, v60
 v_mul_f32 v61, s50, v61
 v_smfmac_f32_16x16x64_bf16 v[64:67], v[28:31], a[8:15], v2
 s_add_u32 s43, s45, 2048
 s_add_u32 s63, s45, 6144
 v_fmac_f32 v60, s50, v62
 v_fmac_f32 v61, s50, v63
 s_waitcnt lgkmcnt(0)
 v_smfmac_f32_16x16x64_bf16 v[68:71], v[36:39], v[44:51], v2
 s_cmp_ge_u32 s36, 62
 s_cbranch_scc1 R20KS
 buffer_store_dwordx4 v[76:79], v0, s[8:11], s48 offen nt
R20KR:
 v_cvt_pk_bf16_f32 v60, v60, v61
 v_smfmac_f32_16x16x64_bf16 v[68:71], v[40:43], a[16:23], v2
 ds_read_b128 v[44:47], v1 offset:22528
 v_mul_f32 v64, s50, v64
 v_mul_f32 v65, s50, v65
 v_fmac_f32 v64, s50, v66
 v_smfmac_f32_16x16x64_bf16 v[68:71], v[20:23], a[24:31], v2
 ds_read_b128 v[48:51], v1 offset:23552
 v_fmac_f32 v65, s50, v67
 v_cvt_pk_bf16_f32 v61, v64, v65
 ds_write_b64 v5, v[60:61] offset:9216
 v_smfmac_f32_16x16x64_bf16 v[68:71], v[24:27], a[32:39], v2
 v_smfmac_f32_16x16x64_bf16 v[68:71], v[28:31], a[40:47], v2
 s_xor_b32 s46, s45, 0x8000
 s_and_b32 s65, s36, 1
 v_smfmac_f32_16x16x64_bf16 v[72:75], v[36:39], a[48:55], v2
 v_smfmac_f32_16x16x64_bf16 v[72:75], v[40:43], a[56:63], v2
 s_waitcnt lgkmcnt(1)
 v_add_f32 v68, v68, v70
 v_smfmac_f32_16x16x64_bf16 v[72:75], v[20:23], v[44:51], v2
 s_waitcnt lgkmcnt(0)
 s_barrier
 ds_read_b64_tr_b16 v[60:61], v6 offset:8192
 ds_read_b64_tr_b16 v[62:63], v6 offset:8704
 v_add_f32 v69, v69, v71
 v_smfmac_f32_16x16x64_bf16 v[72:75], v[24:27], a[64:71], v2
 ds_read_b64_tr_b16 v[64:65], v6 offset:9216
 ds_read_b64_tr_b16 v[66:67], v6 offset:9728
 ds_read_b128 v[44:47], v1 offset:24576
 v_cvt_pk_bf16_f32 v68, v68, v69
 v_smfmac_f32_16x16x64_bf16 v[72:75], v[28:31], a[72:79], v2
 ds_read_b128 v[48:51], v1 offset:25600
 v_smfmac_f32_16x16x64_bf16 v[52:55], v[36:39], a[80:87], v2
 s_waitcnt vmcnt(5) lgkmcnt(4)
 v_mfma_f32_16x16x32_bf16 v[76:79], v[32:35], v[60:63], 0
 s_waitcnt vmcnt(3) lgkmcnt(2)
 v_add_f32 v72, v72, v74
 v_add_f32 v73, v73, v75
 v_mfma_f32_16x16x32_bf16 v[76:79], v[8:11], v[64:67], v[76:79]
 v_cvt_pk_bf16_f32 v69, v72, v73
 ds_write_b64 v5, v[68:69] offset:11264
 v_smfmac_f32_16x16x64_bf16 v[56:59], v[36:39], a[88:95], v2
 s_add_u32 s48, s48, 131072
 s_waitcnt lgkmcnt(1)
 v_smfmac_f32_16x16x64_bf16 v[52:55], v[40:43], v[44:51], v2
 ds_read_b128 v[36:39], v0 offset:15360
 v_add_f32_dpp v76, v78, v76 quad_perm:[2,3,0,1] row_mask:0xf bank_mask:0xf
 v_add_f32_dpp v77, v79, v77 quad_perm:[2,3,0,1] row_mask:0xf bank_mask:0xf
 v_smfmac_f32_16x16x64_bf16 v[56:59], v[40:43], a[96:103], v2
 ds_read_b128 v[44:47], v1 offset:26624
 v_exp_f32_dpp v78, v76 quad_perm:[0,1,0,1] row_mask:0xf bank_mask:0xf
 v_exp_f32_dpp v79, v77 quad_perm:[0,1,0,1] row_mask:0xf bank_mask:0xf
 v_smfmac_f32_16x16x64_bf16 v[52:55], v[20:23], a[104:111], v2
 ds_read_b128 v[48:51], v1 offset:27648
 v_cvt_pk_bf16_f32 v78, v78, v79
 ds_write_b32 v0, v78 offset:14344
 v_smfmac_f32_16x16x64_bf16 v[56:59], v[20:23], a[112:119], v2
 s_waitcnt lgkmcnt(4)
 s_barrier
 ds_read_b64_tr_b16 v[68:69], v6 offset:10240
 ds_read_b64_tr_b16 v[70:71], v6 offset:10752
 v_mov_b32 v33, 0
 v_smfmac_f32_16x16x64_bf16 v[52:55], v[24:27], a[120:127], v2
 ds_read_b64_tr_b16 v[72:73], v6 offset:11264
 ds_read_b64_tr_b16 v[74:75], v6 offset:11776
 v_mov_b32 v34, 0
 v_smfmac_f32_16x16x64_bf16 v[52:55], v[28:31], a[128:135], v2
 s_waitcnt lgkmcnt(5)
 v_smfmac_f32_16x16x64_bf16 v[56:59], v[24:27], v[44:51], v2
 s_waitcnt lgkmcnt(2)
 v_mfma_f32_16x16x32_bf16 v[40:43], v[68:71], v[60:63], 0
 s_barrier
 ds_read_b128 v[8:11], v0 offset:14336
 v_add_f32 v52, v52, v54
 v_add_f32 v53, v53, v55
 s_waitcnt lgkmcnt(1)
 v_mfma_f32_16x16x32_bf16 v[40:43], v[72:75], v[64:67], v[40:43]
 s_cmp_eq_u32 s36, 63
 v_cvt_pk_bf16_f32 v78, v52, v53
 v_smfmac_f32_16x16x64_bf16 v[56:59], v[28:31], a[136:143], v2
 s_waitcnt lgkmcnt(0)
 s_nop 2
 v_add_f32_dpp v40, v42, v40 quad_perm:[2,3,0,1] row_mask:0xf bank_mask:0xf
 v_add_f32_dpp v41, v43, v41 quad_perm:[2,3,0,1] row_mask:0xf bank_mask:0xf
 v_mfma_f32_16x16x32_bf16 v[72:75], v[36:39], v[8:11], 0
 ds_read_b128 v[24:27], v1 offset:28672
 v_exp_f32_dpp v42, v40 quad_perm:[0,1,0,1] row_mask:0xf bank_mask:0xf
 v_exp_f32_dpp v43, v41 quad_perm:[0,1,0,1] row_mask:0xf bank_mask:0xf
 s_waitcnt vmcnt(2)
 v_mfma_f32_16x16x32_bf16 v[44:47], v[12:15], v[8:11], 0
 ds_read_b128 v[28:31], v1 offset:29696
 v_cvt_pk_bf16_f32 v32, v42, v43
 v_cvt_pk_bf16_f32 v35, v42, v43
 v_add_f32 v56, v56, v58
 v_add_f32 v57, v57, v59
 v_mfma_f32_16x16x16_bf16 v[72:75], v[36:37], v[32:33], v[72:75]
 s_waitcnt vmcnt(1)
 v_cvt_pk_bf16_f32 v79, v56, v57
 v_mfma_f32_16x16x32_bf16 v[48:51], v[16:19], v[8:11], 0
 s_cbranch_scc1 R20TAIL
 v_mov_b64 v[68:69], 0
 v_mov_b64 v[70:71], 0
 v_mfma_f32_16x16x16_bf16 v[44:47], v[78:79], v[32:33], v[44:47]
 v_rcp_f32 v72, v72
 v_subrev_u32 v74, s52, v74
 v_mfma_f32_16x16x16_bf16 v[48:51], v[78:79], v[34:35], v[48:51]
 v_cmp_le_u32 vcc, s53, v74
 v_mov_b64 v[52:53], 0
 v_mov_b64 v[54:55], 0
R20RJ:
 s_nop 0
 v_pk_mul_f32 v[44:45], v[44:45], v[72:73] op_sel_hi:[1,0]
 v_pk_mul_f32 v[46:47], v[46:47], v[72:73] op_sel_hi:[1,0]
 s_cbranch_vccnz R20FB
 v_cvt_pk_bf16_f32 v40, v44, v45
 v_cvt_pk_bf16_f32 v41, v46, v47
 v_pk_mul_f32 v[48:49], v[48:49], v[72:73] op_sel_hi:[1,0]
 v_pk_mul_f32 v[50:51], v[50:51], v[72:73] op_sel_hi:[1,0]
 v_cvt_pk_bf16_f32 v42, v48, v49
 v_cvt_pk_bf16_f32 v43, v50, v51
 ds_write_b128 v4, v[40:43] offset:9216
 s_waitcnt lgkmcnt(1)
 v_smfmac_f32_16x16x64_bf16 v[68:71], v[40:43], v[24:31], v2
 v_mov_b64 v[56:57], 0
 v_mov_b64 v[58:59], 0
 v_smfmac_f32_16x16x64_bf16 v[52:55], v[40:43], a[144:151], v2
 v_mov_b64 v[64:65], 0
 v_mov_b64 v[66:67], 0
 v_smfmac_f32_16x16x64_bf16 v[56:59], v[40:43], a[152:159], v2
 s_waitcnt lgkmcnt(0)
 s_barrier
 ds_read_b128 v[32:35], v4 offset:8192
 ds_read_b128 v[36:39], v4 offset:8320
 ds_read_b128 v[72:75], v4 offset:9344
 v_mov_b64 v[60:61], 0
 v_mov_b64 v[62:63], 0
 v_smfmac_f32_16x16x64_bf16 v[64:67], v[40:43], a[160:167], v2
 s_waitcnt lgkmcnt(2)
 v_smfmac_f32_16x16x64_bf16 v[68:71], v[32:35], a[168:175], v2
 ds_read_b128 v[44:47], v3 offset:8192
 s_waitcnt lgkmcnt(2)
 v_lshrrev_b32 v40, 2, v0
 v_smfmac_f32_16x16x64_bf16 v[68:71], v[36:39], a[176:183], v2
 ds_read_b128 v[48:51], v3 offset:9216
 s_waitcnt lgkmcnt(2)
 v_smfmac_f32_16x16x64_bf16 v[68:71], v[72:75], a[184:191], v2
 ds_read_b128 v[24:27], v1 offset:30720
 v_smfmac_f32_16x16x64_bf16 v[52:55], v[32:35], a[192:199], v2
 ds_read_b128 v[28:31], v1 offset:31744
 v_smfmac_f32_16x16x64_bf16 v[52:55], v[36:39], a[200:207], v2
 ds_read_b128 v[8:11], v1 offset:32768
 v_cvt_pk_bf16_f32 v68, v68, v69
 v_smfmac_f32_16x16x64_bf16 v[52:55], v[72:75], a[208:215], v2
 ds_read_b128 v[12:15], v1 offset:33792
 s_waitcnt lgkmcnt(5)
 v_cvt_pk_bf16_f32 v69, v70, v71
 v_smfmac_f32_16x16x64_bf16 v[60:63], v[44:47], a[216:223], v2
 ds_read_b128 v[16:19], v1 offset:34816
 s_waitcnt lgkmcnt(5)
 v_and_or_b32 v68, v68, -2, s65
 v_smfmac_f32_16x16x64_bf16 v[60:63], v[48:51], a[224:231], v2
 ds_read_b128 v[20:23], v1 offset:35840
 v_cvt_pk_bf16_f32 v70, v52, v53
 v_cvt_pk_bf16_f32 v71, v54, v55
 buffer_store_dwordx4 v[68:71], v0, s[8:11], s37 offen
 v_smfmac_f32_16x16x64_bf16 v[56:59], v[32:35], a[232:239], v2
 ds_read_b32 v76, v0 offset:13320
 s_waitcnt lgkmcnt(5)
 v_smfmac_f32_16x16x64_bf16 v[56:59], v[36:39], v[24:31], v2
 s_add_u32 s36, s36, 1
 v_add_f32 v60, v60, v62
 v_smfmac_f32_16x16x64_bf16 v[56:59], v[72:75], a[240:247], v2
 s_waitcnt lgkmcnt(3)
 v_add_f32 v61, v61, v63
 v_smfmac_f32_16x16x64_bf16 v[64:67], v[32:35], v[8:15], v2
 v_cvt_pk_bf16_f32 v41, v60, v61
 v_smfmac_f32_16x16x64_bf16 v[64:67], v[36:39], a[248:255], v2
 s_waitcnt lgkmcnt(1)
 v_and_or_b32 v41, v41, -2, s65
 v_smfmac_f32_16x16x64_bf16 v[64:67], v[72:75], v[16:23], v2
 buffer_store_dword v41, v40, s[8:11], s38 offen
 v_cvt_pk_bf16_f32 v56, v56, v57
 v_cvt_pk_bf16_f32 v57, v58, v59
 v_and_or_b32 v56, v56, -2, s65
 s_nop 3
 v_cvt_pk_bf16_f32 v58, v64, v65
 v_cvt_pk_bf16_f32 v59, v66, v67
 buffer_store_dwordx4 v[56:59], v0, s[8:11], s37 offen offset:1024
R20HOP:
 s_cmp_lg_u32 s55, 0
 s_cbranch_scc1 R20NQ
 ds_read_b128 v[40:43], v0 offset:12288
 s_sub_u32 s49, s49, 1
 s_cselect_b32 s49, 0, s49
 s_cselect_b32 s66, -1, -2
 s_cselect_b32 s67, 1, 0
 s_waitcnt vmcnt(0)
 buffer_load_dwordx4 v[60:63], v7, s[8:11], s39 offen sc1
 buffer_load_dwordx4 v[64:67], v7, s[8:11], s40 offen sc1
 buffer_load_dwordx4 v[68:71], v7, s[8:11], s41 offen sc1
 buffer_load_dwordx4 v[72:75], v7, s[8:11], s42 offen sc1
R20P1:
 s_waitcnt vmcnt(3)
 s_waitcnt lgkmcnt(0)
 v_mfma_f32_16x16x32_bf16 v[36:39], v[40:43], v[60:63], 0
 s_waitcnt vmcnt(2)
 v_mfma_f32_16x16x32_bf16 v[36:39], v[40:43], v[64:67], v[36:39]
 v_bitop3_b32 v60, v60, v64, s65 bitop3:0x7e
 s_waitcnt vmcnt(1)
 v_mfma_f32_16x16x32_bf16 v[36:39], v[40:43], v[68:71], v[36:39]
 s_waitcnt vmcnt(0)
 v_mfma_f32_16x16x32_bf16 v[36:39], v[40:43], v[72:75], v[36:39]
 v_bitop3_b32 v64, v68, v72, s65 bitop3:0x7e
 v_bitop3_b32 v60, v60, v64, 1 bitop3:0xa8
 v_cmp_lt_u32 vcc, s67, v60
 s_cbranch_vccnz R20R1
 s_nop 3
 v_add_f32_dpp v36, v36, v36 row_ror:8 row_mask:0xf bank_mask:0xf
 v_add_f32_dpp v37, v37, v37 row_ror:8 row_mask:0xf bank_mask:0xf
 v_add_f32_dpp v38, v38, v38 row_ror:8 row_mask:0xf bank_mask:0xf
 v_add_f32_dpp v39, v39, v39 row_ror:8 row_mask:0xf bank_mask:0xf
 v_cvt_pk_bf16_f32 v36, v36, v37
 v_cvt_pk_bf16_f32 v37, v38, v39
 buffer_store_dwordx2 v[36:37], v76, s[8:11], s45 offen
 s_barrier
 v_mov_b64 v[60:61], 0
 v_mov_b64 v[62:63], 0
 v_mov_b64 v[64:65], 0
 v_mov_b64 v[66:67], 0
 v_mov_b64 v[68:69], 0
 v_mov_b64 v[70:71], 0
 v_mov_b64 v[72:73], 0
 v_mov_b64 v[74:75], 0
 buffer_load_dwordx4 v[32:35], v0, s[8:11], s43 offen sc1
 ds_read_b128 v[8:11], v1 offset:0
 ds_read_b128 v[12:15], v1 offset:1024
 ds_read_b128 v[16:19], v1 offset:2048
 ds_read_b128 v[20:23], v1 offset:3072
 v_mov_b64 v[52:53], 0
 v_mov_b64 v[54:55], 0
 ds_read_b128 v[24:27], v1 offset:4096
 ds_read_b128 v[28:31], v1 offset:5120
 ds_read_b128 v[44:47], v1 offset:6144
 ds_read_b128 v[48:51], v1 offset:7168
 v_mov_b64 v[56:57], 0
 v_mov_b64 v[58:59], 0
 s_branch R20TOP
R20PB:
 buffer_load_dwordx4 v[36:39], v0, s[8:11], s63 offen sc1
 buffer_load_dwordx4 v[40:43], v0, s[8:11], s44 offen sc1
 s_sub_u32 s49, s49, 1
 s_cselect_b32 s49, 0, s49
 s_cselect_b32 s66, -1, -2
 s_cselect_b32 s67, 1, 0
 s_waitcnt vmcnt(0)
 v_max3_u32 v20, v36, v37, v38
 v_max3_u32 v20, v39, v40, v20
 v_max3_u32 v21, v41, v42, v43
 v_max_u32 v20, v21, v20
 v_cmp_lt_u32 vcc, s66, v20
 ds_write_b128 v0, v[36:39] offset:5120
 s_cbranch_vccnz R20PB
 s_waitcnt lgkmcnt(0)
 s_branch R20B
R20KS:
 s_waitcnt lgkmcnt(0)
 buffer_store_dwordx4 v[76:79], v0, s[8:11], s48 offen sc1
 s_branch R20KR
R20R1:
 buffer_load_dwordx4 v[60:63], v7, s[8:11], s39 offen sc1
 buffer_load_dwordx4 v[64:67], v7, s[8:11], s40 offen sc1
 buffer_load_dwordx4 v[68:71], v7, s[8:11], s41 offen sc1
 buffer_load_dwordx4 v[72:75], v7, s[8:11], s42 offen sc1
 s_sub_u32 s49, s49, 1
 s_cselect_b32 s49, 0, s49
 s_cselect_b32 s66, -1, -2
 s_cselect_b32 s67, 1, 0
 s_waitcnt vmcnt(0)
 s_branch R20P1
R20NQ:
 s_barrier
 v_mov_b64 v[60:61], 0
 v_mov_b64 v[62:63], 0
 v_mov_b64 v[64:65], 0
 v_mov_b64 v[66:67], 0
 v_mov_b64 v[68:69], 0
 v_mov_b64 v[70:71], 0
 v_mov_b64 v[72:73], 0
 v_mov_b64 v[74:75], 0
 buffer_load_dwordx4 v[32:35], v0, s[8:11], s43 offen sc1
 ds_read_b128 v[8:11], v1 offset:0
 ds_read_b128 v[12:15], v1 offset:1024
 ds_read_b128 v[16:19], v1 offset:2048
 ds_read_b128 v[20:23], v1 offset:3072
 v_mov_b64 v[52:53], 0
 v_mov_b64 v[54:55], 0
 ds_read_b128 v[24:27], v1 offset:4096
 ds_read_b128 v[28:31], v1 offset:5120
 ds_read_b128 v[44:47], v1 offset:6144
 ds_read_b128 v[48:51], v1 offset:7168
 v_mov_b64 v[56:57], 0
 v_mov_b64 v[58:59], 0
 s_branch R20TOP
R20TAIL:
 s_waitcnt lgkmcnt(0)
 ds_read_b64_tr_b16 v[76:77], v6 offset:11264
 s_waitcnt lgkmcnt(0)
 buffer_store_dwordx4 v[76:79], v0, s[8:11], s48 offen sc1
 s_waitcnt vmcnt(0)
 s_endpgm
R20FB:
 s_waitcnt vmcnt(0) lgkmcnt(0)
 ds_write_b64 v6, v[76:77] offset:9216
 s_waitcnt lgkmcnt(0)
 s_barrier
 ds_read_b64 v[44:45], v6 offset:8192
 ds_read_b64 v[46:47], v6 offset:8704
 ds_read_b64 v[48:49], v6 offset:9216
 ds_read_b64 v[50:51], v6 offset:9728
 s_waitcnt lgkmcnt(0)
 s_barrier
 v_max3_f32 v72, v44, v45, v46
 v_max3_f32 v72, v72, v47, v48
 v_max3_f32 v72, v72, v49, v50
 v_max3_f32 v72, v72, v51, v40
 v_max_f32 v72, v72, v41
 v_mov_b32 v73, v72
 s_nop 1
 v_permlane16_swap_b32 v72, v73
 v_max_f32 v72, v72, v73
 v_mov_b32 v73, v72
 s_nop 1
 v_permlane32_swap_b32 v72, v73
 v_max_f32 v72, v72, v73
 v_sub_f32 v44, v44, v72
 v_sub_f32 v45, v45, v72
 v_sub_f32 v46, v46, v72
 v_sub_f32 v47, v47, v72
 v_sub_f32 v48, v48, v72
 v_sub_f32 v49, v49, v72
 v_sub_f32 v50, v50, v72
 v_sub_f32 v51, v51, v72
 v_sub_f32 v40, v40, v72
 v_sub_f32 v41, v41, v72
 v_exp_f32_dpp v44, v44 quad_perm:[0,1,0,1] row_mask:0xf bank_mask:0xf
 v_exp_f32_dpp v45, v45 quad_perm:[0,1,0,1] row_mask:0xf bank_mask:0xf
 v_exp_f32_dpp v46, v46 quad_perm:[0,1,0,1] row_mask:0xf bank_mask:0xf
 v_exp_f32_dpp v47, v47 quad_perm:[0,1,0,1] row_mask:0xf bank_mask:0xf
 v_exp_f32_dpp v48, v48 quad_perm:[0,1,0,1] row_mask:0xf bank_mask:0xf
 v_exp_f32_dpp v49, v49 quad_perm:[0,1,0,1] row_mask:0xf bank_mask:0xf
 v_exp_f32_dpp v50, v50 quad_perm:[0,1,0,1] row_mask:0xf bank_mask:0xf
 v_exp_f32_dpp v51, v51 quad_perm:[0,1,0,1] row_mask:0xf bank_mask:0xf
 v_exp_f32_dpp v40, v40 quad_perm:[0,1,0,1] row_mask:0xf bank_mask:0xf
 v_exp_f32_dpp v41, v41 quad_perm:[0,1,0,1] row_mask:0xf bank_mask:0xf
 v_cvt_pk_bf16_f32 v8, v44, v45
 v_cvt_pk_bf16_f32 v9, v46, v47
 v_cvt_pk_bf16_f32 v10, v48, v49
 v_cvt_pk_bf16_f32 v11, v50, v51
 v_cvt_pk_bf16_f32 v32, v40, v41
 v_cvt_pk_bf16_f32 v35, v40, v41
 v_mfma_f32_16x16x32_bf16 v[72:75], v[36:39], v[8:11], 0
 v_mfma_f32_16x16x32_bf16 v[44:47], v[12:15], v[8:11], 0
 v_mfma_f32_16x16x32_bf16 v[48:51], v[16:19], v[8:11], 0
 v_mfma_f32_16x16x16_bf16 v[72:75], v[36:37], v[32:33], v[72:75]
 v_mfma_f32_16x16x16_bf16 v[44:47], v[78:79], v[32:33], v[44:47]
 v_mfma_f32_16x16x16_bf16 v[48:51], v[78:79], v[34:35], v[48:51]
 v_rcp_f32 v72, v72
 s_mov_b64 vcc, 0
 s_nop 7
 s_branch R20RJ
RECM2:
 ds_read_b128 v[8:11], v1 offset:0
 ds_read_b128 v[12:15], v1 offset:1024
 ds_read_b128 v[16:19], v1 offset:2048
 ds_read_b128 v[20:23], v1 offset:3072
 ds_read_b128 v[24:27], v1 offset:4096
 ds_read_b128 v[28:31], v1 offset:5120
 ds_read_b128 v[44:47], v1 offset:6144
 ds_read_b128 v[48:51], v1 offset:7168
 v_mov_b64 v[60:61], 0
 v_mov_b64 v[62:63], 0
 v_mov_b64 v[64:65], 0
 v_mov_b64 v[66:67], 0
 v_mov_b64 v[68:69], 0
 v_mov_b64 v[70:71], 0
 v_mov_b64 v[72:73], 0
 v_mov_b64 v[74:75], 0
 v_mov_b64 v[52:53], 0
 v_mov_b64 v[54:55], 0
 v_mov_b64 v[56:57], 0
 v_mov_b64 v[58:59], 0
 ds_read_b32 v76, v0 offset:13320
 s_mov_b32 s66, -1
 s_waitcnt lgkmcnt(0)
 s_branch R21STEP
.p2align 8
 s_nop 0
 s_nop 0
 s_nop 0
 s_nop 0
 s_nop 0
R21TOP:
 buffer_load_dwordx4 v[32:35], v0, s[8:11], s43 offen sc1
 s_sub_u32 s49, s49, 1
 s_cselect_b32 s49, 0, s49
 s_cselect_b32 s66, -1, -2
 s_cselect_b32 s67, 1, 0
R21TW:
 s_waitcnt vmcnt(1) lgkmcnt(0)
 v_max3_u32 v77, v32, v33, v34
 v_max_u32 v77, v35, v77
 ds_write_b128 v0, v[32:35] offset:4096
 v_cmp_lt_u32 vcc, s66, v77
 s_cbranch_vccnz R21TOP
 buffer_load_dwordx4 v[36:39], v0, s[8:11], s63 offen sc1
 buffer_load_dwordx4 v[40:43], v0, s[8:11], s44 offen sc1
R21STEP:
 v_smfmac_f32_16x16x64_bf16 v[60:63], v[32:35], v[8:15], v2
 v_smfmac_f32_16x16x64_bf16 v[64:67], v[32:35], v[16:23], v2
 s_waitcnt lgkmcnt(0)
 s_barrier
 ds_read_b128 v[8:11], v0 offset:0
 v_smfmac_f32_16x16x64_bf16 v[68:71], v[32:35], v[24:31], v2
 ds_read_b128 v[12:15], v0 offset:2048
 ds_read_b128 v[16:19], v0 offset:6144
 v_smfmac_f32_16x16x64_bf16 v[72:75], v[32:35], v[44:51], v2
 ds_read_b128 v[24:27], v1 offset:8192
 v_mov_b64 v[20:21], -1
 v_smfmac_f32_16x16x64_bf16 v[52:55], v[32:35], v[80:87], v2
 ds_read_b128 v[28:31], v1 offset:9216
 ds_read_b128 v[44:47], v1 offset:10240
 v_smfmac_f32_16x16x64_bf16 v[56:59], v[32:35], v[88:95], v2
 ds_read_b128 v[48:51], v1 offset:11264
 s_waitcnt lgkmcnt(6)
 v_smfmac_f32_16x16x64_bf16 v[60:63], v[8:11], v[96:103], v2
 buffer_load_dwordx4 v[32:35], v3, s[8:11], s47 offen offset:0 sc1
 v_smfmac_f32_16x16x64_bf16 v[64:67], v[8:11], v[104:111], v2
 buffer_store_dwordx2 v[20:21], v76, s[8:11], s46 offen sc1
 v_smfmac_f32_16x16x64_bf16 v[68:71], v[8:11], v[112:119], v2
 s_waitcnt lgkmcnt(2)
 v_smfmac_f32_16x16x64_bf16 v[72:75], v[8:11], v[24:31], v2
 v_smfmac_f32_16x16x64_bf16 v[52:55], v[8:11], v[120:127], v2
 ds_read_b128 v[24:27], v1 offset:12288
 s_waitcnt lgkmcnt(1)
 v_smfmac_f32_16x16x64_bf16 v[56:59], v[8:11], v[44:51], v2
 ds_read_b128 v[28:31], v1 offset:13312
 v_smfmac_f32_16x16x64_bf16 v[60:63], v[12:15], v[128:135], v2
 buffer_load_dwordx4 v[8:11], v3, s[8:11], s47 offen offset:1024 sc1
 ds_read_b128 v[44:47], v1 offset:14336
 v_smfmac_f32_16x16x64_bf16 v[64:67], v[12:15], v[136:143], v2
 ds_read_b128 v[48:51], v1 offset:15360
 v_smfmac_f32_16x16x64_bf16 v[68:71], v[12:15], v[144:151], v2
 ds_read_b64_tr_b16 v[76:77], v6 offset:11264
 v_smfmac_f32_16x16x64_bf16 v[72:75], v[12:15], v[152:159], v2
 s_waitcnt lgkmcnt(3)
 v_smfmac_f32_16x16x64_bf16 v[52:55], v[12:15], v[24:31], v2
 v_smfmac_f32_16x16x64_bf16 v[56:59], v[12:15], v[160:167], v2
 ds_read_b128 v[24:27], v1 offset:16384
 v_smfmac_f32_16x16x64_bf16 v[60:63], v[16:19], v[168:175], v2
 buffer_load_dwordx4 v[12:15], v0, s[8:11], s47 offen offset:2048 sc1
 ds_read_b128 v[28:31], v1 offset:17408
 s_waitcnt lgkmcnt(3)
 v_smfmac_f32_16x16x64_bf16 v[64:67], v[16:19], v[44:51], v2
 s_waitcnt vmcnt(5)
 ds_write_b128 v0, v[36:39] offset:5120
 v_max3_u32 v20, v36, v37, v38
 v_smfmac_f32_16x16x64_bf16 v[68:71], v[16:19], v[176:183], v2
 ds_read_b128 v[44:47], v1 offset:18432
 v_smfmac_f32_16x16x64_bf16 v[72:75], v[16:19], v[184:191], v2
 ds_read_b128 v[48:51], v1 offset:19456
 s_waitcnt vmcnt(4)
 v_max3_u32 v20, v39, v40, v20
 v_max3_u32 v21, v41, v42, v43
 v_smfmac_f32_16x16x64_bf16 v[52:55], v[16:19], v[192:199], v2
 s_waitcnt lgkmcnt(3)
 v_max_u32 v20, v21, v20
 v_cmp_lt_u32 vcc, s66, v20
 v_smfmac_f32_16x16x64_bf16 v[56:59], v[16:19], v[24:31], v2
 s_cbranch_vccnz R21PB
R21B:
 v_smfmac_f32_16x16x64_bf16 v[60:63], v[36:39], v[200:207], v2
 buffer_load_dwordx4 v[16:19], v0, s[8:11], s47 offen offset:3072 sc1
 s_waitcnt lgkmcnt(2)
 s_barrier
 ds_read_b128 v[20:23], v0 offset:1024
 v_smfmac_f32_16x16x64_bf16 v[64:67], v[36:39], v[208:215], v2
 ds_read_b128 v[24:27], v0 offset:3072
 ds_read_b128 v[28:31], v0 offset:7168
 v_smfmac_f32_16x16x64_bf16 v[60:63], v[40:43], v[216:223], v2
 s_add_u32 s47, s47, 524288
 s_waitcnt lgkmcnt(3)
 v_smfmac_f32_16x16x64_bf16 v[64:67], v[40:43], v[44:51], v2
 s_add_u32 s45, s45, 0x4000
 s_waitcnt lgkmcnt(2)
 v_smfmac_f32_16x16x64_bf16 v[60:63], v[20:23], v[224:231], v2
 ds_read_b128 v[44:47], v1 offset:20480
 s_waitcnt lgkmcnt(2)
 v_smfmac_f32_16x16x64_bf16 v[60:63], v[24:27], v[232:239], v2
 ds_read_b128 v[48:51], v1 offset:21504
 s_waitcnt lgkmcnt(2)
 v_smfmac_f32_16x16x64_bf16 v[60:63], v[28:31], v[240:247], v2
 v_smfmac_f32_16x16x64_bf16 v[64:67], v[20:23], v[248:255], v2
 s_bitset0_b32 s45, 16
 s_add_u32 s44, s45, 8192
 v_smfmac_f32_16x16x64_bf16 v[64:67], v[24:27], a[0:7], v2
 v_mul_f32 v60, s50, v60
 v_mul_f32 v61, s50, v61
 v_smfmac_f32_16x16x64_bf16 v[64:67], v[28:31], a[8:15], v2
 s_add_u32 s43, s45, 2048
 s_add_u32 s63, s45, 6144
 v_fmac_f32 v60, s50, v62
 v_fmac_f32 v61, s50, v63
 s_waitcnt lgkmcnt(0)
 v_smfmac_f32_16x16x64_bf16 v[68:71], v[36:39], v[44:51], v2
 buffer_store_dwordx4 v[76:79], v0, s[8:11], s48 offen sc1
 v_cvt_pk_bf16_f32 v60, v60, v61
 v_smfmac_f32_16x16x64_bf16 v[68:71], v[40:43], a[16:23], v2
 ds_read_b128 v[44:47], v1 offset:22528
 v_mul_f32 v64, s50, v64
 v_mul_f32 v65, s50, v65
 v_fmac_f32 v64, s50, v66
 v_smfmac_f32_16x16x64_bf16 v[68:71], v[20:23], a[24:31], v2
 ds_read_b128 v[48:51], v1 offset:23552
 v_fmac_f32 v65, s50, v67
 v_cvt_pk_bf16_f32 v61, v64, v65
 ds_write_b64 v5, v[60:61] offset:9216
 v_smfmac_f32_16x16x64_bf16 v[68:71], v[24:27], a[32:39], v2
 v_smfmac_f32_16x16x64_bf16 v[68:71], v[28:31], a[40:47], v2
 s_xor_b32 s46, s45, 0x8000
 s_and_b32 s65, s36, 1
 v_smfmac_f32_16x16x64_bf16 v[72:75], v[36:39], a[48:55], v2
 v_smfmac_f32_16x16x64_bf16 v[72:75], v[40:43], a[56:63], v2
 s_waitcnt lgkmcnt(1)
 v_add_f32 v68, v68, v70
 v_smfmac_f32_16x16x64_bf16 v[72:75], v[20:23], v[44:51], v2
 s_waitcnt lgkmcnt(0)
 s_barrier
 ds_read_b64_tr_b16 v[60:61], v6 offset:8192
 ds_read_b64_tr_b16 v[62:63], v6 offset:8704
 v_add_f32 v69, v69, v71
 v_smfmac_f32_16x16x64_bf16 v[72:75], v[24:27], a[64:71], v2
 ds_read_b64_tr_b16 v[64:65], v6 offset:9216
 ds_read_b64_tr_b16 v[66:67], v6 offset:9728
 ds_read_b128 v[44:47], v1 offset:24576
 v_cvt_pk_bf16_f32 v68, v68, v69
 v_smfmac_f32_16x16x64_bf16 v[72:75], v[28:31], a[72:79], v2
 ds_read_b128 v[48:51], v1 offset:25600
 v_smfmac_f32_16x16x64_bf16 v[52:55], v[36:39], a[80:87], v2
 s_waitcnt vmcnt(5) lgkmcnt(4)
 v_mfma_f32_16x16x32_bf16 v[76:79], v[32:35], v[60:63], 0
 s_waitcnt vmcnt(3) lgkmcnt(2)
 v_add_f32 v72, v72, v74
 v_add_f32 v73, v73, v75
 v_mfma_f32_16x16x32_bf16 v[76:79], v[8:11], v[64:67], v[76:79]
 v_cvt_pk_bf16_f32 v69, v72, v73
 ds_write_b64 v5, v[68:69] offset:11264
 v_smfmac_f32_16x16x64_bf16 v[56:59], v[36:39], a[88:95], v2
 s_add_u32 s48, s48, 131072
 s_waitcnt lgkmcnt(1)
 v_smfmac_f32_16x16x64_bf16 v[52:55], v[40:43], v[44:51], v2
 ds_read_b128 v[36:39], v0 offset:15360
 v_add_f32_dpp v76, v78, v76 quad_perm:[2,3,0,1] row_mask:0xf bank_mask:0xf
 v_add_f32_dpp v77, v79, v77 quad_perm:[2,3,0,1] row_mask:0xf bank_mask:0xf
 v_smfmac_f32_16x16x64_bf16 v[56:59], v[40:43], a[96:103], v2
 ds_read_b128 v[44:47], v1 offset:26624
 v_exp_f32_dpp v78, v76 quad_perm:[0,1,0,1] row_mask:0xf bank_mask:0xf
 v_exp_f32_dpp v79, v77 quad_perm:[0,1,0,1] row_mask:0xf bank_mask:0xf
 v_smfmac_f32_16x16x64_bf16 v[52:55], v[20:23], a[104:111], v2
 ds_read_b128 v[48:51], v1 offset:27648
 v_cvt_pk_bf16_f32 v78, v78, v79
 ds_write_b32 v0, v78 offset:14344
 v_smfmac_f32_16x16x64_bf16 v[56:59], v[20:23], a[112:119], v2
 s_waitcnt lgkmcnt(4)
 s_barrier
 ds_read_b64_tr_b16 v[68:69], v6 offset:10240
 ds_read_b64_tr_b16 v[70:71], v6 offset:10752
 v_mov_b32 v33, 0
 v_smfmac_f32_16x16x64_bf16 v[52:55], v[24:27], a[120:127], v2
 ds_read_b64_tr_b16 v[72:73], v6 offset:11264
 ds_read_b64_tr_b16 v[74:75], v6 offset:11776
 v_mov_b32 v34, 0
 v_smfmac_f32_16x16x64_bf16 v[52:55], v[28:31], a[128:135], v2
 s_waitcnt lgkmcnt(5)
 v_smfmac_f32_16x16x64_bf16 v[56:59], v[24:27], v[44:51], v2
 s_waitcnt lgkmcnt(2)
 v_mfma_f32_16x16x32_bf16 v[40:43], v[68:71], v[60:63], 0
 s_barrier
 ds_read_b128 v[8:11], v0 offset:14336
 v_add_f32 v52, v52, v54
 v_add_f32 v53, v53, v55
 s_waitcnt lgkmcnt(1)
 v_mfma_f32_16x16x32_bf16 v[40:43], v[72:75], v[64:67], v[40:43]
 s_cmp_eq_u32 s36, 63
 v_cvt_pk_bf16_f32 v78, v52, v53
 v_smfmac_f32_16x16x64_bf16 v[56:59], v[28:31], a[136:143], v2
 s_waitcnt lgkmcnt(0)
 s_nop 2
 v_add_f32_dpp v40, v42, v40 quad_perm:[2,3,0,1] row_mask:0xf bank_mask:0xf
 v_add_f32_dpp v41, v43, v41 quad_perm:[2,3,0,1] row_mask:0xf bank_mask:0xf
 v_mfma_f32_16x16x32_bf16 v[72:75], v[36:39], v[8:11], 0
 ds_read_b128 v[24:27], v1 offset:28672
 v_exp_f32_dpp v42, v40 quad_perm:[0,1,0,1] row_mask:0xf bank_mask:0xf
 v_exp_f32_dpp v43, v41 quad_perm:[0,1,0,1] row_mask:0xf bank_mask:0xf
 s_waitcnt vmcnt(2)
 v_mfma_f32_16x16x32_bf16 v[44:47], v[12:15], v[8:11], 0
 ds_read_b128 v[28:31], v1 offset:29696
 v_cvt_pk_bf16_f32 v32, v42, v43
 v_cvt_pk_bf16_f32 v35, v42, v43
 v_add_f32 v56, v56, v58
 v_add_f32 v57, v57, v59
 v_mfma_f32_16x16x16_bf16 v[72:75], v[36:37], v[32:33], v[72:75]
 s_waitcnt vmcnt(1)
 v_cvt_pk_bf16_f32 v79, v56, v57
 v_mfma_f32_16x16x32_bf16 v[48:51], v[16:19], v[8:11], 0
 s_cbranch_scc1 R21TAIL
 v_mov_b64 v[68:69], 0
 v_mov_b64 v[70:71], 0
 v_mfma_f32_16x16x16_bf16 v[44:47], v[78:79], v[32:33], v[44:47]
 v_rcp_f32 v72, v72
 v_subrev_u32 v74, s52, v74
 v_mfma_f32_16x16x16_bf16 v[48:51], v[78:79], v[34:35], v[48:51]
 v_cmp_le_u32 vcc, s53, v74
 v_mov_b64 v[52:53], 0
 v_mov_b64 v[54:55], 0
R21RJ:
 s_nop 0
 v_pk_mul_f32 v[44:45], v[44:45], v[72:73] op_sel_hi:[1,0]
 v_pk_mul_f32 v[46:47], v[46:47], v[72:73] op_sel_hi:[1,0]
 s_cbranch_vccnz R21FB
 v_cvt_pk_bf16_f32 v40, v44, v45
 v_cvt_pk_bf16_f32 v41, v46, v47
 v_pk_mul_f32 v[48:49], v[48:49], v[72:73] op_sel_hi:[1,0]
 v_pk_mul_f32 v[50:51], v[50:51], v[72:73] op_sel_hi:[1,0]
 v_cvt_pk_bf16_f32 v42, v48, v49
 v_cvt_pk_bf16_f32 v43, v50, v51
 ds_write_b128 v4, v[40:43] offset:9216
 s_waitcnt lgkmcnt(1)
 v_smfmac_f32_16x16x64_bf16 v[68:71], v[40:43], v[24:31], v2
 v_mov_b64 v[56:57], 0
 v_mov_b64 v[58:59], 0
 v_smfmac_f32_16x16x64_bf16 v[52:55], v[40:43], a[144:151], v2
 v_mov_b64 v[64:65], 0
 v_mov_b64 v[66:67], 0
 v_smfmac_f32_16x16x64_bf16 v[56:59], v[40:43], a[152:159], v2
 s_waitcnt lgkmcnt(0)
 s_barrier
 ds_read_b128 v[32:35], v4 offset:8192
 ds_read_b128 v[36:39], v4 offset:8320
 ds_read_b128 v[72:75], v4 offset:9344
 v_mov_b64 v[60:61], 0
 v_mov_b64 v[62:63], 0
 v_smfmac_f32_16x16x64_bf16 v[64:67], v[40:43], a[160:167], v2
 s_waitcnt lgkmcnt(2)
 v_smfmac_f32_16x16x64_bf16 v[68:71], v[32:35], a[168:175], v2
 ds_read_b128 v[44:47], v3 offset:8192
 s_waitcnt lgkmcnt(2)
 v_lshrrev_b32 v40, 2, v0
 v_smfmac_f32_16x16x64_bf16 v[68:71], v[36:39], a[176:183], v2
 ds_read_b128 v[48:51], v3 offset:9216
 s_waitcnt lgkmcnt(2)
 v_smfmac_f32_16x16x64_bf16 v[68:71], v[72:75], a[184:191], v2
 ds_read_b128 v[24:27], v1 offset:30720
 v_smfmac_f32_16x16x64_bf16 v[52:55], v[32:35], a[192:199], v2
 ds_read_b128 v[28:31], v1 offset:31744
 v_smfmac_f32_16x16x64_bf16 v[52:55], v[36:39], a[200:207], v2
 ds_read_b128 v[8:11], v1 offset:32768
 v_cvt_pk_bf16_f32 v68, v68, v69
 v_smfmac_f32_16x16x64_bf16 v[52:55], v[72:75], a[208:215], v2
 ds_read_b128 v[12:15], v1 offset:33792
 s_waitcnt lgkmcnt(5)
 v_cvt_pk_bf16_f32 v69, v70, v71
 v_smfmac_f32_16x16x64_bf16 v[60:63], v[44:47], a[216:223], v2
 ds_read_b128 v[16:19], v1 offset:34816
 s_waitcnt lgkmcnt(5)
 v_and_or_b32 v68, v68, -2, s65
 v_smfmac_f32_16x16x64_bf16 v[60:63], v[48:51], a[224:231], v2
 ds_read_b128 v[20:23], v1 offset:35840
 v_cvt_pk_bf16_f32 v70, v52, v53
 v_cvt_pk_bf16_f32 v71, v54, v55
 buffer_store_dwordx4 v[68:71], v0, s[8:11], s37 offen sc1
 v_smfmac_f32_16x16x64_bf16 v[56:59], v[32:35], a[232:239], v2
 ds_read_b32 v76, v0 offset:13320
 s_waitcnt lgkmcnt(5)
 v_smfmac_f32_16x16x64_bf16 v[56:59], v[36:39], v[24:31], v2
 s_add_u32 s36, s36, 1
 v_add_f32 v60, v60, v62
 v_smfmac_f32_16x16x64_bf16 v[56:59], v[72:75], a[240:247], v2
 s_waitcnt lgkmcnt(3)
 v_add_f32 v61, v61, v63
 v_smfmac_f32_16x16x64_bf16 v[64:67], v[32:35], v[8:15], v2
 v_cvt_pk_bf16_f32 v41, v60, v61
 v_smfmac_f32_16x16x64_bf16 v[64:67], v[36:39], a[248:255], v2
 s_waitcnt lgkmcnt(1)
 v_and_or_b32 v41, v41, -2, s65
 v_smfmac_f32_16x16x64_bf16 v[64:67], v[72:75], v[16:23], v2
 buffer_store_dword v41, v40, s[8:11], s38 offen sc1
 v_cvt_pk_bf16_f32 v56, v56, v57
 v_cvt_pk_bf16_f32 v57, v58, v59
 v_and_or_b32 v56, v56, -2, s65
 s_nop 3
 v_cvt_pk_bf16_f32 v58, v64, v65
 v_cvt_pk_bf16_f32 v59, v66, v67
 buffer_store_dwordx4 v[56:59], v0, s[8:11], s37 offen offset:1024 sc1
R21HOP:
 s_cmp_lg_u32 s55, 0
 s_cbranch_scc1 R21NQ
 ds_read_b128 v[40:43], v0 offset:12288
 s_sub_u32 s49, s49, 1
 s_cselect_b32 s49, 0, s49
 s_cselect_b32 s66, -1, -2
 s_cselect_b32 s67, 1, 0
 s_waitcnt vmcnt(0)
 buffer_load_dwordx4 v[60:63], v7, s[8:11], s39 offen sc1
 buffer_load_dwordx4 v[64:67], v7, s[8:11], s40 offen sc1
 buffer_load_dwordx4 v[68:71], v7, s[8:11], s41 offen sc1
 buffer_load_dwordx4 v[72:75], v7, s[8:11], s42 offen sc1
R21P1:
 s_waitcnt vmcnt(3)
 s_waitcnt lgkmcnt(0)
 v_mfma_f32_16x16x32_bf16 v[36:39], v[40:43], v[60:63], 0
 s_waitcnt vmcnt(2)
 v_mfma_f32_16x16x32_bf16 v[36:39], v[40:43], v[64:67], v[36:39]
 v_bitop3_b32 v60, v60, v64, s65 bitop3:0x7e
 s_waitcnt vmcnt(1)
 v_mfma_f32_16x16x32_bf16 v[36:39], v[40:43], v[68:71], v[36:39]
 s_waitcnt vmcnt(0)
 v_mfma_f32_16x16x32_bf16 v[36:39], v[40:43], v[72:75], v[36:39]
 v_bitop3_b32 v64, v68, v72, s65 bitop3:0x7e
 v_bitop3_b32 v60, v60, v61, s65 bitop3:0xf6
 v_bitop3_b32 v60, v60, v62, s65 bitop3:0xf6
 v_bitop3_b32 v60, v60, v63, s65 bitop3:0xf6
 v_bitop3_b32 v60, v60, v65, s65 bitop3:0xf6
 v_bitop3_b32 v60, v60, v66, s65 bitop3:0xf6
 v_bitop3_b32 v60, v60, v67, s65 bitop3:0xf6
 v_bitop3_b32 v60, v60, v69, s65 bitop3:0xf6
 v_bitop3_b32 v60, v60, v70, s65 bitop3:0xf6
 v_bitop3_b32 v60, v60, v71, s65 bitop3:0xf6
 v_bitop3_b32 v60, v60, v73, s65 bitop3:0xf6
 v_bitop3_b32 v60, v60, v74, s65 bitop3:0xf6
 v_bitop3_b32 v60, v60, v75, s65 bitop3:0xf6
 v_bitop3_b32 v60, v60, v64, 1 bitop3:0xa8
 v_cmp_lt_u32 vcc, s67, v60
 s_cbranch_vccnz R21R1
 v_add_f32_dpp v36, v36, v36 row_ror:8 row_mask:0xf bank_mask:0xf
 v_add_f32_dpp v37, v37, v37 row_ror:8 row_mask:0xf bank_mask:0xf
 v_add_f32_dpp v38, v38, v38 row_ror:8 row_mask:0xf bank_mask:0xf
 v_add_f32_dpp v39, v39, v39 row_ror:8 row_mask:0xf bank_mask:0xf
 v_cvt_pk_bf16_f32 v36, v36, v37
 v_cvt_pk_bf16_f32 v37, v38, v39
 buffer_store_dwordx2 v[36:37], v76, s[8:11], s45 offen sc1
 s_barrier
 v_mov_b64 v[60:61], 0
 v_mov_b64 v[62:63], 0
 v_mov_b64 v[64:65], 0
 v_mov_b64 v[66:67], 0
 v_mov_b64 v[68:69], 0
 v_mov_b64 v[70:71], 0
 v_mov_b64 v[72:73], 0
 v_mov_b64 v[74:75], 0
 buffer_load_dwordx4 v[32:35], v0, s[8:11], s43 offen sc1
 ds_read_b128 v[8:11], v1 offset:0
 ds_read_b128 v[12:15], v1 offset:1024
 ds_read_b128 v[16:19], v1 offset:2048
 ds_read_b128 v[20:23], v1 offset:3072
 v_mov_b64 v[52:53], 0
 v_mov_b64 v[54:55], 0
 ds_read_b128 v[24:27], v1 offset:4096
 ds_read_b128 v[28:31], v1 offset:5120
 ds_read_b128 v[44:47], v1 offset:6144
 ds_read_b128 v[48:51], v1 offset:7168
 v_mov_b64 v[56:57], 0
 v_mov_b64 v[58:59], 0
 s_branch R21TOP
R21PB:
 buffer_load_dwordx4 v[36:39], v0, s[8:11], s63 offen sc1
 buffer_load_dwordx4 v[40:43], v0, s[8:11], s44 offen sc1
 s_sub_u32 s49, s49, 1
 s_cselect_b32 s49, 0, s49
 s_cselect_b32 s66, -1, -2
 s_cselect_b32 s67, 1, 0
 s_waitcnt vmcnt(0)
 v_max3_u32 v20, v36, v37, v38
 v_max3_u32 v20, v39, v40, v20
 v_max3_u32 v21, v41, v42, v43
 v_max_u32 v20, v21, v20
 v_cmp_lt_u32 vcc, s66, v20
 ds_write_b128 v0, v[36:39] offset:5120
 s_cbranch_vccnz R21PB
 s_waitcnt lgkmcnt(0)
 s_branch R21B
R21R1:
 buffer_load_dwordx4 v[60:63], v7, s[8:11], s39 offen sc1
 buffer_load_dwordx4 v[64:67], v7, s[8:11], s40 offen sc1
 buffer_load_dwordx4 v[68:71], v7, s[8:11], s41 offen sc1
 buffer_load_dwordx4 v[72:75], v7, s[8:11], s42 offen sc1
 s_sub_u32 s49, s49, 1
 s_cselect_b32 s49, 0, s49
 s_cselect_b32 s66, -1, -2
 s_cselect_b32 s67, 1, 0
 s_waitcnt vmcnt(0)
 s_branch R21P1
R21NQ:
 s_barrier
 v_mov_b64 v[60:61], 0
 v_mov_b64 v[62:63], 0
 v_mov_b64 v[64:65], 0
 v_mov_b64 v[66:67], 0
 v_mov_b64 v[68:69], 0
 v_mov_b64 v[70:71], 0
 v_mov_b64 v[72:73], 0
 v_mov_b64 v[74:75], 0
 buffer_load_dwordx4 v[32:35], v0, s[8:11], s43 offen sc1
 ds_read_b128 v[8:11], v1 offset:0
 ds_read_b128 v[12:15], v1 offset:1024
 ds_read_b128 v[16:19], v1 offset:2048
 ds_read_b128 v[20:23], v1 offset:3072
 v_mov_b64 v[52:53], 0
 v_mov_b64 v[54:55], 0
 ds_read_b128 v[24:27], v1 offset:4096
 ds_read_b128 v[28:31], v1 offset:5120
 ds_read_b128 v[44:47], v1 offset:6144
 ds_read_b128 v[48:51], v1 offset:7168
 v_mov_b64 v[56:57], 0
 v_mov_b64 v[58:59], 0
 s_branch R21TOP
R21TAIL:
 s_waitcnt lgkmcnt(0)
 ds_read_b64_tr_b16 v[76:77], v6 offset:11264
 s_waitcnt lgkmcnt(0)
 buffer_store_dwordx4 v[76:79], v0, s[8:11], s48 offen sc1
 s_waitcnt vmcnt(0)
 s_endpgm
R21FB:
 s_waitcnt vmcnt(0) lgkmcnt(0)
 ds_write_b64 v6, v[76:77] offset:9216
 s_waitcnt lgkmcnt(0)
 s_barrier
 ds_read_b64 v[44:45], v6 offset:8192
 ds_read_b64 v[46:47], v6 offset:8704
 ds_read_b64 v[48:49], v6 offset:9216
 ds_read_b64 v[50:51], v6 offset:9728
 s_waitcnt lgkmcnt(0)
 s_barrier
 v_max3_f32 v72, v44, v45, v46
 v_max3_f32 v72, v72, v47, v48
 v_max3_f32 v72, v72, v49, v50
 v_max3_f32 v72, v72, v51, v40
 v_max_f32 v72, v72, v41
 v_mov_b32 v73, v72
 s_nop 1
 v_permlane16_swap_b32 v72, v73
 v_max_f32 v72, v72, v73
 v_mov_b32 v73, v72
 s_nop 1
 v_permlane32_swap_b32 v72, v73
 v_max_f32 v72, v72, v73
 v_sub_f32 v44, v44, v72
 v_sub_f32 v45, v45, v72
 v_sub_f32 v46, v46, v72
 v_sub_f32 v47, v47, v72
 v_sub_f32 v48, v48, v72
 v_sub_f32 v49, v49, v72
 v_sub_f32 v50, v50, v72
 v_sub_f32 v51, v51, v72
 v_sub_f32 v40, v40, v72
 v_sub_f32 v41, v41, v72
 v_exp_f32_dpp v44, v44 quad_perm:[0,1,0,1] row_mask:0xf bank_mask:0xf
 v_exp_f32_dpp v45, v45 quad_perm:[0,1,0,1] row_mask:0xf bank_mask:0xf
 v_exp_f32_dpp v46, v46 quad_perm:[0,1,0,1] row_mask:0xf bank_mask:0xf
 v_exp_f32_dpp v47, v47 quad_perm:[0,1,0,1] row_mask:0xf bank_mask:0xf
 v_exp_f32_dpp v48, v48 quad_perm:[0,1,0,1] row_mask:0xf bank_mask:0xf
 v_exp_f32_dpp v49, v49 quad_perm:[0,1,0,1] row_mask:0xf bank_mask:0xf
 v_exp_f32_dpp v50, v50 quad_perm:[0,1,0,1] row_mask:0xf bank_mask:0xf
 v_exp_f32_dpp v51, v51 quad_perm:[0,1,0,1] row_mask:0xf bank_mask:0xf
 v_exp_f32_dpp v40, v40 quad_perm:[0,1,0,1] row_mask:0xf bank_mask:0xf
 v_exp_f32_dpp v41, v41 quad_perm:[0,1,0,1] row_mask:0xf bank_mask:0xf
 v_cvt_pk_bf16_f32 v8, v44, v45
 v_cvt_pk_bf16_f32 v9, v46, v47
 v_cvt_pk_bf16_f32 v10, v48, v49
 v_cvt_pk_bf16_f32 v11, v50, v51
 v_cvt_pk_bf16_f32 v32, v40, v41
 v_cvt_pk_bf16_f32 v35, v40, v41
 v_mfma_f32_16x16x32_bf16 v[72:75], v[36:39], v[8:11], 0
 v_mfma_f32_16x16x32_bf16 v[44:47], v[12:15], v[8:11], 0
 v_mfma_f32_16x16x32_bf16 v[48:51], v[16:19], v[8:11], 0
 v_mfma_f32_16x16x16_bf16 v[72:75], v[36:37], v[32:33], v[72:75]
 v_mfma_f32_16x16x16_bf16 v[44:47], v[78:79], v[32:33], v[44:47]
 v_mfma_f32_16x16x16_bf16 v[48:51], v[78:79], v[34:35], v[48:51]
 v_rcp_f32 v72, v72
 s_mov_b64 vcc, 0
 s_nop 7
 s_branch R21RJ
RECW3:
 v_mbcnt_lo_u32_b32 v8, -1, 0
 v_mbcnt_hi_u32_b32 v8, -1, v8
 v_mov_b32 v4, 128
 v_bfe_u32 v9, v8, 5, 1
 v_lshl_add_u32 v4, v9, 6, v4
 v_mov_b32 v1, 0
 v_bfe_u32 v9, v8, 0, 5
 v_lshl_add_u32 v1, v9, 4, v1
 v_xor_b32 v4, v4, v1
 v_mov_b32 v1, 41472
 v_bfe_u32 v9, v8, 5, 1
 s_mov_b32 s101, 1152
 v_mad_u32_u24 v1, v9, s101, v1
 v_add_u32 v4, v4, v1
 v_mov_b32 v7, 64
 v_bfe_u32 v9, v8, 4, 1
 v_lshl_add_u32 v7, v9, 5, v7
 v_mov_b32 v1, 0
 v_bfe_u32 v9, v8, 0, 3
 v_lshl_add_u32 v1, v9, 4, v1
 v_xor_b32 v7, v7, v1
 v_mov_b32 v1, 41472
 v_bfe_u32 v9, v8, 3, 1
 s_mov_b32 s101, 1152
 v_mad_u32_u24 v1, v9, s101, v1
 v_bfe_u32 v9, v8, 4, 1
 s_mov_b32 s101, 9216
 v_mad_u32_u24 v1, v9, s101, v1
 v_bfe_u32 v9, v8, 5, 1
 s_mov_b32 s101, 73728
 v_mad_u32_u24 v1, v9, s101, v1
 v_add_u32 v7, v7, v1
 s_lshl_b32 s62, s3, 8
 s_mul_i32 s63, s3, 147456
 s_mov_b32 m0, 147456
 s_add_u32 s54, s63, 1024
 buffer_load_dwordx4 v7, s[28:31], s54 offen lds
 s_mov_b32 m0, 148480
 s_add_u32 s54, s63, 3328
 buffer_load_dwordx4 v7, s[28:31], s54 offen lds
 s_mov_b32 m0, 149504
 s_add_u32 s54, s63, 19456
 buffer_load_dwordx4 v7, s[28:31], s54 offen lds
 s_mov_b32 m0, 150528
 s_add_u32 s54, s63, 21760
 buffer_load_dwordx4 v7, s[28:31], s54 offen lds
 s_mov_b32 m0, 151552
 s_add_u32 s54, s63, 0
 buffer_load_dwordx4 v4, s[28:31], s54 offen lds
 s_mov_b32 m0, 152576
 s_add_u32 s54, s63, 2304
 buffer_load_dwordx4 v4, s[28:31], s54 offen lds
 s_mov_b32 m0, 153600
 s_add_u32 s54, s63, 18432
 buffer_load_dwordx4 v4, s[28:31], s54 offen lds
 s_mov_b32 m0, 154624
 s_add_u32 s54, s63, 20736
 buffer_load_dwordx4 v4, s[28:31], s54 offen lds
 s_mov_b32 m0, 155648
 s_add_u32 s54, s63, 512
 buffer_load_dwordx4 v4, s[28:31], s54 offen lds
 s_mov_b32 m0, 156672
 s_add_u32 s54, s63, 2816
 buffer_load_dwordx4 v4, s[28:31], s54 offen lds
 s_mov_b32 m0, 157696
 s_add_u32 s54, s63, 18944
 buffer_load_dwordx4 v4, s[28:31], s54 offen lds
 s_mov_b32 m0, 158720
 s_add_u32 s54, s63, 21248
 buffer_load_dwordx4 v4, s[28:31], s54 offen lds
 s_mul_i32 s54, s3, 9344
 s_add_u32 s37, s54, 6144
 s_add_u32 s38, s54, 8960
 s_mov_b32 s39, 0
 s_mov_b32 s40, 74752
 s_mov_b32 s41, 149504
 s_mov_b32 s42, 224256
 s_mov_b32 s45, 1048576
 s_mov_b32 s46, 1081344
 s_lshl_b32 s54, s3, 14
 s_add_u32 s47, s54, 16789504
 s_add_u32 s58, s54, 16777216
 s_lshl_b32 s54, s3, 12
 s_add_u32 s48, s54, 83889152
 s_mov_b32 s49, 400000
 s_mov_b32 s36, 0
 s_mov_b32 s50, 1040356334
 s_mov_b32 s51, 1040356334
 s_mov_b32 s52, 662700032
 s_mov_b32 s53, 939524096
 s_lshl_b32 s57, s3, 2
 v_mov_b32 v16, 0
 v_bfe_u32 v9, v8, 0, 2
 v_lshl_add_u32 v16, v9, 1, v16
 v_bfe_u32 v9, v8, 2, 1
 v_lshl_add_u32 v16, v9, 0, v16
 v_and_b32 v9, 15, v8
 v_cmp_lt_u32 vcc, 7, v9
 s_nop 1
 v_cndmask_b32 v9, v9, v16, vcc
 v_mov_b32 v10, 0x3f80
 v_mov_b32 v11, 0x3f800000
 v_mov_b32 v12, 0
 v_cmp_eq_u32 vcc, 0, v9
 s_nop 1
 v_cndmask_b32 v12, v12, v10, vcc
 v_cmp_eq_u32 vcc, 1, v9
 s_nop 1
 v_cndmask_b32 v12, v12, v11, vcc
 v_mov_b32 v13, 0
 v_cmp_eq_u32 vcc, 2, v9
 s_nop 1
 v_cndmask_b32 v13, v13, v10, vcc
 v_cmp_eq_u32 vcc, 3, v9
 s_nop 1
 v_cndmask_b32 v13, v13, v11, vcc
 v_mov_b32 v14, 0
 v_cmp_eq_u32 vcc, 4, v9
 s_nop 1
 v_cndmask_b32 v14, v14, v10, vcc
 v_cmp_eq_u32 vcc, 5, v9
 s_nop 1
 v_cndmask_b32 v14, v14, v11, vcc
 v_mov_b32 v15, 0
 v_cmp_eq_u32 vcc, 6, v9
 s_nop 1
 v_cndmask_b32 v15, v15, v10, vcc
 v_cmp_eq_u32 vcc, 7, v9
 s_nop 1
 v_cndmask_b32 v15, v15, v11, vcc
 v_lshlrev_b32 v11, 4, v8
 ds_write_b128 v11, v[12:15] offset:12288
 v_mov_b32 v16, 0x3f803f80
 v_mov_b32 v17, 0x3f803f80
 v_mov_b32 v18, 0x3f803f80
 v_mov_b32 v19, 0x3f803f80
 ds_write_b128 v11, v[16:19] offset:15360
 v_mov_b32 v0, 16
 v_bfe_u32 v9, v8, 4, 2
 v_lshl_add_u32 v0, v9, 6, v0
 v_mov_b32 v1, 0
 v_bfe_u32 v9, v8, 0, 4
 v_lshl_add_u32 v1, v9, 4, v1
 v_xor_b32 v0, v0, v1
 v_mov_b32 v1, 98304
 v_bfe_u32 v9, v8, 4, 1
 v_lshl_add_u32 v1, v9, 13, v1
 v_bfe_u32 v9, v8, 5, 1
 v_lshl_add_u32 v1, v9, 18, v1
 v_add_u32 v0, v0, v1
 v_mov_b32 v2, 144
 v_bfe_u32 v9, v8, 1, 1
 v_lshl_add_u32 v2, v9, 5, v2
 v_mov_b32 v1, 0
 v_bfe_u32 v9, v8, 4, 1
 v_lshl_add_u32 v1, v9, 4, v1
 v_bfe_u32 v9, v8, 2, 2
 v_lshl_add_u32 v1, v9, 6, v1
 v_xor_b32 v2, v2, v1
 v_mov_b32 v1, 16384
 v_bfe_u32 v9, v8, 4, 2
 s_mov_b32 s101, 36864
 v_mad_u32_u24 v1, v9, s101, v1
 v_bfe_u32 v9, v8, 0, 1
 v_lshl_add_u32 v1, v9, 3, v1
 v_bfe_u32 v9, v8, 2, 2
 v_lshl_add_u32 v1, v9, 8, v1
 v_add_u32 v2, v2, v1
 v_mov_b32 v3, 96
 v_bfe_u32 v9, v8, 1, 1
 v_lshl_add_u32 v3, v9, 4, v3
 v_mov_b32 v1, 0
 v_bfe_u32 v9, v8, 3, 1
 v_lshl_add_u32 v1, v9, 5, v1
 v_bfe_u32 v9, v8, 4, 1
 v_lshl_add_u32 v1, v9, 6, v1
 v_xor_b32 v3, v3, v1
 v_mov_b32 v1, 16384
 v_bfe_u32 v9, v8, 4, 2
 s_mov_b32 s101, 36864
 v_mad_u32_u24 v1, v9, s101, v1
 v_bfe_u32 v9, v8, 0, 1
 v_lshl_add_u32 v1, v9, 3, v1
 v_bfe_u32 v9, v8, 2, 2
 v_lshl_add_u32 v1, v9, 7, v1
 v_add_u32 v3, v3, v1
 v_mov_b32 v5, 384
 v_bfe_u32 v9, v8, 1, 1
 v_lshl_add_u32 v5, v9, 4, v5
 v_bfe_u32 v9, v8, 3, 1
 v_lshl_add_u32 v5, v9, 5, v5
 v_mov_b32 v1, 0
 v_bfe_u32 v9, v8, 2, 1
 v_lshl_add_u32 v1, v9, 6, v1
 v_bfe_u32 v9, v8, 4, 1
 v_lshl_add_u32 v1, v9, 7, v1
 v_xor_b32 v5, v5, v1
 v_mov_b32 v1, 16384
 v_bfe_u32 v9, v8, 4, 2
 s_mov_b32 s101, 36864
 v_mad_u32_u24 v1, v9, s101, v1
 v_bfe_u32 v9, v8, 0, 1
 v_lshl_add_u32 v1, v9, 3, v1
 v_bfe_u32 v9, v8, 2, 1
 v_lshl_add_u32 v1, v9, 9, v1
 v_add_u32 v5, v5, v1
 v_xor_b32 v6, 64, v5
 v_mov_b32 v1, 126976
 v_bfe_u32 v9, v8, 0, 6
 v_lshl_add_u32 v1, v9, 4, v1
 s_waitcnt vmcnt(8) lgkmcnt(0)
 s_barrier
 s_mov_b32 m0, 159744
 s_add_u32 s54, s63, 9216
 buffer_load_dwordx4 v4, s[28:31], s54 offen lds
 s_mov_b32 m0, 160768
 s_add_u32 s54, s63, 11520
 buffer_load_dwordx4 v4, s[28:31], s54 offen lds
 s_mov_b32 m0, 161792
 s_add_u32 s54, s63, 27648
 buffer_load_dwordx4 v4, s[28:31], s54 offen lds
 s_mov_b32 m0, 162816
 s_add_u32 s54, s63, 29952
 buffer_load_dwordx4 v4, s[28:31], s54 offen lds
 ds_read_b64_tr_b16 a[216:217], v3 offset:20480
 ds_read_b64_tr_b16 a[218:219], v3 offset:21504
 ds_read_b64_tr_b16 a[220:221], v3 offset:22528
 ds_read_b64_tr_b16 a[222:223], v3 offset:23552
 ds_read_b64_tr_b16 a[224:225], v3 offset:20992
 ds_read_b64_tr_b16 a[226:227], v3 offset:22016
 ds_read_b64_tr_b16 a[228:229], v3 offset:23040
 ds_read_b64_tr_b16 a[230:231], v3 offset:24064
 s_waitcnt vmcnt(8) lgkmcnt(0)
 s_barrier
 s_mov_b32 m0, 147456
 s_add_u32 s54, s63, 9728
 buffer_load_dwordx4 v4, s[28:31], s54 offen lds
 s_mov_b32 m0, 148480
 s_add_u32 s54, s63, 12032
 buffer_load_dwordx4 v4, s[28:31], s54 offen lds
 s_mov_b32 m0, 149504
 s_add_u32 s54, s63, 28160
 buffer_load_dwordx4 v4, s[28:31], s54 offen lds
 s_mov_b32 m0, 150528
 s_add_u32 s54, s63, 30464
 buffer_load_dwordx4 v4, s[28:31], s54 offen lds
 v_xor_b32 v3, 64, v2
 ds_read_b64_tr_b16 a[168:169], v5 offset:24576
 ds_read_b64_tr_b16 a[170:171], v5 offset:25600
 ds_read_b64_tr_b16 a[172:173], v5 offset:26624
 ds_read_b64_tr_b16 a[174:175], v5 offset:27648
 ds_read_b64_tr_b16 a[192:193], v6 offset:24576
 ds_read_b64_tr_b16 a[194:195], v6 offset:25600
 ds_read_b64_tr_b16 a[196:197], v6 offset:26624
 ds_read_b64_tr_b16 a[198:199], v6 offset:27648
 s_waitcnt vmcnt(8) lgkmcnt(0)
 s_barrier
 s_mov_b32 m0, 151552
 s_add_u32 s54, s63, 73728
 buffer_load_dwordx4 v4, s[28:31], s54 offen lds
 s_mov_b32 m0, 152576
 s_add_u32 s54, s63, 76032
 buffer_load_dwordx4 v4, s[28:31], s54 offen lds
 s_mov_b32 m0, 153600
 s_add_u32 s54, s63, 92160
 buffer_load_dwordx4 v4, s[28:31], s54 offen lds
 s_mov_b32 m0, 154624
 s_add_u32 s54, s63, 94464
 buffer_load_dwordx4 v4, s[28:31], s54 offen lds
 ds_read_b64_tr_b16 a[232:233], v5 offset:28672
 ds_read_b64_tr_b16 a[234:235], v5 offset:29696
 ds_read_b64_tr_b16 a[236:237], v5 offset:30720
 ds_read_b64_tr_b16 a[238:239], v5 offset:31744
 ds_read_b64_tr_b16 v[64:65], v6 offset:28672
 ds_read_b64_tr_b16 v[66:67], v6 offset:29696
 ds_read_b64_tr_b16 v[68:69], v6 offset:30720
 ds_read_b64_tr_b16 v[70:71], v6 offset:31744
 s_waitcnt vmcnt(8) lgkmcnt(0)
 s_barrier
 s_mov_b32 m0, 155648
 s_add_u32 s54, s63, 74240
 buffer_load_dwordx4 v4, s[28:31], s54 offen lds
 s_mov_b32 m0, 156672
 s_add_u32 s54, s63, 76544
 buffer_load_dwordx4 v4, s[28:31], s54 offen lds
 s_mov_b32 m0, 157696
 s_add_u32 s54, s63, 92672
 buffer_load_dwordx4 v4, s[28:31], s54 offen lds
 s_mov_b32 m0, 158720
 s_add_u32 s54, s63, 94976
 buffer_load_dwordx4 v4, s[28:31], s54 offen lds
 ds_read_b64_tr_b16 a[176:177], v5 offset:32768
 ds_read_b64_tr_b16 a[178:179], v5 offset:33792
 ds_read_b64_tr_b16 a[180:181], v5 offset:34816
 ds_read_b64_tr_b16 a[182:183], v5 offset:35840
 ds_read_b64_tr_b16 a[200:201], v6 offset:32768
 ds_read_b64_tr_b16 a[202:203], v6 offset:33792
 ds_read_b64_tr_b16 a[204:205], v6 offset:34816
 ds_read_b64_tr_b16 a[206:207], v6 offset:35840
 s_waitcnt vmcnt(8) lgkmcnt(0)
 s_barrier
 s_mov_b32 m0, 159744
 s_add_u32 s54, s63, 82944
 buffer_load_dwordx4 v4, s[28:31], s54 offen lds
 s_mov_b32 m0, 160768
 s_add_u32 s54, s63, 85248
 buffer_load_dwordx4 v4, s[28:31], s54 offen lds
 s_mov_b32 m0, 161792
 s_add_u32 s54, s63, 101376
 buffer_load_dwordx4 v4, s[28:31], s54 offen lds
 s_mov_b32 m0, 162816
 s_add_u32 s54, s63, 103680
 buffer_load_dwordx4 v4, s[28:31], s54 offen lds
 ds_read_b64_tr_b16 v[56:57], v5 offset:20480
 ds_read_b64_tr_b16 v[58:59], v5 offset:21504
 ds_read_b64_tr_b16 v[60:61], v5 offset:22528
 ds_read_b64_tr_b16 v[62:63], v5 offset:23552
 ds_read_b64_tr_b16 a[248:249], v6 offset:20480
 ds_read_b64_tr_b16 a[250:251], v6 offset:21504
 ds_read_b64_tr_b16 a[252:253], v6 offset:22528
 ds_read_b64_tr_b16 a[254:255], v6 offset:23552
 s_waitcnt vmcnt(8) lgkmcnt(0)
 s_barrier
 s_mov_b32 m0, 147456
 s_add_u32 s54, s63, 83456
 buffer_load_dwordx4 v4, s[28:31], s54 offen lds
 s_mov_b32 m0, 148480
 s_add_u32 s54, s63, 85760
 buffer_load_dwordx4 v4, s[28:31], s54 offen lds
 s_mov_b32 m0, 149504
 s_add_u32 s54, s63, 101888
 buffer_load_dwordx4 v4, s[28:31], s54 offen lds
 s_mov_b32 m0, 150528
 s_add_u32 s54, s63, 104192
 buffer_load_dwordx4 v4, s[28:31], s54 offen lds
 ds_read_b64_tr_b16 a[184:185], v5 offset:24576
 ds_read_b64_tr_b16 a[186:187], v5 offset:25600
 ds_read_b64_tr_b16 a[188:189], v5 offset:26624
 ds_read_b64_tr_b16 a[190:191], v5 offset:27648
 ds_read_b64_tr_b16 a[208:209], v6 offset:24576
 ds_read_b64_tr_b16 a[210:211], v6 offset:25600
 ds_read_b64_tr_b16 a[212:213], v6 offset:26624
 ds_read_b64_tr_b16 a[214:215], v6 offset:27648
 s_waitcnt vmcnt(8) lgkmcnt(0)
 s_barrier
 s_mov_b32 m0, 151552
 s_add_u32 s54, s62, 0
 buffer_load_dwordx4 v0, s[16:19], s54 offen lds
 s_mov_b32 m0, 152576
 s_add_u32 s54, s62, 16384
 buffer_load_dwordx4 v0, s[16:19], s54 offen lds
 s_mov_b32 m0, 153600
 s_add_u32 s54, s62, 131072
 buffer_load_dwordx4 v0, s[16:19], s54 offen lds
 s_mov_b32 m0, 154624
 s_add_u32 s54, s62, 147456
 buffer_load_dwordx4 v0, s[16:19], s54 offen lds
 ds_read_b64_tr_b16 a[240:241], v5 offset:28672
 ds_read_b64_tr_b16 a[242:243], v5 offset:29696
 ds_read_b64_tr_b16 a[244:245], v5 offset:30720
 ds_read_b64_tr_b16 a[246:247], v5 offset:31744
 ds_read_b64_tr_b16 v[72:73], v6 offset:28672
 ds_read_b64_tr_b16 v[74:75], v6 offset:29696
 ds_read_b64_tr_b16 v[76:77], v6 offset:30720
 ds_read_b64_tr_b16 v[78:79], v6 offset:31744
 s_waitcnt vmcnt(8) lgkmcnt(0)
 s_barrier
 s_mov_b32 m0, 155648
 s_add_u32 s54, s62, 524288
 buffer_load_dwordx4 v0, s[16:19], s54 offen lds
 s_mov_b32 m0, 156672
 s_add_u32 s54, s62, 540672
 buffer_load_dwordx4 v0, s[16:19], s54 offen lds
 s_mov_b32 m0, 157696
 s_add_u32 s54, s62, 655360
 buffer_load_dwordx4 v0, s[16:19], s54 offen lds
 s_mov_b32 m0, 158720
 s_add_u32 s54, s62, 671744
 buffer_load_dwordx4 v0, s[16:19], s54 offen lds
 ds_read_b64_tr_b16 v[48:49], v5 offset:32768
 ds_read_b64_tr_b16 v[50:51], v5 offset:33792
 ds_read_b64_tr_b16 v[52:53], v5 offset:34816
 ds_read_b64_tr_b16 v[54:55], v5 offset:35840
 ds_read_b64_tr_b16 a[144:145], v6 offset:32768
 ds_read_b64_tr_b16 a[146:147], v6 offset:33792
 ds_read_b64_tr_b16 a[148:149], v6 offset:34816
 ds_read_b64_tr_b16 a[150:151], v6 offset:35840
 s_waitcnt vmcnt(8) lgkmcnt(0)
 s_barrier
 s_mov_b32 m0, 159744
 s_add_u32 s54, s62, 1048576
 buffer_load_dwordx4 v0, s[16:19], s54 offen lds
 s_mov_b32 m0, 160768
 s_add_u32 s54, s62, 1064960
 buffer_load_dwordx4 v0, s[16:19], s54 offen lds
 s_mov_b32 m0, 161792
 s_add_u32 s54, s62, 1179648
 buffer_load_dwordx4 v0, s[16:19], s54 offen lds
 s_mov_b32 m0, 162816
 s_add_u32 s54, s62, 1196032
 buffer_load_dwordx4 v0, s[16:19], s54 offen lds
 ds_read_b64_tr_b16 a[152:153], v5 offset:20480
 ds_read_b64_tr_b16 a[154:155], v5 offset:21504
 ds_read_b64_tr_b16 a[156:157], v5 offset:22528
 ds_read_b64_tr_b16 a[158:159], v5 offset:23552
 ds_read_b64_tr_b16 a[160:161], v6 offset:20480
 ds_read_b64_tr_b16 a[162:163], v6 offset:21504
 ds_read_b64_tr_b16 a[164:165], v6 offset:22528
 ds_read_b64_tr_b16 a[166:167], v6 offset:23552
 s_waitcnt vmcnt(8) lgkmcnt(0)
 s_barrier
 s_mov_b32 m0, 147456
 s_add_u32 s54, s62, 1572864
 buffer_load_dwordx4 v0, s[16:19], s54 offen lds
 s_mov_b32 m0, 148480
 s_add_u32 s54, s62, 1589248
 buffer_load_dwordx4 v0, s[16:19], s54 offen lds
 s_mov_b32 m0, 149504
 s_add_u32 s54, s62, 1703936
 buffer_load_dwordx4 v0, s[16:19], s54 offen lds
 s_mov_b32 m0, 150528
 s_add_u32 s54, s62, 1720320
 buffer_load_dwordx4 v0, s[16:19], s54 offen lds
 ds_read_b64_tr_b16 v[96:97], v2 offset:24576
 ds_read_b64_tr_b16 v[98:99], v2 offset:25600
 ds_read_b64_tr_b16 v[100:101], v2 offset:26624
 ds_read_b64_tr_b16 v[102:103], v2 offset:27648
 ds_read_b64_tr_b16 v[104:105], v3 offset:24576
 ds_read_b64_tr_b16 v[106:107], v3 offset:25600
 ds_read_b64_tr_b16 v[108:109], v3 offset:26624
 ds_read_b64_tr_b16 v[110:111], v3 offset:27648
 s_waitcnt vmcnt(8) lgkmcnt(0)
 s_barrier
 s_mov_b32 m0, 151552
 s_add_u32 s54, s62, 4194304
 buffer_load_dwordx4 v0, s[16:19], s54 offen lds
 s_mov_b32 m0, 152576
 s_add_u32 s54, s62, 4210688
 buffer_load_dwordx4 v0, s[16:19], s54 offen lds
 s_mov_b32 m0, 153600
 s_add_u32 s54, s62, 4325376
 buffer_load_dwordx4 v0, s[16:19], s54 offen lds
 s_mov_b32 m0, 154624
 s_add_u32 s54, s62, 4341760
 buffer_load_dwordx4 v0, s[16:19], s54 offen lds
 ds_read_b64_tr_b16 v[128:129], v2 offset:28672
 ds_read_b64_tr_b16 v[130:131], v2 offset:29696
 ds_read_b64_tr_b16 v[132:133], v2 offset:30720
 ds_read_b64_tr_b16 v[134:135], v2 offset:31744
 ds_read_b64_tr_b16 v[136:137], v3 offset:28672
 ds_read_b64_tr_b16 v[138:139], v3 offset:29696
 ds_read_b64_tr_b16 v[140:141], v3 offset:30720
 ds_read_b64_tr_b16 v[142:143], v3 offset:31744
 s_waitcnt vmcnt(8) lgkmcnt(0)
 s_barrier
 s_mov_b32 m0, 155648
 s_add_u32 s54, s62, 0
 buffer_load_dwordx4 v0, s[20:23], s54 offen lds
 s_mov_b32 m0, 156672
 s_add_u32 s54, s62, 16384
 buffer_load_dwordx4 v0, s[20:23], s54 offen lds
 s_mov_b32 m0, 157696
 s_add_u32 s54, s62, 131072
 buffer_load_dwordx4 v0, s[20:23], s54 offen lds
 s_mov_b32 m0, 158720
 s_add_u32 s54, s62, 147456
 buffer_load_dwordx4 v0, s[20:23], s54 offen lds
 ds_read_b64_tr_b16 v[168:169], v2 offset:32768
 ds_read_b64_tr_b16 v[170:171], v2 offset:33792
 ds_read_b64_tr_b16 v[172:173], v2 offset:34816
 ds_read_b64_tr_b16 v[174:175], v2 offset:35840
 ds_read_b64_tr_b16 v[8:9], v3 offset:32768
 ds_read_b64_tr_b16 v[10:11], v3 offset:33792
 ds_read_b64_tr_b16 v[12:13], v3 offset:34816
 ds_read_b64_tr_b16 v[14:15], v3 offset:35840
 s_waitcnt lgkmcnt(2)
 ds_write_b128 v1, v[8:11] offset:14336
 s_waitcnt lgkmcnt(1)
 ds_write_b128 v1, v[12:15] offset:15360
 s_waitcnt vmcnt(8) lgkmcnt(0)
 s_barrier
 s_mov_b32 m0, 159744
 s_add_u32 s54, s62, 524288
 buffer_load_dwordx4 v0, s[20:23], s54 offen lds
 s_mov_b32 m0, 160768
 s_add_u32 s54, s62, 540672
 buffer_load_dwordx4 v0, s[20:23], s54 offen lds
 s_mov_b32 m0, 161792
 s_add_u32 s54, s62, 655360
 buffer_load_dwordx4 v0, s[20:23], s54 offen lds
 s_mov_b32 m0, 162816
 s_add_u32 s54, s62, 671744
 buffer_load_dwordx4 v0, s[20:23], s54 offen lds
 ds_read_b64_tr_b16 v[8:9], v2 offset:20480
 ds_read_b64_tr_b16 v[10:11], v2 offset:21504
 ds_read_b64_tr_b16 v[12:13], v2 offset:22528
 ds_read_b64_tr_b16 v[14:15], v2 offset:23552
 s_waitcnt lgkmcnt(2)
 ds_write_b128 v1, v[8:11] offset:0
 s_waitcnt lgkmcnt(1)
 ds_write_b128 v1, v[12:15] offset:1024
 ds_read_b64_tr_b16 v[8:9], v3 offset:20480
 ds_read_b64_tr_b16 v[10:11], v3 offset:21504
 ds_read_b64_tr_b16 v[12:13], v3 offset:22528
 ds_read_b64_tr_b16 v[14:15], v3 offset:23552
 s_waitcnt lgkmcnt(2)
 ds_write_b128 v1, v[8:11] offset:2048
 s_waitcnt lgkmcnt(1)
 ds_write_b128 v1, v[12:15] offset:3072
 s_waitcnt vmcnt(8) lgkmcnt(0)
 s_barrier
 s_mov_b32 m0, 147456
 s_add_u32 s54, s62, 1048576
 buffer_load_dwordx4 v0, s[20:23], s54 offen lds
 s_mov_b32 m0, 148480
 s_add_u32 s54, s62, 1064960
 buffer_load_dwordx4 v0, s[20:23], s54 offen lds
 s_mov_b32 m0, 149504
 s_add_u32 s54, s62, 1179648
 buffer_load_dwordx4 v0, s[20:23], s54 offen lds
 s_mov_b32 m0, 150528
 s_add_u32 s54, s62, 1196032
 buffer_load_dwordx4 v0, s[20:23], s54 offen lds
 ds_read_b64_tr_b16 v[216:217], v2 offset:24576
 ds_read_b64_tr_b16 v[218:219], v2 offset:25600
 ds_read_b64_tr_b16 v[220:221], v2 offset:26624
 ds_read_b64_tr_b16 v[222:223], v2 offset:27648
 ds_read_b64_tr_b16 v[8:9], v3 offset:24576
 ds_read_b64_tr_b16 v[10:11], v3 offset:25600
 ds_read_b64_tr_b16 v[12:13], v3 offset:26624
 ds_read_b64_tr_b16 v[14:15], v3 offset:27648
 s_waitcnt lgkmcnt(2)
 ds_write_b128 v1, v[8:11] offset:18432
 s_waitcnt lgkmcnt(1)
 ds_write_b128 v1, v[12:15] offset:19456
 s_waitcnt vmcnt(8) lgkmcnt(0)
 s_barrier
 s_mov_b32 m0, 151552
 s_add_u32 s54, s62, 1572864
 buffer_load_dwordx4 v0, s[20:23], s54 offen lds
 s_mov_b32 m0, 152576
 s_add_u32 s54, s62, 1589248
 buffer_load_dwordx4 v0, s[20:23], s54 offen lds
 s_mov_b32 m0, 153600
 s_add_u32 s54, s62, 1703936
 buffer_load_dwordx4 v0, s[20:23], s54 offen lds
 s_mov_b32 m0, 154624
 s_add_u32 s54, s62, 1720320
 buffer_load_dwordx4 v0, s[20:23], s54 offen lds
 ds_read_b64_tr_b16 v[112:113], v2 offset:28672
 ds_read_b64_tr_b16 v[114:115], v2 offset:29696
 ds_read_b64_tr_b16 v[116:117], v2 offset:30720
 ds_read_b64_tr_b16 v[118:119], v2 offset:31744
 ds_read_b64_tr_b16 v[8:9], v3 offset:28672
 ds_read_b64_tr_b16 v[10:11], v3 offset:29696
 ds_read_b64_tr_b16 v[12:13], v3 offset:30720
 ds_read_b64_tr_b16 v[14:15], v3 offset:31744
 s_waitcnt lgkmcnt(2)
 ds_write_b128 v1, v[8:11] offset:8192
 s_waitcnt lgkmcnt(1)
 ds_write_b128 v1, v[12:15] offset:9216
 s_waitcnt vmcnt(8) lgkmcnt(0)
 s_barrier
 s_mov_b32 m0, 155648
 s_add_u32 s54, s62, 0
 buffer_load_dwordx4 v0, s[24:27], s54 offen lds
 s_mov_b32 m0, 156672
 s_add_u32 s54, s62, 16384
 buffer_load_dwordx4 v0, s[24:27], s54 offen lds
 s_mov_b32 m0, 157696
 s_add_u32 s54, s62, 131072
 buffer_load_dwordx4 v0, s[24:27], s54 offen lds
 s_mov_b32 m0, 158720
 s_add_u32 s54, s62, 147456
 buffer_load_dwordx4 v0, s[24:27], s54 offen lds
 ds_read_b64_tr_b16 v[144:145], v2 offset:32768
 ds_read_b64_tr_b16 v[146:147], v2 offset:33792
 ds_read_b64_tr_b16 v[148:149], v2 offset:34816
 ds_read_b64_tr_b16 v[150:151], v2 offset:35840
 ds_read_b64_tr_b16 v[152:153], v3 offset:32768
 ds_read_b64_tr_b16 v[154:155], v3 offset:33792
 ds_read_b64_tr_b16 v[156:157], v3 offset:34816
 ds_read_b64_tr_b16 v[158:159], v3 offset:35840
 s_waitcnt vmcnt(8) lgkmcnt(0)
 s_barrier
 s_mov_b32 m0, 159744
 s_add_u32 s54, s62, 524288
 buffer_load_dwordx4 v0, s[24:27], s54 offen lds
 s_mov_b32 m0, 160768
 s_add_u32 s54, s62, 540672
 buffer_load_dwordx4 v0, s[24:27], s54 offen lds
 s_mov_b32 m0, 161792
 s_add_u32 s54, s62, 655360
 buffer_load_dwordx4 v0, s[24:27], s54 offen lds
 s_mov_b32 m0, 162816
 s_add_u32 s54, s62, 671744
 buffer_load_dwordx4 v0, s[24:27], s54 offen lds
 ds_read_b64_tr_b16 v[176:177], v2 offset:20480
 ds_read_b64_tr_b16 v[178:179], v2 offset:21504
 ds_read_b64_tr_b16 v[180:181], v2 offset:22528
 ds_read_b64_tr_b16 v[182:183], v2 offset:23552
 ds_read_b64_tr_b16 v[184:185], v3 offset:20480
 ds_read_b64_tr_b16 v[186:187], v3 offset:21504
 ds_read_b64_tr_b16 v[188:189], v3 offset:22528
 ds_read_b64_tr_b16 v[190:191], v3 offset:23552
 s_waitcnt vmcnt(8) lgkmcnt(0)
 s_barrier
 s_mov_b32 m0, 147456
 s_add_u32 s54, s62, 1048576
 buffer_load_dwordx4 v0, s[24:27], s54 offen lds
 s_mov_b32 m0, 148480
 s_add_u32 s54, s62, 1064960
 buffer_load_dwordx4 v0, s[24:27], s54 offen lds
 s_mov_b32 m0, 149504
 s_add_u32 s54, s62, 1179648
 buffer_load_dwordx4 v0, s[24:27], s54 offen lds
 s_mov_b32 m0, 150528
 s_add_u32 s54, s62, 1196032
 buffer_load_dwordx4 v0, s[24:27], s54 offen lds
 ds_read_b64_tr_b16 v[8:9], v2 offset:24576
 ds_read_b64_tr_b16 v[10:11], v2 offset:25600
 ds_read_b64_tr_b16 v[12:13], v2 offset:26624
 ds_read_b64_tr_b16 v[14:15], v2 offset:27648
 s_waitcnt lgkmcnt(2)
 ds_write_b128 v1, v[8:11] offset:4096
 s_waitcnt lgkmcnt(1)
 ds_write_b128 v1, v[12:15] offset:5120
 ds_read_b64_tr_b16 v[8:9], v3 offset:24576
 ds_read_b64_tr_b16 v[10:11], v3 offset:25600
 ds_read_b64_tr_b16 v[12:13], v3 offset:26624
 ds_read_b64_tr_b16 v[14:15], v3 offset:27648
 s_waitcnt lgkmcnt(2)
 ds_write_b128 v1, v[8:11] offset:6144
 s_waitcnt lgkmcnt(1)
 ds_write_b128 v1, v[12:15] offset:7168
 s_waitcnt vmcnt(8) lgkmcnt(0)
 s_barrier
 s_mov_b32 m0, 151552
 s_add_u32 s54, s62, 1572864
 buffer_load_dwordx4 v0, s[24:27], s54 offen lds
 s_mov_b32 m0, 152576
 s_add_u32 s54, s62, 1589248
 buffer_load_dwordx4 v0, s[24:27], s54 offen lds
 s_mov_b32 m0, 153600
 s_add_u32 s54, s62, 1703936
 buffer_load_dwordx4 v0, s[24:27], s54 offen lds
 s_mov_b32 m0, 154624
 s_add_u32 s54, s62, 1720320
 buffer_load_dwordx4 v0, s[24:27], s54 offen lds
 ds_read_b64_tr_b16 v[120:121], v2 offset:28672
 ds_read_b64_tr_b16 v[122:123], v2 offset:29696
 ds_read_b64_tr_b16 v[124:125], v2 offset:30720
 ds_read_b64_tr_b16 v[126:127], v2 offset:31744
 ds_read_b64_tr_b16 v[8:9], v3 offset:28672
 ds_read_b64_tr_b16 v[10:11], v3 offset:29696
 ds_read_b64_tr_b16 v[12:13], v3 offset:30720
 ds_read_b64_tr_b16 v[14:15], v3 offset:31744
 s_waitcnt lgkmcnt(2)
 ds_write_b128 v1, v[8:11] offset:10240
 s_waitcnt lgkmcnt(1)
 ds_write_b128 v1, v[12:15] offset:11264
 s_waitcnt vmcnt(8) lgkmcnt(0)
 s_barrier
 s_mov_b32 m0, 155648
 s_add_u32 s54, s62, 2097152
 buffer_load_dwordx4 v0, s[16:19], s54 offen lds
 s_mov_b32 m0, 156672
 s_add_u32 s54, s62, 2113536
 buffer_load_dwordx4 v0, s[16:19], s54 offen lds
 s_mov_b32 m0, 157696
 s_add_u32 s54, s62, 2228224
 buffer_load_dwordx4 v0, s[16:19], s54 offen lds
 s_mov_b32 m0, 158720
 s_add_u32 s54, s62, 2244608
 buffer_load_dwordx4 v0, s[16:19], s54 offen lds
 ds_read_b64_tr_b16 v[8:9], v2 offset:32768
 ds_read_b64_tr_b16 v[10:11], v2 offset:33792
 ds_read_b64_tr_b16 v[12:13], v2 offset:34816
 ds_read_b64_tr_b16 v[14:15], v2 offset:35840
 s_waitcnt lgkmcnt(2)
 ds_write_b128 v1, v[8:11] offset:12288
 s_waitcnt lgkmcnt(1)
 ds_write_b128 v1, v[12:15] offset:13312
 ds_read_b64_tr_b16 v[160:161], v3 offset:32768
 ds_read_b64_tr_b16 v[162:163], v3 offset:33792
 ds_read_b64_tr_b16 v[164:165], v3 offset:34816
 ds_read_b64_tr_b16 v[166:167], v3 offset:35840
 s_waitcnt vmcnt(8) lgkmcnt(0)
 s_barrier
 s_mov_b32 m0, 159744
 s_add_u32 s54, s62, 2621440
 buffer_load_dwordx4 v0, s[16:19], s54 offen lds
 s_mov_b32 m0, 160768
 s_add_u32 s54, s62, 2637824
 buffer_load_dwordx4 v0, s[16:19], s54 offen lds
 s_mov_b32 m0, 161792
 s_add_u32 s54, s62, 2752512
 buffer_load_dwordx4 v0, s[16:19], s54 offen lds
 s_mov_b32 m0, 162816
 s_add_u32 s54, s62, 2768896
 buffer_load_dwordx4 v0, s[16:19], s54 offen lds
 ds_read_b64_tr_b16 v[192:193], v2 offset:20480
 ds_read_b64_tr_b16 v[194:195], v2 offset:21504
 ds_read_b64_tr_b16 v[196:197], v2 offset:22528
 ds_read_b64_tr_b16 v[198:199], v2 offset:23552
 ds_read_b64_tr_b16 v[8:9], v3 offset:20480
 ds_read_b64_tr_b16 v[10:11], v3 offset:21504
 ds_read_b64_tr_b16 v[12:13], v3 offset:22528
 ds_read_b64_tr_b16 v[14:15], v3 offset:23552
 s_waitcnt lgkmcnt(2)
 ds_write_b128 v1, v[8:11] offset:16384
 s_waitcnt lgkmcnt(1)
 ds_write_b128 v1, v[12:15] offset:17408
 s_waitcnt vmcnt(8) lgkmcnt(0)
 s_barrier
 s_mov_b32 m0, 147456
 s_add_u32 s54, s62, 3145728
 buffer_load_dwordx4 v0, s[16:19], s54 offen lds
 s_mov_b32 m0, 148480
 s_add_u32 s54, s62, 3162112
 buffer_load_dwordx4 v0, s[16:19], s54 offen lds
 s_mov_b32 m0, 149504
 s_add_u32 s54, s62, 3276800
 buffer_load_dwordx4 v0, s[16:19], s54 offen lds
 s_mov_b32 m0, 150528
 s_add_u32 s54, s62, 3293184
 buffer_load_dwordx4 v0, s[16:19], s54 offen lds
 ds_read_b64_tr_b16 v[80:81], v2 offset:24576
 ds_read_b64_tr_b16 v[82:83], v2 offset:25600
 ds_read_b64_tr_b16 v[84:85], v2 offset:26624
 ds_read_b64_tr_b16 v[86:87], v2 offset:27648
 ds_read_b64_tr_b16 v[88:89], v3 offset:24576
 ds_read_b64_tr_b16 v[90:91], v3 offset:25600
 ds_read_b64_tr_b16 v[92:93], v3 offset:26624
 ds_read_b64_tr_b16 v[94:95], v3 offset:27648
 s_waitcnt vmcnt(8) lgkmcnt(0)
 s_barrier
 s_mov_b32 m0, 151552
 s_add_u32 s54, s62, 3670016
 buffer_load_dwordx4 v0, s[16:19], s54 offen lds
 s_mov_b32 m0, 152576
 s_add_u32 s54, s62, 3686400
 buffer_load_dwordx4 v0, s[16:19], s54 offen lds
 s_mov_b32 m0, 153600
 s_add_u32 s54, s62, 3801088
 buffer_load_dwordx4 v0, s[16:19], s54 offen lds
 s_mov_b32 m0, 154624
 s_add_u32 s54, s62, 3817472
 buffer_load_dwordx4 v0, s[16:19], s54 offen lds
 ds_read_b64_tr_b16 v[224:225], v2 offset:28672
 ds_read_b64_tr_b16 v[226:227], v2 offset:29696
 ds_read_b64_tr_b16 v[228:229], v2 offset:30720
 ds_read_b64_tr_b16 v[230:231], v2 offset:31744
 ds_read_b64_tr_b16 v[248:249], v3 offset:28672
 ds_read_b64_tr_b16 v[250:251], v3 offset:29696
 ds_read_b64_tr_b16 v[252:253], v3 offset:30720
 ds_read_b64_tr_b16 v[254:255], v3 offset:31744
 s_waitcnt vmcnt(8) lgkmcnt(0)
 s_barrier
 s_mov_b32 m0, 155648
 s_add_u32 s54, s62, 2097152
 buffer_load_dwordx4 v0, s[20:23], s54 offen lds
 s_mov_b32 m0, 156672
 s_add_u32 s54, s62, 2113536
 buffer_load_dwordx4 v0, s[20:23], s54 offen lds
 s_mov_b32 m0, 157696
 s_add_u32 s54, s62, 2228224
 buffer_load_dwordx4 v0, s[20:23], s54 offen lds
 s_mov_b32 m0, 158720
 s_add_u32 s54, s62, 2244608
 buffer_load_dwordx4 v0, s[20:23], s54 offen lds
 ds_read_b64_tr_b16 v[232:233], v2 offset:32768
 ds_read_b64_tr_b16 v[234:235], v2 offset:33792
 ds_read_b64_tr_b16 v[236:237], v2 offset:34816
 ds_read_b64_tr_b16 v[238:239], v2 offset:35840
 ds_read_b64_tr_b16 a[0:1], v3 offset:32768
 ds_read_b64_tr_b16 a[2:3], v3 offset:33792
 ds_read_b64_tr_b16 a[4:5], v3 offset:34816
 ds_read_b64_tr_b16 a[6:7], v3 offset:35840
 s_waitcnt vmcnt(8) lgkmcnt(0)
 s_barrier
 s_mov_b32 m0, 159744
 s_add_u32 s54, s62, 2621440
 buffer_load_dwordx4 v0, s[20:23], s54 offen lds
 s_mov_b32 m0, 160768
 s_add_u32 s54, s62, 2637824
 buffer_load_dwordx4 v0, s[20:23], s54 offen lds
 s_mov_b32 m0, 161792
 s_add_u32 s54, s62, 2752512
 buffer_load_dwordx4 v0, s[20:23], s54 offen lds
 s_mov_b32 m0, 162816
 s_add_u32 s54, s62, 2768896
 buffer_load_dwordx4 v0, s[20:23], s54 offen lds
 ds_read_b64_tr_b16 v[240:241], v2 offset:20480
 ds_read_b64_tr_b16 v[242:243], v2 offset:21504
 ds_read_b64_tr_b16 v[244:245], v2 offset:22528
 ds_read_b64_tr_b16 v[246:247], v2 offset:23552
 ds_read_b64_tr_b16 a[8:9], v3 offset:20480
 ds_read_b64_tr_b16 a[10:11], v3 offset:21504
 ds_read_b64_tr_b16 a[12:13], v3 offset:22528
 ds_read_b64_tr_b16 a[14:15], v3 offset:23552
 s_waitcnt vmcnt(8) lgkmcnt(0)
 s_barrier
 s_mov_b32 m0, 147456
 s_add_u32 s54, s62, 3145728
 buffer_load_dwordx4 v0, s[20:23], s54 offen lds
 s_mov_b32 m0, 148480
 s_add_u32 s54, s62, 3162112
 buffer_load_dwordx4 v0, s[20:23], s54 offen lds
 s_mov_b32 m0, 149504
 s_add_u32 s54, s62, 3276800
 buffer_load_dwordx4 v0, s[20:23], s54 offen lds
 s_mov_b32 m0, 150528
 s_add_u32 s54, s62, 3293184
 buffer_load_dwordx4 v0, s[20:23], s54 offen lds
 ds_read_b64_tr_b16 v[200:201], v2 offset:24576
 ds_read_b64_tr_b16 v[202:203], v2 offset:25600
 ds_read_b64_tr_b16 v[204:205], v2 offset:26624
 ds_read_b64_tr_b16 v[206:207], v2 offset:27648
 ds_read_b64_tr_b16 v[208:209], v3 offset:24576
 ds_read_b64_tr_b16 v[210:211], v3 offset:25600
 ds_read_b64_tr_b16 v[212:213], v3 offset:26624
 ds_read_b64_tr_b16 v[214:215], v3 offset:27648
 s_waitcnt vmcnt(8) lgkmcnt(0)
 s_barrier
 s_mov_b32 m0, 151552
 s_add_u32 s54, s62, 3670016
 buffer_load_dwordx4 v0, s[20:23], s54 offen lds
 s_mov_b32 m0, 152576
 s_add_u32 s54, s62, 3686400
 buffer_load_dwordx4 v0, s[20:23], s54 offen lds
 s_mov_b32 m0, 153600
 s_add_u32 s54, s62, 3801088
 buffer_load_dwordx4 v0, s[20:23], s54 offen lds
 s_mov_b32 m0, 154624
 s_add_u32 s54, s62, 3817472
 buffer_load_dwordx4 v0, s[20:23], s54 offen lds
 ds_read_b64_tr_b16 a[24:25], v2 offset:28672
 ds_read_b64_tr_b16 a[26:27], v2 offset:29696
 ds_read_b64_tr_b16 a[28:29], v2 offset:30720
 ds_read_b64_tr_b16 a[30:31], v2 offset:31744
 ds_read_b64_tr_b16 v[24:25], v3 offset:28672
 ds_read_b64_tr_b16 v[26:27], v3 offset:29696
 ds_read_b64_tr_b16 v[28:29], v3 offset:30720
 ds_read_b64_tr_b16 v[30:31], v3 offset:31744
 s_waitcnt vmcnt(8) lgkmcnt(0)
 s_barrier
 s_mov_b32 m0, 155648
 s_add_u32 s54, s62, 4194304
 buffer_load_dwordx4 v0, s[20:23], s54 offen lds
 s_mov_b32 m0, 156672
 s_add_u32 s54, s62, 4210688
 buffer_load_dwordx4 v0, s[20:23], s54 offen lds
 s_mov_b32 m0, 157696
 s_add_u32 s54, s62, 4325376
 buffer_load_dwordx4 v0, s[20:23], s54 offen lds
 s_mov_b32 m0, 158720
 s_add_u32 s54, s62, 4341760
 buffer_load_dwordx4 v0, s[20:23], s54 offen lds
 v_mbcnt_lo_u32_b32 v8, -1, 0
 v_mbcnt_hi_u32_b32 v8, -1, v8
 v_lshlrev_b32 v4, 7, v8
 v_mov_b32 v5, 0
 v_bfe_u32 v9, v8, 2, 2
 s_mov_b32 s101, 2304
 v_mad_u32_u24 v5, v9, s101, v5
 v_bfe_u32 v9, v8, 0, 1
 s_mov_b32 s101, 1152
 v_mad_u32_u24 v5, v9, s101, v5
 v_bfe_u32 v9, v8, 1, 1
 v_lshl_add_u32 v5, v9, 6, v5
 v_bfe_u32 v9, v8, 4, 2
 v_lshl_add_u32 v5, v9, 4, v5
 s_mov_b32 m0, 6144
 s_mov_b32 s54, 384
 buffer_load_dwordx4 v5, s[32:35], s54 offen lds
 s_mov_b32 m0, 7168
 s_mov_b32 s54, 896
 buffer_load_dwordx4 v5, s[32:35], s54 offen lds
 s_mov_b32 m0, 8192
 s_mov_b32 s54, 1024
 buffer_load_dwordx4 v5, s[32:35], s54 offen lds
 ds_read_b64_tr_b16 a[32:33], v2 offset:32768
 ds_read_b64_tr_b16 a[34:35], v2 offset:33792
 ds_read_b64_tr_b16 a[36:37], v2 offset:34816
 ds_read_b64_tr_b16 a[38:39], v2 offset:35840
 ds_read_b64_tr_b16 a[64:65], v3 offset:32768
 ds_read_b64_tr_b16 a[66:67], v3 offset:33792
 ds_read_b64_tr_b16 a[68:69], v3 offset:34816
 ds_read_b64_tr_b16 a[70:71], v3 offset:35840
 s_waitcnt vmcnt(11) lgkmcnt(0)
 s_barrier
 s_mov_b32 m0, 159744
 s_add_u32 s54, s62, 2097152
 buffer_load_dwordx4 v0, s[24:27], s54 offen lds
 s_mov_b32 m0, 160768
 s_add_u32 s54, s62, 2113536
 buffer_load_dwordx4 v0, s[24:27], s54 offen lds
 s_mov_b32 m0, 161792
 s_add_u32 s54, s62, 2228224
 buffer_load_dwordx4 v0, s[24:27], s54 offen lds
 s_mov_b32 m0, 162816
 s_add_u32 s54, s62, 2244608
 buffer_load_dwordx4 v0, s[24:27], s54 offen lds
 s_mov_b32 s54, 128
 buffer_load_dwordx4 v[8:11], off, s[12:15], s54 sc1
 buffer_load_dwordx4 v[12:15], off, s[12:15], s54 offset:16 sc1
 buffer_load_dword v5, off, s[12:15], s57 sc1
 ds_read_b64_tr_b16 a[40:41], v2 offset:20480
 ds_read_b64_tr_b16 a[42:43], v2 offset:21504
 ds_read_b64_tr_b16 a[44:45], v2 offset:22528
 ds_read_b64_tr_b16 a[46:47], v2 offset:23552
 ds_read_b64_tr_b16 a[72:73], v3 offset:20480
 ds_read_b64_tr_b16 a[74:75], v3 offset:21504
 ds_read_b64_tr_b16 a[76:77], v3 offset:22528
 ds_read_b64_tr_b16 a[78:79], v3 offset:23552
 s_waitcnt vmcnt(14) lgkmcnt(0)
 s_barrier
 s_mov_b32 m0, 147456
 s_add_u32 s54, s62, 2621440
 buffer_load_dwordx4 v0, s[24:27], s54 offen lds
 s_mov_b32 m0, 148480
 s_add_u32 s54, s62, 2637824
 buffer_load_dwordx4 v0, s[24:27], s54 offen lds
 s_mov_b32 m0, 149504
 s_add_u32 s54, s62, 2752512
 buffer_load_dwordx4 v0, s[24:27], s54 offen lds
 s_mov_b32 m0, 150528
 s_add_u32 s54, s62, 2768896
 buffer_load_dwordx4 v0, s[24:27], s54 offen lds
 ds_read_b64_tr_b16 v[16:17], v2 offset:24576
 ds_read_b64_tr_b16 v[18:19], v2 offset:25600
 ds_read_b64_tr_b16 v[20:21], v2 offset:26624
 ds_read_b64_tr_b16 v[22:23], v2 offset:27648
 ds_read_b64_tr_b16 a[48:49], v3 offset:24576
 ds_read_b64_tr_b16 a[50:51], v3 offset:25600
 ds_read_b64_tr_b16 a[52:53], v3 offset:26624
 ds_read_b64_tr_b16 a[54:55], v3 offset:27648
 s_waitcnt vmcnt(14) lgkmcnt(0)
 s_barrier
 s_mov_b32 m0, 151552
 s_add_u32 s54, s62, 3145728
 buffer_load_dwordx4 v0, s[24:27], s54 offen lds
 s_mov_b32 m0, 152576
 s_add_u32 s54, s62, 3162112
 buffer_load_dwordx4 v0, s[24:27], s54 offen lds
 s_mov_b32 m0, 153600
 s_add_u32 s54, s62, 3276800
 buffer_load_dwordx4 v0, s[24:27], s54 offen lds
 s_mov_b32 m0, 154624
 s_add_u32 s54, s62, 3293184
 buffer_load_dwordx4 v0, s[24:27], s54 offen lds
 ds_read_b64_tr_b16 a[16:17], v2 offset:28672
 ds_read_b64_tr_b16 a[18:19], v2 offset:29696
 ds_read_b64_tr_b16 a[20:21], v2 offset:30720
 ds_read_b64_tr_b16 a[22:23], v2 offset:31744
 ds_read_b64_tr_b16 a[56:57], v3 offset:28672
 ds_read_b64_tr_b16 a[58:59], v3 offset:29696
 ds_read_b64_tr_b16 a[60:61], v3 offset:30720
 ds_read_b64_tr_b16 a[62:63], v3 offset:31744
 s_waitcnt vmcnt(11) lgkmcnt(0)
 s_barrier
 s_mov_b32 m0, 155648
 s_add_u32 s54, s62, 3670016
 buffer_load_dwordx4 v0, s[24:27], s54 offen lds
 s_mov_b32 m0, 156672
 s_add_u32 s54, s62, 3686400
 buffer_load_dwordx4 v0, s[24:27], s54 offen lds
 s_mov_b32 m0, 157696
 s_add_u32 s54, s62, 3801088
 buffer_load_dwordx4 v0, s[24:27], s54 offen lds
 s_mov_b32 m0, 158720
 s_add_u32 s54, s62, 3817472
 buffer_load_dwordx4 v0, s[24:27], s54 offen lds
 ds_read_b64_tr_b16 a[104:105], v2 offset:32768
 ds_read_b64_tr_b16 a[106:107], v2 offset:33792
 ds_read_b64_tr_b16 a[108:109], v2 offset:34816
 ds_read_b64_tr_b16 a[110:111], v2 offset:35840
 ds_read_b64_tr_b16 a[112:113], v3 offset:32768
 ds_read_b64_tr_b16 a[114:115], v3 offset:33792
 ds_read_b64_tr_b16 a[116:117], v3 offset:34816
 ds_read_b64_tr_b16 a[118:119], v3 offset:35840
 s_waitcnt vmcnt(8) lgkmcnt(0)
 s_barrier
 s_mov_b32 m0, 159744
 s_add_u32 s54, s62, 4194304
 buffer_load_dwordx4 v0, s[24:27], s54 offen lds
 s_mov_b32 m0, 160768
 s_add_u32 s54, s62, 4210688
 buffer_load_dwordx4 v0, s[24:27], s54 offen lds
 s_mov_b32 m0, 161792
 s_add_u32 s54, s62, 4325376
 buffer_load_dwordx4 v0, s[24:27], s54 offen lds
 s_mov_b32 m0, 162816
 s_add_u32 s54, s62, 4341760
 buffer_load_dwordx4 v0, s[24:27], s54 offen lds
 s_branch RSC_303
RSB_301:
 s_cmp_lt_u32 s49, 1
 s_cbranch_scc1 RSE_302
 s_sub_u32 s49, s49, 1
 s_mov_b32 s54, 128
 buffer_load_dwordx4 v[8:11], off, s[12:15], s54 sc1
 buffer_load_dwordx4 v[12:15], off, s[12:15], s54 offset:16 sc1
 s_waitcnt vmcnt(0)
RSC_303:
 v_add3_u32 v7, v8, v9, v10
 v_add3_u32 v7, v7, v11, v12
 v_add3_u32 v7, v7, v13, v14
 v_add_u32 v7, v7, v15
 v_cmp_gt_u32 vcc, 32, v7
 s_cbranch_vccnz RSB_301
RSE_302:
 v_max3_u32 v8, v8, v9, v10
 v_max3_u32 v8, v8, v11, v12
 v_max3_u32 v8, v8, v13, v14
 v_max_u32 v8, v8, v15
 s_nop 0
 v_readfirstlane_b32 s64, v8
 s_mov_b32 m0, 11776
 v_mov_b32 v7, v5
 s_mov_b32 s60, 1048576
 v_readfirstlane_b32 s54, v7
 s_and_b32 s59, s54, 0xff
 s_cbranch_scc0 RFN_304
 s_and_b32 s59, s54, 0xff00
 s_cbranch_scc0 RFN_304
 s_and_b32 s59, s54, 0xff0000
 s_cbranch_scc0 RFN_304
 s_and_b32 s59, s54, 0xff000000
 s_cbranch_scc0 RFN_304
 s_mov_b32 s60, s58
RFN_304:
 s_add_u32 s54, s60, 0
 s_nop 1
 buffer_load_dword v4, s[8:11], s54 offen sc1 lds
 s_add_u32 s54, s60, 8192
 buffer_load_dword v4, s[8:11], s54 offen sc1 lds
 ds_read_b64_tr_b16 a[120:121], v2 offset:20480
 ds_read_b64_tr_b16 a[122:123], v2 offset:21504
 ds_read_b64_tr_b16 a[124:125], v2 offset:22528
 ds_read_b64_tr_b16 a[126:127], v2 offset:23552
 ds_read_b64_tr_b16 v[40:41], v3 offset:20480
 ds_read_b64_tr_b16 v[42:43], v3 offset:21504
 ds_read_b64_tr_b16 v[44:45], v3 offset:22528
 ds_read_b64_tr_b16 v[46:47], v3 offset:23552
 s_waitcnt vmcnt(10) lgkmcnt(0)
 s_barrier
 ds_read_b64_tr_b16 a[128:129], v2 offset:24576
 ds_read_b64_tr_b16 a[130:131], v2 offset:25600
 ds_read_b64_tr_b16 a[132:133], v2 offset:26624
 ds_read_b64_tr_b16 a[134:135], v2 offset:27648
 ds_read_b64_tr_b16 a[136:137], v3 offset:24576
 ds_read_b64_tr_b16 a[138:139], v3 offset:25600
 ds_read_b64_tr_b16 a[140:141], v3 offset:26624
 ds_read_b64_tr_b16 a[142:143], v3 offset:27648
 s_waitcnt vmcnt(6) lgkmcnt(0)
 s_barrier
 ds_read_b64_tr_b16 a[80:81], v2 offset:28672
 ds_read_b64_tr_b16 a[82:83], v2 offset:29696
 ds_read_b64_tr_b16 a[84:85], v2 offset:30720
 ds_read_b64_tr_b16 a[86:87], v2 offset:31744
 ds_read_b64_tr_b16 a[88:89], v3 offset:28672
 ds_read_b64_tr_b16 a[90:91], v3 offset:29696
 ds_read_b64_tr_b16 a[92:93], v3 offset:30720
 ds_read_b64_tr_b16 a[94:95], v3 offset:31744
 s_waitcnt vmcnt(2) lgkmcnt(0)
 s_barrier
 ds_read_b64_tr_b16 v[32:33], v2 offset:32768
 ds_read_b64_tr_b16 v[34:35], v2 offset:33792
 ds_read_b64_tr_b16 v[36:37], v2 offset:34816
 ds_read_b64_tr_b16 v[38:39], v2 offset:35840
 ds_read_b64_tr_b16 a[96:97], v3 offset:32768
 ds_read_b64_tr_b16 a[98:99], v3 offset:33792
 ds_read_b64_tr_b16 a[100:101], v3 offset:34816
 ds_read_b64_tr_b16 a[102:103], v3 offset:35840
 s_waitcnt lgkmcnt(0)
 s_barrier
 ds_write_b128 v1, v[16:19] offset:20480
 ds_write_b128 v1, v[20:23] offset:21504
 ds_write_b128 v1, v[24:27] offset:22528
 ds_write_b128 v1, v[28:31] offset:23552
 ds_write_b128 v1, v[32:35] offset:24576
 ds_write_b128 v1, v[36:39] offset:25600
 ds_write_b128 v1, v[40:43] offset:26624
 ds_write_b128 v1, v[44:47] offset:27648
 ds_write_b128 v1, v[48:51] offset:28672
 ds_write_b128 v1, v[52:55] offset:29696
 ds_write_b128 v1, v[56:59] offset:30720
 ds_write_b128 v1, v[60:63] offset:31744
 ds_write_b128 v1, v[64:67] offset:32768
 ds_write_b128 v1, v[68:71] offset:33792
 ds_write_b128 v1, v[72:75] offset:34816
 ds_write_b128 v1, v[76:79] offset:35840
 s_cmp_eq_u32 s60, s58
 s_cbranch_scc1 RFE_306
RF_305:
 s_cmp_lt_u32 s49, 1
 s_cbranch_scc1 RFE_306
 s_sub_u32 s49, s49, 1
 buffer_load_dword v7, off, s[12:15], s57 sc1
 s_waitcnt vmcnt(0)
 v_readfirstlane_b32 s54, v7
 s_and_b32 s59, s54, 0xff
 s_cbranch_scc0 RF_305
 s_and_b32 s59, s54, 0xff00
 s_cbranch_scc0 RF_305
 s_and_b32 s59, s54, 0xff0000
 s_cbranch_scc0 RF_305
 s_and_b32 s59, s54, 0xff000000
 s_cbranch_scc0 RF_305
 s_mov_b32 s60, s58
 s_add_u32 s54, s60, 0
 buffer_load_dword v4, s[8:11], s54 offen sc1 lds
 s_add_u32 s54, s60, 8192
 buffer_load_dword v4, s[8:11], s54 offen sc1 lds
RFE_306:
 s_lshl_b32 s57, s3, 7
 s_add_u32 s57, s57, 1179648
 v_mbcnt_lo_u32_b32 v8, -1, 0
 v_mbcnt_hi_u32_b32 v8, -1, v8
 v_lshlrev_b32 v0, 4, v8
 v_lshrrev_b32 v6, 4, v8
 v_xor_b32 v6, v6, v8
 v_lshlrev_b32 v6, 3, v6
 ds_read_b128 v[32:35], v0 offset:6144
 ds_read_b128 v[36:39], v0 offset:7168
 ds_read_b128 v[40:43], v0 offset:8192
 v_mov_b32 v2, 17476
 v_bfe_u32 v9, v8, 1, 1
 s_mov_b32 s101, 43690
 v_mad_u32_u24 v2, v9, s101, v2
 v_mov_b32 v4, 0
 v_bfe_u32 v9, v8, 4, 2
 v_lshl_add_u32 v4, v9, 8, v4
 v_bfe_u32 v9, v8, 2, 2
 v_lshl_add_u32 v4, v9, 5, v4
 v_bfe_u32 v9, v8, 0, 1
 v_lshl_add_u32 v4, v9, 4, v4
 v_mov_b32 v3, v4
 v_bfe_u32 v9, v8, 1, 1
 v_lshl_add_u32 v3, v9, 7, v3
 v_mov_b32 v5, 0
 v_bfe_u32 v9, v8, 0, 4
 v_lshl_add_u32 v5, v9, 5, v5
 v_bfe_u32 v9, v8, 4, 2
 v_lshl_add_u32 v5, v9, 3, v5
 v_mov_b32 v10, 0
 v_bfe_u32 v9, v8, 2, 2
 v_lshl_add_u32 v10, v9, 3, v10
 v_xor_b32 v5, v5, v10
 s_cmp_eq_u32 s64, 32
 s_cbranch_scc0 RECM3
 ds_read_b128 v[8:11], v1 offset:0
 ds_read_b128 v[12:15], v1 offset:1024
 ds_read_b128 v[16:19], v1 offset:2048
 ds_read_b128 v[20:23], v1 offset:3072
 ds_read_b128 v[24:27], v1 offset:4096
 ds_read_b128 v[28:31], v1 offset:5120
 ds_read_b128 v[44:47], v1 offset:6144
 ds_read_b128 v[48:51], v1 offset:7168
 v_mov_b64 v[60:61], 0
 v_mov_b64 v[62:63], 0
 v_mov_b64 v[64:65], 0
 v_mov_b64 v[66:67], 0
 v_mov_b64 v[68:69], 0
 v_mov_b64 v[70:71], 0
 v_mov_b64 v[72:73], 0
 v_mov_b64 v[74:75], 0
 v_mov_b64 v[52:53], 0
 v_mov_b64 v[54:55], 0
 v_mov_b64 v[56:57], 0
 v_mov_b64 v[58:59], 0
 s_cmp_gt_u32 s36, 63
 s_addc_u32 s59, s36, 1
 s_min_u32 s59, s59, 63
 s_lshl_b32 s60, s59, 3
 s_lshr_b32 s61, s59, 2
 s_lshl_b32 s59, s59, 19
 s_add_u32 s59, s59, s58
 s_add_u32 s62, s59, 8192
 ds_read_b32 v76, v0 offset:13320
 s_mov_b32 s66, -1
 s_waitcnt lgkmcnt(0)
 s_branch R30STEP
.p2align 8
 s_nop 0
 s_nop 0
 s_nop 0
 s_nop 0
 s_nop 0
R30TOP:
 buffer_load_dwordx4 v[32:35], v0, s[8:11], s43 offen sc1
 s_sub_u32 s49, s49, 1
 s_cselect_b32 s49, 0, s49
 s_cselect_b32 s66, -1, -2
 s_cselect_b32 s67, 1, 0
R30TW:
 s_waitcnt vmcnt(1) lgkmcnt(0)
 v_max3_u32 v77, v32, v33, v34
 v_max_u32 v77, v35, v77
 ds_write_b128 v0, v[32:35] offset:6144
 v_cmp_lt_u32 vcc, s66, v77
 s_cbranch_vccnz R30TOP
 buffer_load_dwordx4 v[36:39], v0, s[8:11], s63 offen sc1
 buffer_load_dwordx4 v[40:43], v0, s[8:11], s44 offen sc1
R30STEP:
 v_smfmac_f32_16x16x64_bf16 v[60:63], v[32:35], v[8:15], v2
 v_smfmac_f32_16x16x64_bf16 v[64:67], v[32:35], v[16:23], v2
 s_waitcnt lgkmcnt(0)
 s_barrier
 ds_read_b128 v[8:11], v0 offset:0
 v_smfmac_f32_16x16x64_bf16 v[68:71], v[32:35], v[24:31], v2
 ds_read_b128 v[12:15], v0 offset:2048
 ds_read_b128 v[16:19], v0 offset:4096
 v_smfmac_f32_16x16x64_bf16 v[72:75], v[32:35], v[44:51], v2
 ds_read_b128 v[24:27], v1 offset:8192
 v_readfirstlane_b32 s54, v7
 v_smfmac_f32_16x16x64_bf16 v[52:55], v[32:35], v[80:87], v2
 ds_read_b128 v[28:31], v1 offset:9216
 ds_read_b128 v[44:47], v1 offset:10240
 v_smfmac_f32_16x16x64_bf16 v[56:59], v[32:35], v[88:95], v2
 ds_read_b128 v[48:51], v1 offset:11264
 s_waitcnt lgkmcnt(6)
 v_smfmac_f32_16x16x64_bf16 v[60:63], v[8:11], v[96:103], v2
 buffer_load_dwordx4 v[32:35], v3, s[8:11], s47 offen offset:0 sc1
 s_lshr_b32 s54, s54, s60
 v_smfmac_f32_16x16x64_bf16 v[64:67], v[8:11], v[104:111], v2
 s_and_b32 s54, s54, 0xff
 v_smfmac_f32_16x16x64_bf16 v[68:71], v[8:11], v[112:119], v2
 s_cmp_gt_u32 s54, s61
 s_waitcnt lgkmcnt(2)
 v_smfmac_f32_16x16x64_bf16 v[72:75], v[8:11], v[24:31], v2
 s_cbranch_scc0 R30FL
R30FR:
 v_smfmac_f32_16x16x64_bf16 v[52:55], v[8:11], v[120:127], v2
 ds_read_b128 v[24:27], v1 offset:12288
 s_waitcnt lgkmcnt(1)
 v_smfmac_f32_16x16x64_bf16 v[56:59], v[8:11], v[44:51], v2
 ds_read_b128 v[28:31], v1 offset:13312
 v_smfmac_f32_16x16x64_bf16 v[60:63], v[12:15], v[128:135], v2
 buffer_load_dwordx4 v[8:11], v3, s[8:11], s47 offen offset:1024 sc1
 ds_read_b128 v[44:47], v1 offset:14336
 v_smfmac_f32_16x16x64_bf16 v[64:67], v[12:15], v[136:143], v2
 ds_read_b128 v[48:51], v1 offset:15360
 v_lshlrev_b32 v7, 3, v0
 v_smfmac_f32_16x16x64_bf16 v[68:71], v[12:15], v[144:151], v2
 ds_read_b64_tr_b16 v[76:77], v6 offset:11776
 v_smfmac_f32_16x16x64_bf16 v[72:75], v[12:15], v[152:159], v2
 s_waitcnt lgkmcnt(3)
 v_smfmac_f32_16x16x64_bf16 v[52:55], v[12:15], v[24:31], v2
 v_smfmac_f32_16x16x64_bf16 v[56:59], v[12:15], v[160:167], v2
 ds_read_b128 v[24:27], v1 offset:16384
 v_smfmac_f32_16x16x64_bf16 v[60:63], v[16:19], v[168:175], v2
 buffer_load_dwordx4 v[12:15], v0, s[8:11], s47 offen offset:2048 sc1
 ds_read_b128 v[28:31], v1 offset:17408
 s_waitcnt lgkmcnt(3)
 v_smfmac_f32_16x16x64_bf16 v[64:67], v[16:19], v[44:51], v2
 s_waitcnt vmcnt(4)
 ds_write_b128 v0, v[36:39] offset:7168
 v_max3_u32 v20, v36, v37, v38
 v_smfmac_f32_16x16x64_bf16 v[68:71], v[16:19], v[176:183], v2
 ds_read_b128 v[44:47], v1 offset:18432
 v_smfmac_f32_16x16x64_bf16 v[72:75], v[16:19], v[184:191], v2
 ds_read_b128 v[48:51], v1 offset:19456
 s_waitcnt vmcnt(3)
 v_max3_u32 v20, v39, v40, v20
 v_max3_u32 v21, v41, v42, v43
 v_smfmac_f32_16x16x64_bf16 v[52:55], v[16:19], v[192:199], v2
 s_waitcnt lgkmcnt(3)
 v_max_u32 v20, v21, v20
 v_cmp_lt_u32 vcc, s66, v20
 v_smfmac_f32_16x16x64_bf16 v[56:59], v[16:19], v[24:31], v2
 s_cbranch_vccnz R30PB
R30B:
 v_smfmac_f32_16x16x64_bf16 v[60:63], v[36:39], v[200:207], v2
 buffer_load_dwordx4 v[16:19], v0, s[8:11], s47 offen offset:3072 sc1
 s_waitcnt lgkmcnt(2)
 s_barrier
 ds_read_b128 v[20:23], v0 offset:1024
 v_smfmac_f32_16x16x64_bf16 v[64:67], v[36:39], v[208:215], v2
 ds_read_b128 v[24:27], v0 offset:3072
 ds_read_b128 v[28:31], v0 offset:5120
 v_smfmac_f32_16x16x64_bf16 v[60:63], v[40:43], v[216:223], v2
 s_add_u32 s47, s47, 524288
 buffer_load_dword v7, v7, s[8:11], s59 offen sc1
 s_waitcnt lgkmcnt(3)
 v_smfmac_f32_16x16x64_bf16 v[64:67], v[40:43], v[44:51], v2
 s_add_u32 s45, s45, 0x4000
 buffer_load_dword v7, v7, s[8:11], s62 offen sc1
 s_waitcnt lgkmcnt(2)
 v_smfmac_f32_16x16x64_bf16 v[60:63], v[20:23], v[224:231], v2
 ds_read_b128 v[44:47], v1 offset:20480
 s_waitcnt lgkmcnt(2)
 v_smfmac_f32_16x16x64_bf16 v[60:63], v[24:27], v[232:239], v2
 ds_read_b128 v[48:51], v1 offset:21504
 s_waitcnt lgkmcnt(2)
 v_smfmac_f32_16x16x64_bf16 v[60:63], v[28:31], v[240:247], v2
 buffer_load_dword v7, off, s[8:11], s57 sc1
 v_smfmac_f32_16x16x64_bf16 v[64:67], v[20:23], v[248:255], v2
 s_bitset0_b32 s45, 16
 s_add_u32 s44, s45, 8192
 v_smfmac_f32_16x16x64_bf16 v[64:67], v[24:27], a[0:7], v2
 v_mul_f32 v60, s50, v60
 v_mul_f32 v61, s50, v61
 v_smfmac_f32_16x16x64_bf16 v[64:67], v[28:31], a[8:15], v2
 s_add_u32 s43, s45, 3072
 s_add_u32 s63, s45, 7168
 v_fmac_f32 v60, s50, v62
 v_fmac_f32 v61, s50, v63
 s_waitcnt lgkmcnt(0)
 v_smfmac_f32_16x16x64_bf16 v[68:71], v[36:39], v[44:51], v2
 v_cvt_pk_bf16_f32 v60, v60, v61
 v_smfmac_f32_16x16x64_bf16 v[68:71], v[40:43], a[16:23], v2
 ds_read_b128 v[44:47], v1 offset:22528
 v_mul_f32 v64, s50, v64
 v_mul_f32 v65, s50, v65
 v_fmac_f32 v64, s50, v66
 v_smfmac_f32_16x16x64_bf16 v[68:71], v[20:23], a[24:31], v2
 ds_read_b128 v[48:51], v1 offset:23552
 s_cmp_ge_u32 s36, 62
 s_cbranch_scc1 R30KS
 buffer_store_dwordx4 v[76:79], v0, s[8:11], s48 offen nt
R30KR:
 v_fmac_f32 v65, s50, v67
 v_cvt_pk_bf16_f32 v61, v64, v65
 ds_write_b64 v5, v[60:61] offset:9728
 v_smfmac_f32_16x16x64_bf16 v[68:71], v[24:27], a[32:39], v2
 v_smfmac_f32_16x16x64_bf16 v[68:71], v[28:31], a[40:47], v2
 s_xor_b32 s46, s45, 0x8000
 s_and_b32 s65, s36, 1
 v_smfmac_f32_16x16x64_bf16 v[72:75], v[36:39], a[48:55], v2
 v_smfmac_f32_16x16x64_bf16 v[72:75], v[40:43], a[56:63], v2
 s_waitcnt lgkmcnt(1)
 v_add_f32 v68, v68, v70
 v_smfmac_f32_16x16x64_bf16 v[72:75], v[20:23], v[44:51], v2
 s_waitcnt lgkmcnt(0)
 s_barrier
 ds_read_b64_tr_b16 v[60:61], v6 offset:8192
 ds_read_b64_tr_b16 v[62:63], v6 offset:8704
 v_add_f32 v69, v69, v71
 v_smfmac_f32_16x16x64_bf16 v[72:75], v[24:27], a[64:71], v2
 ds_read_b64_tr_b16 v[64:65], v6 offset:9216
 ds_read_b64_tr_b16 v[66:67], v6 offset:9728
 ds_read_b128 v[44:47], v1 offset:24576
 v_cvt_pk_bf16_f32 v68, v68, v69
 v_smfmac_f32_16x16x64_bf16 v[72:75], v[28:31], a[72:79], v2
 ds_read_b128 v[48:51], v1 offset:25600
 v_smfmac_f32_16x16x64_bf16 v[52:55], v[36:39], a[80:87], v2
 s_waitcnt vmcnt(7) lgkmcnt(4)
 v_mfma_f32_16x16x32_bf16 v[76:79], v[32:35], v[60:63], 0
 s_waitcnt vmcnt(6) lgkmcnt(2)
 v_add_f32 v72, v72, v74
 v_add_f32 v73, v73, v75
 v_mfma_f32_16x16x32_bf16 v[76:79], v[8:11], v[64:67], v[76:79]
 v_cvt_pk_bf16_f32 v69, v72, v73
 ds_write_b64 v5, v[68:69] offset:11776
 v_smfmac_f32_16x16x64_bf16 v[56:59], v[36:39], a[88:95], v2
 s_add_u32 s48, s48, 131072
 s_waitcnt lgkmcnt(1)
 v_smfmac_f32_16x16x64_bf16 v[52:55], v[40:43], v[44:51], v2
 ds_read_b128 v[36:39], v0 offset:15360
 v_add_f32_dpp v76, v78, v76 quad_perm:[2,3,0,1] row_mask:0xf bank_mask:0xf
 v_add_f32_dpp v77, v79, v77 quad_perm:[2,3,0,1] row_mask:0xf bank_mask:0xf
 v_smfmac_f32_16x16x64_bf16 v[56:59], v[40:43], a[96:103], v2
 ds_read_b128 v[44:47], v1 offset:26624
 v_exp_f32_dpp v78, v76 quad_perm:[0,1,0,1] row_mask:0xf bank_mask:0xf
 v_exp_f32_dpp v79, v77 quad_perm:[0,1,0,1] row_mask:0xf bank_mask:0xf
 v_smfmac_f32_16x16x64_bf16 v[52:55], v[20:23], a[104:111], v2
 ds_read_b128 v[48:51], v1 offset:27648
 v_cvt_pk_bf16_f32 v78, v78, v79
 ds_write_b32 v0, v78 offset:14348
 v_smfmac_f32_16x16x64_bf16 v[56:59], v[20:23], a[112:119], v2
 s_waitcnt lgkmcnt(4)
 s_barrier
 ds_read_b64_tr_b16 v[68:69], v6 offset:10240
 ds_read_b64_tr_b16 v[70:71], v6 offset:10752
 v_mov_b32 v33, 0
 v_smfmac_f32_16x16x64_bf16 v[52:55], v[24:27], a[120:127], v2
 ds_read_b64_tr_b16 v[72:73], v6 offset:11264
 ds_read_b64_tr_b16 v[74:75], v6 offset:11776
 v_mov_b32 v34, 0
 v_smfmac_f32_16x16x64_bf16 v[52:55], v[28:31], a[128:135], v2
 s_waitcnt lgkmcnt(5)
 v_smfmac_f32_16x16x64_bf16 v[56:59], v[24:27], v[44:51], v2
 s_waitcnt lgkmcnt(2)
 v_mfma_f32_16x16x32_bf16 v[40:43], v[68:71], v[60:63], 0
 s_barrier
 ds_read_b128 v[8:11], v0 offset:14336
 v_add_f32 v52, v52, v54
 v_add_f32 v53, v53, v55
 s_waitcnt lgkmcnt(1)
 v_mfma_f32_16x16x32_bf16 v[40:43], v[72:75], v[64:67], v[40:43]
 s_cmp_eq_u32 s36, 63
 v_cvt_pk_bf16_f32 v78, v52, v53
 v_smfmac_f32_16x16x64_bf16 v[56:59], v[28:31], a[136:143], v2
 s_waitcnt lgkmcnt(0)
 s_nop 2
 v_add_f32_dpp v40, v42, v40 quad_perm:[2,3,0,1] row_mask:0xf bank_mask:0xf
 v_add_f32_dpp v41, v43, v41 quad_perm:[2,3,0,1] row_mask:0xf bank_mask:0xf
 v_mfma_f32_16x16x32_bf16 v[72:75], v[36:39], v[8:11], 0
 ds_read_b128 v[24:27], v1 offset:28672
 v_exp_f32_dpp v42, v40 quad_perm:[0,1,0,1] row_mask:0xf bank_mask:0xf
 v_exp_f32_dpp v43, v41 quad_perm:[0,1,0,1] row_mask:0xf bank_mask:0xf
 s_waitcnt vmcnt(5)
 v_mfma_f32_16x16x32_bf16 v[44:47], v[12:15], v[8:11], 0
 ds_read_b128 v[28:31], v1 offset:29696
 v_cvt_pk_bf16_f32 v32, v42, v43
 v_cvt_pk_bf16_f32 v35, v42, v43
 v_add_f32 v56, v56, v58
 v_add_f32 v57, v57, v59
 v_mfma_f32_16x16x16_bf16 v[72:75], v[36:37], v[32:33], v[72:75]
 s_waitcnt vmcnt(4)
 v_cvt_pk_bf16_f32 v79, v56, v57
 v_mfma_f32_16x16x32_bf16 v[48:51], v[16:19], v[8:11], 0
 s_cbranch_scc1 R30TAIL
 v_mov_b64 v[68:69], 0
 v_mov_b64 v[70:71], 0
 v_mfma_f32_16x16x16_bf16 v[44:47], v[78:79], v[32:33], v[44:47]
 v_rcp_f32 v72, v72
 v_subrev_u32 v74, s52, v74
 v_mfma_f32_16x16x16_bf16 v[48:51], v[78:79], v[34:35], v[48:51]
 v_cmp_le_u32 vcc, s53, v74
 v_mov_b64 v[52:53], 0
 v_mov_b64 v[54:55], 0
R30RJ:
 s_nop 0
 v_pk_mul_f32 v[44:45], v[44:45], v[72:73] op_sel_hi:[1,0]
 v_pk_mul_f32 v[46:47], v[46:47], v[72:73] op_sel_hi:[1,0]
 s_cbranch_vccnz R30FB
 v_cvt_pk_bf16_f32 v40, v44, v45
 v_cvt_pk_bf16_f32 v41, v46, v47
 v_pk_mul_f32 v[48:49], v[48:49], v[72:73] op_sel_hi:[1,0]
 v_pk_mul_f32 v[50:51], v[50:51], v[72:73] op_sel_hi:[1,0]
 v_cvt_pk_bf16_f32 v42, v48, v49
 v_cvt_pk_bf16_f32 v43, v50, v51
 ds_write_b128 v4, v[40:43] offset:9344
 s_waitcnt lgkmcnt(1)
 v_smfmac_f32_16x16x64_bf16 v[68:71], v[40:43], v[24:31], v2
 v_mov_b64 v[56:57], 0
 v_mov_b64 v[58:59], 0
 v_smfmac_f32_16x16x64_bf16 v[52:55], v[40:43], a[144:151], v2
 v_mov_b64 v[64:65], 0
 v_mov_b64 v[66:67], 0
 v_smfmac_f32_16x16x64_bf16 v[56:59], v[40:43], a[152:159], v2
 s_waitcnt lgkmcnt(0)
 s_barrier
 ds_read_b128 v[32:35], v4 offset:8192
 ds_read_b128 v[36:39], v4 offset:8320
 ds_read_b128 v[72:75], v4 offset:9216
 v_mov_b64 v[60:61], 0
 v_mov_b64 v[62:63], 0
 v_smfmac_f32_16x16x64_bf16 v[64:67], v[40:43], a[160:167], v2
 s_waitcnt lgkmcnt(2)
 v_smfmac_f32_16x16x64_bf16 v[68:71], v[32:35], a[168:175], v2
 ds_read_b128 v[44:47], v3 offset:8192
 s_waitcnt lgkmcnt(2)
 v_lshrrev_b32 v40, 2, v0
 v_smfmac_f32_16x16x64_bf16 v[68:71], v[36:39], a[176:183], v2
 ds_read_b128 v[48:51], v3 offset:9216
 s_waitcnt lgkmcnt(2)
 v_smfmac_f32_16x16x64_bf16 v[68:71], v[72:75], a[184:191], v2
 ds_read_b128 v[24:27], v1 offset:30720
 v_smfmac_f32_16x16x64_bf16 v[52:55], v[32:35], a[192:199], v2
 ds_read_b128 v[28:31], v1 offset:31744
 v_smfmac_f32_16x16x64_bf16 v[52:55], v[36:39], a[200:207], v2
 ds_read_b128 v[8:11], v1 offset:32768
 v_cvt_pk_bf16_f32 v68, v68, v69
 v_smfmac_f32_16x16x64_bf16 v[52:55], v[72:75], a[208:215], v2
 ds_read_b128 v[12:15], v1 offset:33792
 s_waitcnt lgkmcnt(5)
 v_cvt_pk_bf16_f32 v69, v70, v71
 v_smfmac_f32_16x16x64_bf16 v[60:63], v[44:47], a[216:223], v2
 ds_read_b128 v[16:19], v1 offset:34816
 s_waitcnt lgkmcnt(5)
 v_and_or_b32 v68, v68, -2, s65
 v_smfmac_f32_16x16x64_bf16 v[60:63], v[48:51], a[224:231], v2
 ds_read_b128 v[20:23], v1 offset:35840
 v_cvt_pk_bf16_f32 v70, v52, v53
 v_cvt_pk_bf16_f32 v71, v54, v55
 buffer_store_dwordx4 v[68:71], v0, s[8:11], s37 offen
 v_smfmac_f32_16x16x64_bf16 v[56:59], v[32:35], a[232:239], v2
 s_waitcnt lgkmcnt(4)
 v_smfmac_f32_16x16x64_bf16 v[56:59], v[36:39], v[24:31], v2
 s_add_u32 s36, s36, 1
 v_add_f32 v60, v60, v62
 v_smfmac_f32_16x16x64_bf16 v[56:59], v[72:75], a[240:247], v2
 s_waitcnt lgkmcnt(2)
 v_add_f32 v61, v61, v63
 v_smfmac_f32_16x16x64_bf16 v[64:67], v[32:35], v[8:15], v2
 v_cvt_pk_bf16_f32 v41, v60, v61
 v_smfmac_f32_16x16x64_bf16 v[64:67], v[36:39], a[248:255], v2
 s_waitcnt lgkmcnt(0)
 v_and_or_b32 v41, v41, -2, s65
 v_smfmac_f32_16x16x64_bf16 v[64:67], v[72:75], v[16:23], v2
 buffer_store_dword v41, v40, s[8:11], s38 offen
 v_cvt_pk_bf16_f32 v56, v56, v57
 v_cvt_pk_bf16_f32 v57, v58, v59
 v_and_or_b32 v56, v56, -2, s65
 s_nop 3
 v_cvt_pk_bf16_f32 v58, v64, v65
 v_cvt_pk_bf16_f32 v59, v66, v67
 buffer_store_dwordx4 v[56:59], v0, s[8:11], s37 offen offset:1024
R30HOP:
 s_cmp_gt_u32 s36, 63
 s_addc_u32 s59, s36, 1
 s_min_u32 s59, s59, 63
 s_lshl_b32 s60, s59, 3
 s_lshr_b32 s61, s59, 2
 s_lshl_b32 s59, s59, 19
 s_add_u32 s59, s59, s58
 s_add_u32 s62, s59, 8192
 s_barrier
 v_mov_b64 v[60:61], 0
 v_mov_b64 v[62:63], 0
 v_mov_b64 v[64:65], 0
 v_mov_b64 v[66:67], 0
 v_mov_b64 v[68:69], 0
 v_mov_b64 v[70:71], 0
 v_mov_b64 v[72:73], 0
 v_mov_b64 v[74:75], 0
 buffer_load_dwordx4 v[32:35], v0, s[8:11], s43 offen sc1
 ds_read_b128 v[8:11], v1 offset:0
 ds_read_b128 v[12:15], v1 offset:1024
 ds_read_b128 v[16:19], v1 offset:2048
 ds_read_b128 v[20:23], v1 offset:3072
 v_mov_b64 v[52:53], 0
 v_mov_b64 v[54:55], 0
 ds_read_b128 v[24:27], v1 offset:4096
 ds_read_b128 v[28:31], v1 offset:5120
 ds_read_b128 v[44:47], v1 offset:6144
 ds_read_b128 v[48:51], v1 offset:7168
 v_mov_b64 v[56:57], 0
 v_mov_b64 v[58:59], 0
 s_branch R30TOP
R30PB:
 buffer_load_dwordx4 v[36:39], v0, s[8:11], s63 offen sc1
 buffer_load_dwordx4 v[40:43], v0, s[8:11], s44 offen sc1
 s_sub_u32 s49, s49, 1
 s_cselect_b32 s49, 0, s49
 s_cselect_b32 s66, -1, -2
 s_cselect_b32 s67, 1, 0
 s_waitcnt vmcnt(0)
 v_max3_u32 v20, v36, v37, v38
 v_max3_u32 v20, v39, v40, v20
 v_max3_u32 v21, v41, v42, v43
 v_max_u32 v20, v21, v20
 v_cmp_lt_u32 vcc, s66, v20
 ds_write_b128 v0, v[36:39] offset:7168
 s_cbranch_vccnz R30PB
 s_waitcnt lgkmcnt(0)
 s_branch R30B
R30KS:
 s_waitcnt lgkmcnt(0)
 buffer_store_dwordx4 v[76:79], v0, s[8:11], s48 offen sc1
 s_branch R30KR
R30TAIL:
 s_waitcnt lgkmcnt(0)
 ds_read_b64_tr_b16 v[76:77], v6 offset:11776
 s_waitcnt lgkmcnt(0)
 buffer_store_dwordx4 v[76:79], v0, s[8:11], s48 offen sc1
 s_cmp_eq_u32 s3, 0
 s_cbranch_scc0 R30NW
 s_waitcnt vmcnt(0)
 buffer_wbl2 sc1
 s_waitcnt vmcnt(0)
R30NW:
 s_waitcnt vmcnt(0)
 s_endpgm
R30FB:
 s_waitcnt vmcnt(0) lgkmcnt(0)
 ds_write_b64 v6, v[76:77] offset:9728
 s_waitcnt lgkmcnt(0)
 s_barrier
 ds_read_b64 v[44:45], v6 offset:8192
 ds_read_b64 v[46:47], v6 offset:8704
 ds_read_b64 v[48:49], v6 offset:9216
 ds_read_b64 v[50:51], v6 offset:9728
 s_waitcnt lgkmcnt(0)
 s_barrier
 v_max3_f32 v72, v44, v45, v46
 v_max3_f32 v72, v72, v47, v48
 v_max3_f32 v72, v72, v49, v50
 v_max3_f32 v72, v72, v51, v40
 v_max_f32 v72, v72, v41
 v_mov_b32 v73, v72
 s_nop 1
 v_permlane16_swap_b32 v72, v73
 v_max_f32 v72, v72, v73
 v_mov_b32 v73, v72
 s_nop 1
 v_permlane32_swap_b32 v72, v73
 v_max_f32 v72, v72, v73
 v_sub_f32 v44, v44, v72
 v_sub_f32 v45, v45, v72
 v_sub_f32 v46, v46, v72
 v_sub_f32 v47, v47, v72
 v_sub_f32 v48, v48, v72
 v_sub_f32 v49, v49, v72
 v_sub_f32 v50, v50, v72
 v_sub_f32 v51, v51, v72
 v_sub_f32 v40, v40, v72
 v_sub_f32 v41, v41, v72
 v_exp_f32_dpp v44, v44 quad_perm:[0,1,0,1] row_mask:0xf bank_mask:0xf
 v_exp_f32_dpp v45, v45 quad_perm:[0,1,0,1] row_mask:0xf bank_mask:0xf
 v_exp_f32_dpp v46, v46 quad_perm:[0,1,0,1] row_mask:0xf bank_mask:0xf
 v_exp_f32_dpp v47, v47 quad_perm:[0,1,0,1] row_mask:0xf bank_mask:0xf
 v_exp_f32_dpp v48, v48 quad_perm:[0,1,0,1] row_mask:0xf bank_mask:0xf
 v_exp_f32_dpp v49, v49 quad_perm:[0,1,0,1] row_mask:0xf bank_mask:0xf
 v_exp_f32_dpp v50, v50 quad_perm:[0,1,0,1] row_mask:0xf bank_mask:0xf
 v_exp_f32_dpp v51, v51 quad_perm:[0,1,0,1] row_mask:0xf bank_mask:0xf
 v_exp_f32_dpp v40, v40 quad_perm:[0,1,0,1] row_mask:0xf bank_mask:0xf
 v_exp_f32_dpp v41, v41 quad_perm:[0,1,0,1] row_mask:0xf bank_mask:0xf
 v_cvt_pk_bf16_f32 v8, v44, v45
 v_cvt_pk_bf16_f32 v9, v46, v47
 v_cvt_pk_bf16_f32 v10, v48, v49
 v_cvt_pk_bf16_f32 v11, v50, v51
 v_cvt_pk_bf16_f32 v32, v40, v41
 v_cvt_pk_bf16_f32 v35, v40, v41
 v_mfma_f32_16x16x32_bf16 v[72:75], v[36:39], v[8:11], 0
 v_mfma_f32_16x16x32_bf16 v[44:47], v[12:15], v[8:11], 0
 v_mfma_f32_16x16x32_bf16 v[48:51], v[16:19], v[8:11], 0
 v_mfma_f32_16x16x16_bf16 v[72:75], v[36:37], v[32:33], v[72:75]
 v_mfma_f32_16x16x16_bf16 v[44:47], v[78:79], v[32:33], v[44:47]
 v_mfma_f32_16x16x16_bf16 v[48:51], v[78:79], v[34:35], v[48:51]
 v_rcp_f32 v72, v72
 s_mov_b64 vcc, 0
 s_nop 7
 s_branch R30RJ
R30FL:
 buffer_load_dword v7, off, s[8:11], s57 sc1
 s_cmp_lt_u32 s49, 1
 s_waitcnt vmcnt(0)
 s_cbranch_scc1 R30FR
 s_sub_u32 s49, s49, 1
 v_readfirstlane_b32 s54, v7
 s_lshr_b32 s54, s54, s60
 s_and_b32 s54, s54, 0xff
 s_cmp_gt_u32 s54, s61
 s_cbranch_scc1 R30FR
 s_branch R30FL
RECM3:
 ds_read_b128 v[8:11], v1 offset:0
 ds_read_b128 v[12:15], v1 offset:1024
 ds_read_b128 v[16:19], v1 offset:2048
 ds_read_b128 v[20:23], v1 offset:3072
 ds_read_b128 v[24:27], v1 offset:4096
 ds_read_b128 v[28:31], v1 offset:5120
 ds_read_b128 v[44:47], v1 offset:6144
 ds_read_b128 v[48:51], v1 offset:7168
 v_mov_b64 v[60:61], 0
 v_mov_b64 v[62:63], 0
 v_mov_b64 v[64:65], 0
 v_mov_b64 v[66:67], 0
 v_mov_b64 v[68:69], 0
 v_mov_b64 v[70:71], 0
 v_mov_b64 v[72:73], 0
 v_mov_b64 v[74:75], 0
 v_mov_b64 v[52:53], 0
 v_mov_b64 v[54:55], 0
 v_mov_b64 v[56:57], 0
 v_mov_b64 v[58:59], 0
 s_cmp_gt_u32 s36, 63
 s_addc_u32 s59, s36, 1
 s_min_u32 s59, s59, 63
 s_lshl_b32 s60, s59, 3
 s_lshr_b32 s61, s59, 2
 s_lshl_b32 s59, s59, 19
 s_add_u32 s59, s59, s58
 s_add_u32 s62, s59, 8192
 ds_read_b32 v76, v0 offset:13320
 s_mov_b32 s66, -1
 s_waitcnt lgkmcnt(0)
 s_branch R31STEP
.p2align 8
 s_nop 0
 s_nop 0
 s_nop 0
 s_nop 0
 s_nop 0
R31TOP:
 buffer_load_dwordx4 v[32:35], v0, s[8:11], s43 offen sc1
 s_sub_u32 s49, s49, 1
 s_cselect_b32 s49, 0, s49
 s_cselect_b32 s66, -1, -2
 s_cselect_b32 s67, 1, 0
R31TW:
 s_waitcnt vmcnt(1) lgkmcnt(0)
 v_max3_u32 v77, v32, v33, v34
 v_max_u32 v77, v35, v77
 ds_write_b128 v0, v[32:35] offset:6144
 v_cmp_lt_u32 vcc, s66, v77
 s_cbranch_vccnz R31TOP
 buffer_load_dwordx4 v[36:39], v0, s[8:11], s63 offen sc1
 buffer_load_dwordx4 v[40:43], v0, s[8:11], s44 offen sc1
R31STEP:
 v_smfmac_f32_16x16x64_bf16 v[60:63], v[32:35], v[8:15], v2
 v_smfmac_f32_16x16x64_bf16 v[64:67], v[32:35], v[16:23], v2
 s_waitcnt lgkmcnt(0)
 s_barrier
 ds_read_b128 v[8:11], v0 offset:0
 v_smfmac_f32_16x16x64_bf16 v[68:71], v[32:35], v[24:31], v2
 ds_read_b128 v[12:15], v0 offset:2048
 ds_read_b128 v[16:19], v0 offset:4096
 v_smfmac_f32_16x16x64_bf16 v[72:75], v[32:35], v[44:51], v2
 ds_read_b128 v[24:27], v1 offset:8192
 v_readfirstlane_b32 s54, v7
 v_smfmac_f32_16x16x64_bf16 v[52:55], v[32:35], v[80:87], v2
 ds_read_b128 v[28:31], v1 offset:9216
 ds_read_b128 v[44:47], v1 offset:10240
 v_smfmac_f32_16x16x64_bf16 v[56:59], v[32:35], v[88:95], v2
 ds_read_b128 v[48:51], v1 offset:11264
 s_waitcnt lgkmcnt(6)
 v_smfmac_f32_16x16x64_bf16 v[60:63], v[8:11], v[96:103], v2
 buffer_load_dwordx4 v[32:35], v3, s[8:11], s47 offen offset:0 sc1
 s_lshr_b32 s54, s54, s60
 v_smfmac_f32_16x16x64_bf16 v[64:67], v[8:11], v[104:111], v2
 s_and_b32 s54, s54, 0xff
 v_smfmac_f32_16x16x64_bf16 v[68:71], v[8:11], v[112:119], v2
 s_cmp_gt_u32 s54, s61
 s_waitcnt lgkmcnt(2)
 v_smfmac_f32_16x16x64_bf16 v[72:75], v[8:11], v[24:31], v2
 s_cbranch_scc0 R31FL
R31FR:
 v_smfmac_f32_16x16x64_bf16 v[52:55], v[8:11], v[120:127], v2
 ds_read_b128 v[24:27], v1 offset:12288
 s_waitcnt lgkmcnt(1)
 v_smfmac_f32_16x16x64_bf16 v[56:59], v[8:11], v[44:51], v2
 ds_read_b128 v[28:31], v1 offset:13312
 v_smfmac_f32_16x16x64_bf16 v[60:63], v[12:15], v[128:135], v2
 buffer_load_dwordx4 v[8:11], v3, s[8:11], s47 offen offset:1024 sc1
 ds_read_b128 v[44:47], v1 offset:14336
 v_smfmac_f32_16x16x64_bf16 v[64:67], v[12:15], v[136:143], v2
 ds_read_b128 v[48:51], v1 offset:15360
 v_lshlrev_b32 v7, 3, v0
 v_smfmac_f32_16x16x64_bf16 v[68:71], v[12:15], v[144:151], v2
 ds_read_b64_tr_b16 v[76:77], v6 offset:11776
 v_smfmac_f32_16x16x64_bf16 v[72:75], v[12:15], v[152:159], v2
 s_waitcnt lgkmcnt(3)
 v_smfmac_f32_16x16x64_bf16 v[52:55], v[12:15], v[24:31], v2
 v_smfmac_f32_16x16x64_bf16 v[56:59], v[12:15], v[160:167], v2
 ds_read_b128 v[24:27], v1 offset:16384
 v_smfmac_f32_16x16x64_bf16 v[60:63], v[16:19], v[168:175], v2
 buffer_load_dwordx4 v[12:15], v0, s[8:11], s47 offen offset:2048 sc1
 ds_read_b128 v[28:31], v1 offset:17408
 s_waitcnt lgkmcnt(3)
 v_smfmac_f32_16x16x64_bf16 v[64:67], v[16:19], v[44:51], v2
 s_waitcnt vmcnt(4)
 ds_write_b128 v0, v[36:39] offset:7168
 v_max3_u32 v20, v36, v37, v38
 v_smfmac_f32_16x16x64_bf16 v[68:71], v[16:19], v[176:183], v2
 ds_read_b128 v[44:47], v1 offset:18432
 v_smfmac_f32_16x16x64_bf16 v[72:75], v[16:19], v[184:191], v2
 ds_read_b128 v[48:51], v1 offset:19456
 s_waitcnt vmcnt(3)
 v_max3_u32 v20, v39, v40, v20
 v_max3_u32 v21, v41, v42, v43
 v_smfmac_f32_16x16x64_bf16 v[52:55], v[16:19], v[192:199], v2
 s_waitcnt lgkmcnt(3)
 v_max_u32 v20, v21, v20
 v_cmp_lt_u32 vcc, s66, v20
 v_smfmac_f32_16x16x64_bf16 v[56:59], v[16:19], v[24:31], v2
 s_cbranch_vccnz R31PB
R31B:
 v_smfmac_f32_16x16x64_bf16 v[60:63], v[36:39], v[200:207], v2
 buffer_load_dwordx4 v[16:19], v0, s[8:11], s47 offen offset:3072 sc1
 s_waitcnt lgkmcnt(2)
 s_barrier
 ds_read_b128 v[20:23], v0 offset:1024
 v_smfmac_f32_16x16x64_bf16 v[64:67], v[36:39], v[208:215], v2
 ds_read_b128 v[24:27], v0 offset:3072
 ds_read_b128 v[28:31], v0 offset:5120
 v_smfmac_f32_16x16x64_bf16 v[60:63], v[40:43], v[216:223], v2
 s_add_u32 s47, s47, 524288
 buffer_load_dword v7, v7, s[8:11], s59 offen sc1
 s_waitcnt lgkmcnt(3)
 v_smfmac_f32_16x16x64_bf16 v[64:67], v[40:43], v[44:51], v2
 s_add_u32 s45, s45, 0x4000
 buffer_load_dword v7, v7, s[8:11], s62 offen sc1
 s_waitcnt lgkmcnt(2)
 v_smfmac_f32_16x16x64_bf16 v[60:63], v[20:23], v[224:231], v2
 ds_read_b128 v[44:47], v1 offset:20480
 s_waitcnt lgkmcnt(2)
 v_smfmac_f32_16x16x64_bf16 v[60:63], v[24:27], v[232:239], v2
 ds_read_b128 v[48:51], v1 offset:21504
 s_waitcnt lgkmcnt(2)
 v_smfmac_f32_16x16x64_bf16 v[60:63], v[28:31], v[240:247], v2
 buffer_load_dword v7, off, s[8:11], s57 sc1
 v_smfmac_f32_16x16x64_bf16 v[64:67], v[20:23], v[248:255], v2
 s_bitset0_b32 s45, 16
 s_add_u32 s44, s45, 8192
 v_smfmac_f32_16x16x64_bf16 v[64:67], v[24:27], a[0:7], v2
 v_mul_f32 v60, s50, v60
 v_mul_f32 v61, s50, v61
 v_smfmac_f32_16x16x64_bf16 v[64:67], v[28:31], a[8:15], v2
 s_add_u32 s43, s45, 3072
 s_add_u32 s63, s45, 7168
 v_fmac_f32 v60, s50, v62
 v_fmac_f32 v61, s50, v63
 s_waitcnt lgkmcnt(0)
 v_smfmac_f32_16x16x64_bf16 v[68:71], v[36:39], v[44:51], v2
 v_cvt_pk_bf16_f32 v60, v60, v61
 v_smfmac_f32_16x16x64_bf16 v[68:71], v[40:43], a[16:23], v2
 ds_read_b128 v[44:47], v1 offset:22528
 v_mul_f32 v64, s50, v64
 v_mul_f32 v65, s50, v65
 v_fmac_f32 v64, s50, v66
 v_smfmac_f32_16x16x64_bf16 v[68:71], v[20:23], a[24:31], v2
 ds_read_b128 v[48:51], v1 offset:23552
 buffer_store_dwordx4 v[76:79], v0, s[8:11], s48 offen sc1
 v_fmac_f32 v65, s50, v67
 v_cvt_pk_bf16_f32 v61, v64, v65
 ds_write_b64 v5, v[60:61] offset:9728
 v_smfmac_f32_16x16x64_bf16 v[68:71], v[24:27], a[32:39], v2
 v_smfmac_f32_16x16x64_bf16 v[68:71], v[28:31], a[40:47], v2
 s_xor_b32 s46, s45, 0x8000
 s_and_b32 s65, s36, 1
 v_smfmac_f32_16x16x64_bf16 v[72:75], v[36:39], a[48:55], v2
 v_smfmac_f32_16x16x64_bf16 v[72:75], v[40:43], a[56:63], v2
 s_waitcnt lgkmcnt(1)
 v_add_f32 v68, v68, v70
 v_smfmac_f32_16x16x64_bf16 v[72:75], v[20:23], v[44:51], v2
 s_waitcnt lgkmcnt(0)
 s_barrier
 ds_read_b64_tr_b16 v[60:61], v6 offset:8192
 ds_read_b64_tr_b16 v[62:63], v6 offset:8704
 v_add_f32 v69, v69, v71
 v_smfmac_f32_16x16x64_bf16 v[72:75], v[24:27], a[64:71], v2
 ds_read_b64_tr_b16 v[64:65], v6 offset:9216
 ds_read_b64_tr_b16 v[66:67], v6 offset:9728
 ds_read_b128 v[44:47], v1 offset:24576
 v_cvt_pk_bf16_f32 v68, v68, v69
 v_smfmac_f32_16x16x64_bf16 v[72:75], v[28:31], a[72:79], v2
 ds_read_b128 v[48:51], v1 offset:25600
 v_smfmac_f32_16x16x64_bf16 v[52:55], v[36:39], a[80:87], v2
 s_waitcnt vmcnt(7) lgkmcnt(4)
 v_mfma_f32_16x16x32_bf16 v[76:79], v[32:35], v[60:63], 0
 s_waitcnt vmcnt(6) lgkmcnt(2)
 v_add_f32 v72, v72, v74
 v_add_f32 v73, v73, v75
 v_mfma_f32_16x16x32_bf16 v[76:79], v[8:11], v[64:67], v[76:79]
 v_cvt_pk_bf16_f32 v69, v72, v73
 ds_write_b64 v5, v[68:69] offset:11776
 v_smfmac_f32_16x16x64_bf16 v[56:59], v[36:39], a[88:95], v2
 s_add_u32 s48, s48, 131072
 s_waitcnt lgkmcnt(1)
 v_smfmac_f32_16x16x64_bf16 v[52:55], v[40:43], v[44:51], v2
 ds_read_b128 v[36:39], v0 offset:15360
 v_add_f32_dpp v76, v78, v76 quad_perm:[2,3,0,1] row_mask:0xf bank_mask:0xf
 v_add_f32_dpp v77, v79, v77 quad_perm:[2,3,0,1] row_mask:0xf bank_mask:0xf
 v_smfmac_f32_16x16x64_bf16 v[56:59], v[40:43], a[96:103], v2
 ds_read_b128 v[44:47], v1 offset:26624
 v_exp_f32_dpp v78, v76 quad_perm:[0,1,0,1] row_mask:0xf bank_mask:0xf
 v_exp_f32_dpp v79, v77 quad_perm:[0,1,0,1] row_mask:0xf bank_mask:0xf
 v_smfmac_f32_16x16x64_bf16 v[52:55], v[20:23], a[104:111], v2
 ds_read_b128 v[48:51], v1 offset:27648
 v_cvt_pk_bf16_f32 v78, v78, v79
 ds_write_b32 v0, v78 offset:14348
 v_smfmac_f32_16x16x64_bf16 v[56:59], v[20:23], a[112:119], v2
 s_waitcnt lgkmcnt(4)
 s_barrier
 ds_read_b64_tr_b16 v[68:69], v6 offset:10240
 ds_read_b64_tr_b16 v[70:71], v6 offset:10752
 v_mov_b32 v33, 0
 v_smfmac_f32_16x16x64_bf16 v[52:55], v[24:27], a[120:127], v2
 ds_read_b64_tr_b16 v[72:73], v6 offset:11264
 ds_read_b64_tr_b16 v[74:75], v6 offset:11776
 v_mov_b32 v34, 0
 v_smfmac_f32_16x16x64_bf16 v[52:55], v[28:31], a[128:135], v2
 s_waitcnt lgkmcnt(5)
 v_smfmac_f32_16x16x64_bf16 v[56:59], v[24:27], v[44:51], v2
 s_waitcnt lgkmcnt(2)
 v_mfma_f32_16x16x32_bf16 v[40:43], v[68:71], v[60:63], 0
 s_barrier
 ds_read_b128 v[8:11], v0 offset:14336
 v_add_f32 v52, v52, v54
 v_add_f32 v53, v53, v55
 s_waitcnt lgkmcnt(1)
 v_mfma_f32_16x16x32_bf16 v[40:43], v[72:75], v[64:67], v[40:43]
 s_cmp_eq_u32 s36, 63
 v_cvt_pk_bf16_f32 v78, v52, v53
 v_smfmac_f32_16x16x64_bf16 v[56:59], v[28:31], a[136:143], v2
 s_waitcnt lgkmcnt(0)
 s_nop 2
 v_add_f32_dpp v40, v42, v40 quad_perm:[2,3,0,1] row_mask:0xf bank_mask:0xf
 v_add_f32_dpp v41, v43, v41 quad_perm:[2,3,0,1] row_mask:0xf bank_mask:0xf
 v_mfma_f32_16x16x32_bf16 v[72:75], v[36:39], v[8:11], 0
 ds_read_b128 v[24:27], v1 offset:28672
 v_exp_f32_dpp v42, v40 quad_perm:[0,1,0,1] row_mask:0xf bank_mask:0xf
 v_exp_f32_dpp v43, v41 quad_perm:[0,1,0,1] row_mask:0xf bank_mask:0xf
 s_waitcnt vmcnt(5)
 v_mfma_f32_16x16x32_bf16 v[44:47], v[12:15], v[8:11], 0
 ds_read_b128 v[28:31], v1 offset:29696
 v_cvt_pk_bf16_f32 v32, v42, v43
 v_cvt_pk_bf16_f32 v35, v42, v43
 v_add_f32 v56, v56, v58
 v_add_f32 v57, v57, v59
 v_mfma_f32_16x16x16_bf16 v[72:75], v[36:37], v[32:33], v[72:75]
 s_waitcnt vmcnt(4)
 v_cvt_pk_bf16_f32 v79, v56, v57
 v_mfma_f32_16x16x32_bf16 v[48:51], v[16:19], v[8:11], 0
 s_cbranch_scc1 R31TAIL
 v_mov_b64 v[68:69], 0
 v_mov_b64 v[70:71], 0
 v_mfma_f32_16x16x16_bf16 v[44:47], v[78:79], v[32:33], v[44:47]
 v_rcp_f32 v72, v72
 v_subrev_u32 v74, s52, v74
 v_mfma_f32_16x16x16_bf16 v[48:51], v[78:79], v[34:35], v[48:51]
 v_cmp_le_u32 vcc, s53, v74
 v_mov_b64 v[52:53], 0
 v_mov_b64 v[54:55], 0
R31RJ:
 s_nop 0
 v_pk_mul_f32 v[44:45], v[44:45], v[72:73] op_sel_hi:[1,0]
 v_pk_mul_f32 v[46:47], v[46:47], v[72:73] op_sel_hi:[1,0]
 s_cbranch_vccnz R31FB
 v_cvt_pk_bf16_f32 v40, v44, v45
 v_cvt_pk_bf16_f32 v41, v46, v47
 v_pk_mul_f32 v[48:49], v[48:49], v[72:73] op_sel_hi:[1,0]
 v_pk_mul_f32 v[50:51], v[50:51], v[72:73] op_sel_hi:[1,0]
 v_cvt_pk_bf16_f32 v42, v48, v49
 v_cvt_pk_bf16_f32 v43, v50, v51
 ds_write_b128 v4, v[40:43] offset:9344
 s_waitcnt lgkmcnt(1)
 v_smfmac_f32_16x16x64_bf16 v[68:71], v[40:43], v[24:31], v2
 v_mov_b64 v[56:57], 0
 v_mov_b64 v[58:59], 0
 v_smfmac_f32_16x16x64_bf16 v[52:55], v[40:43], a[144:151], v2
 v_mov_b64 v[64:65], 0
 v_mov_b64 v[66:67], 0
 v_smfmac_f32_16x16x64_bf16 v[56:59], v[40:43], a[152:159], v2
 s_waitcnt lgkmcnt(0)
 s_barrier
 ds_read_b128 v[32:35], v4 offset:8192
 ds_read_b128 v[36:39], v4 offset:8320
 ds_read_b128 v[72:75], v4 offset:9216
 v_mov_b64 v[60:61], 0
 v_mov_b64 v[62:63], 0
 v_smfmac_f32_16x16x64_bf16 v[64:67], v[40:43], a[160:167], v2
 s_waitcnt lgkmcnt(2)
 v_smfmac_f32_16x16x64_bf16 v[68:71], v[32:35], a[168:175], v2
 ds_read_b128 v[44:47], v3 offset:8192
 s_waitcnt lgkmcnt(2)
 v_lshrrev_b32 v40, 2, v0
 v_smfmac_f32_16x16x64_bf16 v[68:71], v[36:39], a[176:183], v2
 ds_read_b128 v[48:51], v3 offset:9216
 s_waitcnt lgkmcnt(2)
 v_smfmac_f32_16x16x64_bf16 v[68:71], v[72:75], a[184:191], v2
 ds_read_b128 v[24:27], v1 offset:30720
 v_smfmac_f32_16x16x64_bf16 v[52:55], v[32:35], a[192:199], v2
 ds_read_b128 v[28:31], v1 offset:31744
 v_smfmac_f32_16x16x64_bf16 v[52:55], v[36:39], a[200:207], v2
 ds_read_b128 v[8:11], v1 offset:32768
 v_cvt_pk_bf16_f32 v68, v68, v69
 v_smfmac_f32_16x16x64_bf16 v[52:55], v[72:75], a[208:215], v2
 ds_read_b128 v[12:15], v1 offset:33792
 s_waitcnt lgkmcnt(5)
 v_cvt_pk_bf16_f32 v69, v70, v71
 v_smfmac_f32_16x16x64_bf16 v[60:63], v[44:47], a[216:223], v2
 ds_read_b128 v[16:19], v1 offset:34816
 s_waitcnt lgkmcnt(5)
 v_and_or_b32 v68, v68, -2, s65
 v_smfmac_f32_16x16x64_bf16 v[60:63], v[48:51], a[224:231], v2
 ds_read_b128 v[20:23], v1 offset:35840
 v_cvt_pk_bf16_f32 v70, v52, v53
 v_cvt_pk_bf16_f32 v71, v54, v55
 buffer_store_dwordx4 v[68:71], v0, s[8:11], s37 offen sc1
 v_smfmac_f32_16x16x64_bf16 v[56:59], v[32:35], a[232:239], v2
 s_waitcnt lgkmcnt(4)
 v_smfmac_f32_16x16x64_bf16 v[56:59], v[36:39], v[24:31], v2
 s_add_u32 s36, s36, 1
 v_add_f32 v60, v60, v62
 v_smfmac_f32_16x16x64_bf16 v[56:59], v[72:75], a[240:247], v2
 s_waitcnt lgkmcnt(2)
 v_add_f32 v61, v61, v63
 v_smfmac_f32_16x16x64_bf16 v[64:67], v[32:35], v[8:15], v2
 v_cvt_pk_bf16_f32 v41, v60, v61
 v_smfmac_f32_16x16x64_bf16 v[64:67], v[36:39], a[248:255], v2
 s_waitcnt lgkmcnt(0)
 v_and_or_b32 v41, v41, -2, s65
 v_smfmac_f32_16x16x64_bf16 v[64:67], v[72:75], v[16:23], v2
 buffer_store_dword v41, v40, s[8:11], s38 offen sc1
 v_cvt_pk_bf16_f32 v56, v56, v57
 v_cvt_pk_bf16_f32 v57, v58, v59
 v_and_or_b32 v56, v56, -2, s65
 s_nop 3
 v_cvt_pk_bf16_f32 v58, v64, v65
 v_cvt_pk_bf16_f32 v59, v66, v67
 buffer_store_dwordx4 v[56:59], v0, s[8:11], s37 offen offset:1024 sc1
R31HOP:
 s_cmp_gt_u32 s36, 63
 s_addc_u32 s59, s36, 1
 s_min_u32 s59, s59, 63
 s_lshl_b32 s60, s59, 3
 s_lshr_b32 s61, s59, 2
 s_lshl_b32 s59, s59, 19
 s_add_u32 s59, s59, s58
 s_add_u32 s62, s59, 8192
 s_barrier
 v_mov_b64 v[60:61], 0
 v_mov_b64 v[62:63], 0
 v_mov_b64 v[64:65], 0
 v_mov_b64 v[66:67], 0
 v_mov_b64 v[68:69], 0
 v_mov_b64 v[70:71], 0
 v_mov_b64 v[72:73], 0
 v_mov_b64 v[74:75], 0
 buffer_load_dwordx4 v[32:35], v0, s[8:11], s43 offen sc1
 ds_read_b128 v[8:11], v1 offset:0
 ds_read_b128 v[12:15], v1 offset:1024
 ds_read_b128 v[16:19], v1 offset:2048
 ds_read_b128 v[20:23], v1 offset:3072
 v_mov_b64 v[52:53], 0
 v_mov_b64 v[54:55], 0
 ds_read_b128 v[24:27], v1 offset:4096
 ds_read_b128 v[28:31], v1 offset:5120
 ds_read_b128 v[44:47], v1 offset:6144
 ds_read_b128 v[48:51], v1 offset:7168
 v_mov_b64 v[56:57], 0
 v_mov_b64 v[58:59], 0
 s_branch R31TOP
R31PB:
 buffer_load_dwordx4 v[36:39], v0, s[8:11], s63 offen sc1
 buffer_load_dwordx4 v[40:43], v0, s[8:11], s44 offen sc1
 s_sub_u32 s49, s49, 1
 s_cselect_b32 s49, 0, s49
 s_cselect_b32 s66, -1, -2
 s_cselect_b32 s67, 1, 0
 s_waitcnt vmcnt(0)
 v_max3_u32 v20, v36, v37, v38
 v_max3_u32 v20, v39, v40, v20
 v_max3_u32 v21, v41, v42, v43
 v_max_u32 v20, v21, v20
 v_cmp_lt_u32 vcc, s66, v20
 ds_write_b128 v0, v[36:39] offset:7168
 s_cbranch_vccnz R31PB
 s_waitcnt lgkmcnt(0)
 s_branch R31B
R31TAIL:
 s_waitcnt lgkmcnt(0)
 ds_read_b64_tr_b16 v[76:77], v6 offset:11776
 s_waitcnt lgkmcnt(0)
 buffer_store_dwordx4 v[76:79], v0, s[8:11], s48 offen sc1
 s_waitcnt vmcnt(0)
 s_endpgm
R31FB:
 s_waitcnt vmcnt(0) lgkmcnt(0)
 ds_write_b64 v6, v[76:77] offset:9728
 s_waitcnt lgkmcnt(0)
 s_barrier
 ds_read_b64 v[44:45], v6 offset:8192
 ds_read_b64 v[46:47], v6 offset:8704
 ds_read_b64 v[48:49], v6 offset:9216
 ds_read_b64 v[50:51], v6 offset:9728
 s_waitcnt lgkmcnt(0)
 s_barrier
 v_max3_f32 v72, v44, v45, v46
 v_max3_f32 v72, v72, v47, v48
 v_max3_f32 v72, v72, v49, v50
 v_max3_f32 v72, v72, v51, v40
 v_max_f32 v72, v72, v41
 v_mov_b32 v73, v72
 s_nop 1
 v_permlane16_swap_b32 v72, v73
 v_max_f32 v72, v72, v73
 v_mov_b32 v73, v72
 s_nop 1
 v_permlane32_swap_b32 v72, v73
 v_max_f32 v72, v72, v73
 v_sub_f32 v44, v44, v72
 v_sub_f32 v45, v45, v72
 v_sub_f32 v46, v46, v72
 v_sub_f32 v47, v47, v72
 v_sub_f32 v48, v48, v72
 v_sub_f32 v49, v49, v72
 v_sub_f32 v50, v50, v72
 v_sub_f32 v51, v51, v72
 v_sub_f32 v40, v40, v72
 v_sub_f32 v41, v41, v72
 v_exp_f32_dpp v44, v44 quad_perm:[0,1,0,1] row_mask:0xf bank_mask:0xf
 v_exp_f32_dpp v45, v45 quad_perm:[0,1,0,1] row_mask:0xf bank_mask:0xf
 v_exp_f32_dpp v46, v46 quad_perm:[0,1,0,1] row_mask:0xf bank_mask:0xf
 v_exp_f32_dpp v47, v47 quad_perm:[0,1,0,1] row_mask:0xf bank_mask:0xf
 v_exp_f32_dpp v48, v48 quad_perm:[0,1,0,1] row_mask:0xf bank_mask:0xf
 v_exp_f32_dpp v49, v49 quad_perm:[0,1,0,1] row_mask:0xf bank_mask:0xf
 v_exp_f32_dpp v50, v50 quad_perm:[0,1,0,1] row_mask:0xf bank_mask:0xf
 v_exp_f32_dpp v51, v51 quad_perm:[0,1,0,1] row_mask:0xf bank_mask:0xf
 v_exp_f32_dpp v40, v40 quad_perm:[0,1,0,1] row_mask:0xf bank_mask:0xf
 v_exp_f32_dpp v41, v41 quad_perm:[0,1,0,1] row_mask:0xf bank_mask:0xf
 v_cvt_pk_bf16_f32 v8, v44, v45
 v_cvt_pk_bf16_f32 v9, v46, v47
 v_cvt_pk_bf16_f32 v10, v48, v49
 v_cvt_pk_bf16_f32 v11, v50, v51
 v_cvt_pk_bf16_f32 v32, v40, v41
 v_cvt_pk_bf16_f32 v35, v40, v41
 v_mfma_f32_16x16x32_bf16 v[72:75], v[36:39], v[8:11], 0
 v_mfma_f32_16x16x32_bf16 v[44:47], v[12:15], v[8:11], 0
 v_mfma_f32_16x16x32_bf16 v[48:51], v[16:19], v[8:11], 0
 v_mfma_f32_16x16x16_bf16 v[72:75], v[36:37], v[32:33], v[72:75]
 v_mfma_f32_16x16x16_bf16 v[44:47], v[78:79], v[32:33], v[44:47]
 v_mfma_f32_16x16x16_bf16 v[48:51], v[78:79], v[34:35], v[48:51]
 v_rcp_f32 v72, v72
 s_mov_b64 vcc, 0
 s_nop 7
 s_branch R31RJ
R31FL:
 buffer_load_dword v7, off, s[8:11], s57 sc1
 s_cmp_lt_u32 s49, 1
 s_waitcnt vmcnt(0)
 s_cbranch_scc1 R31FR
 s_sub_u32 s49, s49, 1
 v_readfirstlane_b32 s54, v7
 s_lshr_b32 s54, s54, s60
 s_and_b32 s54, s54, 0xff
 s_cmp_gt_u32 s54, s61
 s_cbranch_scc1 R31FR
 s_branch R31FL
s_endpgm
.section .rodata,"a"
.p2align 6
.amdhsa_kernel gated_mix__memory_aug_recurrent_mem_tr__ssm_conv_s4d__prompt_kernel
  .amdhsa_next_free_vgpr 512
  .amdhsa_next_free_sgpr 102
  .amdhsa_accum_offset 256
  .amdhsa_group_segment_fixed_size 0
  .amdhsa_kernarg_size 144
  .amdhsa_user_sgpr_count 2
  .amdhsa_user_sgpr_kernarg_segment_ptr 1
  .amdhsa_system_sgpr_workgroup_id_x 1
.end_amdhsa_kernel
```
